```python
import torch

def _softmax(x, axis=-1):
    return torch.softmax(x, dim=axis)
def _gelu(x):
    return torch.nn.functional.gelu(x, approximate="tanh")
def _silu(x):
    return torch.nn.functional.silu(x)
def _sigmoid(x):
    return torch.sigmoid(x)
def _layernorm(x, axis=-1, eps=1e-5):
    m = x.mean(dim=axis, keepdim=True)
    v = x.var(dim=axis, keepdim=True, unbiased=False)
    return (x - m) / torch.sqrt(v + eps)
def _scatter_add(tgt, idx, src, axis=0):
    return tgt.clone().index_add_(axis, idx, src)
def _segment_sum(src, seg, n):
    out = torch.zeros((n,) + src.shape[1:], dtype=src.dtype)
    return out.index_add_(0, seg, src)
def _pad(x, pw):
    flat = tuple(v for pair in reversed(pw) for v in pair)
    return torch.nn.functional.pad(x, flat)

kernel_name = 'parallel_sum__compressed_kv_cla__dense_activation_mish__prompt'

def setup_inputs():

    _w = (lambda a: (lambda t: t.to(torch.bfloat16) if t.is_floating_point() else t)(torch.as_tensor(a)))
    def _A_setup():
        B, H, Sq, Sk, D, M = 1, 32, 2048, 2048, 128, 512
        Dc = 4 * D
        return {
            "x": _w((lambda *s: torch.randn(*s, dtype=torch.bfloat16) * 0.05)(B, Sq, M)),
            "c_kv": _w((lambda *s: torch.randn(*s, dtype=torch.bfloat16) * 0.4)(B, Sk, Dc)),
            "w_q": _w((lambda *s: torch.randn(*s, dtype=torch.bfloat16) * 3.2)(M, H, D) * (M ** -0.5)),
            "w_uk": _w((lambda *s: torch.randn(*s, dtype=torch.bfloat16) * 3.2)(Dc, H, D) * (Dc ** -0.5)),
            "w_uv": _w((lambda *s: torch.randn(*s, dtype=torch.bfloat16) * 0.4)(Dc, H, D) * (Dc ** -0.5)),
            "w_o": _w((lambda *s: torch.randn(*s, dtype=torch.bfloat16) * 0.4)(H, D, M) * ((H * D) ** -0.5)),
        }
    _A_in = _A_setup()

    def _B_setup():
        B, S, D, F = 1, 2048, 512, 1792
        return {
            "x": _w((lambda *s: torch.randn(*s, dtype=torch.bfloat16) * 0.05)(B, S, D)),
            "w1": _w((lambda *s: torch.randn(*s, dtype=torch.bfloat16) * 0.8)(D, F) * (D ** -0.5)),
            "b1": _w((lambda *s: torch.randn(*s, dtype=torch.bfloat16) * 0.2)(F)),
            "w2": _w((lambda *s: torch.randn(*s, dtype=torch.bfloat16) * 0.1)(F, D) * (F ** -0.5)),
        }
    _B_in = _B_setup()

    return {
        "A_x": _A_in["x"],
        "A_c_kv": _A_in["c_kv"],
        "A_w_q": _A_in["w_q"],
        "A_w_uk": _A_in["w_uk"],
        "A_w_uv": _A_in["w_uv"],
        "A_w_o": _A_in["w_o"],
        "B_x": _B_in["x"],
        "B_w1": _B_in["w1"],
        "B_b1": _B_in["b1"],
        "B_w2": _B_in["w2"],
    }

def reference(A_x, A_c_kv, A_w_q, A_w_uk, A_w_uv, A_w_o, B_x, B_w1, B_b1, B_w2):
    def _A_ref(x, c_kv, w_q, w_uk, w_uv, w_o):
        B, Sq, M = x.shape[0], x.shape[1], x.shape[2]
        Sk = c_kv.shape[1]
        H, D = w_q.shape[1], w_q.shape[2]
        q = torch.einsum("bqm,mhd->bhqd", x, w_q)
        k = torch.einsum("bkc,chd->bhkd", c_kv, w_uk)
        v = torch.einsum("bkc,chd->bhkd", c_kv, w_uv)
        scores = torch.einsum("bhqd,bhkd->bhqk", q, k) * (D ** -0.5)
        off = Sk - Sq
        qi = torch.arange(Sq)[:, None]
        kj = torch.arange(Sk)[None, :]
        cmask = kj <= (qi + off)
        scores = torch.where(cmask[None, None], scores, -1e9)
        p = _softmax(scores, axis=-1)
        ctx = torch.einsum("bhqk,bhkd->bhqd", p, v)
        return torch.einsum("bhqd,hdm->bqm", ctx, w_o)

    def _B_ref(x, w1, b1, w2):
        h = torch.einsum("bsd,df->bsf", x, w1) + b1
        sp = torch.log1p(torch.exp(-torch.abs(h))) + torch.where(h > 0, h, torch.zeros_like(h))
        act = h * torch.tanh(sp)
        return torch.einsum("bsf,fd->bsd", act, w2)

    x = A_x
    xn = _layernorm(x, axis=-1)
    return x + _A_ref(xn, A_c_kv, A_w_q, A_w_uk, A_w_uv, A_w_o) + _B_ref(xn, B_w1, B_b1, B_w2)
```

```asm
; @launch grid=(256,1,1) block=(256,1,1) lds=163840
.amdgcn_target "amdgcn-amd-amdhsa--gfx950"
.text
.globl parallel_sum__compressed_kv_cla__dense_activation_mish__prompt_kernel
.p2align 8
.type parallel_sum__compressed_kv_cla__dense_activation_mish__prompt_kernel,@function
parallel_sum__compressed_kv_cla__dense_activation_mish__prompt_kernel:
 s_cmp_ge_u32 s2, 256
 s_cbranch_scc1 L_end
 s_load_dwordx16 s[4:19], s[0:1], 0
 s_load_dwordx8 s[20:27], s[0:1], 64
 s_load_dwordx2 s[28:29], s[0:1], 96
 s_getpc_b64 s[96:97]
L_pc:
 s_lshr_b32 s85, s2, 3
 s_lshl_b32 s85, s85, 9
 v_and_b32 v246, 7, v0
 v_lshl_add_u32 v251, v246, 14, s85
 v_and_b32 v246, 0xc0, v0
 v_lshl_add_u32 v251, v246, 1, v251
 v_min_u32 v251, L_code_end-L_pc-4, v251
 global_load_dword v207, v251, s[96:97]
 v_lshrrev_b32 v240, 6, v0
 v_and_b32 v241, 63, v0
 v_readfirstlane_b32 s60, v240
 v_lshlrev_b32 v1, 4, v241
 v_min_u32 v0, 1, v0
 v_lshlrev_b32 v0, 28, v0
 s_and_b32 s61, s2, 7
 s_lshl_b32 s61, s61, 2
 s_bfe_u32 s85, s2, 0x20003
 s_add_u32 s61, s61, s85
 s_lshr_b32 s62, s2, 5
 v_and_b32 v242, 31, v241
 v_lshrrev_b32 v243, 5, v241
 v_lshlrev_b32 v244, 10, v243
 v_lshl_add_u32 v244, v242, 4, v244
 s_lshl_b32 s85, s2, 13
 s_lshl_b32 s86, s60, 11
 s_add_u32 s85, s85, s86
 v_lshrrev_b32 v245, 3, v241
 v_and_b32 v246, 7, v241
 v_lshrrev_b32 v247, 4, v241
 v_xor_b32 v248, v246, v247
 v_lshlrev_b32 v248, 4, v248
 v_lshl_add_u32 v4, v245, 10, v248
 v_xor_b32 v5, 64, v4
 v_add_u32 v5, 7168, v5
 s_lshl_b32 s69, s62, 18
 s_lshl_b32 s86, s60, 16
 s_add_u32 s69, s69, s86
 s_and_b32 s89, s61, 3
 s_mul_i32 s86, s89, 16512
 s_and_b32 s86, s86, 32896
 s_add_u32 s69, s69, s86
 s_lshl_b32 s70, s60, 14
 s_lshl_b32 s71, s60, 13
 s_and_b32 s87, s62, 7
 s_lshl_b32 s88, s87, 10
 s_add_u32 s88, s88, s71
 v_and_b32 v249, 3, v245
 v_lshl_add_u32 v249, v243, 3, v249
 v_lshlrev_b32 v250, 1, v247
 v_xor_b32 v250, v250, v246
 v_lshlrev_b32 v250, 4, v250
 v_lshl_add_u32 v2, v249, 13, v250
 v_mul_u32_u24 v3, 3584, v249
 v_add_u32 v3, v3, v250
 s_xor_b32 s63, s60, s89
 s_and_b32 s63, s63, 1
 s_lshl_b32 s63, s63, 19
 s_and_b32 s86, s87, 1
 s_lshl_b32 s86, s86, 15
 s_add_u32 s63, s63, s86
 s_lshr_b32 s86, s87, 1
 s_lshl_b32 s86, s86, 17
 s_add_u32 s63, s63, s86
 s_lshr_b32 s86, s60, 1
 s_lshl_b32 s86, s86, 7
 s_add_u32 s63, s63, s86
 s_lshl_b32 s86, s61, 8
 s_add_u32 s63, s63, s86
 s_waitcnt lgkmcnt(0)
 s_mov_b32 s52, s4
 s_mov_b32 s53, s5
 s_mov_b32 s54, 2097152
 s_mov_b32 s55, 0x20000
 buffer_load_dwordx4 v[144:147], v244, s[52:55], s85 offen
 buffer_load_dwordx4 v[148:151], v244, s[52:55], s85 offen offset:512
 s_mov_b32 s36, s6
 s_mov_b32 s37, s7
 s_mov_b32 s38, 2097152
 s_mov_b32 s39, 0x20000
 s_mov_b32 s32, s10
 s_mov_b32 s33, s11
 s_mov_b32 s34, 4194304
 s_mov_b32 s35, 0x20000
 s_xor_b32 m0, s88, 32768
 s_xor_b32 s66, s63, 0
 buffer_load_dwordx4 v2, s[32:35], s66 offen lds
 s_add_u32 m0, s70, 65536
 s_xor_b32 s67, s69, 0
 s_add_u32 s68, s67, 14336
 buffer_load_dwordx4 v4, s[36:39], s67 offen offset:0 lds
 buffer_load_dwordx4 v5, s[36:39], s67 offen offset:1024 lds
 buffer_load_dwordx4 v4, s[36:39], s68 offen offset:2048 lds
 buffer_load_dwordx4 v5, s[36:39], s68 offen offset:3072 lds
 s_add_u32 m0, s70, 69632
 s_xor_b32 s65, s69, 128
 s_add_u32 s66, s65, 14336
 buffer_load_dwordx4 v4, s[36:39], s65 offen offset:0 lds
 buffer_load_dwordx4 v5, s[36:39], s65 offen offset:1024 lds
 s_mov_b32 s40, s28
 s_mov_b32 s41, s29
 s_mov_b32 s42, 268435456
 s_mov_b32 s43, 0x20000
 s_mov_b32 s48, s26
 s_mov_b32 s49, s27
 s_mov_b32 s50, 44
 s_mov_b32 s51, 0x20000
 s_mov_b32 s44, s28
 s_mov_b32 s45, s29
 s_mov_b32 s46, 268435456
 s_mov_b32 s47, 0x20000
 s_cmp_lt_u32 s61, 28
 s_cselect_b32 s46, s46, 0
 s_lshl_b32 s3, s61, 7
 s_add_u32 s3, s3, 69206016
 s_lshl_b32 s85, s62, 2
 s_add_u32 s81, s3, s85
 s_lshl_b32 s85, s62, 5
 s_add_u32 s85, s85, s61
 s_lshl_b32 s82, s85, 2
 s_add_u32 s82, s82, 69210112
 s_lshr_b32 s83, s85, 3
 s_lshl_b32 s83, s83, 7
 s_and_b32 s85, s85, 7
 s_lshl_b32 s85, s85, 2
 s_add_u32 s83, s83, s85
 s_add_u32 s83, s83, 69211136
 s_cmp_lt_u32 s2, 11
 s_cselect_b32 s85, s60, 1
 s_lshl_b32 s85, s85, 28
 v_add_u32 v251, s85, v1
 v_mov_b32 v200, 0
 v_mov_b32 v201, 0
 v_mov_b32 v202, 0
 v_mov_b32 v203, 0
 s_lshl_b32 s85, s2, 10
 s_add_u32 s85, s85, 69206016
 buffer_store_dwordx4 v[200:203], v251, s[40:43], s85 offen sc1
 s_and_b32 s85, s89, 1
 s_xor_b32 s85, s85, s60
 s_mul_i32 s64, s85, 229376
 s_lshl_b32 s85, s61, 7
 s_add_u32 s64, s64, s85
 s_lshr_b32 s85, s89, 1
 s_mul_i32 s85, s85, 114688
 s_sub_u32 s31, s64, s85
 s_add_u32 s31, s31, 114688
 s_add_u32 s64, s64, s85
 s_mul_i32 s72, s61, 562176
 s_lshl_b32 s85, s62, 2
 s_add_u32 s85, s85, s60
 s_mul_i32 s85, s85, 17408
 s_add_u32 s72, s72, s85
 s_lshr_b32 s85, s89, 1
 s_lshl_b32 s86, s85, 13
 s_add_u32 s98, s72, s86
 s_sub_u32 s99, s72, s86
 s_lshl_b32 s86, s85, 10
 s_add_u32 s100, s72, s86
 s_sub_u32 s101, s72, s86
 s_lshl_b32 s85, s62, 3
 s_add_u32 s73, s85, s60
 s_sub_u32 s74, s85, s60
 s_add_u32 s74, s74, 7
 s_sub_u32 s75, 127, s74
 s_sub_u32 s76, 127, s73
 s_lshr_b32 s85, s73, 2
 s_mul_i32 s77, s85, 791552
 s_and_b32 s85, s73, 3
 s_lshl_b32 s85, s85, 10
 s_add_u32 s77, s77, s85
 s_add_u32 s77, s77, 40894464
 s_mul_i32 s73, s73, 17408
 s_lshr_b32 s85, s74, 2
 s_mul_i32 s78, s85, 791552
 s_and_b32 s85, s74, 3
 s_lshl_b32 s85, s85, 10
 s_add_u32 s78, s78, s85
 s_add_u32 s78, s78, 40894464
 s_mul_i32 s74, s74, 17408
 s_lshr_b32 s85, s75, 2
 s_mul_i32 s79, s85, 791552
 s_and_b32 s85, s75, 3
 s_lshl_b32 s85, s85, 10
 s_add_u32 s79, s79, s85
 s_add_u32 s79, s79, 40894464
 s_mul_i32 s75, s75, 17408
 s_lshr_b32 s85, s76, 2
 s_mul_i32 s80, s85, 791552
 s_and_b32 s85, s76, 3
 s_lshl_b32 s85, s85, 10
 s_add_u32 s80, s80, s85
 s_add_u32 s80, s80, 40894464
 s_mul_i32 s76, s76, 17408
 s_mov_b32 s84, 0x3e0293ee
 s_mov_b32 s30, 0x3fb8aa3b
 s_mov_b32 s95, 0
 v_and_b32 v251, 15, v241
 v_lshrrev_b32 v252, 1, v251
 s_mov_b64 exec, 0
 s_cmp_eq_u32 s60, 0
 s_cbranch_scc1 L_w2_0
 s_cmp_eq_u32 s60, 1
 s_cbranch_scc1 L_w2_1
 s_cmp_eq_u32 s60, 2
 s_cbranch_scc1 L_w2_2
 s_branch L_w2_3
L_warmed2:
 s_mov_b64 exec, -1
 buffer_load_dwordx4 v4, s[36:39], s66 offen offset:2048 lds
 v_xor_b32 v252, v252, v247
 v_lshlrev_b32 v252, 4, v252
 v_lshl_add_u32 v252, v251, 7, v252
 v_xor_b32 v253, 64, v252
 s_add_u32 s85, s70, 65536
 v_add_u32 v6, s85, v252
 v_add_u32 v7, s85, v253
 v_add_u32 v254, s71, v252
 v_add_u32 v255, s71, v253
 v_bfe_u32 v252, v241, 2, 3
 v_lshlrev_b32 v253, 7, v252
 v_lshl_add_u32 v253, v243, 11, v253
 v_and_b32 v251, 3, v241
 buffer_load_dwordx4 v5, s[36:39], s66 offen offset:3072 lds
 v_lshl_add_u32 v253, v251, 3, v253
 v_lshrrev_b32 v252, 1, v252
 v_lshl_add_u32 v8, v252, 5, v253
 v_xor_b32 v9, 32, v8
 v_xor_b32 v10, 64, v8
 v_xor_b32 v11, 96, v8
 v_add_u32 v12, 131072, v8
 v_add_u32 v13, 131072, v9
 v_add_u32 v14, 131072, v10
 v_add_u32 v15, 131072, v11
 v_lshrrev_b32 v252, 4, v242
 v_lshlrev_b32 v252, 13, v252
 s_xor_b32 m0, s88, 33792
 s_xor_b32 s67, s63, 32768
 buffer_load_dwordx4 v2, s[32:35], s67 offen lds
 v_and_b32 v251, 15, v242
 v_lshl_add_u32 v252, v251, 7, v252
 v_lshl_add_u32 v252, v243, 4, v252
 s_lshl_b32 s85, s60, 5
 v_add_u32 v252, s85, v252
 v_lshlrev_b32 v253, 4, v246
 v_lshl_add_u32 v253, v245, 8, v253
 v_add_u32 v251, s71, v1
 s_lshr_b32 s85, s2, 1
 s_mul_i32 s85, s85, 17408
 s_and_b32 s86, s2, 1
 s_lshl_b32 s86, s86, 7
 s_xor_b32 m0, s88, 34816
 s_xor_b32 s68, s63, 131072
 buffer_load_dwordx4 v2, s[32:35], s68 offen lds
 s_add_u32 s85, s85, s86
 s_lshl_b32 s86, s60, 12
 s_add_u32 s85, s85, s86
 s_waitcnt vmcnt(12)
 v_lshlrev_b32 v152, 16, v144
 v_and_b32 v153, 0xffff0000, v144
 v_lshlrev_b32 v154, 16, v145
 v_and_b32 v155, 0xffff0000, v145
 v_lshlrev_b32 v156, 16, v146
 v_and_b32 v157, 0xffff0000, v146
 v_lshlrev_b32 v158, 16, v147
 v_and_b32 v159, 0xffff0000, v147
 v_lshlrev_b32 v160, 16, v148
 s_xor_b32 m0, s88, 35840
 s_xor_b32 s65, s63, 163840
 buffer_load_dwordx4 v2, s[32:35], s65 offen lds
 v_and_b32 v161, 0xffff0000, v148
 v_lshlrev_b32 v162, 16, v149
 v_and_b32 v163, 0xffff0000, v149
 v_lshlrev_b32 v164, 16, v150
 v_and_b32 v165, 0xffff0000, v150
 v_lshlrev_b32 v166, 16, v151
 v_and_b32 v167, 0xffff0000, v151
 v_add_f32 v188, v152, v153
 v_add_f32 v189, v154, v155
 v_add_f32 v190, v156, v157
 v_add_f32 v191, v158, v159
 v_add_f32 v192, v160, v161
 s_add_u32 m0, s70, 73728
 s_xor_b32 s66, s69, 32768
 s_add_u32 s67, s66, 14336
 buffer_load_dwordx4 v4, s[36:39], s66 offen offset:0 lds
 v_add_f32 v193, v162, v163
 v_add_f32 v194, v164, v165
 v_add_f32 v195, v166, v167
 v_add_f32 v188, v188, v192
 v_add_f32 v189, v189, v193
 v_add_f32 v190, v190, v194
 v_add_f32 v191, v191, v195
 v_add_f32 v188, v188, v190
 v_add_f32 v189, v189, v191
 v_add_f32 v184, v188, v189
 s_nop 1
 v_add_f32_dpp v184, v184, v184 quad_perm:[1,0,3,2] row_mask:0xf bank_mask:0xf
 buffer_load_dwordx4 v5, s[36:39], s66 offen offset:1024 lds
 s_nop 1
 v_add_f32_dpp v184, v184, v184 quad_perm:[2,3,0,1] row_mask:0xf bank_mask:0xf
 s_nop 1
 v_add_f32_dpp v184, v184, v184 row_half_mirror row_mask:0xf bank_mask:0xf
 s_nop 1
 v_add_f32_dpp v184, v184, v184 row_mirror row_mask:0xf bank_mask:0xf
 v_mov_b32 v185, v184
 s_nop 1
 v_permlane16_swap_b32 v184, v185
 v_add_f32 v184, v184, v185
 v_mul_f32 v184, 0x3b000000, v184
 v_mov_b32 v186, v184
 buffer_load_dwordx4 v4, s[36:39], s67 offen offset:2048 lds
 v_sub_f32 v168, v152, v184
 v_sub_f32 v169, v153, v184
 v_sub_f32 v170, v154, v184
 v_sub_f32 v171, v155, v184
 v_sub_f32 v172, v156, v184
 v_sub_f32 v173, v157, v184
 v_sub_f32 v174, v158, v184
 v_sub_f32 v175, v159, v184
 v_sub_f32 v176, v160, v184
 v_sub_f32 v177, v161, v184
 v_sub_f32 v178, v162, v184
 v_sub_f32 v179, v163, v184
 v_sub_f32 v180, v164, v184
 buffer_load_dwordx4 v5, s[36:39], s67 offen offset:3072 lds
 v_sub_f32 v181, v165, v184
 v_sub_f32 v182, v166, v184
 v_sub_f32 v183, v167, v184
 v_mul_f32 v168, v168, v168
 v_mul_f32 v169, v169, v169
 v_mul_f32 v170, v170, v170
 v_mul_f32 v171, v171, v171
 v_mul_f32 v172, v172, v172
 v_mul_f32 v173, v173, v173
 v_mul_f32 v174, v174, v174
 v_mul_f32 v175, v175, v175
 v_mul_f32 v176, v176, v176
 s_xor_b32 m0, s88, 36864
 s_xor_b32 s68, s63, 262144
 buffer_load_dwordx4 v2, s[32:35], s68 offen lds
 v_mul_f32 v177, v177, v177
 v_mul_f32 v178, v178, v178
 v_mul_f32 v179, v179, v179
 v_mul_f32 v180, v180, v180
 v_mul_f32 v181, v181, v181
 v_mul_f32 v182, v182, v182
 v_mul_f32 v183, v183, v183
 v_add_f32 v188, v168, v169
 v_add_f32 v189, v170, v171
 v_add_f32 v190, v172, v173
 v_add_f32 v191, v174, v175
 v_add_f32 v192, v176, v177
 s_xor_b32 m0, s88, 37888
 s_xor_b32 s65, s63, 294912
 buffer_load_dwordx4 v2, s[32:35], s65 offen lds
 v_add_f32 v193, v178, v179
 v_add_f32 v194, v180, v181
 v_add_f32 v195, v182, v183
 v_add_f32 v188, v188, v192
 v_add_f32 v189, v189, v193
 v_add_f32 v190, v190, v194
 v_add_f32 v191, v191, v195
 v_add_f32 v188, v188, v190
 v_add_f32 v189, v189, v191
 v_add_f32 v184, v188, v189
 s_nop 1
 v_add_f32_dpp v184, v184, v184 quad_perm:[1,0,3,2] row_mask:0xf bank_mask:0xf
 s_nop 1
 s_xor_b32 m0, s88, 38912
 s_xor_b32 s66, s63, 393216
 buffer_load_dwordx4 v2, s[32:35], s66 offen lds
 v_add_f32_dpp v184, v184, v184 quad_perm:[2,3,0,1] row_mask:0xf bank_mask:0xf
 s_nop 1
 v_add_f32_dpp v184, v184, v184 row_half_mirror row_mask:0xf bank_mask:0xf
 s_nop 1
 v_add_f32_dpp v184, v184, v184 row_mirror row_mask:0xf bank_mask:0xf
 v_mov_b32 v185, v184
 s_nop 1
 v_permlane16_swap_b32 v184, v185
 v_add_f32 v184, v184, v185
 v_mul_f32 v184, 0x3b000000, v184
 v_cvt_pk_bf16_f32 v184, v184, v184
 v_and_b32 v184, 0xffff0000, v184
 s_xor_b32 m0, s88, 39936
 s_xor_b32 s67, s63, 425984
 buffer_load_dwordx4 v2, s[32:35], s67 offen lds
 v_cvt_pk_bf16_f32 v186, v186, v186
 v_and_b32 v186, 0xffff0000, v186
 v_add_f32 v184, 0x3727c5ac, v184
 v_cvt_pk_bf16_f32 v184, v184, v184
 v_and_b32 v184, 0xffff0000, v184
 v_sqrt_f32 v184, v184
 v_sub_f32 v152, v152, v186
 v_sub_f32 v153, v153, v186
 v_sub_f32 v154, v154, v186
 v_sub_f32 v155, v155, v186
 v_sub_f32 v156, v156, v186
 v_sub_f32 v157, v157, v186
 s_add_u32 m0, s70, 77824
 s_xor_b32 s68, s69, 32896
 s_add_u32 s65, s68, 14336
 buffer_load_dwordx4 v4, s[36:39], s68 offen offset:0 lds
 v_sub_f32 v158, v158, v186
 v_sub_f32 v159, v159, v186
 v_sub_f32 v160, v160, v186
 v_sub_f32 v161, v161, v186
 v_sub_f32 v162, v162, v186
 v_sub_f32 v163, v163, v186
 v_sub_f32 v164, v164, v186
 v_sub_f32 v165, v165, v186
 v_sub_f32 v166, v166, v186
 v_sub_f32 v167, v167, v186
 v_cvt_pk_bf16_f32 v184, v184, v184
 v_and_b32 v184, 0xffff0000, v184
 buffer_load_dwordx4 v5, s[36:39], s68 offen offset:1024 lds
 v_rcp_f32 v184, v184
 v_cvt_pk_bf16_f32 v144, v152, v153
 v_cvt_pk_bf16_f32 v145, v154, v155
 v_cvt_pk_bf16_f32 v146, v156, v157
 v_cvt_pk_bf16_f32 v147, v158, v159
 v_cvt_pk_bf16_f32 v148, v160, v161
 v_cvt_pk_bf16_f32 v149, v162, v163
 v_cvt_pk_bf16_f32 v150, v164, v165
 v_cvt_pk_bf16_f32 v151, v166, v167
 v_lshlrev_b32 v152, 16, v144
 v_and_b32 v153, 0xffff0000, v144
 v_lshlrev_b32 v154, 16, v145
 v_and_b32 v155, 0xffff0000, v145
 buffer_load_dwordx4 v4, s[36:39], s65 offen offset:2048 lds
 v_lshlrev_b32 v156, 16, v146
 v_and_b32 v157, 0xffff0000, v146
 v_lshlrev_b32 v158, 16, v147
 v_and_b32 v159, 0xffff0000, v147
 v_lshlrev_b32 v160, 16, v148
 v_and_b32 v161, 0xffff0000, v148
 v_lshlrev_b32 v162, 16, v149
 v_and_b32 v163, 0xffff0000, v149
 v_lshlrev_b32 v164, 16, v150
 v_and_b32 v165, 0xffff0000, v150
 v_lshlrev_b32 v166, 16, v151
 v_and_b32 v167, 0xffff0000, v151
 buffer_load_dwordx4 v5, s[36:39], s65 offen offset:3072 lds
 v_mul_f32 v152, v152, v184
 v_mul_f32 v153, v153, v184
 v_mul_f32 v154, v154, v184
 v_mul_f32 v155, v155, v184
 v_mul_f32 v156, v156, v184
 v_mul_f32 v157, v157, v184
 v_mul_f32 v158, v158, v184
 v_mul_f32 v159, v159, v184
 v_mul_f32 v160, v160, v184
 v_mul_f32 v161, v161, v184
 v_mul_f32 v162, v162, v184
 v_mul_f32 v163, v163, v184
 v_mul_f32 v164, v164, v184
 v_mul_f32 v165, v165, v184
 v_mul_f32 v166, v166, v184
 v_mul_f32 v167, v167, v184
 v_cvt_pk_bf16_f32 v144, v152, v153
 v_cvt_pk_bf16_f32 v145, v154, v155
 v_cvt_pk_bf16_f32 v146, v156, v157
 v_cvt_pk_bf16_f32 v147, v158, v159
 v_cvt_pk_bf16_f32 v148, v160, v161
 v_cvt_pk_bf16_f32 v149, v162, v163
 v_cvt_pk_bf16_f32 v150, v164, v165
 v_cvt_pk_bf16_f32 v151, v166, v167
 ds_write_b128 v252, v[144:147] offset:0
 ds_write_b128 v252, v[148:151] offset:16384
 s_xor_b32 m0, s88, 131072
 s_xor_b32 s66, s63, 1048576
 buffer_load_dwordx4 v2, s[32:35], s66 offen lds
 s_add_u32 m0, s71, 4096
 s_xor_b32 s67, s69, 256
 s_add_u32 s68, s67, 14336
 buffer_load_dwordx4 v4, s[36:39], s67 offen offset:0 lds
 buffer_load_dwordx4 v5, s[36:39], s67 offen offset:1024 lds
 buffer_load_dwordx4 v4, s[36:39], s68 offen offset:2048 lds
 buffer_load_dwordx4 v5, s[36:39], s68 offen offset:3072 lds
 s_xor_b32 m0, s88, 132096
 s_xor_b32 s65, s63, 1081344
 buffer_load_dwordx4 v2, s[32:35], s65 offen lds
 s_xor_b32 m0, s88, 133120
 s_xor_b32 s66, s63, 1179648
 buffer_load_dwordx4 v2, s[32:35], s66 offen lds
 s_xor_b32 m0, s88, 134144
 s_xor_b32 s67, s63, 1212416
 buffer_load_dwordx4 v2, s[32:35], s67 offen lds
 s_xor_b32 m0, s88, 135168
 s_xor_b32 s68, s63, 1310720
 buffer_load_dwordx4 v2, s[32:35], s68 offen lds
 s_mov_b64 exec, 0
 s_cmp_eq_u32 s60, 0
 s_cbranch_scc1 L_w0_0
 s_cmp_eq_u32 s60, 1
 s_cbranch_scc1 L_w0_1
 s_cmp_eq_u32 s60, 2
 s_cbranch_scc1 L_w0_2
 s_branch L_w0_3
L_warmed0:
 s_mov_b64 exec, -1
 s_waitcnt lgkmcnt(0)
 s_waitcnt vmcnt(9)
 s_branch L_main
.p2align 12
L_main:
 s_barrier
L_w2_0:
L_st2_0:
 s_cbranch_execz L_st2_4
 ds_read_b64_tr_b16 v[208:209], v8 offset:32768
 ds_read_b64_tr_b16 v[210:211], v8 offset:33792
 ds_read_b64_tr_b16 v[212:213], v8 offset:36864
 ds_read_b64_tr_b16 v[214:215], v8 offset:37888
 ds_read_b64_tr_b16 v[216:217], v8 offset:40960
 ds_read_b64_tr_b16 v[218:219], v8 offset:41984
 ds_read_b64_tr_b16 v[220:221], v8 offset:45056
 ds_read_b64_tr_b16 v[222:223], v8 offset:46080
 ds_read_b128 a[0:3], v6 offset:0
 ds_read_b128 a[4:7], v7 offset:0
 ds_read_b128 a[16:19], v6 offset:2048
 ds_read_b128 a[20:23], v7 offset:2048
 s_nop 0
 ds_read_b128 a[8:11], v6 offset:4096
 ds_read_b128 a[12:15], v7 offset:4096
 ds_read_b128 a[24:27], v6 offset:6144
 ds_read_b128 a[28:31], v7 offset:6144
 ds_read_b128 a[32:35], v6 offset:8192
 ds_read_b128 a[36:39], v7 offset:8192
 ds_read_b128 a[48:51], v6 offset:10240
 ds_read_b128 a[52:55], v7 offset:10240
 ds_read_b128 a[40:43], v6 offset:12288
 ds_read_b128 a[44:47], v7 offset:12288
 ds_read_b128 a[56:59], v6 offset:14336
 ds_read_b128 a[60:63], v7 offset:14336
 s_waitcnt lgkmcnt(0)
 v_mfma_f32_16x16x32_bf16 v[16:19], v[208:211], a[0:3], 0
 ds_read_b64_tr_b16 v[224:225], v9 offset:32768
 v_mfma_f32_16x16x32_bf16 v[16:19], v[212:215], a[4:7], v[16:19]
 ds_read_b64_tr_b16 v[226:227], v9 offset:33792
 v_lshl_add_u32 v200, s2, 2, v0
 v_mfma_f32_16x16x32_bf16 v[16:19], v[216:219], a[8:11], v[16:19]
 ds_read_b64_tr_b16 v[228:229], v9 offset:36864
 v_min_u32 v201, 160, v1
 v_mfma_f32_16x16x32_bf16 v[16:19], v[220:223], a[12:15], v[16:19]
 v_lshrrev_b32 v201, 2, v201
 v_mfma_f32_16x16x32_bf16 v[20:23], v[208:211], a[16:19], 0
 s_add_u32 m0, s70, 65536
 ds_read_b64_tr_b16 v[230:231], v9 offset:37888
 v_mfma_f32_16x16x32_bf16 v[20:23], v[212:215], a[20:23], v[20:23]
 s_xor_b32 s65, s69, 384
 ds_read_b64_tr_b16 v[232:233], v9 offset:40960
 v_mfma_f32_16x16x32_bf16 v[20:23], v[216:219], a[24:27], v[20:23]
 s_add_u32 s66, s65, 14336
 ds_read_b64_tr_b16 v[234:235], v9 offset:41984
 v_mfma_f32_16x16x32_bf16 v[20:23], v[220:223], a[28:31], v[20:23]
 buffer_load_dwordx4 v4, s[36:39], s65 offen offset:0 lds
 v_mfma_f32_16x16x32_bf16 v[24:27], v[208:211], a[32:35], 0
 ds_read_b64_tr_b16 v[236:237], v9 offset:45056
 v_mfma_f32_16x16x32_bf16 v[24:27], v[212:215], a[36:39], v[24:27]
 ds_read_b64_tr_b16 v[238:239], v9 offset:46080
 v_mfma_f32_16x16x32_bf16 v[24:27], v[216:219], a[40:43], v[24:27]
 ds_read_b128 v[144:147], v251 offset:0
 v_mfma_f32_16x16x32_bf16 v[24:27], v[220:223], a[44:47], v[24:27]
 buffer_load_dwordx4 v5, s[36:39], s65 offen offset:1024 lds
 v_mfma_f32_16x16x32_bf16 v[28:31], v[208:211], a[48:51], 0
 ds_read_b128 v[148:151], v251 offset:1024
 v_mfma_f32_16x16x32_bf16 v[28:31], v[212:215], a[52:55], v[28:31]
 v_mfma_f32_16x16x32_bf16 v[28:31], v[216:219], a[56:59], v[28:31]
 buffer_load_dwordx4 v4, s[36:39], s66 offen offset:2048 lds
 v_mfma_f32_16x16x32_bf16 v[28:31], v[220:223], a[60:63], v[28:31]
 s_waitcnt lgkmcnt(2)
 v_mfma_f32_16x16x32_bf16 v[32:35], v[224:227], a[0:3], 0
 ds_read_b64_tr_b16 v[208:209], v10 offset:32768
 v_and_b32 v248, 496, v1
 v_mfma_f32_16x16x32_bf16 v[32:35], v[228:231], a[4:7], v[32:35]
 ds_read_b64_tr_b16 v[210:211], v10 offset:33792
 v_lshlrev_b32 v248, 3, v248
 v_mfma_f32_16x16x32_bf16 v[32:35], v[232:235], a[8:11], v[32:35]
 ds_read_b64_tr_b16 v[212:213], v10 offset:36864
 v_min_u32 v249, 1664, v248
 v_mfma_f32_16x16x32_bf16 v[32:35], v[236:239], a[12:15], v[32:35]
 buffer_load_dwordx4 v5, s[36:39], s66 offen offset:3072 lds
 v_mfma_f32_16x16x32_bf16 v[36:39], v[224:227], a[16:19], 0
 s_add_u32 m0, s70, 69632
 ds_read_b64_tr_b16 v[214:215], v10 offset:37888
 v_mfma_f32_16x16x32_bf16 v[36:39], v[228:231], a[20:23], v[36:39]
 s_xor_b32 s67, s69, 33024
 ds_read_b64_tr_b16 v[216:217], v10 offset:40960
 v_mfma_f32_16x16x32_bf16 v[36:39], v[232:235], a[24:27], v[36:39]
 s_add_u32 s68, s67, 14336
 ds_read_b64_tr_b16 v[218:219], v10 offset:41984
 v_mfma_f32_16x16x32_bf16 v[36:39], v[236:239], a[28:31], v[36:39]
 buffer_load_dwordx4 v4, s[36:39], s67 offen offset:0 lds
 v_mfma_f32_16x16x32_bf16 v[40:43], v[224:227], a[32:35], 0
 ds_read_b64_tr_b16 v[220:221], v10 offset:45056
 v_mfma_f32_16x16x32_bf16 v[40:43], v[228:231], a[36:39], v[40:43]
 ds_read_b64_tr_b16 v[222:223], v10 offset:46080
 v_mfma_f32_16x16x32_bf16 v[40:43], v[232:235], a[40:43], v[40:43]
 s_waitcnt vmcnt(9)
 ds_read_b128 a[64:67], v254 offset:4096
 v_mfma_f32_16x16x32_bf16 v[40:43], v[236:239], a[44:47], v[40:43]
 buffer_load_dwordx4 v5, s[36:39], s67 offen offset:1024 lds
 v_mfma_f32_16x16x32_bf16 v[44:47], v[224:227], a[48:51], 0
 ds_read_b128 a[68:71], v255 offset:4096
 v_mfma_f32_16x16x32_bf16 v[44:47], v[228:231], a[52:55], v[44:47]
 ds_read_b128 a[80:83], v254 offset:6144
 v_mfma_f32_16x16x32_bf16 v[44:47], v[232:235], a[56:59], v[44:47]
 buffer_load_dwordx4 v4, s[36:39], s68 offen offset:2048 lds
 v_mfma_f32_16x16x32_bf16 v[44:47], v[236:239], a[60:63], v[44:47]
 s_waitcnt lgkmcnt(3)
 v_mfma_f32_16x16x32_bf16 v[48:51], v[208:211], a[0:3], 0
 ds_read_b64_tr_b16 v[224:225], v11 offset:32768
 v_mfma_f32_16x16x32_bf16 v[48:51], v[212:215], a[4:7], v[48:51]
 ds_read_b64_tr_b16 v[226:227], v11 offset:33792
 v_mfma_f32_16x16x32_bf16 v[48:51], v[216:219], a[8:11], v[48:51]
 ds_read_b64_tr_b16 v[228:229], v11 offset:36864
 v_mfma_f32_16x16x32_bf16 v[48:51], v[220:223], a[12:15], v[48:51]
 buffer_load_dwordx4 v5, s[36:39], s68 offen offset:3072 lds
 v_mfma_f32_16x16x32_bf16 v[52:55], v[208:211], a[16:19], 0
 ds_read_b64_tr_b16 v[230:231], v11 offset:37888
 v_mfma_f32_16x16x32_bf16 v[52:55], v[212:215], a[20:23], v[52:55]
 ds_read_b64_tr_b16 v[232:233], v11 offset:40960
 v_mfma_f32_16x16x32_bf16 v[52:55], v[216:219], a[24:27], v[52:55]
 ds_read_b64_tr_b16 v[234:235], v11 offset:41984
 v_mfma_f32_16x16x32_bf16 v[52:55], v[220:223], a[28:31], v[52:55]
 buffer_store_dword v12, v200, s[48:51], 0 offen sc1
 v_mfma_f32_16x16x32_bf16 v[56:59], v[208:211], a[32:35], 0
 ds_read_b64_tr_b16 v[236:237], v11 offset:45056
 v_mfma_f32_16x16x32_bf16 v[56:59], v[212:215], a[36:39], v[56:59]
 s_xor_b32 m0, s88, 136192
 ds_read_b64_tr_b16 v[238:239], v11 offset:46080
 v_mfma_f32_16x16x32_bf16 v[56:59], v[216:219], a[40:43], v[56:59]
 s_xor_b32 s65, s63, 1343488
 ds_read_b128 a[84:87], v255 offset:6144
 v_mfma_f32_16x16x32_bf16 v[56:59], v[220:223], a[44:47], v[56:59]
 buffer_load_dwordx4 v2, s[32:35], s65 offen lds
 v_mfma_f32_16x16x32_bf16 v[60:63], v[208:211], a[48:51], 0
 s_xor_b32 m0, s88, 137216
 v_mfma_f32_16x16x32_bf16 v[60:63], v[212:215], a[52:55], v[60:63]
 s_xor_b32 s66, s63, 1441792
 v_mfma_f32_16x16x32_bf16 v[60:63], v[216:219], a[56:59], v[60:63]
 buffer_load_dwordx4 v2, s[32:35], s66 offen lds
 v_mfma_f32_16x16x32_bf16 v[60:63], v[220:223], a[60:63], v[60:63]
 s_waitcnt vmcnt(36) lgkmcnt(1)
 v_mfma_f32_16x16x32_bf16 v[64:67], v[224:227], a[0:3], 0
 ds_read_b64_tr_b16 v[208:209], v8 offset:49152
 v_mfma_f32_16x16x32_bf16 v[64:67], v[228:231], a[4:7], v[64:67]
 s_xor_b32 m0, s88, 138240
 ds_read_b64_tr_b16 v[210:211], v8 offset:50176
 v_mfma_f32_16x16x32_bf16 v[64:67], v[232:235], a[8:11], v[64:67]
 s_xor_b32 s67, s63, 1474560
 ds_read_b64_tr_b16 v[212:213], v8 offset:53248
 v_mfma_f32_16x16x32_bf16 v[64:67], v[236:239], a[12:15], v[64:67]
 buffer_load_dwordx4 v2, s[32:35], s67 offen lds
 v_mfma_f32_16x16x32_bf16 v[68:71], v[224:227], a[16:19], 0
 s_add_u32 m0, s70, 73728
 ds_read_b64_tr_b16 v[214:215], v8 offset:54272
 v_mfma_f32_16x16x32_bf16 v[68:71], v[228:231], a[20:23], v[68:71]
 s_xor_b32 s68, s69, 33152
 ds_read_b64_tr_b16 v[216:217], v8 offset:57344
 v_mfma_f32_16x16x32_bf16 v[68:71], v[232:235], a[24:27], v[68:71]
 s_add_u32 s65, s68, 14336
 ds_read_b64_tr_b16 v[218:219], v8 offset:58368
 v_mfma_f32_16x16x32_bf16 v[68:71], v[236:239], a[28:31], v[68:71]
 buffer_load_dwordx4 v4, s[36:39], s68 offen offset:0 lds
 v_mfma_f32_16x16x32_bf16 v[72:75], v[224:227], a[32:35], 0
 ds_read_b64_tr_b16 v[220:221], v8 offset:61440
 v_mfma_f32_16x16x32_bf16 v[72:75], v[228:231], a[36:39], v[72:75]
 ds_read_b64_tr_b16 v[222:223], v8 offset:62464
 v_mfma_f32_16x16x32_bf16 v[72:75], v[232:235], a[40:43], v[72:75]
 buffer_load_dwordx4 v5, s[36:39], s68 offen offset:1024 lds
 v_mfma_f32_16x16x32_bf16 v[72:75], v[236:239], a[44:47], v[72:75]
 v_mfma_f32_16x16x32_bf16 v[76:79], v[224:227], a[48:51], 0
 v_mfma_f32_16x16x32_bf16 v[76:79], v[228:231], a[52:55], v[76:79]
 v_mfma_f32_16x16x32_bf16 v[76:79], v[232:235], a[56:59], v[76:79]
 buffer_load_dwordx4 v4, s[36:39], s65 offen offset:2048 lds
 v_mfma_f32_16x16x32_bf16 v[76:79], v[236:239], a[60:63], v[76:79]
 s_waitcnt lgkmcnt(0)
 v_mfma_f32_16x16x32_bf16 v[80:83], v[208:211], a[0:3], 0
 ds_read_b64_tr_b16 v[224:225], v9 offset:49152
 v_mfma_f32_16x16x32_bf16 v[80:83], v[212:215], a[4:7], v[80:83]
 ds_read_b64_tr_b16 v[226:227], v9 offset:50176
 v_mfma_f32_16x16x32_bf16 v[80:83], v[216:219], a[8:11], v[80:83]
 ds_read_b64_tr_b16 v[228:229], v9 offset:53248
 v_mfma_f32_16x16x32_bf16 v[80:83], v[220:223], a[12:15], v[80:83]
 buffer_load_dwordx4 v5, s[36:39], s65 offen offset:3072 lds
 v_mfma_f32_16x16x32_bf16 v[84:87], v[208:211], a[16:19], 0
 s_add_u32 m0, s70, 77824
 ds_read_b64_tr_b16 v[230:231], v9 offset:54272
 v_mfma_f32_16x16x32_bf16 v[84:87], v[212:215], a[20:23], v[84:87]
 s_xor_b32 s66, s69, 512
 ds_read_b64_tr_b16 v[232:233], v9 offset:57344
 v_mfma_f32_16x16x32_bf16 v[84:87], v[216:219], a[24:27], v[84:87]
 s_add_u32 s67, s66, 14336
 ds_read_b64_tr_b16 v[234:235], v9 offset:58368
 v_mfma_f32_16x16x32_bf16 v[84:87], v[220:223], a[28:31], v[84:87]
 buffer_load_dwordx4 v4, s[36:39], s66 offen offset:0 lds
 v_mfma_f32_16x16x32_bf16 v[88:91], v[208:211], a[32:35], 0
 ds_read_b64_tr_b16 v[236:237], v9 offset:61440
 v_mfma_f32_16x16x32_bf16 v[88:91], v[212:215], a[36:39], v[88:91]
 ds_read_b64_tr_b16 v[238:239], v9 offset:62464
 v_mfma_f32_16x16x32_bf16 v[88:91], v[216:219], a[40:43], v[88:91]
 s_waitcnt vmcnt(13)
 ds_read_b128 a[72:75], v6 offset:0
 v_mfma_f32_16x16x32_bf16 v[88:91], v[220:223], a[44:47], v[88:91]
 buffer_load_dwordx4 v5, s[36:39], s66 offen offset:1024 lds
 v_mfma_f32_16x16x32_bf16 v[92:95], v[208:211], a[48:51], 0
 ds_read_b128 a[76:79], v7 offset:0
 v_mfma_f32_16x16x32_bf16 v[92:95], v[212:215], a[52:55], v[92:95]
 ds_read_b128 a[88:91], v6 offset:2048
 v_mfma_f32_16x16x32_bf16 v[92:95], v[216:219], a[56:59], v[92:95]
 v_mfma_f32_16x16x32_bf16 v[92:95], v[220:223], a[60:63], v[92:95]
 s_waitcnt lgkmcnt(3)
 v_mfma_f32_16x16x32_bf16 v[96:99], v[224:227], a[0:3], 0
 ds_read_b64_tr_b16 v[208:209], v10 offset:49152
 v_mfma_f32_16x16x32_bf16 v[96:99], v[228:231], a[4:7], v[96:99]
 ds_read_b64_tr_b16 v[210:211], v10 offset:50176
 v_mfma_f32_16x16x32_bf16 v[96:99], v[232:235], a[8:11], v[96:99]
 ds_read_b64_tr_b16 v[212:213], v10 offset:53248
 v_mfma_f32_16x16x32_bf16 v[96:99], v[236:239], a[12:15], v[96:99]
 buffer_load_dwordx4 v4, s[36:39], s67 offen offset:2048 lds
 v_mfma_f32_16x16x32_bf16 v[100:103], v[224:227], a[16:19], 0
 ds_read_b64_tr_b16 v[214:215], v10 offset:54272
 v_mfma_f32_16x16x32_bf16 v[100:103], v[228:231], a[20:23], v[100:103]
 ds_read_b64_tr_b16 v[216:217], v10 offset:57344
 v_mfma_f32_16x16x32_bf16 v[100:103], v[232:235], a[24:27], v[100:103]
 ds_read_b64_tr_b16 v[218:219], v10 offset:58368
 v_mfma_f32_16x16x32_bf16 v[100:103], v[236:239], a[28:31], v[100:103]
 buffer_load_dwordx4 v5, s[36:39], s67 offen offset:3072 lds
 v_mfma_f32_16x16x32_bf16 v[104:107], v[224:227], a[32:35], 0
 ds_read_b64_tr_b16 v[220:221], v10 offset:61440
 v_mfma_f32_16x16x32_bf16 v[104:107], v[228:231], a[36:39], v[104:107]
 s_xor_b32 m0, s88, 0
 ds_read_b64_tr_b16 v[222:223], v10 offset:62464
 v_mfma_f32_16x16x32_bf16 v[104:107], v[232:235], a[40:43], v[104:107]
 s_xor_b32 s68, s63, 2097152
 ds_read_b128 a[92:95], v7 offset:2048
 v_mfma_f32_16x16x32_bf16 v[104:107], v[236:239], a[44:47], v[104:107]
 buffer_load_dwordx4 v2, s[32:35], s68 offen lds
 v_mfma_f32_16x16x32_bf16 v[108:111], v[224:227], a[48:51], 0
 s_waitcnt vmcnt(13)
 ds_read_b128 a[96:99], v6 offset:4096
 s_xor_b32 m0, s88, 1024
 v_mfma_f32_16x16x32_bf16 v[108:111], v[228:231], a[52:55], v[108:111]
 s_xor_b32 s65, s63, 2129920
 ds_read_b128 a[100:103], v7 offset:4096
 v_mfma_f32_16x16x32_bf16 v[108:111], v[232:235], a[56:59], v[108:111]
 buffer_load_dwordx4 v2, s[32:35], s65 offen lds
 v_mfma_f32_16x16x32_bf16 v[108:111], v[236:239], a[60:63], v[108:111]
 s_waitcnt lgkmcnt(3)
 v_mfma_f32_16x16x32_bf16 v[112:115], v[208:211], a[0:3], 0
 ds_read_b64_tr_b16 v[224:225], v11 offset:49152
 v_mfma_f32_16x16x32_bf16 v[112:115], v[212:215], a[4:7], v[112:115]
 s_xor_b32 m0, s88, 2048
 ds_read_b64_tr_b16 v[226:227], v11 offset:50176
 v_mfma_f32_16x16x32_bf16 v[112:115], v[216:219], a[8:11], v[112:115]
 s_xor_b32 s66, s63, 2228224
 ds_read_b64_tr_b16 v[228:229], v11 offset:53248
 v_mfma_f32_16x16x32_bf16 v[112:115], v[220:223], a[12:15], v[112:115]
 buffer_load_dwordx4 v2, s[32:35], s66 offen lds
 v_mfma_f32_16x16x32_bf16 v[116:119], v[208:211], a[16:19], 0
 ds_read_b64_tr_b16 v[230:231], v11 offset:54272
 v_mfma_f32_16x16x32_bf16 v[116:119], v[212:215], a[20:23], v[116:119]
 ds_read_b64_tr_b16 v[232:233], v11 offset:57344
 v_mfma_f32_16x16x32_bf16 v[116:119], v[216:219], a[24:27], v[116:119]
 ds_read_b64_tr_b16 v[234:235], v11 offset:58368
 v_mfma_f32_16x16x32_bf16 v[116:119], v[220:223], a[28:31], v[116:119]
 s_add_u32 m0, s70, 65536
 v_mfma_f32_16x16x32_bf16 v[120:123], v[208:211], a[32:35], 0
 ds_read_b64_tr_b16 v[236:237], v11 offset:61440
 v_mfma_f32_16x16x32_bf16 v[120:123], v[212:215], a[36:39], v[120:123]
 ds_read_b64_tr_b16 v[238:239], v11 offset:62464
 v_mfma_f32_16x16x32_bf16 v[120:123], v[216:219], a[40:43], v[120:123]
 ds_read_b128 a[112:115], v6 offset:6144
 v_mfma_f32_16x16x32_bf16 v[120:123], v[220:223], a[44:47], v[120:123]
 s_xor_b32 s67, s69, 640
 v_mfma_f32_16x16x32_bf16 v[124:127], v[208:211], a[48:51], 0
 ds_read_b128 a[116:119], v7 offset:6144
 v_mfma_f32_16x16x32_bf16 v[124:127], v[212:215], a[52:55], v[124:127]
 s_waitcnt vmcnt(7)
 ds_read_b128 a[104:107], v6 offset:8192
 v_mfma_f32_16x16x32_bf16 v[124:127], v[216:219], a[56:59], v[124:127]
 s_add_u32 s68, s67, 14336
 v_mfma_f32_16x16x32_bf16 v[124:127], v[220:223], a[60:63], v[124:127]
 s_waitcnt lgkmcnt(3)
 s_barrier
 v_mfma_f32_16x16x32_bf16 v[128:131], v[224:227], a[0:3], 0
 ds_read_b64_tr_b16 v[208:209], v12 offset:0
 v_mfma_f32_16x16x32_bf16 v[128:131], v[228:231], a[4:7], v[128:131]
 ds_read_b64_tr_b16 v[210:211], v12 offset:1024
 v_mfma_f32_16x16x32_bf16 v[128:131], v[232:235], a[8:11], v[128:131]
 ds_read_b64_tr_b16 v[212:213], v12 offset:4096
 v_mfma_f32_16x16x32_bf16 v[128:131], v[236:239], a[12:15], v[128:131]
 buffer_load_dwordx4 v4, s[36:39], s67 offen offset:0 lds
 v_mfma_f32_16x16x32_bf16 v[132:135], v[224:227], a[16:19], 0
 ds_read_b64_tr_b16 v[214:215], v12 offset:5120
 v_mfma_f32_16x16x32_bf16 v[132:135], v[228:231], a[20:23], v[132:135]
 ds_read_b64_tr_b16 v[216:217], v12 offset:8192
 v_mfma_f32_16x16x32_bf16 v[132:135], v[232:235], a[24:27], v[132:135]
 ds_read_b64_tr_b16 v[218:219], v12 offset:9216
 v_mfma_f32_16x16x32_bf16 v[132:135], v[236:239], a[28:31], v[132:135]
 buffer_load_dwordx4 v5, s[36:39], s67 offen offset:1024 lds
 v_mfma_f32_16x16x32_bf16 v[136:139], v[224:227], a[32:35], 0
 ds_read_b64_tr_b16 v[220:221], v12 offset:12288
 v_mfma_f32_16x16x32_bf16 v[136:139], v[228:231], a[36:39], v[136:139]
 ds_read_b64_tr_b16 v[222:223], v12 offset:13312
 v_mfma_f32_16x16x32_bf16 v[136:139], v[232:235], a[40:43], v[136:139]
 ds_read_b128 a[108:111], v7 offset:8192
 v_mfma_f32_16x16x32_bf16 v[136:139], v[236:239], a[44:47], v[136:139]
 buffer_load_dwordx4 v4, s[36:39], s68 offen offset:2048 lds
 v_mfma_f32_16x16x32_bf16 v[140:143], v[224:227], a[48:51], 0
 ds_read_b128 a[120:123], v6 offset:10240
 v_mfma_f32_16x16x32_bf16 v[140:143], v[228:231], a[52:55], v[140:143]
 ds_read_b128 a[124:127], v7 offset:10240
 v_mfma_f32_16x16x32_bf16 v[140:143], v[232:235], a[56:59], v[140:143]
 buffer_load_dwordx4 v5, s[36:39], s68 offen offset:3072 lds
 v_mfma_f32_16x16x32_bf16 v[140:143], v[236:239], a[60:63], v[140:143]
 s_waitcnt lgkmcnt(3)
 s_xor_b32 m0, s88, 3072
 v_mfma_f32_16x16x32_bf16 v[16:19], v[208:211], a[64:67], v[16:19]
 ds_read_b64_tr_b16 v[224:225], v13 offset:0
 v_lshrrev_b32 v252, 8, v1
 v_mfma_f32_16x16x32_bf16 v[16:19], v[212:215], a[68:71], v[16:19]
 ds_read_b64_tr_b16 v[226:227], v13 offset:1024
 v_lshlrev_b32 v252, 3, v252
 v_mfma_f32_16x16x32_bf16 v[16:19], v[216:219], a[72:75], v[16:19]
 s_xor_b32 s65, s63, 2260992
 ds_read_b64_tr_b16 v[228:229], v13 offset:4096
 v_mfma_f32_16x16x32_bf16 v[16:19], v[220:223], a[76:79], v[16:19]
 buffer_load_dwordx4 v2, s[32:35], s65 offen lds
 v_mfma_f32_16x16x32_bf16 v[20:23], v[208:211], a[80:83], v[20:23]
 s_add_u32 m0, s70, 69632
 ds_read_b64_tr_b16 v[230:231], v13 offset:5120
 v_mfma_f32_16x16x32_bf16 v[20:23], v[212:215], a[84:87], v[20:23]
 s_xor_b32 s66, s69, 33280
 ds_read_b64_tr_b16 v[232:233], v13 offset:8192
 v_mfma_f32_16x16x32_bf16 v[20:23], v[216:219], a[88:91], v[20:23]
 s_add_u32 s67, s66, 14336
 ds_read_b64_tr_b16 v[234:235], v13 offset:9216
 v_mfma_f32_16x16x32_bf16 v[20:23], v[220:223], a[92:95], v[20:23]
 buffer_load_dwordx4 v4, s[36:39], s66 offen offset:0 lds
 v_mfma_f32_16x16x32_bf16 v[24:27], v[208:211], a[96:99], v[24:27]
 ds_read_b64_tr_b16 v[236:237], v13 offset:12288
 v_mfma_f32_16x16x32_bf16 v[24:27], v[212:215], a[100:103], v[24:27]
 ds_read_b64_tr_b16 v[238:239], v13 offset:13312
 v_mfma_f32_16x16x32_bf16 v[24:27], v[216:219], a[104:107], v[24:27]
 s_waitcnt vmcnt(9) lgkmcnt(8)
 ds_read_b128 a[128:131], v6 offset:12288
 v_mfma_f32_16x16x32_bf16 v[24:27], v[220:223], a[108:111], v[24:27]
 buffer_load_dwordx4 v5, s[36:39], s66 offen offset:1024 lds
 v_mfma_f32_16x16x32_bf16 v[28:31], v[208:211], a[112:115], v[28:31]
 ds_read_b128 a[132:135], v7 offset:12288
 v_mfma_f32_16x16x32_bf16 v[28:31], v[212:215], a[116:119], v[28:31]
 ds_read_b128 a[144:147], v6 offset:14336
 v_mfma_f32_16x16x32_bf16 v[28:31], v[216:219], a[120:123], v[28:31]
 buffer_load_dwordx4 v4, s[36:39], s67 offen offset:2048 lds
 v_mfma_f32_16x16x32_bf16 v[28:31], v[220:223], a[124:127], v[28:31]
 s_waitcnt lgkmcnt(3)
 v_mfma_f32_16x16x32_bf16 v[32:35], v[224:227], a[64:67], v[32:35]
 ds_read_b64_tr_b16 v[208:209], v14 offset:0
 v_mfma_f32_16x16x32_bf16 v[32:35], v[228:231], a[68:71], v[32:35]
 ds_read_b64_tr_b16 v[210:211], v14 offset:1024
 v_mfma_f32_16x16x32_bf16 v[32:35], v[232:235], a[72:75], v[32:35]
 ds_read_b64_tr_b16 v[212:213], v14 offset:4096
 v_mfma_f32_16x16x32_bf16 v[32:35], v[236:239], a[76:79], v[32:35]
 buffer_load_dwordx4 v5, s[36:39], s67 offen offset:3072 lds
 v_mfma_f32_16x16x32_bf16 v[36:39], v[224:227], a[80:83], v[36:39]
 ds_read_b64_tr_b16 v[214:215], v14 offset:5120
 v_mfma_f32_16x16x32_bf16 v[36:39], v[228:231], a[84:87], v[36:39]
 s_xor_b32 m0, s88, 4096
 ds_read_b64_tr_b16 v[216:217], v14 offset:8192
 v_mfma_f32_16x16x32_bf16 v[36:39], v[232:235], a[88:91], v[36:39]
 s_xor_b32 s68, s63, 2359296
 ds_read_b64_tr_b16 v[218:219], v14 offset:9216
 v_mfma_f32_16x16x32_bf16 v[36:39], v[236:239], a[92:95], v[36:39]
 buffer_load_dwordx4 v2, s[32:35], s68 offen lds
 v_mfma_f32_16x16x32_bf16 v[40:43], v[224:227], a[96:99], v[40:43]
 ds_read_b64_tr_b16 v[220:221], v14 offset:12288
 v_mfma_f32_16x16x32_bf16 v[40:43], v[228:231], a[100:103], v[40:43]
 s_xor_b32 m0, s88, 5120
 ds_read_b64_tr_b16 v[222:223], v14 offset:13312
 v_mfma_f32_16x16x32_bf16 v[40:43], v[232:235], a[104:107], v[40:43]
 s_xor_b32 s65, s63, 2392064
 ds_read_b128 a[148:151], v7 offset:14336
 v_mfma_f32_16x16x32_bf16 v[40:43], v[236:239], a[108:111], v[40:43]
 buffer_load_dwordx4 v2, s[32:35], s65 offen lds
 v_mfma_f32_16x16x32_bf16 v[44:47], v[224:227], a[112:115], v[44:47]
 v_mfma_f32_16x16x32_bf16 v[44:47], v[228:231], a[116:119], v[44:47]
 s_add_u32 m0, s70, 73728
 s_xor_b32 s66, s69, 33408
 s_add_u32 s67, s66, 14336
 v_mfma_f32_16x16x32_bf16 v[44:47], v[232:235], a[120:123], v[44:47]
 buffer_load_dwordx4 v4, s[36:39], s66 offen offset:0 lds
 v_mfma_f32_16x16x32_bf16 v[44:47], v[236:239], a[124:127], v[44:47]
 s_waitcnt lgkmcnt(1)
 v_mfma_f32_16x16x32_bf16 v[48:51], v[208:211], a[64:67], v[48:51]
 ds_read_b64_tr_b16 v[224:225], v15 offset:0
 v_mfma_f32_16x16x32_bf16 v[48:51], v[212:215], a[68:71], v[48:51]
 ds_read_b64_tr_b16 v[226:227], v15 offset:1024
 v_mfma_f32_16x16x32_bf16 v[48:51], v[216:219], a[72:75], v[48:51]
 ds_read_b64_tr_b16 v[228:229], v15 offset:4096
 v_mfma_f32_16x16x32_bf16 v[48:51], v[220:223], a[76:79], v[48:51]
 buffer_load_dwordx4 v5, s[36:39], s66 offen offset:1024 lds
 v_mfma_f32_16x16x32_bf16 v[52:55], v[208:211], a[80:83], v[52:55]
 ds_read_b64_tr_b16 v[230:231], v15 offset:5120
 v_mfma_f32_16x16x32_bf16 v[52:55], v[212:215], a[84:87], v[52:55]
 ds_read_b64_tr_b16 v[232:233], v15 offset:8192
 v_mfma_f32_16x16x32_bf16 v[52:55], v[216:219], a[88:91], v[52:55]
 ds_read_b64_tr_b16 v[234:235], v15 offset:9216
 v_mfma_f32_16x16x32_bf16 v[52:55], v[220:223], a[92:95], v[52:55]
 buffer_load_dwordx4 v4, s[36:39], s67 offen offset:2048 lds
 v_mfma_f32_16x16x32_bf16 v[56:59], v[208:211], a[96:99], v[56:59]
 ds_read_b64_tr_b16 v[236:237], v15 offset:12288
 v_mfma_f32_16x16x32_bf16 v[56:59], v[212:215], a[100:103], v[56:59]
 ds_read_b64_tr_b16 v[238:239], v15 offset:13312
 v_mfma_f32_16x16x32_bf16 v[56:59], v[216:219], a[104:107], v[56:59]
 s_waitcnt vmcnt(10)
 ds_read_b128 a[136:139], v6 offset:0
 v_mfma_f32_16x16x32_bf16 v[56:59], v[220:223], a[108:111], v[56:59]
 buffer_load_dwordx4 v5, s[36:39], s67 offen offset:3072 lds
 v_mfma_f32_16x16x32_bf16 v[60:63], v[208:211], a[112:115], v[60:63]
 ds_read_b128 a[140:143], v7 offset:0
 v_mfma_f32_16x16x32_bf16 v[60:63], v[212:215], a[116:119], v[60:63]
 ds_read_b128 a[152:155], v6 offset:2048
 v_mfma_f32_16x16x32_bf16 v[60:63], v[216:219], a[120:123], v[60:63]
 v_mfma_f32_16x16x32_bf16 v[60:63], v[220:223], a[124:127], v[60:63]
 s_waitcnt vmcnt(36) lgkmcnt(3)
 v_mfma_f32_16x16x32_bf16 v[64:67], v[224:227], a[64:67], v[64:67]
 ds_read_b64_tr_b16 v[208:209], v12 offset:16384
 v_mfma_f32_16x16x32_bf16 v[64:67], v[228:231], a[68:71], v[64:67]
 s_xor_b32 m0, s88, 6144
 ds_read_b64_tr_b16 v[210:211], v12 offset:17408
 v_mfma_f32_16x16x32_bf16 v[64:67], v[232:235], a[72:75], v[64:67]
 s_xor_b32 s68, s63, 2490368
 ds_read_b64_tr_b16 v[212:213], v12 offset:20480
 v_mfma_f32_16x16x32_bf16 v[64:67], v[236:239], a[76:79], v[64:67]
 buffer_load_dwordx4 v2, s[32:35], s68 offen lds
 v_mfma_f32_16x16x32_bf16 v[68:71], v[224:227], a[80:83], v[68:71]
 ds_read_b64_tr_b16 v[214:215], v12 offset:21504
 v_mfma_f32_16x16x32_bf16 v[68:71], v[228:231], a[84:87], v[68:71]
 s_xor_b32 m0, s88, 7168
 ds_read_b64_tr_b16 v[216:217], v12 offset:24576
 v_mfma_f32_16x16x32_bf16 v[68:71], v[232:235], a[88:91], v[68:71]
 s_xor_b32 s65, s63, 2523136
 ds_read_b64_tr_b16 v[218:219], v12 offset:25600
 v_mfma_f32_16x16x32_bf16 v[68:71], v[236:239], a[92:95], v[68:71]
 buffer_load_dwordx4 v2, s[32:35], s65 offen lds
 v_mfma_f32_16x16x32_bf16 v[72:75], v[224:227], a[96:99], v[72:75]
 ds_read_b64_tr_b16 v[220:221], v12 offset:28672
 v_mfma_f32_16x16x32_bf16 v[72:75], v[228:231], a[100:103], v[72:75]
 ds_read_b64_tr_b16 v[222:223], v12 offset:29696
 v_mfma_f32_16x16x32_bf16 v[72:75], v[232:235], a[104:107], v[72:75]
 ds_read_b128 a[156:159], v7 offset:2048
 v_mfma_f32_16x16x32_bf16 v[72:75], v[236:239], a[108:111], v[72:75]
 v_mfma_f32_16x16x32_bf16 v[76:79], v[224:227], a[112:115], v[76:79]
 s_add_u32 m0, s70, 77824
 v_mfma_f32_16x16x32_bf16 v[76:79], v[228:231], a[116:119], v[76:79]
 s_xor_b32 s66, s69, 768
 v_mfma_f32_16x16x32_bf16 v[76:79], v[232:235], a[120:123], v[76:79]
 s_add_u32 s67, s66, 14336
 v_mfma_f32_16x16x32_bf16 v[76:79], v[236:239], a[124:127], v[76:79]
 s_waitcnt lgkmcnt(1)
 v_mfma_f32_16x16x32_bf16 v[80:83], v[208:211], a[64:67], v[80:83]
 ds_read_b64_tr_b16 v[224:225], v13 offset:16384
 v_mfma_f32_16x16x32_bf16 v[80:83], v[212:215], a[68:71], v[80:83]
 ds_read_b64_tr_b16 v[226:227], v13 offset:17408
 v_mfma_f32_16x16x32_bf16 v[80:83], v[216:219], a[72:75], v[80:83]
 ds_read_b64_tr_b16 v[228:229], v13 offset:20480
 v_mfma_f32_16x16x32_bf16 v[80:83], v[220:223], a[76:79], v[80:83]
 buffer_load_dwordx4 v4, s[36:39], s66 offen offset:0 lds
 v_mfma_f32_16x16x32_bf16 v[84:87], v[208:211], a[80:83], v[84:87]
 ds_read_b64_tr_b16 v[230:231], v13 offset:21504
 v_mfma_f32_16x16x32_bf16 v[84:87], v[212:215], a[84:87], v[84:87]
 ds_read_b64_tr_b16 v[232:233], v13 offset:24576
 v_mfma_f32_16x16x32_bf16 v[84:87], v[216:219], a[88:91], v[84:87]
 ds_read_b64_tr_b16 v[234:235], v13 offset:25600
 v_mfma_f32_16x16x32_bf16 v[84:87], v[220:223], a[92:95], v[84:87]
 buffer_load_dwordx4 v5, s[36:39], s66 offen offset:1024 lds
 v_mfma_f32_16x16x32_bf16 v[88:91], v[208:211], a[96:99], v[88:91]
 ds_read_b64_tr_b16 v[236:237], v13 offset:28672
 v_mfma_f32_16x16x32_bf16 v[88:91], v[212:215], a[100:103], v[88:91]
 ds_read_b64_tr_b16 v[238:239], v13 offset:29696
 v_mfma_f32_16x16x32_bf16 v[88:91], v[216:219], a[104:107], v[88:91]
 s_waitcnt vmcnt(10)
 ds_read_b128 a[160:163], v6 offset:4096
 v_mfma_f32_16x16x32_bf16 v[88:91], v[220:223], a[108:111], v[88:91]
 buffer_load_dwordx4 v4, s[36:39], s67 offen offset:2048 lds
 v_mfma_f32_16x16x32_bf16 v[92:95], v[208:211], a[112:115], v[92:95]
 ds_read_b128 a[164:167], v7 offset:4096
 v_mfma_f32_16x16x32_bf16 v[92:95], v[212:215], a[116:119], v[92:95]
 ds_read_b128 a[176:179], v6 offset:6144
 v_mfma_f32_16x16x32_bf16 v[92:95], v[216:219], a[120:123], v[92:95]
 buffer_load_dwordx4 v5, s[36:39], s67 offen offset:3072 lds
 v_mfma_f32_16x16x32_bf16 v[92:95], v[220:223], a[124:127], v[92:95]
 s_waitcnt lgkmcnt(3)
 v_mfma_f32_16x16x32_bf16 v[96:99], v[224:227], a[64:67], v[96:99]
 ds_read_b64_tr_b16 v[208:209], v14 offset:16384
 v_mfma_f32_16x16x32_bf16 v[96:99], v[228:231], a[68:71], v[96:99]
 s_xor_b32 m0, s88, 32768
 ds_read_b64_tr_b16 v[210:211], v14 offset:17408
 v_mfma_f32_16x16x32_bf16 v[96:99], v[232:235], a[72:75], v[96:99]
 s_xor_b32 s68, s63, 3145728
 ds_read_b64_tr_b16 v[212:213], v14 offset:20480
 v_mfma_f32_16x16x32_bf16 v[96:99], v[236:239], a[76:79], v[96:99]
 buffer_load_dwordx4 v2, s[32:35], s68 offen lds
 v_mfma_f32_16x16x32_bf16 v[100:103], v[224:227], a[80:83], v[100:103]
 ds_read_b64_tr_b16 v[214:215], v14 offset:21504
 v_mfma_f32_16x16x32_bf16 v[100:103], v[228:231], a[84:87], v[100:103]
 s_xor_b32 m0, s88, 33792
 ds_read_b64_tr_b16 v[216:217], v14 offset:24576
 v_mfma_f32_16x16x32_bf16 v[100:103], v[232:235], a[88:91], v[100:103]
 s_xor_b32 s65, s63, 3178496
 ds_read_b64_tr_b16 v[218:219], v14 offset:25600
 v_mfma_f32_16x16x32_bf16 v[100:103], v[236:239], a[92:95], v[100:103]
 buffer_load_dwordx4 v2, s[32:35], s65 offen lds
 v_mfma_f32_16x16x32_bf16 v[104:107], v[224:227], a[96:99], v[104:107]
 ds_read_b64_tr_b16 v[220:221], v14 offset:28672
 v_mfma_f32_16x16x32_bf16 v[104:107], v[228:231], a[100:103], v[104:107]
 ds_read_b64_tr_b16 v[222:223], v14 offset:29696
 v_mfma_f32_16x16x32_bf16 v[104:107], v[232:235], a[104:107], v[104:107]
 ds_read_b128 a[180:183], v7 offset:6144
 v_mfma_f32_16x16x32_bf16 v[104:107], v[236:239], a[108:111], v[104:107]
 v_mfma_f32_16x16x32_bf16 v[108:111], v[224:227], a[112:115], v[108:111]
 s_add_u32 m0, s70, 65536
 v_mfma_f32_16x16x32_bf16 v[108:111], v[228:231], a[116:119], v[108:111]
 s_xor_b32 s66, s69, 896
 v_mfma_f32_16x16x32_bf16 v[108:111], v[232:235], a[120:123], v[108:111]
 s_add_u32 s67, s66, 14336
 v_mfma_f32_16x16x32_bf16 v[108:111], v[236:239], a[124:127], v[108:111]
 s_waitcnt lgkmcnt(1)
 v_mfma_f32_16x16x32_bf16 v[112:115], v[208:211], a[64:67], v[112:115]
 ds_read_b64_tr_b16 v[224:225], v15 offset:16384
 v_mfma_f32_16x16x32_bf16 v[112:115], v[212:215], a[68:71], v[112:115]
 ds_read_b64_tr_b16 v[226:227], v15 offset:17408
 v_mfma_f32_16x16x32_bf16 v[112:115], v[216:219], a[72:75], v[112:115]
L_w2_1:
L_st2_1:
 s_cbranch_execz L_st2_5
 ds_read_b64_tr_b16 v[228:229], v15 offset:20480
 v_mfma_f32_16x16x32_bf16 v[112:115], v[220:223], a[76:79], v[112:115]
 buffer_load_dwordx4 v4, s[36:39], s66 offen offset:0 lds
 v_mfma_f32_16x16x32_bf16 v[116:119], v[208:211], a[80:83], v[116:119]
 ds_read_b64_tr_b16 v[230:231], v15 offset:21504
 v_mfma_f32_16x16x32_bf16 v[116:119], v[212:215], a[84:87], v[116:119]
 ds_read_b64_tr_b16 v[232:233], v15 offset:24576
 v_mfma_f32_16x16x32_bf16 v[116:119], v[216:219], a[88:91], v[116:119]
 ds_read_b64_tr_b16 v[234:235], v15 offset:25600
 v_mfma_f32_16x16x32_bf16 v[116:119], v[220:223], a[92:95], v[116:119]
 buffer_load_dwordx4 v5, s[36:39], s66 offen offset:1024 lds
 v_mfma_f32_16x16x32_bf16 v[120:123], v[208:211], a[96:99], v[120:123]
 ds_read_b64_tr_b16 v[236:237], v15 offset:28672
 v_mfma_f32_16x16x32_bf16 v[120:123], v[212:215], a[100:103], v[120:123]
 ds_read_b64_tr_b16 v[238:239], v15 offset:29696
 v_mfma_f32_16x16x32_bf16 v[120:123], v[216:219], a[104:107], v[120:123]
 s_waitcnt vmcnt(10)
 ds_read_b128 a[168:171], v6 offset:8192
 v_mfma_f32_16x16x32_bf16 v[120:123], v[220:223], a[108:111], v[120:123]
 buffer_load_dwordx4 v4, s[36:39], s67 offen offset:2048 lds
 v_mfma_f32_16x16x32_bf16 v[124:127], v[208:211], a[112:115], v[124:127]
 ds_read_b128 a[172:175], v7 offset:8192
 v_mfma_f32_16x16x32_bf16 v[124:127], v[212:215], a[116:119], v[124:127]
 ds_read_b128 a[184:187], v6 offset:10240
 v_mfma_f32_16x16x32_bf16 v[124:127], v[216:219], a[120:123], v[124:127]
 buffer_load_dwordx4 v5, s[36:39], s67 offen offset:3072 lds
 v_mfma_f32_16x16x32_bf16 v[124:127], v[220:223], a[124:127], v[124:127]
 s_waitcnt vmcnt(10) lgkmcnt(3)
 s_barrier
 v_mfma_f32_16x16x32_bf16 v[128:131], v[224:227], a[64:67], v[128:131]
 ds_read_b64_tr_b16 v[208:209], v8 offset:0
 v_mfma_f32_16x16x32_bf16 v[128:131], v[228:231], a[68:71], v[128:131]
 s_xor_b32 m0, s88, 34816
 ds_read_b64_tr_b16 v[210:211], v8 offset:1024
 v_mfma_f32_16x16x32_bf16 v[128:131], v[232:235], a[72:75], v[128:131]
 s_xor_b32 s68, s63, 3276800
 ds_read_b64_tr_b16 v[212:213], v8 offset:4096
 v_mfma_f32_16x16x32_bf16 v[128:131], v[236:239], a[76:79], v[128:131]
 buffer_load_dwordx4 v2, s[32:35], s68 offen lds
 v_mfma_f32_16x16x32_bf16 v[132:135], v[224:227], a[80:83], v[132:135]
 ds_read_b64_tr_b16 v[214:215], v8 offset:5120
 v_mfma_f32_16x16x32_bf16 v[132:135], v[228:231], a[84:87], v[132:135]
 s_xor_b32 m0, s88, 35840
 ds_read_b64_tr_b16 v[216:217], v8 offset:8192
 v_mfma_f32_16x16x32_bf16 v[132:135], v[232:235], a[88:91], v[132:135]
 s_xor_b32 s65, s63, 3309568
 ds_read_b64_tr_b16 v[218:219], v8 offset:9216
 v_mfma_f32_16x16x32_bf16 v[132:135], v[236:239], a[92:95], v[132:135]
 buffer_load_dwordx4 v2, s[32:35], s65 offen lds
 v_mfma_f32_16x16x32_bf16 v[136:139], v[224:227], a[96:99], v[136:139]
 ds_read_b64_tr_b16 v[220:221], v8 offset:12288
 v_mfma_f32_16x16x32_bf16 v[136:139], v[228:231], a[100:103], v[136:139]
 ds_read_b64_tr_b16 v[222:223], v8 offset:13312
 v_mfma_f32_16x16x32_bf16 v[136:139], v[232:235], a[104:107], v[136:139]
 ds_read_b128 a[188:191], v7 offset:10240
 v_mfma_f32_16x16x32_bf16 v[136:139], v[236:239], a[108:111], v[136:139]
 buffer_load_dword v251, v201, s[48:51], 0 offen sc1
 v_mfma_f32_16x16x32_bf16 v[140:143], v[224:227], a[112:115], v[140:143]
 s_add_u32 m0, s70, 69632
 v_mfma_f32_16x16x32_bf16 v[140:143], v[228:231], a[116:119], v[140:143]
 s_xor_b32 s66, s69, 33536
 v_mfma_f32_16x16x32_bf16 v[140:143], v[232:235], a[120:123], v[140:143]
 s_add_u32 s67, s66, 14336
 v_mfma_f32_16x16x32_bf16 v[140:143], v[236:239], a[124:127], v[140:143]
 s_waitcnt lgkmcnt(1)
 v_mfma_f32_16x16x32_bf16 v[16:19], v[208:211], a[128:131], v[16:19]
 ds_read_b64_tr_b16 v[224:225], v9 offset:0
 v_mfma_f32_16x16x32_bf16 v[16:19], v[212:215], a[132:135], v[16:19]
 ds_read_b64_tr_b16 v[226:227], v9 offset:1024
 v_mfma_f32_16x16x32_bf16 v[16:19], v[216:219], a[136:139], v[16:19]
 ds_read_b64_tr_b16 v[228:229], v9 offset:4096
 v_mfma_f32_16x16x32_bf16 v[16:19], v[220:223], a[140:143], v[16:19]
 buffer_load_dwordx4 v4, s[36:39], s66 offen offset:0 lds
 v_mfma_f32_16x16x32_bf16 v[20:23], v[208:211], a[144:147], v[20:23]
 ds_read_b64_tr_b16 v[230:231], v9 offset:5120
 v_mfma_f32_16x16x32_bf16 v[20:23], v[212:215], a[148:151], v[20:23]
 ds_read_b64_tr_b16 v[232:233], v9 offset:8192
 v_mfma_f32_16x16x32_bf16 v[20:23], v[216:219], a[152:155], v[20:23]
 ds_read_b64_tr_b16 v[234:235], v9 offset:9216
 v_mfma_f32_16x16x32_bf16 v[20:23], v[220:223], a[156:159], v[20:23]
 buffer_load_dwordx4 v5, s[36:39], s66 offen offset:1024 lds
 v_mfma_f32_16x16x32_bf16 v[24:27], v[208:211], a[160:163], v[24:27]
 ds_read_b64_tr_b16 v[236:237], v9 offset:12288
 v_mfma_f32_16x16x32_bf16 v[24:27], v[212:215], a[164:167], v[24:27]
 ds_read_b64_tr_b16 v[238:239], v9 offset:13312
 v_mfma_f32_16x16x32_bf16 v[24:27], v[216:219], a[168:171], v[24:27]
 s_waitcnt vmcnt(11) lgkmcnt(8)
 ds_read_b128 a[192:195], v6 offset:12288
 v_mfma_f32_16x16x32_bf16 v[24:27], v[220:223], a[172:175], v[24:27]
 buffer_load_dwordx4 v4, s[36:39], s67 offen offset:2048 lds
 v_mfma_f32_16x16x32_bf16 v[28:31], v[208:211], a[176:179], v[28:31]
 ds_read_b128 a[196:199], v7 offset:12288
 v_mfma_f32_16x16x32_bf16 v[28:31], v[212:215], a[180:183], v[28:31]
 ds_read_b128 a[208:211], v6 offset:14336
 v_mfma_f32_16x16x32_bf16 v[28:31], v[216:219], a[184:187], v[28:31]
 buffer_load_dwordx4 v5, s[36:39], s67 offen offset:3072 lds
 v_mfma_f32_16x16x32_bf16 v[28:31], v[220:223], a[188:191], v[28:31]
 s_waitcnt lgkmcnt(3)
 v_mfma_f32_16x16x32_bf16 v[32:35], v[224:227], a[128:131], v[32:35]
 ds_read_b64_tr_b16 v[208:209], v10 offset:0
 v_mfma_f32_16x16x32_bf16 v[32:35], v[228:231], a[132:135], v[32:35]
 s_xor_b32 m0, s88, 36864
 ds_read_b64_tr_b16 v[210:211], v10 offset:1024
 v_mfma_f32_16x16x32_bf16 v[32:35], v[232:235], a[136:139], v[32:35]
 s_xor_b32 s68, s63, 3407872
 ds_read_b64_tr_b16 v[212:213], v10 offset:4096
 v_mfma_f32_16x16x32_bf16 v[32:35], v[236:239], a[140:143], v[32:35]
 buffer_load_dwordx4 v2, s[32:35], s68 offen lds
 v_mfma_f32_16x16x32_bf16 v[36:39], v[224:227], a[144:147], v[36:39]
 ds_read_b64_tr_b16 v[214:215], v10 offset:5120
 v_mfma_f32_16x16x32_bf16 v[36:39], v[228:231], a[148:151], v[36:39]
 s_xor_b32 m0, s88, 37888
 ds_read_b64_tr_b16 v[216:217], v10 offset:8192
 v_mfma_f32_16x16x32_bf16 v[36:39], v[232:235], a[152:155], v[36:39]
 s_xor_b32 s65, s63, 3440640
 ds_read_b64_tr_b16 v[218:219], v10 offset:9216
 v_mfma_f32_16x16x32_bf16 v[36:39], v[236:239], a[156:159], v[36:39]
 buffer_load_dwordx4 v2, s[32:35], s65 offen lds
 v_mfma_f32_16x16x32_bf16 v[40:43], v[224:227], a[160:163], v[40:43]
 s_add_u32 m0, s70, 73728
 ds_read_b64_tr_b16 v[220:221], v10 offset:12288
 v_mfma_f32_16x16x32_bf16 v[40:43], v[228:231], a[164:167], v[40:43]
 s_xor_b32 s66, s69, 33664
 ds_read_b64_tr_b16 v[222:223], v10 offset:13312
 v_mfma_f32_16x16x32_bf16 v[40:43], v[232:235], a[168:171], v[40:43]
 s_add_u32 s67, s66, 14336
 ds_read_b128 a[212:215], v7 offset:14336
 v_mfma_f32_16x16x32_bf16 v[40:43], v[236:239], a[172:175], v[40:43]
 buffer_load_dwordx4 v4, s[36:39], s66 offen offset:0 lds
 v_mfma_f32_16x16x32_bf16 v[44:47], v[224:227], a[176:179], v[44:47]
 v_mfma_f32_16x16x32_bf16 v[44:47], v[228:231], a[180:183], v[44:47]
 v_mfma_f32_16x16x32_bf16 v[44:47], v[232:235], a[184:187], v[44:47]
 buffer_load_dwordx4 v5, s[36:39], s66 offen offset:1024 lds
 v_mfma_f32_16x16x32_bf16 v[44:47], v[236:239], a[188:191], v[44:47]
 s_waitcnt lgkmcnt(1)
 v_mfma_f32_16x16x32_bf16 v[48:51], v[208:211], a[128:131], v[48:51]
 ds_read_b64_tr_b16 v[224:225], v11 offset:0
 v_mfma_f32_16x16x32_bf16 v[48:51], v[212:215], a[132:135], v[48:51]
 ds_read_b64_tr_b16 v[226:227], v11 offset:1024
 v_mfma_f32_16x16x32_bf16 v[48:51], v[216:219], a[136:139], v[48:51]
 ds_read_b64_tr_b16 v[228:229], v11 offset:4096
 v_mfma_f32_16x16x32_bf16 v[48:51], v[220:223], a[140:143], v[48:51]
 buffer_load_dwordx4 v4, s[36:39], s67 offen offset:2048 lds
 v_mfma_f32_16x16x32_bf16 v[52:55], v[208:211], a[144:147], v[52:55]
 ds_read_b64_tr_b16 v[230:231], v11 offset:5120
 v_mfma_f32_16x16x32_bf16 v[52:55], v[212:215], a[148:151], v[52:55]
 ds_read_b64_tr_b16 v[232:233], v11 offset:8192
 v_mfma_f32_16x16x32_bf16 v[52:55], v[216:219], a[152:155], v[52:55]
 ds_read_b64_tr_b16 v[234:235], v11 offset:9216
 v_mfma_f32_16x16x32_bf16 v[52:55], v[220:223], a[156:159], v[52:55]
 buffer_load_dwordx4 v5, s[36:39], s67 offen offset:3072 lds
 v_mfma_f32_16x16x32_bf16 v[56:59], v[208:211], a[160:163], v[56:59]
 ds_read_b64_tr_b16 v[236:237], v11 offset:12288
 v_mfma_f32_16x16x32_bf16 v[56:59], v[212:215], a[164:167], v[56:59]
 ds_read_b64_tr_b16 v[238:239], v11 offset:13312
 v_mfma_f32_16x16x32_bf16 v[56:59], v[216:219], a[168:171], v[56:59]
 s_waitcnt vmcnt(13)
 ds_read_b128 a[200:203], v6 offset:0
 v_mfma_f32_16x16x32_bf16 v[56:59], v[220:223], a[172:175], v[56:59]
 buffer_store_dwordx4 v[144:147], v253, s[40:43], s85 offen sc1
 v_mfma_f32_16x16x32_bf16 v[60:63], v[208:211], a[176:179], v[60:63]
 ds_read_b128 a[204:207], v7 offset:0
 v_mfma_f32_16x16x32_bf16 v[60:63], v[212:215], a[180:183], v[60:63]
 ds_read_b128 a[216:219], v6 offset:2048
 v_mfma_f32_16x16x32_bf16 v[60:63], v[216:219], a[184:187], v[60:63]
 buffer_store_dwordx4 v[148:151], v253, s[40:43], s85 offen offset:2048 sc1
 v_mfma_f32_16x16x32_bf16 v[60:63], v[220:223], a[188:191], v[60:63]
 s_waitcnt vmcnt(36) lgkmcnt(3)
 v_mfma_f32_16x16x32_bf16 v[64:67], v[224:227], a[128:131], v[64:67]
 ds_read_b64_tr_b16 v[208:209], v8 offset:16384
 v_mfma_f32_16x16x32_bf16 v[64:67], v[228:231], a[132:135], v[64:67]
 s_xor_b32 m0, s88, 38912
 ds_read_b64_tr_b16 v[210:211], v8 offset:17408
 v_mfma_f32_16x16x32_bf16 v[64:67], v[232:235], a[136:139], v[64:67]
 s_xor_b32 s68, s63, 3538944
 ds_read_b64_tr_b16 v[212:213], v8 offset:20480
 v_mfma_f32_16x16x32_bf16 v[64:67], v[236:239], a[140:143], v[64:67]
 buffer_load_dwordx4 v2, s[32:35], s68 offen lds
 v_mfma_f32_16x16x32_bf16 v[68:71], v[224:227], a[144:147], v[68:71]
 ds_read_b64_tr_b16 v[214:215], v8 offset:21504
 v_mfma_f32_16x16x32_bf16 v[68:71], v[228:231], a[148:151], v[68:71]
 s_xor_b32 m0, s88, 39936
 ds_read_b64_tr_b16 v[216:217], v8 offset:24576
 v_mfma_f32_16x16x32_bf16 v[68:71], v[232:235], a[152:155], v[68:71]
 s_xor_b32 s65, s63, 3571712
 ds_read_b64_tr_b16 v[218:219], v8 offset:25600
 v_mfma_f32_16x16x32_bf16 v[68:71], v[236:239], a[156:159], v[68:71]
 buffer_load_dwordx4 v2, s[32:35], s65 offen lds
 v_mfma_f32_16x16x32_bf16 v[72:75], v[224:227], a[160:163], v[72:75]
 ds_read_b64_tr_b16 v[220:221], v8 offset:28672
 v_mfma_f32_16x16x32_bf16 v[72:75], v[228:231], a[164:167], v[72:75]
 ds_read_b64_tr_b16 v[222:223], v8 offset:29696
 v_mfma_f32_16x16x32_bf16 v[72:75], v[232:235], a[168:171], v[72:75]
 ds_read_b128 a[220:223], v7 offset:2048
 v_mfma_f32_16x16x32_bf16 v[72:75], v[236:239], a[172:175], v[72:75]
 s_mov_b32 s52, s20
 v_mfma_f32_16x16x32_bf16 v[76:79], v[224:227], a[176:179], v[76:79]
 s_waitcnt vmcnt(14)
 s_mov_b32 s53, s21
 v_cmp_eq_u32 vcc, 0, v251
 v_mfma_f32_16x16x32_bf16 v[76:79], v[228:231], a[180:183], v[76:79]
 s_cbranch_vccnz L_spin_clr
L_back_clr:
 s_min_u32 s54, s46, 3584
 s_lshl_b32 s66, s61, 7
 v_mfma_f32_16x16x32_bf16 v[76:79], v[232:235], a[184:187], v[76:79]
 buffer_load_dwordx2 v[240:241], v252, s[52:55], s66 offen offset:0
 v_mfma_f32_16x16x32_bf16 v[76:79], v[236:239], a[188:191], v[76:79]
 s_waitcnt lgkmcnt(1)
 v_mfma_f32_16x16x32_bf16 v[80:83], v[208:211], a[128:131], v[80:83]
 ds_read_b64_tr_b16 v[224:225], v9 offset:16384
 v_mfma_f32_16x16x32_bf16 v[80:83], v[212:215], a[132:135], v[80:83]
 ds_read_b64_tr_b16 v[226:227], v9 offset:17408
 v_mfma_f32_16x16x32_bf16 v[80:83], v[216:219], a[136:139], v[80:83]
 ds_read_b64_tr_b16 v[228:229], v9 offset:20480
 v_mfma_f32_16x16x32_bf16 v[80:83], v[220:223], a[140:143], v[80:83]
 buffer_load_dwordx2 v[242:243], v252, s[52:55], s66 offen offset:32
 v_mfma_f32_16x16x32_bf16 v[84:87], v[208:211], a[144:147], v[84:87]
 ds_read_b64_tr_b16 v[230:231], v9 offset:21504
 v_mfma_f32_16x16x32_bf16 v[84:87], v[212:215], a[148:151], v[84:87]
 ds_read_b64_tr_b16 v[232:233], v9 offset:24576
 v_mfma_f32_16x16x32_bf16 v[84:87], v[216:219], a[152:155], v[84:87]
 ds_read_b64_tr_b16 v[234:235], v9 offset:25600
 v_mfma_f32_16x16x32_bf16 v[84:87], v[220:223], a[156:159], v[84:87]
 buffer_load_dwordx2 v[244:245], v252, s[52:55], s66 offen offset:64
 v_mfma_f32_16x16x32_bf16 v[88:91], v[208:211], a[160:163], v[88:91]
 ds_read_b64_tr_b16 v[236:237], v9 offset:28672
 v_mfma_f32_16x16x32_bf16 v[88:91], v[212:215], a[164:167], v[88:91]
 ds_read_b64_tr_b16 v[238:239], v9 offset:29696
 v_mfma_f32_16x16x32_bf16 v[88:91], v[216:219], a[168:171], v[88:91]
 s_waitcnt vmcnt(13)
 ds_read_b128 a[224:227], v6 offset:4096
 v_mfma_f32_16x16x32_bf16 v[88:91], v[220:223], a[172:175], v[88:91]
 buffer_load_dwordx2 v[246:247], v252, s[52:55], s66 offen offset:96
 v_mfma_f32_16x16x32_bf16 v[92:95], v[208:211], a[176:179], v[92:95]
 ds_read_b128 a[228:231], v7 offset:4096
 v_mfma_f32_16x16x32_bf16 v[92:95], v[212:215], a[180:183], v[92:95]
 ds_read_b128 a[240:243], v6 offset:6144
 v_mfma_f32_16x16x32_bf16 v[92:95], v[216:219], a[184:187], v[92:95]
 v_mfma_f32_16x16x32_bf16 v[92:95], v[220:223], a[188:191], v[92:95]
 s_waitcnt lgkmcnt(3)
 v_mfma_f32_16x16x32_bf16 v[96:99], v[224:227], a[128:131], v[96:99]
 s_mov_b32 s52, s12
 ds_read_b64_tr_b16 v[208:209], v10 offset:16384
 v_mfma_f32_16x16x32_bf16 v[96:99], v[228:231], a[132:135], v[96:99]
 s_lshr_b32 s86, s2, 4
 ds_read_b64_tr_b16 v[210:211], v10 offset:17408
 s_mul_i32 s86, s86, 16
 v_mfma_f32_16x16x32_bf16 v[96:99], v[232:235], a[136:139], v[96:99]
 s_add_u32 s86, s86, s2
 ds_read_b64_tr_b16 v[212:213], v10 offset:20480
 s_lshl_b32 s86, s86, 2
 v_mfma_f32_16x16x32_bf16 v[96:99], v[236:239], a[140:143], v[96:99]
 s_add_u32 s86, s86, 69215232
 s_mov_b32 s53, s13
 s_mov_b32 s54, 4194304
 v_mfma_f32_16x16x32_bf16 v[100:103], v[224:227], a[144:147], v[100:103]
 s_lshl_b32 s67, s2, 2
 ds_read_b64_tr_b16 v[214:215], v10 offset:21504
 v_mfma_f32_16x16x32_bf16 v[100:103], v[228:231], a[148:151], v[100:103]
 s_add_u32 s67, s67, s60
 ds_read_b64_tr_b16 v[216:217], v10 offset:24576
 v_mfma_f32_16x16x32_bf16 v[100:103], v[232:235], a[152:155], v[100:103]
 s_mul_i32 s67, s67, 4096
 ds_read_b64_tr_b16 v[218:219], v10 offset:25600
 v_mfma_f32_16x16x32_bf16 v[100:103], v[236:239], a[156:159], v[100:103]
 buffer_load_dword v250, v248, s[52:55], s67 offen
 v_mfma_f32_16x16x32_bf16 v[104:107], v[224:227], a[160:163], v[104:107]
 s_mov_b32 s52, s18
 ds_read_b64_tr_b16 v[220:221], v10 offset:28672
 v_mfma_f32_16x16x32_bf16 v[104:107], v[228:231], a[164:167], v[104:107]
 s_mov_b32 s53, s19
 ds_read_b64_tr_b16 v[222:223], v10 offset:29696
 v_mfma_f32_16x16x32_bf16 v[104:107], v[232:235], a[168:171], v[104:107]
 s_mov_b32 s54, 1835008
 ds_read_b128 a[244:247], v7 offset:6144
 v_mfma_f32_16x16x32_bf16 v[104:107], v[236:239], a[172:175], v[104:107]
 s_lshl_b32 s68, s2, 2
 s_add_u32 s68, s68, s60
 s_mul_i32 s68, s68, 1792
 v_mfma_f32_16x16x32_bf16 v[108:111], v[224:227], a[176:179], v[108:111]
 buffer_load_dword v250, v249, s[52:55], s68 offen
 v_mfma_f32_16x16x32_bf16 v[108:111], v[228:231], a[180:183], v[108:111]
 v_mfma_f32_16x16x32_bf16 v[108:111], v[232:235], a[184:187], v[108:111]
 v_mfma_f32_16x16x32_bf16 v[108:111], v[236:239], a[188:191], v[108:111]
 s_waitcnt lgkmcnt(1)
 v_mfma_f32_16x16x32_bf16 v[112:115], v[208:211], a[128:131], v[112:115]
 ds_read_b64_tr_b16 v[224:225], v11 offset:16384
 v_mfma_f32_16x16x32_bf16 v[112:115], v[212:215], a[132:135], v[112:115]
 ds_read_b64_tr_b16 v[226:227], v11 offset:17408
 v_mfma_f32_16x16x32_bf16 v[112:115], v[216:219], a[136:139], v[112:115]
 ds_read_b64_tr_b16 v[228:229], v11 offset:20480
 v_mfma_f32_16x16x32_bf16 v[112:115], v[220:223], a[140:143], v[112:115]
 v_mfma_f32_16x16x32_bf16 v[116:119], v[208:211], a[144:147], v[116:119]
 ds_read_b64_tr_b16 v[230:231], v11 offset:21504
 v_mfma_f32_16x16x32_bf16 v[116:119], v[212:215], a[148:151], v[116:119]
 ds_read_b64_tr_b16 v[232:233], v11 offset:24576
 v_mfma_f32_16x16x32_bf16 v[116:119], v[216:219], a[152:155], v[116:119]
 ds_read_b64_tr_b16 v[234:235], v11 offset:25600
 v_mfma_f32_16x16x32_bf16 v[116:119], v[220:223], a[156:159], v[116:119]
 v_mfma_f32_16x16x32_bf16 v[120:123], v[208:211], a[160:163], v[120:123]
 ds_read_b64_tr_b16 v[236:237], v11 offset:28672
 v_mfma_f32_16x16x32_bf16 v[120:123], v[212:215], a[164:167], v[120:123]
 ds_read_b64_tr_b16 v[238:239], v11 offset:29696
 v_mfma_f32_16x16x32_bf16 v[120:123], v[216:219], a[168:171], v[120:123]
 s_waitcnt vmcnt(10)
 ds_read_b128 a[232:235], v6 offset:8192
 v_mfma_f32_16x16x32_bf16 v[120:123], v[220:223], a[172:175], v[120:123]
 v_mfma_f32_16x16x32_bf16 v[124:127], v[208:211], a[176:179], v[124:127]
 ds_read_b128 a[236:239], v7 offset:8192
 v_mfma_f32_16x16x32_bf16 v[124:127], v[212:215], a[180:183], v[124:127]
 ds_read_b128 a[248:251], v6 offset:10240
 v_mfma_f32_16x16x32_bf16 v[124:127], v[216:219], a[184:187], v[124:127]
 v_mfma_f32_16x16x32_bf16 v[124:127], v[220:223], a[188:191], v[124:127]
 s_waitcnt vmcnt(6) lgkmcnt(3)
 s_barrier
 v_mfma_f32_16x16x32_bf16 v[128:131], v[224:227], a[128:131], v[128:131]
 ds_read_b64_tr_b16 v[208:209], v8 offset:32768
 v_mfma_f32_16x16x32_bf16 v[128:131], v[228:231], a[132:135], v[128:131]
 ds_read_b64_tr_b16 v[210:211], v8 offset:33792
 v_mfma_f32_16x16x32_bf16 v[128:131], v[232:235], a[136:139], v[128:131]
 ds_read_b64_tr_b16 v[212:213], v8 offset:36864
 v_mfma_f32_16x16x32_bf16 v[128:131], v[236:239], a[140:143], v[128:131]
 buffer_store_dword v12, v0, s[40:43], s86 offen sc1
 v_mfma_f32_16x16x32_bf16 v[132:135], v[224:227], a[144:147], v[132:135]
 ds_read_b64_tr_b16 v[214:215], v8 offset:37888
 v_mfma_f32_16x16x32_bf16 v[132:135], v[228:231], a[148:151], v[132:135]
 ds_read_b64_tr_b16 v[216:217], v8 offset:40960
 v_mfma_f32_16x16x32_bf16 v[132:135], v[232:235], a[152:155], v[132:135]
 ds_read_b64_tr_b16 v[218:219], v8 offset:41984
 v_mfma_f32_16x16x32_bf16 v[132:135], v[236:239], a[156:159], v[132:135]
 v_mfma_f32_16x16x32_bf16 v[136:139], v[224:227], a[160:163], v[136:139]
 ds_read_b64_tr_b16 v[220:221], v8 offset:45056
 v_mfma_f32_16x16x32_bf16 v[136:139], v[228:231], a[164:167], v[136:139]
 ds_read_b64_tr_b16 v[222:223], v8 offset:46080
 v_mfma_f32_16x16x32_bf16 v[136:139], v[232:235], a[168:171], v[136:139]
 ds_read_b128 a[252:255], v7 offset:10240
 v_mfma_f32_16x16x32_bf16 v[136:139], v[236:239], a[172:175], v[136:139]
 v_mfma_f32_16x16x32_bf16 v[140:143], v[224:227], a[176:179], v[140:143]
 v_mfma_f32_16x16x32_bf16 v[140:143], v[228:231], a[180:183], v[140:143]
 v_mfma_f32_16x16x32_bf16 v[140:143], v[232:235], a[184:187], v[140:143]
 v_mfma_f32_16x16x32_bf16 v[140:143], v[236:239], a[188:191], v[140:143]
 s_waitcnt lgkmcnt(1)
 v_mfma_f32_16x16x32_bf16 v[16:19], v[208:211], a[192:195], v[16:19]
 ds_read_b64_tr_b16 v[224:225], v9 offset:32768
 v_mfma_f32_16x16x32_bf16 v[16:19], v[212:215], a[196:199], v[16:19]
 ds_read_b64_tr_b16 v[226:227], v9 offset:33792
 v_mfma_f32_16x16x32_bf16 v[16:19], v[216:219], a[200:203], v[16:19]
 ds_read_b64_tr_b16 v[228:229], v9 offset:36864
 v_mfma_f32_16x16x32_bf16 v[16:19], v[220:223], a[204:207], v[16:19]
 v_mfma_f32_16x16x32_bf16 v[20:23], v[208:211], a[208:211], v[20:23]
 ds_read_b64_tr_b16 v[230:231], v9 offset:37888
 v_mfma_f32_16x16x32_bf16 v[20:23], v[212:215], a[212:215], v[20:23]
 ds_read_b64_tr_b16 v[232:233], v9 offset:40960
 v_mfma_f32_16x16x32_bf16 v[20:23], v[216:219], a[216:219], v[20:23]
 ds_read_b64_tr_b16 v[234:235], v9 offset:41984
 v_mul_f32 v16, s84, v16
 v_mfma_f32_16x16x32_bf16 v[20:23], v[220:223], a[220:223], v[20:23]
 v_mul_f32 v17, s84, v17
 v_mul_f32 v18, s84, v18
 v_mfma_f32_16x16x32_bf16 v[24:27], v[208:211], a[224:227], v[24:27]
 ds_read_b64_tr_b16 v[236:237], v9 offset:45056
 v_mul_f32 v19, s84, v19
 v_mfma_f32_16x16x32_bf16 v[24:27], v[212:215], a[228:231], v[24:27]
 ds_read_b64_tr_b16 v[238:239], v9 offset:46080
 v_cvt_pk_bf16_f32 v144, v16, v17
 v_mfma_f32_16x16x32_bf16 v[24:27], v[216:219], a[232:235], v[24:27]
 v_cvt_pk_bf16_f32 v145, v18, v19
 v_mul_f32 v20, s84, v20
 v_mfma_f32_16x16x32_bf16 v[24:27], v[220:223], a[236:239], v[24:27]
 v_mul_f32 v21, s84, v21
 v_mul_f32 v22, s84, v22
 v_mfma_f32_16x16x32_bf16 v[28:31], v[208:211], a[240:243], v[28:31]
 v_mul_f32 v23, s84, v23
 v_cvt_pk_bf16_f32 v148, v20, v21
 v_mfma_f32_16x16x32_bf16 v[28:31], v[212:215], a[244:247], v[28:31]
 s_waitcnt lgkmcnt(8)
 s_mov_b32 s32, s12
 v_cvt_pk_bf16_f32 v149, v22, v23
 v_mfma_f32_16x16x32_bf16 v[28:31], v[216:219], a[248:251], v[28:31]
 s_mov_b32 s33, s13
 v_mul_f32 v24, s84, v24
 v_mul_f32 v25, s84, v25
 v_mfma_f32_16x16x32_bf16 v[28:31], v[220:223], a[252:255], v[28:31]
 s_waitcnt lgkmcnt(0)
 v_mul_f32 v26, s84, v26
 v_mul_f32 v27, s84, v27
 v_mfma_f32_16x16x32_bf16 v[32:35], v[224:227], a[192:195], v[32:35]
 ds_read_b64_tr_b16 v[208:209], v10 offset:32768
 v_cvt_pk_bf16_f32 v152, v24, v25
 v_mfma_f32_16x16x32_bf16 v[32:35], v[228:231], a[196:199], v[32:35]
 ds_read_b64_tr_b16 v[210:211], v10 offset:33792
 v_cvt_pk_bf16_f32 v153, v26, v27
 v_mfma_f32_16x16x32_bf16 v[32:35], v[232:235], a[200:203], v[32:35]
 ds_read_b64_tr_b16 v[212:213], v10 offset:36864
 v_mul_f32 v28, s84, v28
 v_mfma_f32_16x16x32_bf16 v[32:35], v[236:239], a[204:207], v[32:35]
 s_xor_b32 m0, s88, 131072
 v_mul_f32 v29, s84, v29
 v_mul_f32 v30, s84, v30
 v_mfma_f32_16x16x32_bf16 v[36:39], v[224:227], a[208:211], v[36:39]
 ds_read_b64_tr_b16 v[214:215], v10 offset:37888
 v_mul_f32 v31, s84, v31
 v_mfma_f32_16x16x32_bf16 v[36:39], v[228:231], a[212:215], v[36:39]
 ds_read_b64_tr_b16 v[216:217], v10 offset:40960
 v_cvt_pk_bf16_f32 v156, v28, v29
 v_mfma_f32_16x16x32_bf16 v[36:39], v[232:235], a[216:219], v[36:39]
 ds_read_b64_tr_b16 v[218:219], v10 offset:41984
 v_mul_f32 v32, s84, v32
 v_mfma_f32_16x16x32_bf16 v[36:39], v[236:239], a[220:223], v[36:39]
 s_xor_b32 s65, s63, 0
 v_mul_f32 v33, s84, v33
 v_mul_f32 v34, s84, v34
 v_mfma_f32_16x16x32_bf16 v[40:43], v[224:227], a[224:227], v[40:43]
 ds_read_b64_tr_b16 v[220:221], v10 offset:45056
 v_mul_f32 v35, s84, v35
 v_mfma_f32_16x16x32_bf16 v[40:43], v[228:231], a[228:231], v[40:43]
 ds_read_b64_tr_b16 v[222:223], v10 offset:46080
 v_cvt_pk_bf16_f32 v146, v32, v33
 v_mfma_f32_16x16x32_bf16 v[40:43], v[232:235], a[232:235], v[40:43]
 buffer_load_dwordx4 v2, s[32:35], s65 offen lds
 v_mfma_f32_16x16x32_bf16 v[40:43], v[236:239], a[236:239], v[40:43]
 s_xor_b32 m0, s88, 132096
 v_cvt_pk_bf16_f32 v147, v34, v35
 v_mul_f32 v36, s84, v36
 v_mfma_f32_16x16x32_bf16 v[44:47], v[224:227], a[240:243], v[44:47]
 s_xor_b32 s66, s63, 32768
 v_mul_f32 v37, s84, v37
 v_mul_f32 v38, s84, v38
 v_mfma_f32_16x16x32_bf16 v[44:47], v[228:231], a[244:247], v[44:47]
 buffer_load_dwordx4 v2, s[32:35], s66 offen lds
 v_mfma_f32_16x16x32_bf16 v[44:47], v[232:235], a[248:251], v[44:47]
 v_mul_f32 v39, s84, v39
 v_cvt_pk_bf16_f32 v150, v36, v37
 v_mfma_f32_16x16x32_bf16 v[44:47], v[236:239], a[252:255], v[44:47]
 s_waitcnt lgkmcnt(0)
 v_cvt_pk_bf16_f32 v151, v38, v39
 v_mul_f32 v40, s84, v40
 v_mfma_f32_16x16x32_bf16 v[48:51], v[208:211], a[192:195], v[48:51]
 ds_read_b64_tr_b16 v[224:225], v11 offset:32768
 v_mul_f32 v41, s84, v41
 v_mfma_f32_16x16x32_bf16 v[48:51], v[212:215], a[196:199], v[48:51]
 s_xor_b32 m0, s88, 133120
 ds_read_b64_tr_b16 v[226:227], v11 offset:33792
 v_mul_f32 v42, s84, v42
 v_mfma_f32_16x16x32_bf16 v[48:51], v[216:219], a[200:203], v[48:51]
 s_xor_b32 s67, s63, 131072
 ds_read_b64_tr_b16 v[228:229], v11 offset:36864
 v_mul_f32 v43, s84, v43
 v_mfma_f32_16x16x32_bf16 v[48:51], v[220:223], a[204:207], v[48:51]
 buffer_load_dwordx4 v2, s[32:35], s67 offen lds
 v_mfma_f32_16x16x32_bf16 v[52:55], v[208:211], a[208:211], v[52:55]
 ds_read_b64_tr_b16 v[230:231], v11 offset:37888
 v_cvt_pk_bf16_f32 v154, v40, v41
 v_mfma_f32_16x16x32_bf16 v[52:55], v[212:215], a[212:215], v[52:55]
 s_xor_b32 m0, s88, 134144
 ds_read_b64_tr_b16 v[232:233], v11 offset:40960
 v_cvt_pk_bf16_f32 v155, v42, v43
 v_mfma_f32_16x16x32_bf16 v[52:55], v[216:219], a[216:219], v[52:55]
 s_xor_b32 s68, s63, 163840
 ds_read_b64_tr_b16 v[234:235], v11 offset:41984
 v_cvt_pk_bf16_f32 v157, v30, v31
 v_mfma_f32_16x16x32_bf16 v[52:55], v[220:223], a[220:223], v[52:55]
 buffer_load_dwordx4 v2, s[32:35], s68 offen lds
 v_mfma_f32_16x16x32_bf16 v[56:59], v[208:211], a[224:227], v[56:59]
 ds_read_b64_tr_b16 v[236:237], v11 offset:45056
 v_mul_f32 v44, s84, v44
 v_mfma_f32_16x16x32_bf16 v[56:59], v[212:215], a[228:231], v[56:59]
 ds_read_b64_tr_b16 v[238:239], v11 offset:46080
 v_mul_f32 v45, s84, v45
 v_mfma_f32_16x16x32_bf16 v[56:59], v[216:219], a[232:235], v[56:59]
 v_mul_f32 v46, s84, v46
 v_mul_f32 v47, s84, v47
 v_mfma_f32_16x16x32_bf16 v[56:59], v[220:223], a[236:239], v[56:59]
 s_xor_b32 m0, s88, 135168
 v_cvt_pk_bf16_f32 v158, v44, v45
 v_cvt_pk_bf16_f32 v159, v46, v47
 v_mfma_f32_16x16x32_bf16 v[60:63], v[208:211], a[240:243], v[60:63]
 s_xor_b32 s65, s63, 262144
 v_mul_f32 v48, s84, v48
 v_mul_f32 v49, s84, v49
 v_mfma_f32_16x16x32_bf16 v[60:63], v[212:215], a[244:247], v[60:63]
 buffer_load_dwordx4 v2, s[32:35], s65 offen lds
 v_mfma_f32_16x16x32_bf16 v[60:63], v[216:219], a[248:251], v[60:63]
 v_mul_f32 v50, s84, v50
 v_mul_f32 v51, s84, v51
 v_mfma_f32_16x16x32_bf16 v[60:63], v[220:223], a[252:255], v[60:63]
 s_waitcnt vmcnt(36) lgkmcnt(0)
 v_cvt_pk_bf16_f32 v160, v48, v49
 v_cvt_pk_bf16_f32 v161, v50, v51
 v_mfma_f32_16x16x32_bf16 v[64:67], v[224:227], a[192:195], v[64:67]
 ds_read_b64_tr_b16 v[208:209], v8 offset:49152
 v_mul_f32 v52, s84, v52
 v_mfma_f32_16x16x32_bf16 v[64:67], v[228:231], a[196:199], v[64:67]
 s_xor_b32 m0, s88, 136192
 ds_read_b64_tr_b16 v[210:211], v8 offset:50176
 v_mul_f32 v53, s84, v53
 v_mfma_f32_16x16x32_bf16 v[64:67], v[232:235], a[200:203], v[64:67]
 s_xor_b32 s66, s63, 294912
 ds_read_b64_tr_b16 v[212:213], v8 offset:53248
 v_mul_f32 v54, s84, v54
 v_mfma_f32_16x16x32_bf16 v[64:67], v[236:239], a[204:207], v[64:67]
 buffer_load_dwordx4 v2, s[32:35], s66 offen lds
 v_mfma_f32_16x16x32_bf16 v[68:71], v[224:227], a[208:211], v[68:71]
 ds_read_b64_tr_b16 v[214:215], v8 offset:54272
 v_mul_f32 v55, s84, v55
 v_mfma_f32_16x16x32_bf16 v[68:71], v[228:231], a[212:215], v[68:71]
 s_xor_b32 m0, s88, 137216
 ds_read_b64_tr_b16 v[216:217], v8 offset:57344
 v_cvt_pk_bf16_f32 v164, v52, v53
 v_mfma_f32_16x16x32_bf16 v[68:71], v[232:235], a[216:219], v[68:71]
 s_xor_b32 s67, s63, 393216
 ds_read_b64_tr_b16 v[218:219], v8 offset:58368
 v_mul_f32 v64, s84, v64
 v_mfma_f32_16x16x32_bf16 v[68:71], v[236:239], a[220:223], v[68:71]
 buffer_load_dwordx4 v2, s[32:35], s67 offen lds
 v_mfma_f32_16x16x32_bf16 v[72:75], v[224:227], a[224:227], v[72:75]
 ds_read_b64_tr_b16 v[220:221], v8 offset:61440
 v_mul_f32 v65, s84, v65
 v_mfma_f32_16x16x32_bf16 v[72:75], v[228:231], a[228:231], v[72:75]
 ds_read_b64_tr_b16 v[222:223], v8 offset:62464
 v_mul_f32 v66, s84, v66
 v_mfma_f32_16x16x32_bf16 v[72:75], v[232:235], a[232:235], v[72:75]
 s_xor_b32 m0, s88, 138240
 v_mul_f32 v67, s84, v67
 v_cvt_pk_bf16_f32 v162, v64, v65
 v_mfma_f32_16x16x32_bf16 v[72:75], v[236:239], a[236:239], v[72:75]
 s_xor_b32 s68, s63, 425984
 v_cvt_pk_bf16_f32 v163, v66, v67
 v_cvt_pk_bf16_f32 v165, v54, v55
 v_mfma_f32_16x16x32_bf16 v[76:79], v[224:227], a[240:243], v[76:79]
 buffer_load_dwordx4 v2, s[32:35], s68 offen lds
 v_mfma_f32_16x16x32_bf16 v[76:79], v[228:231], a[244:247], v[76:79]
 v_mul_f32 v68, s84, v68
 v_mul_f32 v69, s84, v69
 v_mfma_f32_16x16x32_bf16 v[76:79], v[232:235], a[248:251], v[76:79]
 v_mul_f32 v70, s84, v70
 v_mul_f32 v71, s84, v71
 v_mfma_f32_16x16x32_bf16 v[76:79], v[236:239], a[252:255], v[76:79]
 s_waitcnt lgkmcnt(0)
 v_cvt_pk_bf16_f32 v166, v68, v69
 v_cvt_pk_bf16_f32 v167, v70, v71
 v_mfma_f32_16x16x32_bf16 v[80:83], v[208:211], a[192:195], v[80:83]
 ds_read_b64_tr_b16 v[224:225], v9 offset:49152
 v_mul_f32 v56, s84, v56
 v_mfma_f32_16x16x32_bf16 v[80:83], v[212:215], a[196:199], v[80:83]
 ds_read_b64_tr_b16 v[226:227], v9 offset:50176
 v_mul_f32 v57, s84, v57
 v_mfma_f32_16x16x32_bf16 v[80:83], v[216:219], a[200:203], v[80:83]
 ds_read_b64_tr_b16 v[228:229], v9 offset:53248
 v_mul_f32 v58, s84, v58
 v_mfma_f32_16x16x32_bf16 v[80:83], v[220:223], a[204:207], v[80:83]
 v_mul_f32 v59, s84, v59
 v_cvt_pk_bf16_f32 v168, v56, v57
 v_mfma_f32_16x16x32_bf16 v[84:87], v[208:211], a[208:211], v[84:87]
 ds_read_b64_tr_b16 v[230:231], v9 offset:54272
 v_cvt_pk_bf16_f32 v169, v58, v59
 v_mfma_f32_16x16x32_bf16 v[84:87], v[212:215], a[212:215], v[84:87]
 ds_read_b64_tr_b16 v[232:233], v9 offset:57344
 v_mul_f32 v72, s84, v72
 v_mfma_f32_16x16x32_bf16 v[84:87], v[216:219], a[216:219], v[84:87]
L_w2_2:
L_st2_2:
 s_cbranch_execz L_st2_6
 ds_read_b64_tr_b16 v[234:235], v9 offset:58368
 v_mul_f32 v73, s84, v73
 v_mfma_f32_16x16x32_bf16 v[84:87], v[220:223], a[220:223], v[84:87]
 v_mul_f32 v74, s84, v74
 v_mul_f32 v75, s84, v75
 v_mfma_f32_16x16x32_bf16 v[88:91], v[208:211], a[224:227], v[88:91]
 ds_read_b64_tr_b16 v[236:237], v9 offset:61440
 v_cvt_pk_bf16_f32 v170, v72, v73
 v_mfma_f32_16x16x32_bf16 v[88:91], v[212:215], a[228:231], v[88:91]
 ds_read_b64_tr_b16 v[238:239], v9 offset:62464
 v_cvt_pk_bf16_f32 v171, v74, v75
 v_mfma_f32_16x16x32_bf16 v[88:91], v[216:219], a[232:235], v[88:91]
 v_mul_f32 v60, s84, v60
 v_mul_f32 v61, s84, v61
 v_mfma_f32_16x16x32_bf16 v[88:91], v[220:223], a[236:239], v[88:91]
 v_mul_f32 v62, s84, v62
 v_mul_f32 v63, s84, v63
 v_mfma_f32_16x16x32_bf16 v[92:95], v[208:211], a[240:243], v[92:95]
 v_cvt_pk_bf16_f32 v172, v60, v61
 v_cvt_pk_bf16_f32 v173, v62, v63
 v_mfma_f32_16x16x32_bf16 v[92:95], v[212:215], a[244:247], v[92:95]
 s_xor_b32 m0, s88, 0
 v_mul_f32 v76, s84, v76
 v_mul_f32 v77, s84, v77
 v_mfma_f32_16x16x32_bf16 v[92:95], v[216:219], a[248:251], v[92:95]
 s_xor_b32 s65, s63, 1048576
 v_mul_f32 v78, s84, v78
 v_mul_f32 v79, s84, v79
 v_mfma_f32_16x16x32_bf16 v[92:95], v[220:223], a[252:255], v[92:95]
 s_waitcnt lgkmcnt(0)
 v_cvt_pk_bf16_f32 v174, v76, v77
 v_cvt_pk_bf16_f32 v175, v78, v79
 v_mfma_f32_16x16x32_bf16 v[96:99], v[224:227], a[192:195], v[96:99]
 ds_read_b64_tr_b16 v[208:209], v10 offset:49152
 v_mul_f32 v80, s84, v80
 v_mfma_f32_16x16x32_bf16 v[96:99], v[228:231], a[196:199], v[96:99]
 ds_read_b64_tr_b16 v[210:211], v10 offset:50176
 v_mul_f32 v81, s84, v81
 v_mfma_f32_16x16x32_bf16 v[96:99], v[232:235], a[200:203], v[96:99]
 ds_read_b64_tr_b16 v[212:213], v10 offset:53248
 v_mul_f32 v82, s84, v82
 v_mfma_f32_16x16x32_bf16 v[96:99], v[236:239], a[204:207], v[96:99]
 buffer_load_dwordx4 v2, s[32:35], s65 offen lds
 v_mfma_f32_16x16x32_bf16 v[100:103], v[224:227], a[208:211], v[100:103]
 ds_read_b64_tr_b16 v[214:215], v10 offset:54272
 v_mul_f32 v83, s84, v83
 v_mfma_f32_16x16x32_bf16 v[100:103], v[228:231], a[212:215], v[100:103]
 ds_read_b64_tr_b16 v[216:217], v10 offset:57344
 v_cvt_pk_bf16_f32 v176, v80, v81
 v_mfma_f32_16x16x32_bf16 v[100:103], v[232:235], a[216:219], v[100:103]
 s_add_u32 s66, s98, 3145728
 ds_read_b64_tr_b16 v[218:219], v10 offset:58368
 v_cvt_pk_bf16_f32 v177, v82, v83
 v_mfma_f32_16x16x32_bf16 v[100:103], v[236:239], a[220:223], v[100:103]
 buffer_store_dwordx4 v[144:147], v1, s[40:43], s66 offen offset:0 sc1
 v_mul_f32 v96, s84, v96
 v_mul_f32 v97, s84, v97
 v_mul_f32 v98, s84, v98
 v_mfma_f32_16x16x32_bf16 v[104:107], v[224:227], a[224:227], v[104:107]
 s_xor_b32 m0, s88, 1024
 ds_read_b64_tr_b16 v[220:221], v10 offset:61440
 v_mul_f32 v99, s84, v99
 v_mfma_f32_16x16x32_bf16 v[104:107], v[228:231], a[228:231], v[104:107]
 s_xor_b32 s67, s63, 1081344
 ds_read_b64_tr_b16 v[222:223], v10 offset:62464
 v_cvt_pk_bf16_f32 v178, v96, v97
 v_mfma_f32_16x16x32_bf16 v[104:107], v[232:235], a[232:235], v[104:107]
 buffer_load_dwordx4 v2, s[32:35], s67 offen lds
 v_mfma_f32_16x16x32_bf16 v[104:107], v[236:239], a[236:239], v[104:107]
 v_cvt_pk_bf16_f32 v179, v98, v99
 v_mul_f32 v84, s84, v84
 v_mfma_f32_16x16x32_bf16 v[108:111], v[224:227], a[240:243], v[108:111]
 v_mul_f32 v85, s84, v85
 v_mul_f32 v86, s84, v86
 v_mfma_f32_16x16x32_bf16 v[108:111], v[228:231], a[244:247], v[108:111]
 v_mul_f32 v87, s84, v87
 v_cvt_pk_bf16_f32 v180, v84, v85
 v_mfma_f32_16x16x32_bf16 v[108:111], v[232:235], a[248:251], v[108:111]
 s_add_u32 s68, s98, 3149824
 v_cvt_pk_bf16_f32 v181, v86, v87
 v_mul_f32 v100, s84, v100
 v_mfma_f32_16x16x32_bf16 v[108:111], v[236:239], a[252:255], v[108:111]
 s_waitcnt lgkmcnt(0)
 v_mul_f32 v101, s84, v101
 v_mul_f32 v102, s84, v102
 v_mfma_f32_16x16x32_bf16 v[112:115], v[208:211], a[192:195], v[112:115]
 ds_read_b64_tr_b16 v[224:225], v11 offset:49152
 v_mul_f32 v103, s84, v103
 v_mfma_f32_16x16x32_bf16 v[112:115], v[212:215], a[196:199], v[112:115]
 ds_read_b64_tr_b16 v[226:227], v11 offset:50176
 v_cvt_pk_bf16_f32 v182, v100, v101
 v_mfma_f32_16x16x32_bf16 v[112:115], v[216:219], a[200:203], v[112:115]
 ds_read_b64_tr_b16 v[228:229], v11 offset:53248
 v_cvt_pk_bf16_f32 v183, v102, v103
 v_mfma_f32_16x16x32_bf16 v[112:115], v[220:223], a[204:207], v[112:115]
 buffer_store_dwordx4 v[148:151], v1, s[40:43], s68 offen offset:0 sc1
 v_mul_f32 v88, s84, v88
 v_mul_f32 v89, s84, v89
 v_mul_f32 v90, s84, v90
 v_mfma_f32_16x16x32_bf16 v[116:119], v[208:211], a[208:211], v[116:119]
 ds_read_b64_tr_b16 v[230:231], v11 offset:54272
 v_mul_f32 v91, s84, v91
 v_mfma_f32_16x16x32_bf16 v[116:119], v[212:215], a[212:215], v[116:119]
 s_xor_b32 m0, s88, 2048
 ds_read_b64_tr_b16 v[232:233], v11 offset:57344
 v_cvt_pk_bf16_f32 v184, v88, v89
 v_mfma_f32_16x16x32_bf16 v[116:119], v[216:219], a[216:219], v[116:119]
 s_xor_b32 s65, s63, 1179648
 ds_read_b64_tr_b16 v[234:235], v11 offset:58368
 v_cvt_pk_bf16_f32 v185, v90, v91
 v_mfma_f32_16x16x32_bf16 v[116:119], v[220:223], a[220:223], v[116:119]
 buffer_load_dwordx4 v2, s[32:35], s65 offen lds
 v_mfma_f32_16x16x32_bf16 v[120:123], v[208:211], a[224:227], v[120:123]
 ds_read_b64_tr_b16 v[236:237], v11 offset:61440
 v_mul_f32 v104, s84, v104
 v_mfma_f32_16x16x32_bf16 v[120:123], v[212:215], a[228:231], v[120:123]
 ds_read_b64_tr_b16 v[238:239], v11 offset:62464
 v_mul_f32 v105, s84, v105
 v_mfma_f32_16x16x32_bf16 v[120:123], v[216:219], a[232:235], v[120:123]
 s_xor_b32 m0, s88, 3072
 v_mul_f32 v106, s84, v106
 v_mul_f32 v107, s84, v107
 v_mfma_f32_16x16x32_bf16 v[120:123], v[220:223], a[236:239], v[120:123]
 s_xor_b32 s66, s63, 1212416
 v_cvt_pk_bf16_f32 v186, v104, v105
 v_cvt_pk_bf16_f32 v187, v106, v107
 v_mfma_f32_16x16x32_bf16 v[124:127], v[208:211], a[240:243], v[124:127]
 buffer_load_dwordx4 v2, s[32:35], s66 offen lds
 v_mfma_f32_16x16x32_bf16 v[124:127], v[212:215], a[244:247], v[124:127]
 v_mul_f32 v92, s84, v92
 v_mul_f32 v93, s84, v93
 v_mfma_f32_16x16x32_bf16 v[124:127], v[216:219], a[248:251], v[124:127]
 s_add_u32 s67, s99, 3153920
 v_mul_f32 v94, s84, v94
 v_mul_f32 v95, s84, v95
 v_mfma_f32_16x16x32_bf16 v[124:127], v[220:223], a[252:255], v[124:127]
 s_waitcnt vmcnt(6) lgkmcnt(0)
 s_barrier
 v_mfma_f32_16x16x32_bf16 v[128:131], v[224:227], a[192:195], v[128:131]
 ds_read_b64_tr_b16 v[208:209], v12 offset:0
 v_cvt_pk_bf16_f32 v188, v92, v93
 v_mfma_f32_16x16x32_bf16 v[128:131], v[228:231], a[196:199], v[128:131]
 ds_read_b64_tr_b16 v[210:211], v12 offset:1024
 v_cvt_pk_bf16_f32 v189, v94, v95
 v_mfma_f32_16x16x32_bf16 v[128:131], v[232:235], a[200:203], v[128:131]
 ds_read_b64_tr_b16 v[212:213], v12 offset:4096
 v_mul_f32 v108, s84, v108
 v_mfma_f32_16x16x32_bf16 v[128:131], v[236:239], a[204:207], v[128:131]
 buffer_store_dwordx4 v[152:155], v1, s[40:43], s67 offen offset:0 sc1
 v_mul_f32 v109, s84, v109
 v_mul_f32 v110, s84, v110
 v_mul_f32 v111, s84, v111
 v_mfma_f32_16x16x32_bf16 v[132:135], v[224:227], a[208:211], v[132:135]
 ds_read_b64_tr_b16 v[214:215], v12 offset:5120
 v_cvt_pk_bf16_f32 v190, v108, v109
 v_mfma_f32_16x16x32_bf16 v[132:135], v[228:231], a[212:215], v[132:135]
 s_xor_b32 m0, s88, 4096
 ds_read_b64_tr_b16 v[216:217], v12 offset:8192
 v_cvt_pk_bf16_f32 v191, v110, v111
 v_mfma_f32_16x16x32_bf16 v[132:135], v[232:235], a[216:219], v[132:135]
 s_xor_b32 s68, s63, 1310720
 ds_read_b64_tr_b16 v[218:219], v12 offset:9216
 v_mul_f32 v112, s84, v112
 v_mfma_f32_16x16x32_bf16 v[132:135], v[236:239], a[220:223], v[132:135]
 buffer_load_dwordx4 v2, s[32:35], s68 offen lds
 v_mfma_f32_16x16x32_bf16 v[136:139], v[224:227], a[224:227], v[136:139]
 ds_read_b64_tr_b16 v[220:221], v12 offset:12288
 v_mul_f32 v113, s84, v113
 v_mfma_f32_16x16x32_bf16 v[136:139], v[228:231], a[228:231], v[136:139]
 ds_read_b64_tr_b16 v[222:223], v12 offset:13312
 v_mul_f32 v114, s84, v114
 v_mfma_f32_16x16x32_bf16 v[136:139], v[232:235], a[232:235], v[136:139]
 v_mul_f32 v115, s84, v115
 v_cvt_pk_bf16_f32 v192, v112, v113
 v_mfma_f32_16x16x32_bf16 v[136:139], v[236:239], a[236:239], v[136:139]
 v_cvt_pk_bf16_f32 v193, v114, v115
 v_mul_f32 v128, s84, v128
 v_mfma_f32_16x16x32_bf16 v[140:143], v[224:227], a[240:243], v[140:143]
 v_mul_f32 v129, s84, v129
 v_mul_f32 v130, s84, v130
 v_mfma_f32_16x16x32_bf16 v[140:143], v[228:231], a[244:247], v[140:143]
 s_xor_b32 m0, s88, 5120
 v_mul_f32 v131, s84, v131
 v_cvt_pk_bf16_f32 v194, v128, v129
 v_mfma_f32_16x16x32_bf16 v[140:143], v[232:235], a[248:251], v[140:143]
 s_xor_b32 s65, s63, 1343488
 v_cvt_pk_bf16_f32 v195, v130, v131
 v_mul_f32 v116, s84, v116
 v_mfma_f32_16x16x32_bf16 v[140:143], v[236:239], a[252:255], v[140:143]
 s_waitcnt lgkmcnt(0)
 v_mul_f32 v117, s84, v117
 v_mul_f32 v118, s84, v118
 v_mfma_f32_16x16x32_bf16 v[16:19], a[0:3], v[208:211], 0
 ds_read_b64_tr_b16 v[224:225], v13 offset:0
 v_mul_f32 v119, s84, v119
 v_mfma_f32_16x16x32_bf16 v[16:19], a[4:7], v[212:215], v[16:19]
 ds_read_b64_tr_b16 v[226:227], v13 offset:1024
 v_cvt_pk_bf16_f32 v196, v116, v117
 v_mfma_f32_16x16x32_bf16 v[16:19], a[8:11], v[216:219], v[16:19]
 ds_read_b64_tr_b16 v[228:229], v13 offset:4096
 v_cvt_pk_bf16_f32 v197, v118, v119
 v_mfma_f32_16x16x32_bf16 v[16:19], a[12:15], v[220:223], v[16:19]
 buffer_load_dwordx4 v2, s[32:35], s65 offen lds
 v_mfma_f32_16x16x32_bf16 v[20:23], a[16:19], v[208:211], 0
 ds_read_b64_tr_b16 v[230:231], v13 offset:5120
 v_mul_f32 v132, s84, v132
 v_mfma_f32_16x16x32_bf16 v[20:23], a[20:23], v[212:215], v[20:23]
 ds_read_b64_tr_b16 v[232:233], v13 offset:8192
 v_mul_f32 v133, s84, v133
 v_mfma_f32_16x16x32_bf16 v[20:23], a[24:27], v[216:219], v[20:23]
 s_add_u32 s66, s99, 3158016
 ds_read_b64_tr_b16 v[234:235], v13 offset:9216
 v_mul_f32 v134, s84, v134
 v_mfma_f32_16x16x32_bf16 v[20:23], a[28:31], v[220:223], v[20:23]
 buffer_store_dwordx4 v[156:159], v1, s[40:43], s66 offen offset:0 sc1
 v_mul_f32 v135, s84, v135
 v_cvt_pk_bf16_f32 v198, v132, v133
 v_cvt_pk_bf16_f32 v199, v134, v135
 v_mfma_f32_16x16x32_bf16 v[24:27], a[32:35], v[208:211], 0
 s_xor_b32 m0, s88, 6144
 ds_read_b64_tr_b16 v[236:237], v13 offset:12288
 v_mul_f32 v120, s84, v120
 v_mfma_f32_16x16x32_bf16 v[24:27], a[36:39], v[212:215], v[24:27]
 s_xor_b32 s67, s63, 1441792
 ds_read_b64_tr_b16 v[238:239], v13 offset:13312
 v_mul_f32 v121, s84, v121
 v_mfma_f32_16x16x32_bf16 v[24:27], a[40:43], v[216:219], v[24:27]
 buffer_load_dwordx4 v2, s[32:35], s67 offen lds
 v_mfma_f32_16x16x32_bf16 v[24:27], a[44:47], v[220:223], v[24:27]
 v_mul_f32 v122, s84, v122
 v_mul_f32 v123, s84, v123
 v_mfma_f32_16x16x32_bf16 v[28:31], a[48:51], v[208:211], 0
 v_cvt_pk_bf16_f32 v200, v120, v121
 v_cvt_pk_bf16_f32 v201, v122, v123
 v_mfma_f32_16x16x32_bf16 v[28:31], a[52:55], v[212:215], v[28:31]
 v_mul_f32 v136, s84, v136
 v_mul_f32 v137, s84, v137
 v_mfma_f32_16x16x32_bf16 v[28:31], a[56:59], v[216:219], v[28:31]
 v_mul_f32 v138, s84, v138
 v_mul_f32 v139, s84, v139
 v_mfma_f32_16x16x32_bf16 v[28:31], a[60:63], v[220:223], v[28:31]
 s_waitcnt lgkmcnt(0)
 v_cvt_pk_bf16_f32 v202, v136, v137
 v_cvt_pk_bf16_f32 v203, v138, v139
 v_mfma_f32_16x16x32_bf16 v[32:35], a[0:3], v[224:227], 0
 ds_read_b64_tr_b16 v[208:209], v14 offset:0
 v_bfe_u32 v252, v1, 8, 1
 v_mfma_f32_16x16x32_bf16 v[32:35], a[4:7], v[228:231], v[32:35]
 ds_read_b64_tr_b16 v[210:211], v14 offset:1024
 v_mul_u32_u24 v252, 15, v252
 v_mfma_f32_16x16x32_bf16 v[32:35], a[8:11], v[232:235], v[32:35]
 ds_read_b64_tr_b16 v[212:213], v14 offset:4096
 v_xor_b32 v252, s62, v252
 v_mfma_f32_16x16x32_bf16 v[32:35], a[12:15], v[236:239], v[32:35]
 s_add_u32 s68, s98, 3145728
 v_lshlrev_b32 v252, 7, v252
 v_bfe_u32 v253, v1, 2, 6
 v_mfma_f32_16x16x32_bf16 v[36:39], a[16:19], v[224:227], 0
 ds_read_b64_tr_b16 v[214:215], v14 offset:5120
 v_add_u32 v252, v252, v253
 v_mfma_f32_16x16x32_bf16 v[36:39], a[20:23], v[228:231], v[36:39]
 ds_read_b64_tr_b16 v[216:217], v14 offset:8192
 v_add_u32 v252, 69215232, v252
 v_mfma_f32_16x16x32_bf16 v[36:39], a[24:27], v[232:235], v[36:39]
 ds_read_b64_tr_b16 v[218:219], v14 offset:9216
 v_mul_f32 v124, s84, v124
 v_mfma_f32_16x16x32_bf16 v[36:39], a[28:31], v[236:239], v[36:39]
 buffer_store_dwordx4 v[160:163], v1, s[40:43], s68 offen offset:1024 sc1
 v_mul_f32 v125, s84, v125
 v_mul_f32 v126, s84, v126
 v_mul_f32 v127, s84, v127
 v_mfma_f32_16x16x32_bf16 v[40:43], a[32:35], v[224:227], 0
 s_xor_b32 m0, s88, 7168
 ds_read_b64_tr_b16 v[220:221], v14 offset:12288
 v_cvt_pk_bf16_f32 v204, v124, v125
 v_mfma_f32_16x16x32_bf16 v[40:43], a[36:39], v[228:231], v[40:43]
 s_xor_b32 s65, s63, 1474560
 ds_read_b64_tr_b16 v[222:223], v14 offset:13312
 v_cvt_pk_bf16_f32 v205, v126, v127
 v_mfma_f32_16x16x32_bf16 v[40:43], a[40:43], v[232:235], v[40:43]
 buffer_load_dwordx4 v2, s[32:35], s65 offen lds
 v_mfma_f32_16x16x32_bf16 v[40:43], a[44:47], v[236:239], v[40:43]
 v_mul_f32 v140, s84, v140
 v_mul_f32 v141, s84, v141
 v_mfma_f32_16x16x32_bf16 v[44:47], a[48:51], v[224:227], 0
 v_mul_f32 v142, s84, v142
 v_mul_f32 v143, s84, v143
 v_mfma_f32_16x16x32_bf16 v[44:47], a[52:55], v[228:231], v[44:47]
 s_xor_b32 m0, s88, 32768
 v_cvt_pk_bf16_f32 v206, v140, v141
 v_cvt_pk_bf16_f32 v207, v142, v143
 v_mfma_f32_16x16x32_bf16 v[44:47], a[56:59], v[232:235], v[44:47]
 s_xor_b32 s66, s63, 2097152
 v_mfma_f32_16x16x32_bf16 v[44:47], a[60:63], v[236:239], v[44:47]
 s_waitcnt lgkmcnt(0)
 v_mfma_f32_16x16x32_bf16 v[48:51], a[0:3], v[208:211], 0
 ds_read_b64_tr_b16 v[224:225], v15 offset:0
 v_mfma_f32_16x16x32_bf16 v[48:51], a[4:7], v[212:215], v[48:51]
 ds_read_b64_tr_b16 v[226:227], v15 offset:1024
 v_mfma_f32_16x16x32_bf16 v[48:51], a[8:11], v[216:219], v[48:51]
 ds_read_b64_tr_b16 v[228:229], v15 offset:4096
 v_mfma_f32_16x16x32_bf16 v[48:51], a[12:15], v[220:223], v[48:51]
 buffer_load_dwordx4 v2, s[32:35], s66 offen lds
 v_mfma_f32_16x16x32_bf16 v[52:55], a[16:19], v[208:211], 0
 ds_read_b64_tr_b16 v[230:231], v15 offset:5120
 v_mfma_f32_16x16x32_bf16 v[52:55], a[20:23], v[212:215], v[52:55]
 ds_read_b64_tr_b16 v[232:233], v15 offset:8192
 v_mfma_f32_16x16x32_bf16 v[52:55], a[24:27], v[216:219], v[52:55]
 s_add_u32 s67, s98, 3149824
 ds_read_b64_tr_b16 v[234:235], v15 offset:9216
 v_mfma_f32_16x16x32_bf16 v[52:55], a[28:31], v[220:223], v[52:55]
 buffer_store_dwordx4 v[164:167], v1, s[40:43], s67 offen offset:1024 sc1
 v_mfma_f32_16x16x32_bf16 v[56:59], a[32:35], v[208:211], 0
 s_xor_b32 m0, s88, 33792
 ds_read_b64_tr_b16 v[236:237], v15 offset:12288
 v_mfma_f32_16x16x32_bf16 v[56:59], a[36:39], v[212:215], v[56:59]
 s_xor_b32 s68, s63, 2129920
 ds_read_b64_tr_b16 v[238:239], v15 offset:13312
 v_mfma_f32_16x16x32_bf16 v[56:59], a[40:43], v[216:219], v[56:59]
 buffer_load_dwordx4 v2, s[32:35], s68 offen lds
 v_mfma_f32_16x16x32_bf16 v[56:59], a[44:47], v[220:223], v[56:59]
 v_mfma_f32_16x16x32_bf16 v[60:63], a[48:51], v[208:211], 0
 v_mfma_f32_16x16x32_bf16 v[60:63], a[52:55], v[212:215], v[60:63]
 v_mfma_f32_16x16x32_bf16 v[60:63], a[56:59], v[216:219], v[60:63]
 v_mfma_f32_16x16x32_bf16 v[60:63], a[60:63], v[220:223], v[60:63]
 s_waitcnt vmcnt(36) lgkmcnt(0)
 v_mfma_f32_16x16x32_bf16 v[64:67], a[0:3], v[224:227], 0
 s_mul_i32 s86, s89, 2560
 ds_read_b64_tr_b16 v[208:209], v12 offset:16384
 s_and_b32 s86, s86, 3072
 v_mfma_f32_16x16x32_bf16 v[64:67], a[4:7], v[228:231], v[64:67]
 ds_read_b64_tr_b16 v[210:211], v12 offset:17408
 v_xor_b32 v4, s86, v1
 v_mfma_f32_16x16x32_bf16 v[64:67], a[8:11], v[232:235], v[64:67]
 ds_read_b64_tr_b16 v[212:213], v12 offset:20480
 v_xor_b32 v5, 1024, v4
 v_mfma_f32_16x16x32_bf16 v[64:67], a[12:15], v[236:239], v[64:67]
 s_add_u32 s65, s99, 3153920
 v_xor_b32 v6, 2048, v4
 v_xor_b32 v7, 3072, v4
 v_mfma_f32_16x16x32_bf16 v[68:71], a[16:19], v[224:227], 0
 ds_read_b64_tr_b16 v[214:215], v12 offset:21504
 v_mfma_f32_16x16x32_bf16 v[68:71], a[20:23], v[228:231], v[68:71]
 ds_read_b64_tr_b16 v[216:217], v12 offset:24576
 v_mfma_f32_16x16x32_bf16 v[68:71], a[24:27], v[232:235], v[68:71]
 ds_read_b64_tr_b16 v[218:219], v12 offset:25600
 v_mfma_f32_16x16x32_bf16 v[68:71], a[28:31], v[236:239], v[68:71]
 buffer_store_dwordx4 v[168:171], v1, s[40:43], s65 offen offset:1024 sc1
 v_mfma_f32_16x16x32_bf16 v[72:75], a[32:35], v[224:227], 0
 s_xor_b32 m0, s88, 34816
 ds_read_b64_tr_b16 v[220:221], v12 offset:28672
 v_mfma_f32_16x16x32_bf16 v[72:75], a[36:39], v[228:231], v[72:75]
 s_xor_b32 s66, s63, 2228224
 ds_read_b64_tr_b16 v[222:223], v12 offset:29696
 v_mfma_f32_16x16x32_bf16 v[72:75], a[40:43], v[232:235], v[72:75]
 buffer_load_dwordx4 v2, s[32:35], s66 offen lds
 v_mfma_f32_16x16x32_bf16 v[72:75], a[44:47], v[236:239], v[72:75]
 s_xor_b32 m0, s88, 35840
 v_mfma_f32_16x16x32_bf16 v[76:79], a[48:51], v[224:227], 0
 s_xor_b32 s67, s63, 2260992
 v_mfma_f32_16x16x32_bf16 v[76:79], a[52:55], v[228:231], v[76:79]
 buffer_load_dwordx4 v2, s[32:35], s67 offen lds
 v_mfma_f32_16x16x32_bf16 v[76:79], a[56:59], v[232:235], v[76:79]
 s_add_u32 s68, s99, 3158016
 v_mfma_f32_16x16x32_bf16 v[76:79], a[60:63], v[236:239], v[76:79]
 s_waitcnt lgkmcnt(0)
 v_mfma_f32_16x16x32_bf16 v[80:83], a[0:3], v[208:211], 0
 ds_read_b64_tr_b16 v[224:225], v13 offset:16384
 v_mfma_f32_16x16x32_bf16 v[80:83], a[4:7], v[212:215], v[80:83]
 ds_read_b64_tr_b16 v[226:227], v13 offset:17408
 v_mfma_f32_16x16x32_bf16 v[80:83], a[8:11], v[216:219], v[80:83]
 ds_read_b64_tr_b16 v[228:229], v13 offset:20480
 v_mfma_f32_16x16x32_bf16 v[80:83], a[12:15], v[220:223], v[80:83]
 buffer_store_dwordx4 v[172:175], v1, s[40:43], s68 offen offset:1024 sc1
 v_mfma_f32_16x16x32_bf16 v[84:87], a[16:19], v[208:211], 0
 ds_read_b64_tr_b16 v[230:231], v13 offset:21504
 v_mfma_f32_16x16x32_bf16 v[84:87], a[20:23], v[212:215], v[84:87]
 s_xor_b32 m0, s88, 36864
 ds_read_b64_tr_b16 v[232:233], v13 offset:24576
 v_mfma_f32_16x16x32_bf16 v[84:87], a[24:27], v[216:219], v[84:87]
 s_xor_b32 s65, s63, 2359296
 ds_read_b64_tr_b16 v[234:235], v13 offset:25600
 v_mfma_f32_16x16x32_bf16 v[84:87], a[28:31], v[220:223], v[84:87]
 buffer_load_dwordx4 v2, s[32:35], s65 offen lds
 v_mfma_f32_16x16x32_bf16 v[88:91], a[32:35], v[208:211], 0
 ds_read_b64_tr_b16 v[236:237], v13 offset:28672
 v_mfma_f32_16x16x32_bf16 v[88:91], a[36:39], v[212:215], v[88:91]
 ds_read_b64_tr_b16 v[238:239], v13 offset:29696
 v_mfma_f32_16x16x32_bf16 v[88:91], a[40:43], v[216:219], v[88:91]
 v_mfma_f32_16x16x32_bf16 v[88:91], a[44:47], v[220:223], v[88:91]
 v_mfma_f32_16x16x32_bf16 v[92:95], a[48:51], v[208:211], 0
 v_mfma_f32_16x16x32_bf16 v[92:95], a[52:55], v[212:215], v[92:95]
 s_xor_b32 m0, s88, 37888
 v_mfma_f32_16x16x32_bf16 v[92:95], a[56:59], v[216:219], v[92:95]
 s_xor_b32 s66, s63, 2392064
 v_mfma_f32_16x16x32_bf16 v[92:95], a[60:63], v[220:223], v[92:95]
 s_waitcnt lgkmcnt(0)
 v_mfma_f32_16x16x32_bf16 v[96:99], a[0:3], v[224:227], 0
 ds_read_b64_tr_b16 v[208:209], v14 offset:16384
 v_mfma_f32_16x16x32_bf16 v[96:99], a[4:7], v[228:231], v[96:99]
 ds_read_b64_tr_b16 v[210:211], v14 offset:17408
 v_mfma_f32_16x16x32_bf16 v[96:99], a[8:11], v[232:235], v[96:99]
 ds_read_b64_tr_b16 v[212:213], v14 offset:20480
 v_mfma_f32_16x16x32_bf16 v[96:99], a[12:15], v[236:239], v[96:99]
 buffer_load_dwordx4 v2, s[32:35], s66 offen lds
 v_mfma_f32_16x16x32_bf16 v[100:103], a[16:19], v[224:227], 0
 ds_read_b64_tr_b16 v[214:215], v14 offset:21504
 v_mfma_f32_16x16x32_bf16 v[100:103], a[20:23], v[228:231], v[100:103]
 ds_read_b64_tr_b16 v[216:217], v14 offset:24576
 v_mfma_f32_16x16x32_bf16 v[100:103], a[24:27], v[232:235], v[100:103]
 s_add_u32 s67, s98, 3145728
 ds_read_b64_tr_b16 v[218:219], v14 offset:25600
 v_mfma_f32_16x16x32_bf16 v[100:103], a[28:31], v[236:239], v[100:103]
 buffer_store_dwordx4 v[176:179], v1, s[40:43], s67 offen offset:2048 sc1
 v_mfma_f32_16x16x32_bf16 v[104:107], a[32:35], v[224:227], 0
 s_xor_b32 m0, s88, 38912
 ds_read_b64_tr_b16 v[220:221], v14 offset:28672
 v_mfma_f32_16x16x32_bf16 v[104:107], a[36:39], v[228:231], v[104:107]
 s_xor_b32 s68, s63, 2490368
 ds_read_b64_tr_b16 v[222:223], v14 offset:29696
 v_mfma_f32_16x16x32_bf16 v[104:107], a[40:43], v[232:235], v[104:107]
 buffer_load_dwordx4 v2, s[32:35], s68 offen lds
 v_mfma_f32_16x16x32_bf16 v[104:107], a[44:47], v[236:239], v[104:107]
 v_mfma_f32_16x16x32_bf16 v[108:111], a[48:51], v[224:227], 0
 v_mfma_f32_16x16x32_bf16 v[108:111], a[52:55], v[228:231], v[108:111]
 v_mfma_f32_16x16x32_bf16 v[108:111], a[56:59], v[232:235], v[108:111]
 s_add_u32 s65, s98, 3149824
 v_mfma_f32_16x16x32_bf16 v[108:111], a[60:63], v[236:239], v[108:111]
 s_waitcnt lgkmcnt(0)
 v_mfma_f32_16x16x32_bf16 v[112:115], a[0:3], v[208:211], 0
 ds_read_b64_tr_b16 v[224:225], v15 offset:16384
 v_mfma_f32_16x16x32_bf16 v[112:115], a[4:7], v[212:215], v[112:115]
 ds_read_b64_tr_b16 v[226:227], v15 offset:17408
 v_mfma_f32_16x16x32_bf16 v[112:115], a[8:11], v[216:219], v[112:115]
 ds_read_b64_tr_b16 v[228:229], v15 offset:20480
 v_mfma_f32_16x16x32_bf16 v[112:115], a[12:15], v[220:223], v[112:115]
 buffer_store_dwordx4 v[180:183], v1, s[40:43], s65 offen offset:2048 sc1
 v_mfma_f32_16x16x32_bf16 v[116:119], a[16:19], v[208:211], 0
 ds_read_b64_tr_b16 v[230:231], v15 offset:21504
 v_mfma_f32_16x16x32_bf16 v[116:119], a[20:23], v[212:215], v[116:119]
 s_xor_b32 m0, s88, 39936
 ds_read_b64_tr_b16 v[232:233], v15 offset:24576
 v_mfma_f32_16x16x32_bf16 v[116:119], a[24:27], v[216:219], v[116:119]
 s_xor_b32 s66, s63, 2523136
 ds_read_b64_tr_b16 v[234:235], v15 offset:25600
 v_mfma_f32_16x16x32_bf16 v[116:119], a[28:31], v[220:223], v[116:119]
 buffer_load_dwordx4 v2, s[32:35], s66 offen lds
 v_mfma_f32_16x16x32_bf16 v[120:123], a[32:35], v[208:211], 0
 ds_read_b64_tr_b16 v[236:237], v15 offset:28672
 v_mfma_f32_16x16x32_bf16 v[120:123], a[36:39], v[212:215], v[120:123]
 ds_read_b64_tr_b16 v[238:239], v15 offset:29696
 v_mfma_f32_16x16x32_bf16 v[120:123], a[40:43], v[216:219], v[120:123]
 v_mfma_f32_16x16x32_bf16 v[120:123], a[44:47], v[220:223], v[120:123]
 v_mfma_f32_16x16x32_bf16 v[124:127], a[48:51], v[208:211], 0
 v_mfma_f32_16x16x32_bf16 v[124:127], a[52:55], v[212:215], v[124:127]
 s_xor_b32 m0, s88, 131072
 v_mfma_f32_16x16x32_bf16 v[124:127], a[56:59], v[216:219], v[124:127]
 s_xor_b32 s67, s63, 3145728
 v_mfma_f32_16x16x32_bf16 v[124:127], a[60:63], v[220:223], v[124:127]
 s_waitcnt vmcnt(13) lgkmcnt(0)
 s_barrier
 v_mfma_f32_16x16x32_bf16 v[128:131], a[0:3], v[224:227], 0
 ds_read_b64_tr_b16 v[208:209], v8 offset:0
 v_mfma_f32_16x16x32_bf16 v[128:131], a[4:7], v[228:231], v[128:131]
 ds_read_b64_tr_b16 v[210:211], v8 offset:1024
 v_mfma_f32_16x16x32_bf16 v[128:131], a[8:11], v[232:235], v[128:131]
 ds_read_b64_tr_b16 v[212:213], v8 offset:4096
 v_mfma_f32_16x16x32_bf16 v[128:131], a[12:15], v[236:239], v[128:131]
 buffer_load_dwordx4 v2, s[32:35], s67 offen lds
 v_mfma_f32_16x16x32_bf16 v[132:135], a[16:19], v[224:227], 0
 ds_read_b64_tr_b16 v[214:215], v8 offset:5120
 v_mfma_f32_16x16x32_bf16 v[132:135], a[20:23], v[228:231], v[132:135]
 ds_read_b64_tr_b16 v[216:217], v8 offset:8192
 v_mfma_f32_16x16x32_bf16 v[132:135], a[24:27], v[232:235], v[132:135]
 s_add_u32 s68, s99, 3153920
 ds_read_b64_tr_b16 v[218:219], v8 offset:9216
 v_mfma_f32_16x16x32_bf16 v[132:135], a[28:31], v[236:239], v[132:135]
 buffer_store_dwordx4 v[184:187], v1, s[40:43], s68 offen offset:2048 sc1
 v_mfma_f32_16x16x32_bf16 v[136:139], a[32:35], v[224:227], 0
 ds_read_b64_tr_b16 v[220:221], v8 offset:12288
 v_mfma_f32_16x16x32_bf16 v[136:139], a[36:39], v[228:231], v[136:139]
 ds_read_b64_tr_b16 v[222:223], v8 offset:13312
 v_mfma_f32_16x16x32_bf16 v[136:139], a[40:43], v[232:235], v[136:139]
 buffer_load_dword v251, v252, s[40:43], 0 offen sc1
 v_mfma_f32_16x16x32_bf16 v[136:139], a[44:47], v[236:239], v[136:139]
 s_xor_b32 m0, s88, 132096
 v_mfma_f32_16x16x32_bf16 v[140:143], a[48:51], v[224:227], 0
 s_xor_b32 s65, s63, 3178496
 v_mfma_f32_16x16x32_bf16 v[140:143], a[52:55], v[228:231], v[140:143]
 buffer_load_dwordx4 v2, s[32:35], s65 offen lds
 v_mfma_f32_16x16x32_bf16 v[140:143], a[56:59], v[232:235], v[140:143]
 s_add_u32 s66, s99, 3158016
 v_mfma_f32_16x16x32_bf16 v[140:143], a[60:63], v[236:239], v[140:143]
 s_waitcnt lgkmcnt(0)
 v_mfma_f32_16x16x32_bf16 v[16:19], a[64:67], v[208:211], v[16:19]
 ds_read_b64_tr_b16 v[224:225], v9 offset:0
 v_mfma_f32_16x16x32_bf16 v[16:19], a[68:71], v[212:215], v[16:19]
 ds_read_b64_tr_b16 v[226:227], v9 offset:1024
 v_mfma_f32_16x16x32_bf16 v[16:19], a[72:75], v[216:219], v[16:19]
 ds_read_b64_tr_b16 v[228:229], v9 offset:4096
 v_mfma_f32_16x16x32_bf16 v[16:19], a[76:79], v[220:223], v[16:19]
 buffer_store_dwordx4 v[188:191], v1, s[40:43], s66 offen offset:2048 sc1
 v_mfma_f32_16x16x32_bf16 v[20:23], a[80:83], v[208:211], v[20:23]
 ds_read_b64_tr_b16 v[230:231], v9 offset:5120
 v_mfma_f32_16x16x32_bf16 v[20:23], a[84:87], v[212:215], v[20:23]
 s_xor_b32 m0, s88, 133120
 ds_read_b64_tr_b16 v[232:233], v9 offset:8192
 v_mfma_f32_16x16x32_bf16 v[20:23], a[88:91], v[216:219], v[20:23]
 s_xor_b32 s67, s63, 3276800
 ds_read_b64_tr_b16 v[234:235], v9 offset:9216
 v_mfma_f32_16x16x32_bf16 v[20:23], a[92:95], v[220:223], v[20:23]
 buffer_load_dwordx4 v2, s[32:35], s67 offen lds
 v_mfma_f32_16x16x32_bf16 v[24:27], a[96:99], v[208:211], v[24:27]
 ds_read_b64_tr_b16 v[236:237], v9 offset:12288
 v_mfma_f32_16x16x32_bf16 v[24:27], a[100:103], v[212:215], v[24:27]
 ds_read_b64_tr_b16 v[238:239], v9 offset:13312
 v_mfma_f32_16x16x32_bf16 v[24:27], a[104:107], v[216:219], v[24:27]
 v_mfma_f32_16x16x32_bf16 v[24:27], a[108:111], v[220:223], v[24:27]
 v_mfma_f32_16x16x32_bf16 v[28:31], a[112:115], v[208:211], v[28:31]
 v_mfma_f32_16x16x32_bf16 v[28:31], a[116:119], v[212:215], v[28:31]
 v_mfma_f32_16x16x32_bf16 v[28:31], a[120:123], v[216:219], v[28:31]
 s_add_u32 s68, s98, 3145728
 v_mfma_f32_16x16x32_bf16 v[28:31], a[124:127], v[220:223], v[28:31]
 s_waitcnt lgkmcnt(0)
 v_mfma_f32_16x16x32_bf16 v[32:35], a[64:67], v[224:227], v[32:35]
 ds_read_b64_tr_b16 v[208:209], v10 offset:0
 v_mfma_f32_16x16x32_bf16 v[32:35], a[68:71], v[228:231], v[32:35]
 ds_read_b64_tr_b16 v[210:211], v10 offset:1024
 v_mfma_f32_16x16x32_bf16 v[32:35], a[72:75], v[232:235], v[32:35]
 ds_read_b64_tr_b16 v[212:213], v10 offset:4096
 v_mfma_f32_16x16x32_bf16 v[32:35], a[76:79], v[236:239], v[32:35]
 buffer_store_dwordx4 v[192:195], v1, s[40:43], s68 offen offset:3072 sc1
 v_mfma_f32_16x16x32_bf16 v[36:39], a[80:83], v[224:227], v[36:39]
 ds_read_b64_tr_b16 v[214:215], v10 offset:5120
 v_mfma_f32_16x16x32_bf16 v[36:39], a[84:87], v[228:231], v[36:39]
 s_xor_b32 m0, s88, 134144
 ds_read_b64_tr_b16 v[216:217], v10 offset:8192
 v_mfma_f32_16x16x32_bf16 v[36:39], a[88:91], v[232:235], v[36:39]
 s_xor_b32 s65, s63, 3309568
 ds_read_b64_tr_b16 v[218:219], v10 offset:9216
 v_mfma_f32_16x16x32_bf16 v[36:39], a[92:95], v[236:239], v[36:39]
 buffer_load_dwordx4 v2, s[32:35], s65 offen lds
 v_mfma_f32_16x16x32_bf16 v[40:43], a[96:99], v[224:227], v[40:43]
 ds_read_b64_tr_b16 v[220:221], v10 offset:12288
 v_mfma_f32_16x16x32_bf16 v[40:43], a[100:103], v[228:231], v[40:43]
 ds_read_b64_tr_b16 v[222:223], v10 offset:13312
 v_mfma_f32_16x16x32_bf16 v[40:43], a[104:107], v[232:235], v[40:43]
 s_xor_b32 m0, s88, 135168
 v_mfma_f32_16x16x32_bf16 v[40:43], a[108:111], v[236:239], v[40:43]
 s_xor_b32 s66, s63, 3407872
 v_mfma_f32_16x16x32_bf16 v[44:47], a[112:115], v[224:227], v[44:47]
 buffer_load_dwordx4 v2, s[32:35], s66 offen lds
 v_mfma_f32_16x16x32_bf16 v[44:47], a[116:119], v[228:231], v[44:47]
 v_mfma_f32_16x16x32_bf16 v[44:47], a[120:123], v[232:235], v[44:47]
 s_add_u32 s67, s98, 3149824
 v_mfma_f32_16x16x32_bf16 v[44:47], a[124:127], v[236:239], v[44:47]
 s_waitcnt lgkmcnt(0)
 v_mfma_f32_16x16x32_bf16 v[48:51], a[64:67], v[208:211], v[48:51]
 ds_read_b64_tr_b16 v[224:225], v11 offset:0
 v_mfma_f32_16x16x32_bf16 v[48:51], a[68:71], v[212:215], v[48:51]
L_w2_3:
L_st2_3:
 s_cbranch_execz L_st2_7
 ds_read_b64_tr_b16 v[226:227], v11 offset:1024
 v_mfma_f32_16x16x32_bf16 v[48:51], a[72:75], v[216:219], v[48:51]
 ds_read_b64_tr_b16 v[228:229], v11 offset:4096
 v_mfma_f32_16x16x32_bf16 v[48:51], a[76:79], v[220:223], v[48:51]
 buffer_store_dwordx4 v[196:199], v1, s[40:43], s67 offen offset:3072 sc1
 v_mfma_f32_16x16x32_bf16 v[52:55], a[80:83], v[208:211], v[52:55]
 ds_read_b64_tr_b16 v[230:231], v11 offset:5120
 v_mfma_f32_16x16x32_bf16 v[52:55], a[84:87], v[212:215], v[52:55]
 ds_read_b64_tr_b16 v[232:233], v11 offset:8192
 v_mfma_f32_16x16x32_bf16 v[52:55], a[88:91], v[216:219], v[52:55]
 ds_read_b64_tr_b16 v[234:235], v11 offset:9216
 v_mfma_f32_16x16x32_bf16 v[52:55], a[92:95], v[220:223], v[52:55]
 v_mfma_f32_16x16x32_bf16 v[56:59], a[96:99], v[208:211], v[56:59]
 s_xor_b32 m0, s88, 136192
 ds_read_b64_tr_b16 v[236:237], v11 offset:12288
 v_mfma_f32_16x16x32_bf16 v[56:59], a[100:103], v[212:215], v[56:59]
 s_xor_b32 s68, s63, 3440640
 ds_read_b64_tr_b16 v[238:239], v11 offset:13312
 v_mfma_f32_16x16x32_bf16 v[56:59], a[104:107], v[216:219], v[56:59]
 buffer_load_dwordx4 v2, s[32:35], s68 offen lds
 v_mfma_f32_16x16x32_bf16 v[56:59], a[108:111], v[220:223], v[56:59]
 v_mfma_f32_16x16x32_bf16 v[60:63], a[112:115], v[208:211], v[60:63]
 v_mfma_f32_16x16x32_bf16 v[60:63], a[116:119], v[212:215], v[60:63]
 v_mfma_f32_16x16x32_bf16 v[60:63], a[120:123], v[216:219], v[60:63]
 s_add_u32 s65, s99, 3153920
 v_mfma_f32_16x16x32_bf16 v[60:63], a[124:127], v[220:223], v[60:63]
 s_waitcnt vmcnt(36) lgkmcnt(0)
 v_mfma_f32_16x16x32_bf16 v[64:67], a[64:67], v[224:227], v[64:67]
 ds_read_b64_tr_b16 v[208:209], v8 offset:16384
 v_mfma_f32_16x16x32_bf16 v[64:67], a[68:71], v[228:231], v[64:67]
 ds_read_b64_tr_b16 v[210:211], v8 offset:17408
 v_mfma_f32_16x16x32_bf16 v[64:67], a[72:75], v[232:235], v[64:67]
 ds_read_b64_tr_b16 v[212:213], v8 offset:20480
 v_mfma_f32_16x16x32_bf16 v[64:67], a[76:79], v[236:239], v[64:67]
 buffer_store_dwordx4 v[200:203], v1, s[40:43], s65 offen offset:3072 sc1
 v_mfma_f32_16x16x32_bf16 v[68:71], a[80:83], v[224:227], v[68:71]
 ds_read_b64_tr_b16 v[214:215], v8 offset:21504
 v_mfma_f32_16x16x32_bf16 v[68:71], a[84:87], v[228:231], v[68:71]
 s_xor_b32 m0, s88, 137216
 ds_read_b64_tr_b16 v[216:217], v8 offset:24576
 v_mfma_f32_16x16x32_bf16 v[68:71], a[88:91], v[232:235], v[68:71]
 s_xor_b32 s66, s63, 3538944
 ds_read_b64_tr_b16 v[218:219], v8 offset:25600
 v_mfma_f32_16x16x32_bf16 v[68:71], a[92:95], v[236:239], v[68:71]
 buffer_load_dwordx4 v2, s[32:35], s66 offen lds
 v_mfma_f32_16x16x32_bf16 v[72:75], a[96:99], v[224:227], v[72:75]
 ds_read_b64_tr_b16 v[220:221], v8 offset:28672
 v_mfma_f32_16x16x32_bf16 v[72:75], a[100:103], v[228:231], v[72:75]
 ds_read_b64_tr_b16 v[222:223], v8 offset:29696
 v_mfma_f32_16x16x32_bf16 v[72:75], a[104:107], v[232:235], v[72:75]
 v_mfma_f32_16x16x32_bf16 v[72:75], a[108:111], v[236:239], v[72:75]
 v_mfma_f32_16x16x32_bf16 v[76:79], a[112:115], v[224:227], v[76:79]
 s_xor_b32 m0, s88, 138240
 v_mfma_f32_16x16x32_bf16 v[76:79], a[116:119], v[228:231], v[76:79]
 s_xor_b32 s67, s63, 3571712
 v_mfma_f32_16x16x32_bf16 v[76:79], a[120:123], v[232:235], v[76:79]
 buffer_load_dwordx4 v2, s[32:35], s67 offen lds
 v_mfma_f32_16x16x32_bf16 v[76:79], a[124:127], v[236:239], v[76:79]
 s_waitcnt lgkmcnt(0)
 v_mfma_f32_16x16x32_bf16 v[80:83], a[64:67], v[208:211], v[80:83]
 ds_read_b64_tr_b16 v[224:225], v9 offset:16384
 v_mfma_f32_16x16x32_bf16 v[80:83], a[68:71], v[212:215], v[80:83]
 ds_read_b64_tr_b16 v[226:227], v9 offset:17408
 v_mfma_f32_16x16x32_bf16 v[80:83], a[72:75], v[216:219], v[80:83]
 s_add_u32 s68, s99, 3158016
 ds_read_b64_tr_b16 v[228:229], v9 offset:20480
 v_mfma_f32_16x16x32_bf16 v[80:83], a[76:79], v[220:223], v[80:83]
 buffer_store_dwordx4 v[204:207], v1, s[40:43], s68 offen offset:3072 sc1
 v_mfma_f32_16x16x32_bf16 v[84:87], a[80:83], v[208:211], v[84:87]
 ds_read_b64_tr_b16 v[230:231], v9 offset:21504
 v_mfma_f32_16x16x32_bf16 v[84:87], a[84:87], v[212:215], v[84:87]
 ds_read_b64_tr_b16 v[232:233], v9 offset:24576
 v_mfma_f32_16x16x32_bf16 v[84:87], a[88:91], v[216:219], v[84:87]
 ds_read_b64_tr_b16 v[234:235], v9 offset:25600
 v_mfma_f32_16x16x32_bf16 v[84:87], a[92:95], v[220:223], v[84:87]
 v_mfma_f32_16x16x32_bf16 v[88:91], a[96:99], v[208:211], v[88:91]
 ds_read_b64_tr_b16 v[236:237], v9 offset:28672
 v_mfma_f32_16x16x32_bf16 v[88:91], a[100:103], v[212:215], v[88:91]
 ds_read_b64_tr_b16 v[238:239], v9 offset:29696
 v_mfma_f32_16x16x32_bf16 v[88:91], a[104:107], v[216:219], v[88:91]
 v_mfma_f32_16x16x32_bf16 v[88:91], a[108:111], v[220:223], v[88:91]
 v_mfma_f32_16x16x32_bf16 v[92:95], a[112:115], v[208:211], v[92:95]
 s_waitcnt vmcnt(12)
 v_cmp_eq_u32 vcc, 0, v251
 v_mfma_f32_16x16x32_bf16 v[92:95], a[116:119], v[212:215], v[92:95]
 s_cbranch_vccnz L_spin_xn
L_back_xn:
 v_mfma_f32_16x16x32_bf16 v[92:95], a[120:123], v[216:219], v[92:95]
 v_mfma_f32_16x16x32_bf16 v[92:95], a[124:127], v[220:223], v[92:95]
 s_waitcnt lgkmcnt(0)
 v_mfma_f32_16x16x32_bf16 v[96:99], a[64:67], v[224:227], v[96:99]
 ds_read_b64_tr_b16 v[208:209], v10 offset:16384
 v_mfma_f32_16x16x32_bf16 v[96:99], a[68:71], v[228:231], v[96:99]
 ds_read_b64_tr_b16 v[210:211], v10 offset:17408
 v_mfma_f32_16x16x32_bf16 v[96:99], a[72:75], v[232:235], v[96:99]
 ds_read_b64_tr_b16 v[212:213], v10 offset:20480
 v_mfma_f32_16x16x32_bf16 v[96:99], a[76:79], v[236:239], v[96:99]
 buffer_load_dwordx4 a[0:3], v4, s[40:43], s73 offen sc1
 v_mfma_f32_16x16x32_bf16 v[100:103], a[80:83], v[224:227], v[100:103]
 ds_read_b64_tr_b16 v[214:215], v10 offset:21504
 v_mfma_f32_16x16x32_bf16 v[100:103], a[84:87], v[228:231], v[100:103]
 ds_read_b64_tr_b16 v[216:217], v10 offset:24576
 v_mfma_f32_16x16x32_bf16 v[100:103], a[88:91], v[232:235], v[100:103]
 ds_read_b64_tr_b16 v[218:219], v10 offset:25600
 v_mfma_f32_16x16x32_bf16 v[100:103], a[92:95], v[236:239], v[100:103]
 buffer_load_dwordx4 a[16:19], v4, s[40:43], s74 offen sc1
 v_mfma_f32_16x16x32_bf16 v[104:107], a[96:99], v[224:227], v[104:107]
 ds_read_b64_tr_b16 v[220:221], v10 offset:28672
 v_mfma_f32_16x16x32_bf16 v[104:107], a[100:103], v[228:231], v[104:107]
 ds_read_b64_tr_b16 v[222:223], v10 offset:29696
 v_mfma_f32_16x16x32_bf16 v[104:107], a[104:107], v[232:235], v[104:107]
 v_mfma_f32_16x16x32_bf16 v[104:107], a[108:111], v[236:239], v[104:107]
 buffer_load_dwordx4 a[32:35], v4, s[40:43], s75 offen sc1
 v_mfma_f32_16x16x32_bf16 v[108:111], a[112:115], v[224:227], v[108:111]
 v_mfma_f32_16x16x32_bf16 v[108:111], a[116:119], v[228:231], v[108:111]
 v_mfma_f32_16x16x32_bf16 v[108:111], a[120:123], v[232:235], v[108:111]
 v_mfma_f32_16x16x32_bf16 v[108:111], a[124:127], v[236:239], v[108:111]
 s_waitcnt lgkmcnt(0)
 v_mfma_f32_16x16x32_bf16 v[112:115], a[64:67], v[208:211], v[112:115]
 ds_read_b64_tr_b16 v[224:225], v11 offset:16384
 v_mfma_f32_16x16x32_bf16 v[112:115], a[68:71], v[212:215], v[112:115]
 ds_read_b64_tr_b16 v[226:227], v11 offset:17408
 v_mfma_f32_16x16x32_bf16 v[112:115], a[72:75], v[216:219], v[112:115]
 ds_read_b64_tr_b16 v[228:229], v11 offset:20480
 v_mfma_f32_16x16x32_bf16 v[112:115], a[76:79], v[220:223], v[112:115]
 buffer_load_dwordx4 a[48:51], v4, s[40:43], s76 offen sc1
 v_mfma_f32_16x16x32_bf16 v[116:119], a[80:83], v[208:211], v[116:119]
 ds_read_b64_tr_b16 v[230:231], v11 offset:21504
 v_mfma_f32_16x16x32_bf16 v[116:119], a[84:87], v[212:215], v[116:119]
 ds_read_b64_tr_b16 v[232:233], v11 offset:24576
 v_mfma_f32_16x16x32_bf16 v[116:119], a[88:91], v[216:219], v[116:119]
 ds_read_b64_tr_b16 v[234:235], v11 offset:25600
 v_mfma_f32_16x16x32_bf16 v[116:119], a[92:95], v[220:223], v[116:119]
 buffer_load_dwordx4 a[4:7], v5, s[40:43], s73 offen sc1
 v_mfma_f32_16x16x32_bf16 v[120:123], a[96:99], v[208:211], v[120:123]
 ds_read_b64_tr_b16 v[236:237], v11 offset:28672
 v_mfma_f32_16x16x32_bf16 v[120:123], a[100:103], v[212:215], v[120:123]
 ds_read_b64_tr_b16 v[238:239], v11 offset:29696
 v_mfma_f32_16x16x32_bf16 v[120:123], a[104:107], v[216:219], v[120:123]
 v_mfma_f32_16x16x32_bf16 v[120:123], a[108:111], v[220:223], v[120:123]
 v_mfma_f32_16x16x32_bf16 v[124:127], a[112:115], v[208:211], v[124:127]
 buffer_load_dwordx4 a[20:23], v5, s[40:43], s74 offen sc1
 v_mfma_f32_16x16x32_bf16 v[124:127], a[116:119], v[212:215], v[124:127]
 v_mfma_f32_16x16x32_bf16 v[124:127], a[120:123], v[216:219], v[124:127]
 v_mfma_f32_16x16x32_bf16 v[124:127], a[124:127], v[220:223], v[124:127]
 s_waitcnt lgkmcnt(0)
 s_barrier
 v_mfma_f32_16x16x32_bf16 v[128:131], a[64:67], v[224:227], v[128:131]
 ds_read_b64_tr_b16 v[208:209], v8 offset:32768
 v_mfma_f32_16x16x32_bf16 v[128:131], a[68:71], v[228:231], v[128:131]
 ds_read_b64_tr_b16 v[210:211], v8 offset:33792
 v_mfma_f32_16x16x32_bf16 v[128:131], a[72:75], v[232:235], v[128:131]
 ds_read_b64_tr_b16 v[212:213], v8 offset:36864
 v_mfma_f32_16x16x32_bf16 v[128:131], a[76:79], v[236:239], v[128:131]
 buffer_load_dwordx4 a[36:39], v5, s[40:43], s75 offen sc1
 v_mfma_f32_16x16x32_bf16 v[132:135], a[80:83], v[224:227], v[132:135]
 ds_read_b64_tr_b16 v[214:215], v8 offset:37888
 v_mfma_f32_16x16x32_bf16 v[132:135], a[84:87], v[228:231], v[132:135]
 ds_read_b64_tr_b16 v[216:217], v8 offset:40960
 v_mfma_f32_16x16x32_bf16 v[132:135], a[88:91], v[232:235], v[132:135]
 ds_read_b64_tr_b16 v[218:219], v8 offset:41984
 v_mfma_f32_16x16x32_bf16 v[132:135], a[92:95], v[236:239], v[132:135]
 v_mfma_f32_16x16x32_bf16 v[136:139], a[96:99], v[224:227], v[136:139]
 ds_read_b64_tr_b16 v[220:221], v8 offset:45056
 v_mfma_f32_16x16x32_bf16 v[136:139], a[100:103], v[228:231], v[136:139]
 ds_read_b64_tr_b16 v[222:223], v8 offset:46080
 v_mfma_f32_16x16x32_bf16 v[136:139], a[104:107], v[232:235], v[136:139]
 buffer_load_dwordx4 a[52:55], v5, s[40:43], s76 offen sc1
 v_mfma_f32_16x16x32_bf16 v[136:139], a[108:111], v[236:239], v[136:139]
 v_mfma_f32_16x16x32_bf16 v[140:143], a[112:115], v[224:227], v[140:143]
 v_mfma_f32_16x16x32_bf16 v[140:143], a[116:119], v[228:231], v[140:143]
 v_mfma_f32_16x16x32_bf16 v[140:143], a[120:123], v[232:235], v[140:143]
 buffer_load_dwordx4 a[8:11], v6, s[40:43], s73 offen sc1
 v_mfma_f32_16x16x32_bf16 v[140:143], a[124:127], v[236:239], v[140:143]
 s_waitcnt lgkmcnt(0)
 s_mov_b32 s32, s18
 s_mov_b32 s33, s19
 v_mfma_f32_16x16x32_bf16 v[16:19], a[128:131], v[208:211], v[16:19]
 s_min_u32 s34, s46, 1835008
 ds_read_b64_tr_b16 v[224:225], v9 offset:32768
 v_mfma_f32_16x16x32_bf16 v[16:19], a[132:135], v[212:215], v[16:19]
 s_add_u32 m0, s71, 0
 ds_read_b64_tr_b16 v[226:227], v9 offset:33792
 v_mfma_f32_16x16x32_bf16 v[16:19], a[136:139], v[216:219], v[16:19]
 s_add_u32 s65, s64, 0
 ds_read_b64_tr_b16 v[228:229], v9 offset:36864
 v_mfma_f32_16x16x32_bf16 v[16:19], a[140:143], v[220:223], v[16:19]
 buffer_load_dwordx4 v3, s[32:35], s65 offen offset:0 lds
 v_mfma_f32_16x16x32_bf16 v[20:23], a[144:147], v[208:211], v[20:23]
 ds_read_b64_tr_b16 v[230:231], v9 offset:37888
 v_mfma_f32_16x16x32_bf16 v[20:23], a[148:151], v[212:215], v[20:23]
 ds_read_b64_tr_b16 v[232:233], v9 offset:40960
 v_mfma_f32_16x16x32_bf16 v[20:23], a[152:155], v[216:219], v[20:23]
 ds_read_b64_tr_b16 v[234:235], v9 offset:41984
 v_mfma_f32_16x16x32_bf16 v[20:23], a[156:159], v[220:223], v[20:23]
 buffer_load_dwordx4 a[24:27], v6, s[40:43], s74 offen sc1
 v_mfma_f32_16x16x32_bf16 v[24:27], a[160:163], v[208:211], v[24:27]
 ds_read_b64_tr_b16 v[236:237], v9 offset:45056
 v_mfma_f32_16x16x32_bf16 v[24:27], a[164:167], v[212:215], v[24:27]
 ds_read_b64_tr_b16 v[238:239], v9 offset:46080
 v_mfma_f32_16x16x32_bf16 v[24:27], a[168:171], v[216:219], v[24:27]
 buffer_load_dwordx4 a[40:43], v6, s[40:43], s75 offen sc1
 v_mfma_f32_16x16x32_bf16 v[24:27], a[172:175], v[220:223], v[24:27]
 v_mfma_f32_16x16x32_bf16 v[28:31], a[176:179], v[208:211], v[28:31]
 v_mfma_f32_16x16x32_bf16 v[28:31], a[180:183], v[212:215], v[28:31]
 s_add_u32 s66, s64, 13312
 v_mfma_f32_16x16x32_bf16 v[28:31], a[184:187], v[216:219], v[28:31]
 buffer_load_dwordx4 v3, s[32:35], s66 offen offset:1024 lds
 v_mfma_f32_16x16x32_bf16 v[28:31], a[188:191], v[220:223], v[28:31]
 s_waitcnt lgkmcnt(0)
 v_mfma_f32_16x16x32_bf16 v[32:35], a[128:131], v[224:227], v[32:35]
 ds_read_b64_tr_b16 v[208:209], v10 offset:32768
 v_mfma_f32_16x16x32_bf16 v[32:35], a[132:135], v[228:231], v[32:35]
 ds_read_b64_tr_b16 v[210:211], v10 offset:33792
 v_mfma_f32_16x16x32_bf16 v[32:35], a[136:139], v[232:235], v[32:35]
 ds_read_b64_tr_b16 v[212:213], v10 offset:36864
 v_mfma_f32_16x16x32_bf16 v[32:35], a[140:143], v[236:239], v[32:35]
 buffer_load_dwordx4 a[56:59], v6, s[40:43], s76 offen sc1
 v_mfma_f32_16x16x32_bf16 v[36:39], a[144:147], v[224:227], v[36:39]
 ds_read_b64_tr_b16 v[214:215], v10 offset:37888
 v_mfma_f32_16x16x32_bf16 v[36:39], a[148:151], v[228:231], v[36:39]
 ds_read_b64_tr_b16 v[216:217], v10 offset:40960
 v_mfma_f32_16x16x32_bf16 v[36:39], a[152:155], v[232:235], v[36:39]
 ds_read_b64_tr_b16 v[218:219], v10 offset:41984
 v_mfma_f32_16x16x32_bf16 v[36:39], a[156:159], v[236:239], v[36:39]
 buffer_load_dwordx4 a[12:15], v7, s[40:43], s73 offen sc1
 v_mfma_f32_16x16x32_bf16 v[40:43], a[160:163], v[224:227], v[40:43]
 s_add_u32 s73, s73, 4096
 ds_read_b64_tr_b16 v[220:221], v10 offset:45056
 v_mfma_f32_16x16x32_bf16 v[40:43], a[164:167], v[228:231], v[40:43]
 ds_read_b64_tr_b16 v[222:223], v10 offset:46080
 v_mfma_f32_16x16x32_bf16 v[40:43], a[168:171], v[232:235], v[40:43]
 buffer_load_dwordx4 a[28:31], v7, s[40:43], s74 offen sc1
 v_mfma_f32_16x16x32_bf16 v[40:43], a[172:175], v[236:239], v[40:43]
 s_add_u32 s74, s74, 4096
 v_mfma_f32_16x16x32_bf16 v[44:47], a[176:179], v[224:227], v[44:47]
 s_add_u32 s67, s64, 55296
 v_mfma_f32_16x16x32_bf16 v[44:47], a[180:183], v[228:231], v[44:47]
 buffer_load_dwordx4 v3, s[32:35], s67 offen offset:2048 lds
 v_mfma_f32_16x16x32_bf16 v[44:47], a[184:187], v[232:235], v[44:47]
 v_mfma_f32_16x16x32_bf16 v[44:47], a[188:191], v[236:239], v[44:47]
 s_waitcnt lgkmcnt(0)
 v_mfma_f32_16x16x32_bf16 v[48:51], a[128:131], v[208:211], v[48:51]
 ds_read_b64_tr_b16 v[224:225], v11 offset:32768
 v_mfma_f32_16x16x32_bf16 v[48:51], a[132:135], v[212:215], v[48:51]
 ds_read_b64_tr_b16 v[226:227], v11 offset:33792
 v_mfma_f32_16x16x32_bf16 v[48:51], a[136:139], v[216:219], v[48:51]
 ds_read_b64_tr_b16 v[228:229], v11 offset:36864
 v_mfma_f32_16x16x32_bf16 v[48:51], a[140:143], v[220:223], v[48:51]
 buffer_load_dwordx4 a[44:47], v7, s[40:43], s75 offen sc1
 v_mfma_f32_16x16x32_bf16 v[52:55], a[144:147], v[208:211], v[52:55]
 s_add_u32 s75, s75, 4096
 ds_read_b64_tr_b16 v[230:231], v11 offset:37888
 v_mfma_f32_16x16x32_bf16 v[52:55], a[148:151], v[212:215], v[52:55]
 ds_read_b64_tr_b16 v[232:233], v11 offset:40960
 v_mfma_f32_16x16x32_bf16 v[52:55], a[152:155], v[216:219], v[52:55]
 ds_read_b64_tr_b16 v[234:235], v11 offset:41984
 v_mfma_f32_16x16x32_bf16 v[52:55], a[156:159], v[220:223], v[52:55]
 buffer_load_dwordx4 a[60:63], v7, s[40:43], s76 offen sc1
 v_mfma_f32_16x16x32_bf16 v[56:59], a[160:163], v[208:211], v[56:59]
 s_add_u32 s76, s76, 4096
 ds_read_b64_tr_b16 v[236:237], v11 offset:45056
 v_mfma_f32_16x16x32_bf16 v[56:59], a[164:167], v[212:215], v[56:59]
 ds_read_b64_tr_b16 v[238:239], v11 offset:46080
 v_mfma_f32_16x16x32_bf16 v[56:59], a[168:171], v[216:219], v[56:59]
 s_add_u32 s68, s64, 68608
 v_mfma_f32_16x16x32_bf16 v[56:59], a[172:175], v[220:223], v[56:59]
 buffer_load_dwordx4 v3, s[32:35], s68 offen offset:3072 lds
 v_mfma_f32_16x16x32_bf16 v[60:63], a[176:179], v[208:211], v[60:63]
 v_mfma_f32_16x16x32_bf16 v[60:63], a[180:183], v[212:215], v[60:63]
 v_mfma_f32_16x16x32_bf16 v[60:63], a[184:187], v[216:219], v[60:63]
 buffer_load_dwordx4 a[64:67], v4, s[40:43], s73 offen sc1
 v_mfma_f32_16x16x32_bf16 v[60:63], a[188:191], v[220:223], v[60:63]
 s_waitcnt vmcnt(36) lgkmcnt(0)
 v_mfma_f32_16x16x32_bf16 v[64:67], a[128:131], v[224:227], v[64:67]
 ds_read_b64_tr_b16 v[208:209], v8 offset:49152
 v_mfma_f32_16x16x32_bf16 v[64:67], a[132:135], v[228:231], v[64:67]
 ds_read_b64_tr_b16 v[210:211], v8 offset:50176
 v_mfma_f32_16x16x32_bf16 v[64:67], a[136:139], v[232:235], v[64:67]
 ds_read_b64_tr_b16 v[212:213], v8 offset:53248
 v_mfma_f32_16x16x32_bf16 v[64:67], a[140:143], v[236:239], v[64:67]
 buffer_load_dwordx4 a[80:83], v4, s[40:43], s74 offen sc1
 v_mfma_f32_16x16x32_bf16 v[68:71], a[144:147], v[224:227], v[68:71]
 ds_read_b64_tr_b16 v[214:215], v8 offset:54272
 v_mfma_f32_16x16x32_bf16 v[68:71], a[148:151], v[228:231], v[68:71]
 ds_read_b64_tr_b16 v[216:217], v8 offset:57344
 v_mfma_f32_16x16x32_bf16 v[68:71], a[152:155], v[232:235], v[68:71]
 ds_read_b64_tr_b16 v[218:219], v8 offset:58368
 v_mfma_f32_16x16x32_bf16 v[68:71], a[156:159], v[236:239], v[68:71]
 buffer_load_dwordx4 a[96:99], v4, s[40:43], s75 offen sc1
 v_mfma_f32_16x16x32_bf16 v[72:75], a[160:163], v[224:227], v[72:75]
 s_add_u32 m0, s71, 4096
 ds_read_b64_tr_b16 v[220:221], v8 offset:61440
 v_mfma_f32_16x16x32_bf16 v[72:75], a[164:167], v[228:231], v[72:75]
 s_add_u32 s65, s31, 0
 ds_read_b64_tr_b16 v[222:223], v8 offset:62464
 v_mfma_f32_16x16x32_bf16 v[72:75], a[168:171], v[232:235], v[72:75]
 buffer_load_dwordx4 v3, s[32:35], s65 offen offset:0 lds
 v_mfma_f32_16x16x32_bf16 v[72:75], a[172:175], v[236:239], v[72:75]
 v_mfma_f32_16x16x32_bf16 v[76:79], a[176:179], v[224:227], v[76:79]
 v_mfma_f32_16x16x32_bf16 v[76:79], a[180:183], v[228:231], v[76:79]
 v_mfma_f32_16x16x32_bf16 v[76:79], a[184:187], v[232:235], v[76:79]
 buffer_load_dwordx4 a[112:115], v4, s[40:43], s76 offen sc1
 v_mfma_f32_16x16x32_bf16 v[76:79], a[188:191], v[236:239], v[76:79]
 s_waitcnt lgkmcnt(0)
 v_mfma_f32_16x16x32_bf16 v[80:83], a[128:131], v[208:211], v[80:83]
 ds_read_b64_tr_b16 v[224:225], v9 offset:49152
 v_mfma_f32_16x16x32_bf16 v[80:83], a[132:135], v[212:215], v[80:83]
 ds_read_b64_tr_b16 v[226:227], v9 offset:50176
 v_mfma_f32_16x16x32_bf16 v[80:83], a[136:139], v[216:219], v[80:83]
 ds_read_b64_tr_b16 v[228:229], v9 offset:53248
 v_mfma_f32_16x16x32_bf16 v[80:83], a[140:143], v[220:223], v[80:83]
 buffer_load_dwordx4 a[68:71], v5, s[40:43], s73 offen sc1
 v_mfma_f32_16x16x32_bf16 v[84:87], a[144:147], v[208:211], v[84:87]
 ds_read_b64_tr_b16 v[230:231], v9 offset:54272
 v_mfma_f32_16x16x32_bf16 v[84:87], a[148:151], v[212:215], v[84:87]
 ds_read_b64_tr_b16 v[232:233], v9 offset:57344
 v_mfma_f32_16x16x32_bf16 v[84:87], a[152:155], v[216:219], v[84:87]
 ds_read_b64_tr_b16 v[234:235], v9 offset:58368
 v_mfma_f32_16x16x32_bf16 v[84:87], a[156:159], v[220:223], v[84:87]
 s_add_u32 s66, s31, 13312
 v_mfma_f32_16x16x32_bf16 v[88:91], a[160:163], v[208:211], v[88:91]
 ds_read_b64_tr_b16 v[236:237], v9 offset:61440
 v_mfma_f32_16x16x32_bf16 v[88:91], a[164:167], v[212:215], v[88:91]
 ds_read_b64_tr_b16 v[238:239], v9 offset:62464
 v_mfma_f32_16x16x32_bf16 v[88:91], a[168:171], v[216:219], v[88:91]
 buffer_load_dwordx4 v3, s[32:35], s66 offen offset:1024 lds
 v_mfma_f32_16x16x32_bf16 v[88:91], a[172:175], v[220:223], v[88:91]
 v_mfma_f32_16x16x32_bf16 v[92:95], a[176:179], v[208:211], v[92:95]
 v_mfma_f32_16x16x32_bf16 v[92:95], a[180:183], v[212:215], v[92:95]
 buffer_load_dwordx4 a[84:87], v5, s[40:43], s74 offen sc1
 v_mfma_f32_16x16x32_bf16 v[92:95], a[184:187], v[216:219], v[92:95]
 v_mfma_f32_16x16x32_bf16 v[92:95], a[188:191], v[220:223], v[92:95]
 s_waitcnt lgkmcnt(0)
 v_mfma_f32_16x16x32_bf16 v[96:99], a[128:131], v[224:227], v[96:99]
 ds_read_b64_tr_b16 v[208:209], v10 offset:49152
 v_mfma_f32_16x16x32_bf16 v[96:99], a[132:135], v[228:231], v[96:99]
 ds_read_b64_tr_b16 v[210:211], v10 offset:50176
 v_mfma_f32_16x16x32_bf16 v[96:99], a[136:139], v[232:235], v[96:99]
 ds_read_b64_tr_b16 v[212:213], v10 offset:53248
 v_mfma_f32_16x16x32_bf16 v[96:99], a[140:143], v[236:239], v[96:99]
 buffer_load_dwordx4 a[100:103], v5, s[40:43], s75 offen sc1
 v_mfma_f32_16x16x32_bf16 v[100:103], a[144:147], v[224:227], v[100:103]
 ds_read_b64_tr_b16 v[214:215], v10 offset:54272
 v_mfma_f32_16x16x32_bf16 v[100:103], a[148:151], v[228:231], v[100:103]
 ds_read_b64_tr_b16 v[216:217], v10 offset:57344
 v_mfma_f32_16x16x32_bf16 v[100:103], a[152:155], v[232:235], v[100:103]
 ds_read_b64_tr_b16 v[218:219], v10 offset:58368
 v_mfma_f32_16x16x32_bf16 v[100:103], a[156:159], v[236:239], v[100:103]
 buffer_load_dwordx4 a[116:119], v5, s[40:43], s76 offen sc1
 v_mfma_f32_16x16x32_bf16 v[104:107], a[160:163], v[224:227], v[104:107]
 ds_read_b64_tr_b16 v[220:221], v10 offset:61440
 v_mfma_f32_16x16x32_bf16 v[104:107], a[164:167], v[228:231], v[104:107]
 s_add_u32 s67, s31, 55296
 ds_read_b64_tr_b16 v[222:223], v10 offset:62464
 v_mfma_f32_16x16x32_bf16 v[104:107], a[168:171], v[232:235], v[104:107]
 buffer_load_dwordx4 v3, s[32:35], s67 offen offset:2048 lds
 v_mfma_f32_16x16x32_bf16 v[104:107], a[172:175], v[236:239], v[104:107]
 v_mfma_f32_16x16x32_bf16 v[108:111], a[176:179], v[224:227], v[108:111]
 v_mfma_f32_16x16x32_bf16 v[108:111], a[180:183], v[228:231], v[108:111]
 buffer_load_dwordx4 a[72:75], v6, s[40:43], s73 offen sc1
 v_mfma_f32_16x16x32_bf16 v[108:111], a[184:187], v[232:235], v[108:111]
 v_mfma_f32_16x16x32_bf16 v[108:111], a[188:191], v[236:239], v[108:111]
 s_waitcnt lgkmcnt(0)
 v_mfma_f32_16x16x32_bf16 v[112:115], a[128:131], v[208:211], v[112:115]
 ds_read_b64_tr_b16 v[224:225], v11 offset:49152
 v_mfma_f32_16x16x32_bf16 v[112:115], a[132:135], v[212:215], v[112:115]
 ds_read_b64_tr_b16 v[226:227], v11 offset:50176
 v_mfma_f32_16x16x32_bf16 v[112:115], a[136:139], v[216:219], v[112:115]
 ds_read_b64_tr_b16 v[228:229], v11 offset:53248
 v_mfma_f32_16x16x32_bf16 v[112:115], a[140:143], v[220:223], v[112:115]
 buffer_load_dwordx4 a[88:91], v6, s[40:43], s74 offen sc1
 v_mfma_f32_16x16x32_bf16 v[116:119], a[144:147], v[208:211], v[116:119]
 ds_read_b64_tr_b16 v[230:231], v11 offset:54272
 v_mfma_f32_16x16x32_bf16 v[116:119], a[148:151], v[212:215], v[116:119]
 ds_read_b64_tr_b16 v[232:233], v11 offset:57344
 v_mfma_f32_16x16x32_bf16 v[116:119], a[152:155], v[216:219], v[116:119]
 s_add_u32 s68, s31, 68608
 ds_read_b64_tr_b16 v[234:235], v11 offset:58368
 v_mfma_f32_16x16x32_bf16 v[116:119], a[156:159], v[220:223], v[116:119]
 buffer_load_dwordx4 v3, s[32:35], s68 offen offset:3072 lds
 v_mfma_f32_16x16x32_bf16 v[120:123], a[160:163], v[208:211], v[120:123]
 ds_read_b64_tr_b16 v[236:237], v11 offset:61440
 v_mfma_f32_16x16x32_bf16 v[120:123], a[164:167], v[212:215], v[120:123]
 ds_read_b64_tr_b16 v[238:239], v11 offset:62464
 v_mfma_f32_16x16x32_bf16 v[120:123], a[168:171], v[216:219], v[120:123]
 buffer_load_dwordx4 a[104:107], v6, s[40:43], s75 offen sc1
 v_mfma_f32_16x16x32_bf16 v[120:123], a[172:175], v[220:223], v[120:123]
 v_mfma_f32_16x16x32_bf16 v[124:127], a[176:179], v[208:211], v[124:127]
 v_mfma_f32_16x16x32_bf16 v[124:127], a[180:183], v[212:215], v[124:127]
 v_mfma_f32_16x16x32_bf16 v[124:127], a[184:187], v[216:219], v[124:127]
 v_mfma_f32_16x16x32_bf16 v[124:127], a[188:191], v[220:223], v[124:127]
 s_waitcnt vmcnt(36) lgkmcnt(0)
 s_barrier
 v_mfma_f32_16x16x32_bf16 v[128:131], a[128:131], v[224:227], v[128:131]
 ds_read_b64_tr_b16 v[208:209], v12 offset:0
 v_mfma_f32_16x16x32_bf16 v[128:131], a[132:135], v[228:231], v[128:131]
 ds_read_b64_tr_b16 v[210:211], v12 offset:1024
 v_mfma_f32_16x16x32_bf16 v[128:131], a[136:139], v[232:235], v[128:131]
 ds_read_b64_tr_b16 v[212:213], v12 offset:4096
 v_mfma_f32_16x16x32_bf16 v[128:131], a[140:143], v[236:239], v[128:131]
 buffer_load_dwordx4 a[120:123], v6, s[40:43], s76 offen sc1
 v_mfma_f32_16x16x32_bf16 v[132:135], a[144:147], v[224:227], v[132:135]
 ds_read_b64_tr_b16 v[214:215], v12 offset:5120
 v_mfma_f32_16x16x32_bf16 v[132:135], a[148:151], v[228:231], v[132:135]
 ds_read_b64_tr_b16 v[216:217], v12 offset:8192
 v_mfma_f32_16x16x32_bf16 v[132:135], a[152:155], v[232:235], v[132:135]
 ds_read_b64_tr_b16 v[218:219], v12 offset:9216
 v_mfma_f32_16x16x32_bf16 v[132:135], a[156:159], v[236:239], v[132:135]
 s_mov_b32 s52, s8
 v_mfma_f32_16x16x32_bf16 v[136:139], a[160:163], v[224:227], v[136:139]
 ds_read_b64_tr_b16 v[220:221], v12 offset:12288
 v_mfma_f32_16x16x32_bf16 v[136:139], a[164:167], v[228:231], v[136:139]
 ds_read_b64_tr_b16 v[222:223], v12 offset:13312
 v_mfma_f32_16x16x32_bf16 v[136:139], a[168:171], v[232:235], v[136:139]
 s_mov_b32 s53, s9
 v_mfma_f32_16x16x32_bf16 v[136:139], a[172:175], v[236:239], v[136:139]
 s_mov_b32 s54, 4194304
 v_mfma_f32_16x16x32_bf16 v[140:143], a[176:179], v[224:227], v[140:143]
 s_lshl_b32 s65, s2, 2
 v_mfma_f32_16x16x32_bf16 v[140:143], a[180:183], v[228:231], v[140:143]
 s_add_u32 s65, s65, s60
 v_mfma_f32_16x16x32_bf16 v[140:143], a[184:187], v[232:235], v[140:143]
 s_mul_i32 s65, s65, 4096
 v_mfma_f32_16x16x32_bf16 v[140:143], a[188:191], v[236:239], v[140:143]
 s_waitcnt lgkmcnt(0)
 v_mfma_f32_16x16x32_bf16 v[16:19], a[192:195], v[208:211], v[16:19]
 ds_read_b64_tr_b16 v[224:225], v13 offset:0
 v_mfma_f32_16x16x32_bf16 v[16:19], a[196:199], v[212:215], v[16:19]
 ds_read_b64_tr_b16 v[226:227], v13 offset:1024
 v_mfma_f32_16x16x32_bf16 v[16:19], a[200:203], v[216:219], v[16:19]
 ds_read_b64_tr_b16 v[228:229], v13 offset:4096
 v_mfma_f32_16x16x32_bf16 v[16:19], a[204:207], v[220:223], v[16:19]
 buffer_load_dword v250, v248, s[52:55], s65 offen
 v_mfma_f32_16x16x32_bf16 v[20:23], a[208:211], v[208:211], v[20:23]
 ds_read_b64_tr_b16 v[230:231], v13 offset:5120
 v_mfma_f32_16x16x32_bf16 v[20:23], a[212:215], v[212:215], v[20:23]
 ds_read_b64_tr_b16 v[232:233], v13 offset:8192
 v_mfma_f32_16x16x32_bf16 v[20:23], a[216:219], v[216:219], v[20:23]
 ds_read_b64_tr_b16 v[234:235], v13 offset:9216
 v_cvt_pk_bf16_f32 v144, v16, v17
 v_mfma_f32_16x16x32_bf16 v[20:23], a[220:223], v[220:223], v[20:23]
 v_cvt_pk_bf16_f32 v145, v18, v19
 v_mfma_f32_16x16x32_bf16 v[24:27], a[224:227], v[208:211], v[24:27]
 ds_read_b64_tr_b16 v[236:237], v13 offset:12288
 v_mfma_f32_16x16x32_bf16 v[24:27], a[228:231], v[212:215], v[24:27]
 ds_read_b64_tr_b16 v[238:239], v13 offset:13312
 v_mfma_f32_16x16x32_bf16 v[24:27], a[232:235], v[216:219], v[24:27]
 v_cvt_pk_bf16_f32 v146, v20, v21
 v_cvt_pk_bf16_f32 v147, v22, v23
 v_mfma_f32_16x16x32_bf16 v[24:27], a[236:239], v[220:223], v[24:27]
 v_mfma_f32_16x16x32_bf16 v[28:31], a[240:243], v[208:211], v[28:31]
 v_mfma_f32_16x16x32_bf16 v[28:31], a[244:247], v[212:215], v[28:31]
 v_mfma_f32_16x16x32_bf16 v[28:31], a[248:251], v[216:219], v[28:31]
 v_cvt_pk_bf16_f32 v148, v24, v25
 v_cvt_pk_bf16_f32 v149, v26, v27
 v_mfma_f32_16x16x32_bf16 v[28:31], a[252:255], v[220:223], v[28:31]
 s_waitcnt lgkmcnt(0)
 v_mfma_f32_16x16x32_bf16 v[32:35], a[192:195], v[224:227], v[32:35]
 ds_read_b64_tr_b16 v[208:209], v14 offset:0
 v_mfma_f32_16x16x32_bf16 v[32:35], a[196:199], v[228:231], v[32:35]
 ds_read_b64_tr_b16 v[210:211], v14 offset:1024
 v_mfma_f32_16x16x32_bf16 v[32:35], a[200:203], v[232:235], v[32:35]
 ds_read_b64_tr_b16 v[212:213], v14 offset:4096
 v_cvt_pk_bf16_f32 v150, v28, v29
 v_mfma_f32_16x16x32_bf16 v[32:35], a[204:207], v[236:239], v[32:35]
 v_cvt_pk_bf16_f32 v151, v30, v31
 v_mfma_f32_16x16x32_bf16 v[36:39], a[208:211], v[224:227], v[36:39]
 ds_read_b64_tr_b16 v[214:215], v14 offset:5120
 v_mfma_f32_16x16x32_bf16 v[36:39], a[212:215], v[228:231], v[36:39]
 ds_read_b64_tr_b16 v[216:217], v14 offset:8192
 v_mfma_f32_16x16x32_bf16 v[36:39], a[216:219], v[232:235], v[36:39]
 ds_read_b64_tr_b16 v[218:219], v14 offset:9216
 v_cvt_pk_bf16_f32 v152, v32, v33
 v_mfma_f32_16x16x32_bf16 v[36:39], a[220:223], v[236:239], v[36:39]
 v_cvt_pk_bf16_f32 v153, v34, v35
 v_mfma_f32_16x16x32_bf16 v[40:43], a[224:227], v[224:227], v[40:43]
 ds_read_b64_tr_b16 v[220:221], v14 offset:12288
 v_mfma_f32_16x16x32_bf16 v[40:43], a[228:231], v[228:231], v[40:43]
 ds_read_b64_tr_b16 v[222:223], v14 offset:13312
 v_mfma_f32_16x16x32_bf16 v[40:43], a[232:235], v[232:235], v[40:43]
 v_cvt_pk_bf16_f32 v154, v36, v37
 v_cvt_pk_bf16_f32 v155, v38, v39
 v_mfma_f32_16x16x32_bf16 v[40:43], a[236:239], v[236:239], v[40:43]
 v_mfma_f32_16x16x32_bf16 v[44:47], a[240:243], v[224:227], v[44:47]
 v_mfma_f32_16x16x32_bf16 v[44:47], a[244:247], v[228:231], v[44:47]
 v_mfma_f32_16x16x32_bf16 v[44:47], a[248:251], v[232:235], v[44:47]
 v_cvt_pk_bf16_f32 v156, v40, v41
 v_cvt_pk_bf16_f32 v157, v42, v43
 v_mfma_f32_16x16x32_bf16 v[44:47], a[252:255], v[236:239], v[44:47]
 s_waitcnt lgkmcnt(0)
 v_mfma_f32_16x16x32_bf16 v[48:51], a[192:195], v[208:211], v[48:51]
 ds_read_b64_tr_b16 v[224:225], v15 offset:0
 v_mfma_f32_16x16x32_bf16 v[48:51], a[196:199], v[212:215], v[48:51]
 ds_read_b64_tr_b16 v[226:227], v15 offset:1024
 v_mfma_f32_16x16x32_bf16 v[48:51], a[200:203], v[216:219], v[48:51]
 ds_read_b64_tr_b16 v[228:229], v15 offset:4096
 v_cvt_pk_bf16_f32 v158, v44, v45
 v_mfma_f32_16x16x32_bf16 v[48:51], a[204:207], v[220:223], v[48:51]
 v_cvt_pk_bf16_f32 v159, v46, v47
 v_mfma_f32_16x16x32_bf16 v[52:55], a[208:211], v[208:211], v[52:55]
 ds_read_b64_tr_b16 v[230:231], v15 offset:5120
 v_mfma_f32_16x16x32_bf16 v[52:55], a[212:215], v[212:215], v[52:55]
 ds_read_b64_tr_b16 v[232:233], v15 offset:8192
 v_mfma_f32_16x16x32_bf16 v[52:55], a[216:219], v[216:219], v[52:55]
 ds_read_b64_tr_b16 v[234:235], v15 offset:9216
 v_cvt_pk_bf16_f32 v160, v48, v49
 v_mfma_f32_16x16x32_bf16 v[52:55], a[220:223], v[220:223], v[52:55]
 v_cvt_pk_bf16_f32 v161, v50, v51
 v_mfma_f32_16x16x32_bf16 v[56:59], a[224:227], v[208:211], v[56:59]
 ds_read_b64_tr_b16 v[236:237], v15 offset:12288
 v_mfma_f32_16x16x32_bf16 v[56:59], a[228:231], v[212:215], v[56:59]
 ds_read_b64_tr_b16 v[238:239], v15 offset:13312
 v_mfma_f32_16x16x32_bf16 v[56:59], a[232:235], v[216:219], v[56:59]
 v_cvt_pk_bf16_f32 v162, v52, v53
 v_cvt_pk_bf16_f32 v163, v54, v55
 v_mfma_f32_16x16x32_bf16 v[56:59], a[236:239], v[220:223], v[56:59]
 v_mfma_f32_16x16x32_bf16 v[60:63], a[240:243], v[208:211], v[60:63]
 v_mfma_f32_16x16x32_bf16 v[60:63], a[244:247], v[212:215], v[60:63]
 v_mfma_f32_16x16x32_bf16 v[60:63], a[248:251], v[216:219], v[60:63]
 v_cvt_pk_bf16_f32 v164, v56, v57
 v_cvt_pk_bf16_f32 v165, v58, v59
 v_mfma_f32_16x16x32_bf16 v[60:63], a[252:255], v[220:223], v[60:63]
 s_waitcnt vmcnt(36) lgkmcnt(0)
 v_mfma_f32_16x16x32_bf16 v[64:67], a[192:195], v[224:227], v[64:67]
 ds_read_b64_tr_b16 v[208:209], v12 offset:16384
 v_mfma_f32_16x16x32_bf16 v[64:67], a[196:199], v[228:231], v[64:67]
L_st2_4:
 s_cbranch_execz L_st2_8
 ds_read_b64_tr_b16 v[210:211], v12 offset:17408
 v_mfma_f32_16x16x32_bf16 v[64:67], a[200:203], v[232:235], v[64:67]
 ds_read_b64_tr_b16 v[212:213], v12 offset:20480
 v_cvt_pk_bf16_f32 v166, v60, v61
 v_mfma_f32_16x16x32_bf16 v[64:67], a[204:207], v[236:239], v[64:67]
 v_cvt_pk_bf16_f32 v167, v62, v63
 v_mfma_f32_16x16x32_bf16 v[68:71], a[208:211], v[224:227], v[68:71]
 ds_read_b64_tr_b16 v[214:215], v12 offset:21504
 v_mfma_f32_16x16x32_bf16 v[68:71], a[212:215], v[228:231], v[68:71]
 ds_read_b64_tr_b16 v[216:217], v12 offset:24576
 v_mfma_f32_16x16x32_bf16 v[68:71], a[216:219], v[232:235], v[68:71]
 ds_read_b64_tr_b16 v[218:219], v12 offset:25600
 v_cvt_pk_bf16_f32 v168, v64, v65
 v_mfma_f32_16x16x32_bf16 v[68:71], a[220:223], v[236:239], v[68:71]
 v_cvt_pk_bf16_f32 v169, v66, v67
 v_mfma_f32_16x16x32_bf16 v[72:75], a[224:227], v[224:227], v[72:75]
 ds_read_b64_tr_b16 v[220:221], v12 offset:28672
 v_mfma_f32_16x16x32_bf16 v[72:75], a[228:231], v[228:231], v[72:75]
 ds_read_b64_tr_b16 v[222:223], v12 offset:29696
 v_mfma_f32_16x16x32_bf16 v[72:75], a[232:235], v[232:235], v[72:75]
 buffer_load_dwordx4 a[76:79], v7, s[40:43], s73 offen sc1
 v_mfma_f32_16x16x32_bf16 v[72:75], a[236:239], v[236:239], v[72:75]
 s_add_u32 s73, s73, 4096
 v_cvt_pk_bf16_f32 v170, v68, v69
 v_cvt_pk_bf16_f32 v171, v70, v71
 v_mfma_f32_16x16x32_bf16 v[76:79], a[240:243], v[224:227], v[76:79]
 v_mfma_f32_16x16x32_bf16 v[76:79], a[244:247], v[228:231], v[76:79]
 v_mfma_f32_16x16x32_bf16 v[76:79], a[248:251], v[232:235], v[76:79]
 v_cvt_pk_bf16_f32 v172, v72, v73
 v_cvt_pk_bf16_f32 v173, v74, v75
 v_mfma_f32_16x16x32_bf16 v[76:79], a[252:255], v[236:239], v[76:79]
 s_waitcnt lgkmcnt(0)
 v_mfma_f32_16x16x32_bf16 v[80:83], a[192:195], v[208:211], v[80:83]
 ds_read_b64_tr_b16 v[224:225], v13 offset:16384
 v_mfma_f32_16x16x32_bf16 v[80:83], a[196:199], v[212:215], v[80:83]
 ds_read_b64_tr_b16 v[226:227], v13 offset:17408
 v_mfma_f32_16x16x32_bf16 v[80:83], a[200:203], v[216:219], v[80:83]
 ds_read_b64_tr_b16 v[228:229], v13 offset:20480
 v_cvt_pk_bf16_f32 v174, v76, v77
 v_mfma_f32_16x16x32_bf16 v[80:83], a[204:207], v[220:223], v[80:83]
 buffer_load_dwordx4 a[92:95], v7, s[40:43], s74 offen sc1
 v_mfma_f32_16x16x32_bf16 v[84:87], a[208:211], v[208:211], v[84:87]
 s_add_u32 s74, s74, 4096
 ds_read_b64_tr_b16 v[230:231], v13 offset:21504
 v_cvt_pk_bf16_f32 v175, v78, v79
 v_mfma_f32_16x16x32_bf16 v[84:87], a[212:215], v[212:215], v[84:87]
 ds_read_b64_tr_b16 v[232:233], v13 offset:24576
 v_mfma_f32_16x16x32_bf16 v[84:87], a[216:219], v[216:219], v[84:87]
 ds_read_b64_tr_b16 v[234:235], v13 offset:25600
 v_cvt_pk_bf16_f32 v176, v80, v81
 v_mfma_f32_16x16x32_bf16 v[84:87], a[220:223], v[220:223], v[84:87]
 buffer_load_dwordx4 a[108:111], v7, s[40:43], s75 offen sc1
 v_mfma_f32_16x16x32_bf16 v[88:91], a[224:227], v[208:211], v[88:91]
 s_add_u32 s75, s75, 4096
 ds_read_b64_tr_b16 v[236:237], v13 offset:28672
 v_cvt_pk_bf16_f32 v177, v82, v83
 v_mfma_f32_16x16x32_bf16 v[88:91], a[228:231], v[212:215], v[88:91]
 ds_read_b64_tr_b16 v[238:239], v13 offset:29696
 v_mfma_f32_16x16x32_bf16 v[88:91], a[232:235], v[216:219], v[88:91]
 buffer_load_dwordx4 a[124:127], v7, s[40:43], s76 offen sc1
 v_mfma_f32_16x16x32_bf16 v[88:91], a[236:239], v[220:223], v[88:91]
 s_add_u32 s76, s76, 4096
 v_cvt_pk_bf16_f32 v178, v84, v85
 v_cvt_pk_bf16_f32 v179, v86, v87
 v_mfma_f32_16x16x32_bf16 v[92:95], a[240:243], v[208:211], v[92:95]
 v_mfma_f32_16x16x32_bf16 v[92:95], a[244:247], v[212:215], v[92:95]
 s_add_u32 m0, s71, 32768
 v_mfma_f32_16x16x32_bf16 v[92:95], a[248:251], v[216:219], v[92:95]
 s_add_u32 s66, s64, 917504
 v_cvt_pk_bf16_f32 v180, v88, v89
 v_cvt_pk_bf16_f32 v181, v90, v91
 v_mfma_f32_16x16x32_bf16 v[92:95], a[252:255], v[220:223], v[92:95]
 s_waitcnt lgkmcnt(0)
 v_mfma_f32_16x16x32_bf16 v[96:99], a[192:195], v[224:227], v[96:99]
 ds_read_b64_tr_b16 v[208:209], v14 offset:16384
 v_mfma_f32_16x16x32_bf16 v[96:99], a[196:199], v[228:231], v[96:99]
 ds_read_b64_tr_b16 v[210:211], v14 offset:17408
 v_mfma_f32_16x16x32_bf16 v[96:99], a[200:203], v[232:235], v[96:99]
 ds_read_b64_tr_b16 v[212:213], v14 offset:20480
 v_cvt_pk_bf16_f32 v182, v92, v93
 v_mfma_f32_16x16x32_bf16 v[96:99], a[204:207], v[236:239], v[96:99]
 buffer_load_dwordx4 v3, s[32:35], s66 offen offset:0 lds
 v_mfma_f32_16x16x32_bf16 v[100:103], a[208:211], v[224:227], v[100:103]
 ds_read_b64_tr_b16 v[214:215], v14 offset:21504
 v_cvt_pk_bf16_f32 v183, v94, v95
 v_mfma_f32_16x16x32_bf16 v[100:103], a[212:215], v[228:231], v[100:103]
 ds_read_b64_tr_b16 v[216:217], v14 offset:24576
 v_mfma_f32_16x16x32_bf16 v[100:103], a[216:219], v[232:235], v[100:103]
 ds_read_b64_tr_b16 v[218:219], v14 offset:25600
 v_cvt_pk_bf16_f32 v184, v96, v97
 v_mfma_f32_16x16x32_bf16 v[100:103], a[220:223], v[236:239], v[100:103]
 buffer_load_dwordx4 a[128:131], v4, s[40:43], s73 offen sc1
 v_mfma_f32_16x16x32_bf16 v[104:107], a[224:227], v[224:227], v[104:107]
 ds_read_b64_tr_b16 v[220:221], v14 offset:28672
 v_cvt_pk_bf16_f32 v185, v98, v99
 v_mfma_f32_16x16x32_bf16 v[104:107], a[228:231], v[228:231], v[104:107]
 ds_read_b64_tr_b16 v[222:223], v14 offset:29696
 v_mfma_f32_16x16x32_bf16 v[104:107], a[232:235], v[232:235], v[104:107]
 buffer_load_dwordx4 a[144:147], v4, s[40:43], s74 offen sc1
 v_mfma_f32_16x16x32_bf16 v[104:107], a[236:239], v[236:239], v[104:107]
 v_cvt_pk_bf16_f32 v186, v100, v101
 v_cvt_pk_bf16_f32 v187, v102, v103
 v_mfma_f32_16x16x32_bf16 v[108:111], a[240:243], v[224:227], v[108:111]
 v_mfma_f32_16x16x32_bf16 v[108:111], a[244:247], v[228:231], v[108:111]
 buffer_load_dwordx4 a[160:163], v4, s[40:43], s75 offen sc1
 v_mfma_f32_16x16x32_bf16 v[108:111], a[248:251], v[232:235], v[108:111]
 s_add_u32 s67, s64, 930816
 v_cvt_pk_bf16_f32 v188, v104, v105
 v_cvt_pk_bf16_f32 v189, v106, v107
 v_mfma_f32_16x16x32_bf16 v[108:111], a[252:255], v[236:239], v[108:111]
 s_waitcnt lgkmcnt(0)
 v_mfma_f32_16x16x32_bf16 v[112:115], a[192:195], v[208:211], v[112:115]
 ds_read_b64_tr_b16 v[224:225], v15 offset:16384
 v_mfma_f32_16x16x32_bf16 v[112:115], a[196:199], v[212:215], v[112:115]
 ds_read_b64_tr_b16 v[226:227], v15 offset:17408
 v_mfma_f32_16x16x32_bf16 v[112:115], a[200:203], v[216:219], v[112:115]
 ds_read_b64_tr_b16 v[228:229], v15 offset:20480
 v_cvt_pk_bf16_f32 v190, v108, v109
 v_mfma_f32_16x16x32_bf16 v[112:115], a[204:207], v[220:223], v[112:115]
 buffer_load_dwordx4 v3, s[32:35], s67 offen offset:1024 lds
 v_mfma_f32_16x16x32_bf16 v[116:119], a[208:211], v[208:211], v[116:119]
 ds_read_b64_tr_b16 v[230:231], v15 offset:21504
 v_cvt_pk_bf16_f32 v191, v110, v111
 v_mfma_f32_16x16x32_bf16 v[116:119], a[212:215], v[212:215], v[116:119]
 ds_read_b64_tr_b16 v[232:233], v15 offset:24576
 v_mfma_f32_16x16x32_bf16 v[116:119], a[216:219], v[216:219], v[116:119]
 ds_read_b64_tr_b16 v[234:235], v15 offset:25600
 v_cvt_pk_bf16_f32 v192, v112, v113
 v_mfma_f32_16x16x32_bf16 v[116:119], a[220:223], v[220:223], v[116:119]
 buffer_load_dwordx4 a[176:179], v4, s[40:43], s76 offen sc1
 v_mfma_f32_16x16x32_bf16 v[120:123], a[224:227], v[208:211], v[120:123]
 ds_read_b64_tr_b16 v[236:237], v15 offset:28672
 v_cvt_pk_bf16_f32 v193, v114, v115
 v_mfma_f32_16x16x32_bf16 v[120:123], a[228:231], v[212:215], v[120:123]
 ds_read_b64_tr_b16 v[238:239], v15 offset:29696
 v_mfma_f32_16x16x32_bf16 v[120:123], a[232:235], v[216:219], v[120:123]
 buffer_load_dwordx4 a[132:135], v5, s[40:43], s73 offen sc1
 v_mfma_f32_16x16x32_bf16 v[120:123], a[236:239], v[220:223], v[120:123]
 v_cvt_pk_bf16_f32 v194, v116, v117
 v_cvt_pk_bf16_f32 v195, v118, v119
 v_mfma_f32_16x16x32_bf16 v[124:127], a[240:243], v[208:211], v[124:127]
 s_add_u32 s68, s64, 972800
 v_mfma_f32_16x16x32_bf16 v[124:127], a[244:247], v[212:215], v[124:127]
 buffer_load_dwordx4 v3, s[32:35], s68 offen offset:2048 lds
 v_mfma_f32_16x16x32_bf16 v[124:127], a[248:251], v[216:219], v[124:127]
 v_cvt_pk_bf16_f32 v196, v120, v121
 v_cvt_pk_bf16_f32 v197, v122, v123
 v_mfma_f32_16x16x32_bf16 v[124:127], a[252:255], v[220:223], v[124:127]
 s_waitcnt vmcnt(12) lgkmcnt(0)
 s_barrier
 v_mfma_f32_16x16x32_bf16 v[128:131], a[192:195], v[224:227], v[128:131]
 ds_read_b64_tr_b16 v[208:209], v8 offset:0
 v_lshlrev_b32 v248, 16, v240
 v_mfma_f32_16x16x32_bf16 v[128:131], a[196:199], v[228:231], v[128:131]
 ds_read_b64_tr_b16 v[210:211], v8 offset:1024
 v_and_b32 v249, 0xffff0000, v240
 v_mfma_f32_16x16x32_bf16 v[128:131], a[200:203], v[232:235], v[128:131]
 ds_read_b64_tr_b16 v[212:213], v8 offset:4096
 v_cvt_pk_bf16_f32 v198, v124, v125
 v_mfma_f32_16x16x32_bf16 v[128:131], a[204:207], v[236:239], v[128:131]
 buffer_load_dwordx4 a[148:151], v5, s[40:43], s74 offen sc1
 v_mfma_f32_16x16x32_bf16 v[132:135], a[208:211], v[224:227], v[132:135]
 ds_read_b64_tr_b16 v[214:215], v8 offset:5120
 v_cvt_pk_bf16_f32 v199, v126, v127
 v_mfma_f32_16x16x32_bf16 v[132:135], a[212:215], v[228:231], v[132:135]
 ds_read_b64_tr_b16 v[216:217], v8 offset:8192
 v_lshlrev_b32 v250, 16, v241
 v_mfma_f32_16x16x32_bf16 v[132:135], a[216:219], v[232:235], v[132:135]
 ds_read_b64_tr_b16 v[218:219], v8 offset:9216
 v_cvt_pk_bf16_f32 v200, v128, v129
 v_mfma_f32_16x16x32_bf16 v[132:135], a[220:223], v[236:239], v[132:135]
 buffer_load_dwordx4 a[164:167], v5, s[40:43], s75 offen sc1
 v_mfma_f32_16x16x32_bf16 v[136:139], a[224:227], v[224:227], v[136:139]
 ds_read_b64_tr_b16 v[220:221], v8 offset:12288
 v_cvt_pk_bf16_f32 v201, v130, v131
 v_mfma_f32_16x16x32_bf16 v[136:139], a[228:231], v[228:231], v[136:139]
 s_add_u32 s65, s64, 986112
 ds_read_b64_tr_b16 v[222:223], v8 offset:13312
 v_and_b32 v251, 0xffff0000, v241
 v_mfma_f32_16x16x32_bf16 v[136:139], a[232:235], v[232:235], v[136:139]
 buffer_load_dwordx4 v3, s[32:35], s65 offen offset:3072 lds
 v_mfma_f32_16x16x32_bf16 v[136:139], a[236:239], v[236:239], v[136:139]
 v_cvt_pk_bf16_f32 v202, v132, v133
 v_cvt_pk_bf16_f32 v203, v134, v135
 v_mfma_f32_16x16x32_bf16 v[140:143], a[240:243], v[224:227], v[140:143]
 v_mfma_f32_16x16x32_bf16 v[140:143], a[244:247], v[228:231], v[140:143]
 buffer_load_dwordx4 a[180:183], v5, s[40:43], s76 offen sc1
 v_mfma_f32_16x16x32_bf16 v[140:143], a[248:251], v[232:235], v[140:143]
 v_cvt_pk_bf16_f32 v204, v136, v137
 v_cvt_pk_bf16_f32 v205, v138, v139
 v_mfma_f32_16x16x32_bf16 v[140:143], a[252:255], v[236:239], v[140:143]
 s_waitcnt lgkmcnt(0)
 v_mfma_f32_16x16x32_bf16 v[16:19], v[208:211], a[0:3], v[248:251]
 ds_read_b64_tr_b16 v[224:225], v9 offset:0
 v_lshlrev_b32 v252, 16, v242
 v_mfma_f32_16x16x32_bf16 v[16:19], v[212:215], a[4:7], v[16:19]
 ds_read_b64_tr_b16 v[226:227], v9 offset:1024
 v_and_b32 v253, 0xffff0000, v242
 v_mfma_f32_16x16x32_bf16 v[16:19], v[216:219], a[8:11], v[16:19]
 ds_read_b64_tr_b16 v[228:229], v9 offset:4096
 v_cvt_pk_bf16_f32 v206, v140, v141
 v_mfma_f32_16x16x32_bf16 v[16:19], v[220:223], a[12:15], v[16:19]
 buffer_load_dwordx4 a[136:139], v6, s[40:43], s73 offen sc1
 v_mfma_f32_16x16x32_bf16 v[20:23], v[208:211], a[16:19], v[248:251]
 ds_read_b64_tr_b16 v[230:231], v9 offset:5120
 v_cvt_pk_bf16_f32 v207, v142, v143
 v_mfma_f32_16x16x32_bf16 v[20:23], v[212:215], a[20:23], v[20:23]
 s_add_u32 m0, s71, 36864
 ds_read_b64_tr_b16 v[232:233], v9 offset:8192
 v_lshlrev_b32 v254, 16, v243
 v_mfma_f32_16x16x32_bf16 v[20:23], v[216:219], a[24:27], v[20:23]
 s_add_u32 s66, s31, 917504
 ds_read_b64_tr_b16 v[234:235], v9 offset:9216
 v_and_b32 v255, 0xffff0000, v243
 v_mfma_f32_16x16x32_bf16 v[20:23], v[220:223], a[28:31], v[20:23]
 buffer_load_dwordx4 v3, s[32:35], s66 offen offset:0 lds
 v_mfma_f32_16x16x32_bf16 v[24:27], v[208:211], a[32:35], v[248:251]
 ds_read_b64_tr_b16 v[236:237], v9 offset:12288
 v_mfma_f32_16x16x32_bf16 v[24:27], v[212:215], a[36:39], v[24:27]
 ds_read_b64_tr_b16 v[238:239], v9 offset:13312
 v_mfma_f32_16x16x32_bf16 v[24:27], v[216:219], a[40:43], v[24:27]
 buffer_load_dwordx4 a[152:155], v6, s[40:43], s74 offen sc1
 v_mfma_f32_16x16x32_bf16 v[24:27], v[220:223], a[44:47], v[24:27]
 v_mfma_f32_16x16x32_bf16 v[28:31], v[208:211], a[48:51], v[248:251]
 v_mfma_f32_16x16x32_bf16 v[28:31], v[212:215], a[52:55], v[28:31]
 v_mfma_f32_16x16x32_bf16 v[28:31], v[216:219], a[56:59], v[28:31]
 v_mfma_f32_16x16x32_bf16 v[28:31], v[220:223], a[60:63], v[28:31]
 s_waitcnt lgkmcnt(0)
 v_mfma_f32_16x16x32_bf16 v[32:35], v[224:227], a[0:3], v[252:255]
 ds_read_b64_tr_b16 v[208:209], v10 offset:0
 v_lshlrev_b32 v248, 16, v244
 v_mfma_f32_16x16x32_bf16 v[32:35], v[228:231], a[4:7], v[32:35]
 ds_read_b64_tr_b16 v[210:211], v10 offset:1024
 v_and_b32 v249, 0xffff0000, v244
 v_mfma_f32_16x16x32_bf16 v[32:35], v[232:235], a[8:11], v[32:35]
 ds_read_b64_tr_b16 v[212:213], v10 offset:4096
 v_lshlrev_b32 v250, 16, v245
 v_mfma_f32_16x16x32_bf16 v[32:35], v[236:239], a[12:15], v[32:35]
 buffer_load_dwordx4 a[168:171], v6, s[40:43], s75 offen sc1
 v_mfma_f32_16x16x32_bf16 v[36:39], v[224:227], a[16:19], v[252:255]
 ds_read_b64_tr_b16 v[214:215], v10 offset:5120
 v_and_b32 v251, 0xffff0000, v245
 v_mfma_f32_16x16x32_bf16 v[36:39], v[228:231], a[20:23], v[36:39]
 ds_read_b64_tr_b16 v[216:217], v10 offset:8192
 v_mfma_f32_16x16x32_bf16 v[36:39], v[232:235], a[24:27], v[36:39]
 ds_read_b64_tr_b16 v[218:219], v10 offset:9216
 v_mfma_f32_16x16x32_bf16 v[36:39], v[236:239], a[28:31], v[36:39]
 buffer_load_dwordx4 a[184:187], v6, s[40:43], s76 offen sc1
 v_mfma_f32_16x16x32_bf16 v[40:43], v[224:227], a[32:35], v[252:255]
 ds_read_b64_tr_b16 v[220:221], v10 offset:12288
 v_mfma_f32_16x16x32_bf16 v[40:43], v[228:231], a[36:39], v[40:43]
 s_add_u32 s67, s31, 930816
 ds_read_b64_tr_b16 v[222:223], v10 offset:13312
 v_mfma_f32_16x16x32_bf16 v[40:43], v[232:235], a[40:43], v[40:43]
 buffer_load_dwordx4 v3, s[32:35], s67 offen offset:1024 lds
 v_mfma_f32_16x16x32_bf16 v[40:43], v[236:239], a[44:47], v[40:43]
 v_mfma_f32_16x16x32_bf16 v[44:47], v[224:227], a[48:51], v[252:255]
 v_mfma_f32_16x16x32_bf16 v[44:47], v[228:231], a[52:55], v[44:47]
 buffer_load_dwordx4 a[140:143], v7, s[40:43], s73 offen sc1
 v_mfma_f32_16x16x32_bf16 v[44:47], v[232:235], a[56:59], v[44:47]
 s_add_u32 s73, s73, 4096
 v_mfma_f32_16x16x32_bf16 v[44:47], v[236:239], a[60:63], v[44:47]
 s_waitcnt lgkmcnt(0)
 v_mfma_f32_16x16x32_bf16 v[48:51], v[208:211], a[0:3], v[248:251]
 s_mul_i32 s85, s61, 562176
 ds_read_b64_tr_b16 v[224:225], v11 offset:0
 s_lshl_b32 s38, s62, 1
 v_mfma_f32_16x16x32_bf16 v[48:51], v[212:215], a[4:7], v[48:51]
 s_sub_u32 s38, 32, s38
 ds_read_b64_tr_b16 v[226:227], v11 offset:1024
 s_mul_i32 s38, s38, 17408
 v_mfma_f32_16x16x32_bf16 v[48:51], v[216:219], a[8:11], v[48:51]
 s_mov_b32 s58, s38
 ds_read_b64_tr_b16 v[228:229], v11 offset:4096
 s_mov_b32 s59, 0x20000
 v_mfma_f32_16x16x32_bf16 v[48:51], v[220:223], a[12:15], v[48:51]
 s_add_u32 s85, s85, 3145728
 s_lshl_b32 s92, s60, 12
 s_add_u32 s93, s92, 32768
 v_mfma_f32_16x16x32_bf16 v[52:55], v[208:211], a[16:19], v[248:251]
 s_mov_b32 s90, s92
 ds_read_b64_tr_b16 v[230:231], v11 offset:5120
 s_mov_b32 s91, s92
 v_mfma_f32_16x16x32_bf16 v[52:55], v[212:215], a[20:23], v[52:55]
 ds_read_b64_tr_b16 v[232:233], v11 offset:8192
 v_lshlrev_b32 v252, 16, v246
 v_mfma_f32_16x16x32_bf16 v[52:55], v[216:219], a[24:27], v[52:55]
 ds_read_b64_tr_b16 v[234:235], v11 offset:9216
 v_and_b32 v253, 0xffff0000, v246
 v_mfma_f32_16x16x32_bf16 v[52:55], v[220:223], a[28:31], v[52:55]
 s_add_u32 s36, s28, s85
 s_addc_u32 s37, s29, 0
 v_lshlrev_b32 v254, 16, v247
 v_mfma_f32_16x16x32_bf16 v[56:59], v[208:211], a[32:35], v[248:251]
 ds_read_b64_tr_b16 v[236:237], v11 offset:12288
 v_and_b32 v255, 0xffff0000, v247
 v_mfma_f32_16x16x32_bf16 v[56:59], v[212:215], a[36:39], v[56:59]
 ds_read_b64_tr_b16 v[238:239], v11 offset:13312
 v_mfma_f32_16x16x32_bf16 v[56:59], v[216:219], a[40:43], v[56:59]
 s_add_u32 s85, s85, 18884608
 s_add_u32 s56, s28, s85
 s_addc_u32 s57, s29, 0
 v_mfma_f32_16x16x32_bf16 v[56:59], v[220:223], a[44:47], v[56:59]
 buffer_load_dwordx4 a[156:159], v7, s[40:43], s74 offen sc1
 v_mfma_f32_16x16x32_bf16 v[60:63], v[208:211], a[48:51], v[248:251]
 s_add_u32 s74, s74, 4096
 v_mfma_f32_16x16x32_bf16 v[60:63], v[212:215], a[52:55], v[60:63]
 s_add_u32 s68, s31, 972800
 v_mfma_f32_16x16x32_bf16 v[60:63], v[216:219], a[56:59], v[60:63]
 buffer_load_dwordx4 v3, s[32:35], s68 offen offset:2048 lds
 v_mfma_f32_16x16x32_bf16 v[60:63], v[220:223], a[60:63], v[60:63]
 s_waitcnt vmcnt(36) lgkmcnt(0)
 v_mfma_f32_16x16x32_bf16 v[64:67], v[224:227], a[0:3], v[252:255]
 ds_read_b64_tr_b16 v[208:209], v8 offset:16384
 v_mfma_f32_16x16x32_bf16 v[64:67], v[228:231], a[4:7], v[64:67]
 ds_read_b64_tr_b16 v[210:211], v8 offset:17408
 v_mfma_f32_16x16x32_bf16 v[64:67], v[232:235], a[8:11], v[64:67]
 ds_read_b64_tr_b16 v[212:213], v8 offset:20480
 v_mfma_f32_16x16x32_bf16 v[64:67], v[236:239], a[12:15], v[64:67]
 buffer_load_dwordx4 a[172:175], v7, s[40:43], s75 offen sc1
 v_mfma_f32_16x16x32_bf16 v[68:71], v[224:227], a[16:19], v[252:255]
 s_add_u32 s75, s75, 4096
 ds_read_b64_tr_b16 v[214:215], v8 offset:21504
 v_mfma_f32_16x16x32_bf16 v[68:71], v[228:231], a[20:23], v[68:71]
 ds_read_b64_tr_b16 v[216:217], v8 offset:24576
 v_mfma_f32_16x16x32_bf16 v[68:71], v[232:235], a[24:27], v[68:71]
 ds_read_b64_tr_b16 v[218:219], v8 offset:25600
 v_mfma_f32_16x16x32_bf16 v[68:71], v[236:239], a[28:31], v[68:71]
 buffer_load_dwordx4 a[188:191], v7, s[40:43], s76 offen sc1
 v_mfma_f32_16x16x32_bf16 v[72:75], v[224:227], a[32:35], v[252:255]
 s_add_u32 s76, s76, 4096
 ds_read_b64_tr_b16 v[220:221], v8 offset:28672
 v_mfma_f32_16x16x32_bf16 v[72:75], v[228:231], a[36:39], v[72:75]
 s_add_u32 s65, s31, 986112
 ds_read_b64_tr_b16 v[222:223], v8 offset:29696
 v_mfma_f32_16x16x32_bf16 v[72:75], v[232:235], a[40:43], v[72:75]
 buffer_load_dwordx4 v3, s[32:35], s65 offen offset:3072 lds
 v_mfma_f32_16x16x32_bf16 v[72:75], v[236:239], a[44:47], v[72:75]
 v_mfma_f32_16x16x32_bf16 v[76:79], v[224:227], a[48:51], v[252:255]
 v_mfma_f32_16x16x32_bf16 v[76:79], v[228:231], a[52:55], v[76:79]
 buffer_load_dwordx4 a[192:195], v4, s[40:43], s73 offen sc1
 v_mfma_f32_16x16x32_bf16 v[76:79], v[232:235], a[56:59], v[76:79]
 v_mfma_f32_16x16x32_bf16 v[76:79], v[236:239], a[60:63], v[76:79]
 s_waitcnt vmcnt(25) lgkmcnt(0)
 v_mfma_f32_16x16x32_bf16 v[16:19], v[208:211], a[64:67], v[16:19]
 ds_read_b64_tr_b16 v[224:225], v9 offset:16384
 v_mfma_f32_16x16x32_bf16 v[16:19], v[212:215], a[68:71], v[16:19]
 ds_read_b64_tr_b16 v[226:227], v9 offset:17408
 v_mfma_f32_16x16x32_bf16 v[16:19], v[216:219], a[72:75], v[16:19]
 ds_read_b64_tr_b16 v[228:229], v9 offset:20480
 v_mfma_f32_16x16x32_bf16 v[16:19], v[220:223], a[76:79], v[16:19]
 buffer_load_dwordx4 a[208:211], v4, s[40:43], s74 offen sc1
 v_mfma_f32_16x16x32_bf16 v[20:23], v[208:211], a[80:83], v[20:23]
 ds_read_b64_tr_b16 v[230:231], v9 offset:21504
 v_mfma_f32_16x16x32_bf16 v[20:23], v[212:215], a[84:87], v[20:23]
 ds_read_b64_tr_b16 v[232:233], v9 offset:24576
 v_mfma_f32_16x16x32_bf16 v[20:23], v[216:219], a[88:91], v[20:23]
 ds_read_b64_tr_b16 v[234:235], v9 offset:25600
 v_mfma_f32_16x16x32_bf16 v[20:23], v[220:223], a[92:95], v[20:23]
 buffer_load_dwordx4 a[224:227], v4, s[40:43], s75 offen sc1
 v_mfma_f32_16x16x32_bf16 v[24:27], v[208:211], a[96:99], v[24:27]
 ds_read_b64_tr_b16 v[236:237], v9 offset:28672
 v_mfma_f32_16x16x32_bf16 v[24:27], v[212:215], a[100:103], v[24:27]
 ds_read_b64_tr_b16 v[238:239], v9 offset:29696
 v_mfma_f32_16x16x32_bf16 v[24:27], v[216:219], a[104:107], v[24:27]
 buffer_load_dwordx4 a[240:243], v4, s[40:43], s76 offen sc1
 v_mfma_f32_16x16x32_bf16 v[24:27], v[220:223], a[108:111], v[24:27]
 v_mfma_f32_16x16x32_bf16 v[28:31], v[208:211], a[112:115], v[28:31]
 v_mfma_f32_16x16x32_bf16 v[28:31], v[212:215], a[116:119], v[28:31]
 buffer_load_dwordx4 a[196:199], v5, s[40:43], s73 offen sc1
 v_mfma_f32_16x16x32_bf16 v[28:31], v[216:219], a[120:123], v[28:31]
 v_mfma_f32_16x16x32_bf16 v[28:31], v[220:223], a[124:127], v[28:31]
 s_waitcnt lgkmcnt(0)
 v_mfma_f32_16x16x32_bf16 v[32:35], v[224:227], a[64:67], v[32:35]
 ds_read_b64_tr_b16 v[208:209], v10 offset:16384
 v_bfe_u32 v248, v1, 4, 4
 v_mfma_f32_16x16x32_bf16 v[32:35], v[228:231], a[68:71], v[32:35]
 ds_read_b64_tr_b16 v[210:211], v10 offset:17408
 v_lshrrev_b32 v249, 8, v1
 v_mfma_f32_16x16x32_bf16 v[32:35], v[232:235], a[72:75], v[32:35]
 ds_read_b64_tr_b16 v[212:213], v10 offset:20480
 v_lshlrev_b32 v249, 2, v249
 v_mfma_f32_16x16x32_bf16 v[32:35], v[236:239], a[76:79], v[32:35]
 v_sub_u32 v248, v248, v249
 v_lshlrev_b32 v254, 4, s60
 v_mfma_f32_16x16x32_bf16 v[36:39], v[224:227], a[80:83], v[36:39]
 ds_read_b64_tr_b16 v[214:215], v10 offset:21504
 v_sub_u32 v249, v248, v254
 v_mfma_f32_16x16x32_bf16 v[36:39], v[228:231], a[84:87], v[36:39]
 ds_read_b64_tr_b16 v[216:217], v10 offset:24576
 v_add_u32 v249, 48, v249
 v_mfma_f32_16x16x32_bf16 v[36:39], v[232:235], a[88:91], v[36:39]
 ds_read_b64_tr_b16 v[218:219], v10 offset:25600
 v_add_u32 v248, v248, v254
 v_mfma_f32_16x16x32_bf16 v[36:39], v[236:239], a[92:95], v[36:39]
 v_mov_b32 v250, 0xff800000
 v_bfe_u32 v252, v1, 2, 5
 v_mfma_f32_16x16x32_bf16 v[40:43], v[224:227], a[96:99], v[40:43]
 ds_read_b64_tr_b16 v[220:221], v10 offset:28672
 v_lshlrev_b32 v254, 7, s62
 v_mfma_f32_16x16x32_bf16 v[40:43], v[228:231], a[100:103], v[40:43]
 ds_read_b64_tr_b16 v[222:223], v10 offset:29696
 v_add_u32 v254, v254, v248
 v_mfma_f32_16x16x32_bf16 v[40:43], v[232:235], a[104:107], v[40:43]
 buffer_load_dwordx4 a[212:215], v5, s[40:43], s74 offen sc1
 v_mfma_f32_16x16x32_bf16 v[40:43], v[236:239], a[108:111], v[40:43]
 v_mfma_f32_16x16x32_bf16 v[44:47], v[224:227], a[112:115], v[44:47]
 v_mfma_f32_16x16x32_bf16 v[44:47], v[228:231], a[116:119], v[44:47]
 buffer_load_dwordx4 a[228:231], v5, s[40:43], s75 offen sc1
 v_mfma_f32_16x16x32_bf16 v[44:47], v[232:235], a[120:123], v[44:47]
 v_mfma_f32_16x16x32_bf16 v[44:47], v[236:239], a[124:127], v[44:47]
 s_waitcnt lgkmcnt(0)
 v_mfma_f32_16x16x32_bf16 v[48:51], v[208:211], a[64:67], v[48:51]
 ds_read_b64_tr_b16 v[224:225], v11 offset:16384
 v_mfma_f32_16x16x32_bf16 v[48:51], v[212:215], a[68:71], v[48:51]
 ds_read_b64_tr_b16 v[226:227], v11 offset:17408
 v_mfma_f32_16x16x32_bf16 v[48:51], v[216:219], a[72:75], v[48:51]
 ds_read_b64_tr_b16 v[228:229], v11 offset:20480
 v_mfma_f32_16x16x32_bf16 v[48:51], v[220:223], a[76:79], v[48:51]
 buffer_load_dwordx4 a[244:247], v5, s[40:43], s76 offen sc1
 v_mfma_f32_16x16x32_bf16 v[52:55], v[208:211], a[80:83], v[52:55]
 ds_read_b64_tr_b16 v[230:231], v11 offset:21504
 v_mfma_f32_16x16x32_bf16 v[52:55], v[212:215], a[84:87], v[52:55]
 ds_read_b64_tr_b16 v[232:233], v11 offset:24576
 v_mfma_f32_16x16x32_bf16 v[52:55], v[216:219], a[88:91], v[52:55]
 ds_read_b64_tr_b16 v[234:235], v11 offset:25600
 v_mfma_f32_16x16x32_bf16 v[52:55], v[220:223], a[92:95], v[52:55]
 buffer_load_dwordx4 a[200:203], v6, s[40:43], s73 offen sc1
 v_mfma_f32_16x16x32_bf16 v[56:59], v[208:211], a[96:99], v[56:59]
 ds_read_b64_tr_b16 v[236:237], v11 offset:28672
 v_mfma_f32_16x16x32_bf16 v[56:59], v[212:215], a[100:103], v[56:59]
 ds_read_b64_tr_b16 v[238:239], v11 offset:29696
 v_mfma_f32_16x16x32_bf16 v[56:59], v[216:219], a[104:107], v[56:59]
 buffer_load_dwordx4 a[216:219], v6, s[40:43], s74 offen sc1
 v_mfma_f32_16x16x32_bf16 v[56:59], v[220:223], a[108:111], v[56:59]
 v_mfma_f32_16x16x32_bf16 v[60:63], v[208:211], a[112:115], v[60:63]
 v_mfma_f32_16x16x32_bf16 v[60:63], v[212:215], a[116:119], v[60:63]
 buffer_load_dwordx4 a[232:235], v6, s[40:43], s75 offen sc1
 v_mfma_f32_16x16x32_bf16 v[60:63], v[216:219], a[120:123], v[60:63]
 v_mfma_f32_16x16x32_bf16 v[60:63], v[220:223], a[124:127], v[60:63]
 s_waitcnt vmcnt(11) lgkmcnt(0)
 s_barrier
 v_mfma_f32_16x16x32_bf16 v[64:67], v[224:227], a[64:67], v[64:67]
 ds_read_b64_tr_b16 v[208:209], v8 offset:32768
 v_mfma_f32_16x16x32_bf16 v[64:67], v[228:231], a[68:71], v[64:67]
 ds_read_b64_tr_b16 v[210:211], v8 offset:33792
 v_mfma_f32_16x16x32_bf16 v[64:67], v[232:235], a[72:75], v[64:67]
 ds_read_b64_tr_b16 v[212:213], v8 offset:36864
 v_mfma_f32_16x16x32_bf16 v[64:67], v[236:239], a[76:79], v[64:67]
 buffer_load_dwordx4 a[248:251], v6, s[40:43], s76 offen sc1
 v_mfma_f32_16x16x32_bf16 v[68:71], v[224:227], a[80:83], v[68:71]
 ds_read_b64_tr_b16 v[214:215], v8 offset:37888
 v_mfma_f32_16x16x32_bf16 v[68:71], v[228:231], a[84:87], v[68:71]
 ds_read_b64_tr_b16 v[216:217], v8 offset:40960
 v_mfma_f32_16x16x32_bf16 v[68:71], v[232:235], a[88:91], v[68:71]
 ds_read_b64_tr_b16 v[218:219], v8 offset:41984
 v_mfma_f32_16x16x32_bf16 v[68:71], v[236:239], a[92:95], v[68:71]
 buffer_store_dword v12, v0, s[40:43], s81 offen sc1
 v_mfma_f32_16x16x32_bf16 v[72:75], v[224:227], a[96:99], v[72:75]
 ds_read_b64_tr_b16 v[220:221], v8 offset:45056
 v_mfma_f32_16x16x32_bf16 v[72:75], v[228:231], a[100:103], v[72:75]
 ds_read_b64_tr_b16 v[222:223], v8 offset:46080
 v_mfma_f32_16x16x32_bf16 v[72:75], v[232:235], a[104:107], v[72:75]
 buffer_load_dwordx4 a[204:207], v7, s[40:43], s73 offen sc1
 v_mfma_f32_16x16x32_bf16 v[72:75], v[236:239], a[108:111], v[72:75]
 v_mfma_f32_16x16x32_bf16 v[76:79], v[224:227], a[112:115], v[76:79]
 v_mfma_f32_16x16x32_bf16 v[76:79], v[228:231], a[116:119], v[76:79]
 buffer_load_dwordx4 a[220:223], v7, s[40:43], s74 offen sc1
 v_mfma_f32_16x16x32_bf16 v[76:79], v[232:235], a[120:123], v[76:79]
 v_mfma_f32_16x16x32_bf16 v[76:79], v[236:239], a[124:127], v[76:79]
 s_waitcnt lgkmcnt(0)
 v_mfma_f32_16x16x32_bf16 v[16:19], v[208:211], a[128:131], v[16:19]
 s_lshl_b32 s31, s61, 13
 ds_read_b64_tr_b16 v[224:225], v9 offset:32768
 s_add_u32 s31, s31, 557056
 v_mfma_f32_16x16x32_bf16 v[16:19], v[212:215], a[132:135], v[16:19]
 ds_read_b64_tr_b16 v[226:227], v9 offset:33792
 v_mfma_f32_16x16x32_bf16 v[16:19], v[216:219], a[136:139], v[16:19]
 ds_read_b64_tr_b16 v[228:229], v9 offset:36864
 v_mfma_f32_16x16x32_bf16 v[16:19], v[220:223], a[140:143], v[16:19]
 buffer_load_dwordx4 a[236:239], v7, s[40:43], s75 offen sc1
 v_mfma_f32_16x16x32_bf16 v[20:23], v[208:211], a[144:147], v[20:23]
 ds_read_b64_tr_b16 v[230:231], v9 offset:37888
 v_mfma_f32_16x16x32_bf16 v[20:23], v[212:215], a[148:151], v[20:23]
 ds_read_b64_tr_b16 v[232:233], v9 offset:40960
 v_mfma_f32_16x16x32_bf16 v[20:23], v[216:219], a[152:155], v[20:23]
 ds_read_b64_tr_b16 v[234:235], v9 offset:41984
 v_mfma_f32_16x16x32_bf16 v[20:23], v[220:223], a[156:159], v[20:23]
 buffer_load_dwordx4 a[252:255], v7, s[40:43], s76 offen sc1
 v_mfma_f32_16x16x32_bf16 v[24:27], v[208:211], a[160:163], v[24:27]
 s_mov_b32 s32, s8
 ds_read_b64_tr_b16 v[236:237], v9 offset:45056
 v_mfma_f32_16x16x32_bf16 v[24:27], v[212:215], a[164:167], v[24:27]
 s_mov_b32 s33, s9
 ds_read_b64_tr_b16 v[238:239], v9 offset:46080
 v_mfma_f32_16x16x32_bf16 v[24:27], v[216:219], a[168:171], v[24:27]
 s_mov_b32 s34, 4194304
 s_lshr_b32 s66, s89, 1
 s_lshl_b32 s66, s66, 18
 v_mfma_f32_16x16x32_bf16 v[24:27], v[220:223], a[172:175], v[24:27]
 s_xor_b32 s63, s63, s66
 s_lshr_b32 s66, s60, 1
 s_mul_i32 s66, s66, 1048704
 v_mfma_f32_16x16x32_bf16 v[28:31], v[208:211], a[176:179], v[28:31]
 s_xor_b32 s63, s63, s66
 s_xor_b32 m0, s88, 131072
 s_xor_b32 s67, s63, 0
 v_mfma_f32_16x16x32_bf16 v[28:31], v[212:215], a[180:183], v[28:31]
 buffer_load_dwordx4 v2, s[32:35], s67 offen lds
 v_mfma_f32_16x16x32_bf16 v[28:31], v[216:219], a[184:187], v[28:31]
 v_mfma_f32_16x16x32_bf16 v[28:31], v[220:223], a[188:191], v[28:31]
 s_waitcnt lgkmcnt(0)
 v_mfma_f32_16x16x32_bf16 v[32:35], v[224:227], a[128:131], v[32:35]
 ds_read_b64_tr_b16 v[208:209], v10 offset:32768
 v_mfma_f32_16x16x32_bf16 v[32:35], v[228:231], a[132:135], v[32:35]
 s_xor_b32 m0, s88, 132096
 ds_read_b64_tr_b16 v[210:211], v10 offset:33792
 v_mfma_f32_16x16x32_bf16 v[32:35], v[232:235], a[136:139], v[32:35]
 s_xor_b32 s68, s63, 32768
 ds_read_b64_tr_b16 v[212:213], v10 offset:36864
 v_mfma_f32_16x16x32_bf16 v[32:35], v[236:239], a[140:143], v[32:35]
 buffer_load_dwordx4 v2, s[32:35], s68 offen lds
 v_mfma_f32_16x16x32_bf16 v[36:39], v[224:227], a[144:147], v[36:39]
 ds_read_b64_tr_b16 v[214:215], v10 offset:37888
 v_mfma_f32_16x16x32_bf16 v[36:39], v[228:231], a[148:151], v[36:39]
 s_xor_b32 m0, s88, 133120
 ds_read_b64_tr_b16 v[216:217], v10 offset:40960
 v_mfma_f32_16x16x32_bf16 v[36:39], v[232:235], a[152:155], v[36:39]
 s_xor_b32 s65, s63, 131072
 ds_read_b64_tr_b16 v[218:219], v10 offset:41984
 v_mfma_f32_16x16x32_bf16 v[36:39], v[236:239], a[156:159], v[36:39]
 buffer_load_dwordx4 v2, s[32:35], s65 offen lds
 v_mfma_f32_16x16x32_bf16 v[40:43], v[224:227], a[160:163], v[40:43]
 ds_read_b64_tr_b16 v[220:221], v10 offset:45056
 v_mfma_f32_16x16x32_bf16 v[40:43], v[228:231], a[164:167], v[40:43]
 ds_read_b64_tr_b16 v[222:223], v10 offset:46080
 v_mfma_f32_16x16x32_bf16 v[40:43], v[232:235], a[168:171], v[40:43]
L_st2_5:
 s_cbranch_execz L_st2_9
 s_xor_b32 m0, s88, 134144
 s_xor_b32 s66, s63, 163840
 v_mfma_f32_16x16x32_bf16 v[40:43], v[236:239], a[172:175], v[40:43]
 buffer_load_dwordx4 v2, s[32:35], s66 offen lds
 v_mfma_f32_16x16x32_bf16 v[44:47], v[224:227], a[176:179], v[44:47]
 v_mfma_f32_16x16x32_bf16 v[44:47], v[228:231], a[180:183], v[44:47]
 v_mfma_f32_16x16x32_bf16 v[44:47], v[232:235], a[184:187], v[44:47]
 s_add_u32 s67, s100, 22030336
 v_mfma_f32_16x16x32_bf16 v[44:47], v[236:239], a[188:191], v[44:47]
 s_waitcnt lgkmcnt(0)
 v_mfma_f32_16x16x32_bf16 v[48:51], v[208:211], a[128:131], v[48:51]
 ds_read_b64_tr_b16 v[224:225], v11 offset:32768
 v_mfma_f32_16x16x32_bf16 v[48:51], v[212:215], a[132:135], v[48:51]
 ds_read_b64_tr_b16 v[226:227], v11 offset:33792
 v_mfma_f32_16x16x32_bf16 v[48:51], v[216:219], a[136:139], v[48:51]
 ds_read_b64_tr_b16 v[228:229], v11 offset:36864
 v_mfma_f32_16x16x32_bf16 v[48:51], v[220:223], a[140:143], v[48:51]
 buffer_store_dwordx4 v[144:147], v1, s[40:43], s67 offen offset:0 sc1
 v_mfma_f32_16x16x32_bf16 v[52:55], v[208:211], a[144:147], v[52:55]
 ds_read_b64_tr_b16 v[230:231], v11 offset:37888
 v_mfma_f32_16x16x32_bf16 v[52:55], v[212:215], a[148:151], v[52:55]
 s_xor_b32 m0, s88, 135168
 ds_read_b64_tr_b16 v[232:233], v11 offset:40960
 v_mfma_f32_16x16x32_bf16 v[52:55], v[216:219], a[152:155], v[52:55]
 s_xor_b32 s68, s63, 262144
 ds_read_b64_tr_b16 v[234:235], v11 offset:41984
 v_mfma_f32_16x16x32_bf16 v[52:55], v[220:223], a[156:159], v[52:55]
 buffer_load_dwordx4 v2, s[32:35], s68 offen lds
 v_mfma_f32_16x16x32_bf16 v[56:59], v[208:211], a[160:163], v[56:59]
 s_xor_b32 m0, s88, 136192
 ds_read_b64_tr_b16 v[236:237], v11 offset:45056
 v_mfma_f32_16x16x32_bf16 v[56:59], v[212:215], a[164:167], v[56:59]
 s_xor_b32 s65, s63, 294912
 ds_read_b64_tr_b16 v[238:239], v11 offset:46080
 v_mfma_f32_16x16x32_bf16 v[56:59], v[216:219], a[168:171], v[56:59]
 buffer_load_dwordx4 v2, s[32:35], s65 offen lds
 v_mfma_f32_16x16x32_bf16 v[56:59], v[220:223], a[172:175], v[56:59]
 v_mfma_f32_16x16x32_bf16 v[60:63], v[208:211], a[176:179], v[60:63]
 s_xor_b32 m0, s88, 137216
 v_mfma_f32_16x16x32_bf16 v[60:63], v[212:215], a[180:183], v[60:63]
 s_xor_b32 s66, s63, 393216
 v_mfma_f32_16x16x32_bf16 v[60:63], v[216:219], a[184:187], v[60:63]
 buffer_load_dwordx4 v2, s[32:35], s66 offen lds
 v_mfma_f32_16x16x32_bf16 v[60:63], v[220:223], a[188:191], v[60:63]
 s_waitcnt vmcnt(36) lgkmcnt(0)
 v_mfma_f32_16x16x32_bf16 v[64:67], v[224:227], a[128:131], v[64:67]
 ds_read_b64_tr_b16 v[208:209], v8 offset:49152
 v_add_u32 v4, 65536, v1
 v_mfma_f32_16x16x32_bf16 v[64:67], v[228:231], a[132:135], v[64:67]
 ds_read_b64_tr_b16 v[210:211], v8 offset:50176
 v_add_u32 v5, 98304, v1
 v_mfma_f32_16x16x32_bf16 v[64:67], v[232:235], a[136:139], v[64:67]
 ds_read_b64_tr_b16 v[212:213], v8 offset:53248
 v_mov_b32 v6, v1
 v_mfma_f32_16x16x32_bf16 v[64:67], v[236:239], a[140:143], v[64:67]
 s_add_u32 s67, s101, 22030336
 v_add_u32 v7, 32768, v1
 v_mfma_f32_16x16x32_bf16 v[68:71], v[224:227], a[144:147], v[68:71]
 ds_read_b64_tr_b16 v[214:215], v8 offset:54272
 v_mfma_f32_16x16x32_bf16 v[68:71], v[228:231], a[148:151], v[68:71]
 ds_read_b64_tr_b16 v[216:217], v8 offset:57344
 v_mfma_f32_16x16x32_bf16 v[68:71], v[232:235], a[152:155], v[68:71]
 ds_read_b64_tr_b16 v[218:219], v8 offset:58368
 v_mfma_f32_16x16x32_bf16 v[68:71], v[236:239], a[156:159], v[68:71]
 buffer_store_dwordx4 v[148:151], v1, s[40:43], s67 offen offset:1024 sc1
 v_mfma_f32_16x16x32_bf16 v[72:75], v[224:227], a[160:163], v[72:75]
 s_xor_b32 m0, s88, 138240
 ds_read_b64_tr_b16 v[220:221], v8 offset:61440
 v_mfma_f32_16x16x32_bf16 v[72:75], v[228:231], a[164:167], v[72:75]
 s_xor_b32 s68, s63, 425984
 ds_read_b64_tr_b16 v[222:223], v8 offset:62464
 v_mfma_f32_16x16x32_bf16 v[72:75], v[232:235], a[168:171], v[72:75]
 buffer_load_dwordx4 v2, s[32:35], s68 offen lds
 v_mfma_f32_16x16x32_bf16 v[72:75], v[236:239], a[172:175], v[72:75]
 v_mfma_f32_16x16x32_bf16 v[76:79], v[224:227], a[176:179], v[76:79]
 v_mfma_f32_16x16x32_bf16 v[76:79], v[228:231], a[180:183], v[76:79]
 s_add_u32 s65, s100, 22030336
 v_mfma_f32_16x16x32_bf16 v[76:79], v[232:235], a[184:187], v[76:79]
 buffer_store_dwordx4 v[152:155], v1, s[40:43], s65 offen offset:2048 sc1
 v_mfma_f32_16x16x32_bf16 v[76:79], v[236:239], a[188:191], v[76:79]
 s_waitcnt vmcnt(11) lgkmcnt(0)
 v_mfma_f32_16x16x32_bf16 v[16:19], v[208:211], a[192:195], v[16:19]
 ds_read_b64_tr_b16 v[224:225], v9 offset:49152
 v_mfma_f32_16x16x32_bf16 v[16:19], v[212:215], a[196:199], v[16:19]
 s_xor_b32 m0, s88, 0
 ds_read_b64_tr_b16 v[226:227], v9 offset:50176
 v_mfma_f32_16x16x32_bf16 v[16:19], v[216:219], a[200:203], v[16:19]
 s_xor_b32 s66, s63, 2097152
 ds_read_b64_tr_b16 v[228:229], v9 offset:53248
 v_mfma_f32_16x16x32_bf16 v[16:19], v[220:223], a[204:207], v[16:19]
 buffer_load_dwordx4 v2, s[32:35], s66 offen lds
 v_mfma_f32_16x16x32_bf16 v[20:23], v[208:211], a[208:211], v[20:23]
 ds_read_b64_tr_b16 v[230:231], v9 offset:54272
 v_mfma_f32_16x16x32_bf16 v[20:23], v[212:215], a[212:215], v[20:23]
 ds_read_b64_tr_b16 v[232:233], v9 offset:57344
 v_mfma_f32_16x16x32_bf16 v[20:23], v[216:219], a[216:219], v[20:23]
 ds_read_b64_tr_b16 v[234:235], v9 offset:58368
 v_mul_f32 v240, s30, v16
 v_mfma_f32_16x16x32_bf16 v[20:23], v[220:223], a[220:223], v[20:23]
 v_exp_f32 v240, v240
 v_mfma_f32_16x16x32_bf16 v[24:27], v[208:211], a[224:227], v[24:27]
 ds_read_b64_tr_b16 v[236:237], v9 offset:61440
 v_mul_f32 v241, s30, v17
 v_mfma_f32_16x16x32_bf16 v[24:27], v[212:215], a[228:231], v[24:27]
 ds_read_b64_tr_b16 v[238:239], v9 offset:62464
 v_mul_f32 v242, s30, v18
 v_mfma_f32_16x16x32_bf16 v[24:27], v[216:219], a[232:235], v[24:27]
 v_exp_f32 v241, v241
 v_mfma_f32_16x16x32_bf16 v[24:27], v[220:223], a[236:239], v[24:27]
 v_exp_f32 v242, v242
 v_mfma_f32_16x16x32_bf16 v[28:31], v[208:211], a[240:243], v[28:31]
 s_add_u32 s67, s101, 22030336
 v_mul_f32 v243, s30, v19
 v_add_f32 v240, 1.0, v240
 v_mfma_f32_16x16x32_bf16 v[28:31], v[212:215], a[244:247], v[28:31]
 buffer_store_dwordx4 v[156:159], v1, s[40:43], s67 offen offset:3072 sc1
 v_exp_f32 v243, v243
 v_fma_f32 v240, v240, v240, 1.0
 v_mfma_f32_16x16x32_bf16 v[28:31], v[216:219], a[248:251], v[28:31]
 v_rcp_f32 v240, v240
 v_mfma_f32_16x16x32_bf16 v[28:31], v[220:223], a[252:255], v[28:31]
 s_waitcnt lgkmcnt(0)
 v_add_f32 v241, 1.0, v241
 v_fma_f32 v241, v241, v241, 1.0
 v_mfma_f32_16x16x32_bf16 v[32:35], v[224:227], a[192:195], v[32:35]
 ds_read_b64_tr_b16 v[208:209], v10 offset:49152
 v_add_f32 v242, 1.0, v242
 v_mfma_f32_16x16x32_bf16 v[32:35], v[228:231], a[196:199], v[32:35]
 s_xor_b32 m0, s88, 1024
 ds_read_b64_tr_b16 v[210:211], v10 offset:50176
 v_fma_f32 v242, v242, v242, 1.0
 v_mfma_f32_16x16x32_bf16 v[32:35], v[232:235], a[200:203], v[32:35]
 s_xor_b32 s68, s63, 2129920
 ds_read_b64_tr_b16 v[212:213], v10 offset:53248
 v_add_f32 v243, 1.0, v243
 v_mfma_f32_16x16x32_bf16 v[32:35], v[236:239], a[204:207], v[32:35]
 buffer_load_dwordx4 v2, s[32:35], s68 offen lds
 v_mfma_f32_16x16x32_bf16 v[36:39], v[224:227], a[208:211], v[36:39]
 ds_read_b64_tr_b16 v[214:215], v10 offset:54272
 v_fma_f32 v243, v243, v243, 1.0
 v_mfma_f32_16x16x32_bf16 v[36:39], v[228:231], a[212:215], v[36:39]
 ds_read_b64_tr_b16 v[216:217], v10 offset:57344
 v_fma_f32 v240, v240, -2.0, 1.0
 v_mfma_f32_16x16x32_bf16 v[36:39], v[232:235], a[216:219], v[36:39]
 ds_read_b64_tr_b16 v[218:219], v10 offset:58368
 v_mul_f32 v244, s30, v32
 v_mfma_f32_16x16x32_bf16 v[36:39], v[236:239], a[220:223], v[36:39]
 v_exp_f32 v244, v244
 v_mfma_f32_16x16x32_bf16 v[40:43], v[224:227], a[224:227], v[40:43]
 ds_read_b64_tr_b16 v[220:221], v10 offset:61440
 v_mul_f32 v245, s30, v33
 v_mfma_f32_16x16x32_bf16 v[40:43], v[228:231], a[228:231], v[40:43]
 ds_read_b64_tr_b16 v[222:223], v10 offset:62464
 v_mul_f32 v246, s30, v34
 v_mfma_f32_16x16x32_bf16 v[40:43], v[232:235], a[232:235], v[40:43]
 s_xor_b32 m0, s88, 2048
 v_exp_f32 v245, v245
 v_mfma_f32_16x16x32_bf16 v[40:43], v[236:239], a[236:239], v[40:43]
 s_xor_b32 s65, s63, 2228224
 v_exp_f32 v246, v246
 v_mfma_f32_16x16x32_bf16 v[44:47], v[224:227], a[240:243], v[44:47]
 buffer_load_dwordx4 v2, s[32:35], s65 offen lds
 v_mfma_f32_16x16x32_bf16 v[44:47], v[228:231], a[244:247], v[44:47]
 v_rcp_f32 v241, v241
 v_mfma_f32_16x16x32_bf16 v[44:47], v[232:235], a[248:251], v[44:47]
 s_add_u32 s66, s100, 22034432
 v_rcp_f32 v242, v242
 v_mfma_f32_16x16x32_bf16 v[44:47], v[236:239], a[252:255], v[44:47]
 s_waitcnt lgkmcnt(0)
 v_rcp_f32 v243, v243
 v_mfma_f32_16x16x32_bf16 v[48:51], v[208:211], a[192:195], v[48:51]
 ds_read_b64_tr_b16 v[224:225], v11 offset:49152
 v_mul_f32 v247, s30, v35
 v_mfma_f32_16x16x32_bf16 v[48:51], v[212:215], a[196:199], v[48:51]
 ds_read_b64_tr_b16 v[226:227], v11 offset:50176
 v_add_f32 v244, 1.0, v244
 v_mfma_f32_16x16x32_bf16 v[48:51], v[216:219], a[200:203], v[48:51]
 ds_read_b64_tr_b16 v[228:229], v11 offset:53248
 v_fma_f32 v244, v244, v244, 1.0
 v_mfma_f32_16x16x32_bf16 v[48:51], v[220:223], a[204:207], v[48:51]
 buffer_store_dwordx4 v[160:163], v1, s[40:43], s66 offen offset:0 sc1
 v_exp_f32 v247, v247
 v_add_f32 v245, 1.0, v245
 v_mfma_f32_16x16x32_bf16 v[52:55], v[208:211], a[208:211], v[52:55]
 ds_read_b64_tr_b16 v[230:231], v11 offset:54272
 v_fma_f32 v245, v245, v245, 1.0
 v_mfma_f32_16x16x32_bf16 v[52:55], v[212:215], a[212:215], v[52:55]
 ds_read_b64_tr_b16 v[232:233], v11 offset:57344
 v_add_f32 v246, 1.0, v246
 v_mfma_f32_16x16x32_bf16 v[52:55], v[216:219], a[216:219], v[52:55]
 ds_read_b64_tr_b16 v[234:235], v11 offset:58368
 v_fma_f32 v246, v246, v246, 1.0
 v_mfma_f32_16x16x32_bf16 v[52:55], v[220:223], a[220:223], v[52:55]
 s_xor_b32 m0, s88, 3072
 v_rcp_f32 v244, v244
 v_mfma_f32_16x16x32_bf16 v[56:59], v[208:211], a[224:227], v[56:59]
 ds_read_b64_tr_b16 v[236:237], v11 offset:61440
 v_add_f32 v247, 1.0, v247
 v_mfma_f32_16x16x32_bf16 v[56:59], v[212:215], a[228:231], v[56:59]
 ds_read_b64_tr_b16 v[238:239], v11 offset:62464
 v_fma_f32 v247, v247, v247, 1.0
 v_mfma_f32_16x16x32_bf16 v[56:59], v[216:219], a[232:235], v[56:59]
 s_xor_b32 s67, s63, 2260992
 v_rcp_f32 v245, v245
 v_mfma_f32_16x16x32_bf16 v[56:59], v[220:223], a[236:239], v[56:59]
 buffer_load_dwordx4 v2, s[32:35], s67 offen lds
 v_mfma_f32_16x16x32_bf16 v[60:63], v[208:211], a[240:243], v[60:63]
 v_rcp_f32 v246, v246
 v_mfma_f32_16x16x32_bf16 v[60:63], v[212:215], a[244:247], v[60:63]
 s_add_u32 s68, s101, 22034432
 v_rcp_f32 v247, v247
 v_mfma_f32_16x16x32_bf16 v[60:63], v[216:219], a[248:251], v[60:63]
 buffer_store_dwordx4 v[164:167], v1, s[40:43], s68 offen offset:1024 sc1
 v_mul_f32 v240, v240, v16
 v_fma_f32 v241, v241, -2.0, 1.0
 v_mul_f32 v241, v241, v17
 v_mfma_f32_16x16x32_bf16 v[60:63], v[220:223], a[252:255], v[60:63]
 s_waitcnt vmcnt(8) lgkmcnt(0)
 s_barrier
 v_mfma_f32_16x16x32_bf16 v[64:67], v[224:227], a[192:195], v[64:67]
 ds_read_b64_tr_b16 v[208:209], v12 offset:0
 v_fma_f32 v242, v242, -2.0, 1.0
 v_mfma_f32_16x16x32_bf16 v[64:67], v[228:231], a[196:199], v[64:67]
 ds_read_b64_tr_b16 v[210:211], v12 offset:1024
 v_mul_f32 v242, v242, v18
 v_mfma_f32_16x16x32_bf16 v[64:67], v[232:235], a[200:203], v[64:67]
 ds_read_b64_tr_b16 v[212:213], v12 offset:4096
 v_fma_f32 v243, v243, -2.0, 1.0
 v_mfma_f32_16x16x32_bf16 v[64:67], v[236:239], a[204:207], v[64:67]
 s_xor_b32 m0, s88, 4096
 v_mul_f32 v243, v243, v19
 v_cvt_pk_bf16_f32 v16, v240, v241
 v_mfma_f32_16x16x32_bf16 v[68:71], v[224:227], a[208:211], v[68:71]
 ds_read_b64_tr_b16 v[214:215], v12 offset:5120
 v_cvt_pk_bf16_f32 v17, v242, v243
 v_mfma_f32_16x16x32_bf16 v[68:71], v[228:231], a[212:215], v[68:71]
 ds_read_b64_tr_b16 v[216:217], v12 offset:8192
 v_fma_f32 v244, v244, -2.0, 1.0
 v_mfma_f32_16x16x32_bf16 v[68:71], v[232:235], a[216:219], v[68:71]
 ds_read_b64_tr_b16 v[218:219], v12 offset:9216
 v_mul_f32 v244, v244, v32
 v_mfma_f32_16x16x32_bf16 v[68:71], v[236:239], a[220:223], v[68:71]
 s_xor_b32 s65, s63, 2359296
 v_fma_f32 v245, v245, -2.0, 1.0
 v_mul_f32 v245, v245, v33
 v_mfma_f32_16x16x32_bf16 v[72:75], v[224:227], a[224:227], v[72:75]
 ds_read_b64_tr_b16 v[220:221], v12 offset:12288
 v_fma_f32 v246, v246, -2.0, 1.0
 v_mfma_f32_16x16x32_bf16 v[72:75], v[228:231], a[228:231], v[72:75]
 ds_read_b64_tr_b16 v[222:223], v12 offset:13312
 v_mul_f32 v246, v246, v34
 v_mfma_f32_16x16x32_bf16 v[72:75], v[232:235], a[232:235], v[72:75]
 buffer_load_dwordx4 v2, s[32:35], s65 offen lds
 v_mfma_f32_16x16x32_bf16 v[72:75], v[236:239], a[236:239], v[72:75]
 v_fma_f32 v247, v247, -2.0, 1.0
 v_mul_f32 v247, v247, v35
 v_mfma_f32_16x16x32_bf16 v[76:79], v[224:227], a[240:243], v[76:79]
 s_add_u32 s66, s100, 22034432
 v_cvt_pk_bf16_f32 v18, v244, v245
 v_cvt_pk_bf16_f32 v19, v246, v247
 v_mfma_f32_16x16x32_bf16 v[76:79], v[228:231], a[244:247], v[76:79]
 buffer_store_dwordx4 v[168:171], v1, s[40:43], s66 offen offset:2048 sc1
 v_mul_f32 v240, s30, v20
 v_mul_f32 v241, s30, v21
 v_mul_f32 v242, s30, v22
 v_mfma_f32_16x16x32_bf16 v[76:79], v[232:235], a[248:251], v[76:79]
 v_exp_f32 v240, v240
 v_mfma_f32_16x16x32_bf16 v[76:79], v[236:239], a[252:255], v[76:79]
 s_waitcnt lgkmcnt(0)
 v_exp_f32 v241, v241
 v_mfma_f32_16x16x32_bf16 v[80:83], v[208:211], a[0:3], 0
 ds_read_b64_tr_b16 v[224:225], v13 offset:0
 v_mul_f32 v243, s30, v23
 v_mfma_f32_16x16x32_bf16 v[80:83], v[212:215], a[4:7], v[80:83]
 ds_read_b64_tr_b16 v[226:227], v13 offset:1024
 v_mul_f32 v244, s30, v36
 v_mfma_f32_16x16x32_bf16 v[80:83], v[216:219], a[8:11], v[80:83]
 ds_read_b64_tr_b16 v[228:229], v13 offset:4096
 v_mul_f32 v245, s30, v37
 v_mfma_f32_16x16x32_bf16 v[80:83], v[220:223], a[12:15], v[80:83]
 s_xor_b32 m0, s88, 5120
 v_exp_f32 v242, v242
 v_mfma_f32_16x16x32_bf16 v[84:87], v[208:211], a[16:19], 0
 ds_read_b64_tr_b16 v[230:231], v13 offset:5120
 v_mul_f32 v246, s30, v38
 v_mfma_f32_16x16x32_bf16 v[84:87], v[212:215], a[20:23], v[84:87]
 ds_read_b64_tr_b16 v[232:233], v13 offset:8192
 v_mul_f32 v247, s30, v39
 v_mfma_f32_16x16x32_bf16 v[84:87], v[216:219], a[24:27], v[84:87]
 ds_read_b64_tr_b16 v[234:235], v13 offset:9216
 v_add_f32 v240, 1.0, v240
 v_mfma_f32_16x16x32_bf16 v[84:87], v[220:223], a[28:31], v[84:87]
 s_xor_b32 s67, s63, 2392064
 v_exp_f32 v243, v243
 v_mfma_f32_16x16x32_bf16 v[88:91], v[208:211], a[32:35], 0
 ds_read_b64_tr_b16 v[236:237], v13 offset:12288
 v_fma_f32 v240, v240, v240, 1.0
 v_mfma_f32_16x16x32_bf16 v[88:91], v[212:215], a[36:39], v[88:91]
 ds_read_b64_tr_b16 v[238:239], v13 offset:13312
 v_add_f32 v241, 1.0, v241
 v_mfma_f32_16x16x32_bf16 v[88:91], v[216:219], a[40:43], v[88:91]
 buffer_load_dwordx4 v2, s[32:35], s67 offen lds
 v_mfma_f32_16x16x32_bf16 v[88:91], v[220:223], a[44:47], v[88:91]
 v_exp_f32 v244, v244
 v_mfma_f32_16x16x32_bf16 v[92:95], v[208:211], a[48:51], 0
 s_add_u32 s68, s101, 22034432
 v_exp_f32 v245, v245
 v_mfma_f32_16x16x32_bf16 v[92:95], v[212:215], a[52:55], v[92:95]
 buffer_store_dwordx4 v[172:175], v1, s[40:43], s68 offen offset:3072 sc1
 v_exp_f32 v246, v246
 v_fma_f32 v241, v241, v241, 1.0
 v_mfma_f32_16x16x32_bf16 v[92:95], v[216:219], a[56:59], v[92:95]
 s_xor_b32 m0, s88, 6144
 v_exp_f32 v247, v247
 v_mfma_f32_16x16x32_bf16 v[92:95], v[220:223], a[60:63], v[92:95]
 s_waitcnt lgkmcnt(0)
 v_rcp_f32 v240, v240
 v_mfma_f32_16x16x32_bf16 v[96:99], v[224:227], a[0:3], 0
 ds_read_b64_tr_b16 v[208:209], v14 offset:0
 v_add_f32 v242, 1.0, v242
 v_mfma_f32_16x16x32_bf16 v[96:99], v[228:231], a[4:7], v[96:99]
 ds_read_b64_tr_b16 v[210:211], v14 offset:1024
 v_fma_f32 v242, v242, v242, 1.0
 v_mfma_f32_16x16x32_bf16 v[96:99], v[232:235], a[8:11], v[96:99]
 ds_read_b64_tr_b16 v[212:213], v14 offset:4096
 v_add_f32 v243, 1.0, v243
 v_mfma_f32_16x16x32_bf16 v[96:99], v[236:239], a[12:15], v[96:99]
 s_xor_b32 s65, s63, 2490368
 v_rcp_f32 v241, v241
 v_mfma_f32_16x16x32_bf16 v[100:103], v[224:227], a[16:19], 0
 ds_read_b64_tr_b16 v[214:215], v14 offset:5120
 v_fma_f32 v243, v243, v243, 1.0
 v_mfma_f32_16x16x32_bf16 v[100:103], v[228:231], a[20:23], v[100:103]
 ds_read_b64_tr_b16 v[216:217], v14 offset:8192
 v_add_f32 v244, 1.0, v244
 v_mfma_f32_16x16x32_bf16 v[100:103], v[232:235], a[24:27], v[100:103]
 ds_read_b64_tr_b16 v[218:219], v14 offset:9216
 v_fma_f32 v244, v244, v244, 1.0
 v_mfma_f32_16x16x32_bf16 v[100:103], v[236:239], a[28:31], v[100:103]
 buffer_load_dwordx4 v2, s[32:35], s65 offen lds
 v_mfma_f32_16x16x32_bf16 v[104:107], v[224:227], a[32:35], 0
 ds_read_b64_tr_b16 v[220:221], v14 offset:12288
 v_add_f32 v245, 1.0, v245
 v_mfma_f32_16x16x32_bf16 v[104:107], v[228:231], a[36:39], v[104:107]
 s_add_u32 s66, s100, 22038528
 ds_read_b64_tr_b16 v[222:223], v14 offset:13312
 v_fma_f32 v245, v245, v245, 1.0
 v_mfma_f32_16x16x32_bf16 v[104:107], v[232:235], a[40:43], v[104:107]
 buffer_store_dwordx4 v[176:179], v1, s[40:43], s66 offen offset:0 sc1
 v_rcp_f32 v242, v242
 v_add_f32 v246, 1.0, v246
 v_mfma_f32_16x16x32_bf16 v[104:107], v[236:239], a[44:47], v[104:107]
 v_rcp_f32 v243, v243
 v_mfma_f32_16x16x32_bf16 v[108:111], v[224:227], a[48:51], 0
 v_rcp_f32 v244, v244
 v_mfma_f32_16x16x32_bf16 v[108:111], v[228:231], a[52:55], v[108:111]
 v_rcp_f32 v245, v245
 v_mfma_f32_16x16x32_bf16 v[108:111], v[232:235], a[56:59], v[108:111]
 s_xor_b32 m0, s88, 7168
 v_fma_f32 v246, v246, v246, 1.0
 v_add_f32 v247, 1.0, v247
 v_mfma_f32_16x16x32_bf16 v[108:111], v[236:239], a[60:63], v[108:111]
 s_waitcnt lgkmcnt(0)
 v_rcp_f32 v246, v246
 v_mfma_f32_16x16x32_bf16 v[112:115], v[208:211], a[0:3], 0
 ds_read_b64_tr_b16 v[224:225], v15 offset:0
 v_fma_f32 v247, v247, v247, 1.0
 v_mfma_f32_16x16x32_bf16 v[112:115], v[212:215], a[4:7], v[112:115]
 ds_read_b64_tr_b16 v[226:227], v15 offset:1024
 v_fma_f32 v240, v240, -2.0, 1.0
 v_mfma_f32_16x16x32_bf16 v[112:115], v[216:219], a[8:11], v[112:115]
 ds_read_b64_tr_b16 v[228:229], v15 offset:4096
 v_mul_f32 v240, v240, v20
 v_mfma_f32_16x16x32_bf16 v[112:115], v[220:223], a[12:15], v[112:115]
 s_xor_b32 s67, s63, 2523136
 v_rcp_f32 v247, v247
 v_mfma_f32_16x16x32_bf16 v[116:119], v[208:211], a[16:19], 0
 ds_read_b64_tr_b16 v[230:231], v15 offset:5120
 v_fma_f32 v241, v241, -2.0, 1.0
 v_mfma_f32_16x16x32_bf16 v[116:119], v[212:215], a[20:23], v[116:119]
 ds_read_b64_tr_b16 v[232:233], v15 offset:8192
 v_mul_f32 v241, v241, v21
 v_mfma_f32_16x16x32_bf16 v[116:119], v[216:219], a[24:27], v[116:119]
 ds_read_b64_tr_b16 v[234:235], v15 offset:9216
 v_fma_f32 v242, v242, -2.0, 1.0
 v_mfma_f32_16x16x32_bf16 v[116:119], v[220:223], a[28:31], v[116:119]
 buffer_load_dwordx4 v2, s[32:35], s67 offen lds
 v_mfma_f32_16x16x32_bf16 v[120:123], v[208:211], a[32:35], 0
 ds_read_b64_tr_b16 v[236:237], v15 offset:12288
 v_mul_f32 v242, v242, v22
 v_mfma_f32_16x16x32_bf16 v[120:123], v[212:215], a[36:39], v[120:123]
 s_add_u32 s68, s101, 22038528
 ds_read_b64_tr_b16 v[238:239], v15 offset:13312
 v_fma_f32 v243, v243, -2.0, 1.0
 v_mfma_f32_16x16x32_bf16 v[120:123], v[216:219], a[40:43], v[120:123]
 buffer_store_dwordx4 v[180:183], v1, s[40:43], s68 offen offset:1024 sc1
 v_mul_f32 v243, v243, v23
 v_cvt_pk_bf16_f32 v20, v240, v241
 v_cvt_pk_bf16_f32 v21, v242, v243
 v_mfma_f32_16x16x32_bf16 v[120:123], v[220:223], a[44:47], v[120:123]
 v_fma_f32 v244, v244, -2.0, 1.0
 v_mul_f32 v244, v244, v36
 v_mfma_f32_16x16x32_bf16 v[124:127], v[208:211], a[48:51], 0
 v_fma_f32 v245, v245, -2.0, 1.0
 v_mul_f32 v245, v245, v37
 v_mfma_f32_16x16x32_bf16 v[124:127], v[212:215], a[52:55], v[124:127]
 v_fma_f32 v246, v246, -2.0, 1.0
 v_mul_f32 v246, v246, v38
 v_mfma_f32_16x16x32_bf16 v[124:127], v[216:219], a[56:59], v[124:127]
 v_fma_f32 v247, v247, -2.0, 1.0
 v_mul_f32 v247, v247, v39
 v_mfma_f32_16x16x32_bf16 v[124:127], v[220:223], a[60:63], v[124:127]
 s_waitcnt vmcnt(36) lgkmcnt(0)
 v_cvt_pk_bf16_f32 v22, v244, v245
 v_cvt_pk_bf16_f32 v23, v246, v247
 v_mfma_f32_16x16x32_bf16 v[128:131], v[224:227], a[0:3], 0
 ds_read_b64_tr_b16 v[208:209], v12 offset:16384
 v_mul_f32 v240, s30, v24
 v_mfma_f32_16x16x32_bf16 v[128:131], v[228:231], a[4:7], v[128:131]
 ds_read_b64_tr_b16 v[210:211], v12 offset:17408
 v_mul_f32 v241, s30, v25
 v_mfma_f32_16x16x32_bf16 v[128:131], v[232:235], a[8:11], v[128:131]
 ds_read_b64_tr_b16 v[212:213], v12 offset:20480
 v_mul_f32 v242, s30, v26
 v_mfma_f32_16x16x32_bf16 v[128:131], v[236:239], a[12:15], v[128:131]
 v_exp_f32 v240, v240
 v_mfma_f32_16x16x32_bf16 v[132:135], v[224:227], a[16:19], 0
 ds_read_b64_tr_b16 v[214:215], v12 offset:21504
 v_mul_f32 v243, s30, v27
 v_mfma_f32_16x16x32_bf16 v[132:135], v[228:231], a[20:23], v[132:135]
 ds_read_b64_tr_b16 v[216:217], v12 offset:24576
 v_mul_f32 v244, s30, v40
 v_mfma_f32_16x16x32_bf16 v[132:135], v[232:235], a[24:27], v[132:135]
 ds_read_b64_tr_b16 v[218:219], v12 offset:25600
 v_mul_f32 v245, s30, v41
 v_mfma_f32_16x16x32_bf16 v[132:135], v[236:239], a[28:31], v[132:135]
 s_add_u32 s65, s100, 22038528
 v_exp_f32 v241, v241
 v_mfma_f32_16x16x32_bf16 v[136:139], v[224:227], a[32:35], 0
 ds_read_b64_tr_b16 v[220:221], v12 offset:28672
 v_mul_f32 v246, s30, v42
 v_mfma_f32_16x16x32_bf16 v[136:139], v[228:231], a[36:39], v[136:139]
 ds_read_b64_tr_b16 v[222:223], v12 offset:29696
 v_mul_f32 v247, s30, v43
 v_mfma_f32_16x16x32_bf16 v[136:139], v[232:235], a[40:43], v[136:139]
 buffer_store_dwordx4 v[184:187], v1, s[40:43], s65 offen offset:2048 sc1
 v_exp_f32 v242, v242
 v_add_f32 v240, 1.0, v240
 v_mfma_f32_16x16x32_bf16 v[136:139], v[236:239], a[44:47], v[136:139]
 v_exp_f32 v243, v243
 v_mfma_f32_16x16x32_bf16 v[140:143], v[224:227], a[48:51], 0
 v_exp_f32 v244, v244
 v_mfma_f32_16x16x32_bf16 v[140:143], v[228:231], a[52:55], v[140:143]
 s_xor_b32 m0, s88, 32768
 v_exp_f32 v245, v245
 v_mfma_f32_16x16x32_bf16 v[140:143], v[232:235], a[56:59], v[140:143]
 s_xor_b32 s66, s63, 128
 v_exp_f32 v246, v246
 v_mfma_f32_16x16x32_bf16 v[140:143], v[236:239], a[60:63], v[140:143]
 s_waitcnt lgkmcnt(0)
 v_exp_f32 v247, v247
 v_mfma_f32_16x16x32_bf16 v[80:83], v[208:211], a[64:67], v[80:83]
 ds_read_b64_tr_b16 v[224:225], v13 offset:16384
 v_fma_f32 v240, v240, v240, 1.0
 v_mfma_f32_16x16x32_bf16 v[80:83], v[212:215], a[68:71], v[80:83]
 ds_read_b64_tr_b16 v[226:227], v13 offset:17408
 v_add_f32 v241, 1.0, v241
 v_mfma_f32_16x16x32_bf16 v[80:83], v[216:219], a[72:75], v[80:83]
 ds_read_b64_tr_b16 v[228:229], v13 offset:20480
 v_fma_f32 v241, v241, v241, 1.0
 v_mfma_f32_16x16x32_bf16 v[80:83], v[220:223], a[76:79], v[80:83]
 buffer_load_dwordx4 v2, s[32:35], s66 offen lds
 v_mfma_f32_16x16x32_bf16 v[84:87], v[208:211], a[80:83], v[84:87]
 ds_read_b64_tr_b16 v[230:231], v13 offset:21504
 v_add_f32 v242, 1.0, v242
 v_mfma_f32_16x16x32_bf16 v[84:87], v[212:215], a[84:87], v[84:87]
 ds_read_b64_tr_b16 v[232:233], v13 offset:24576
 v_fma_f32 v242, v242, v242, 1.0
 v_mfma_f32_16x16x32_bf16 v[84:87], v[216:219], a[88:91], v[84:87]
 s_add_u32 s67, s101, 22038528
 ds_read_b64_tr_b16 v[234:235], v13 offset:25600
 v_add_f32 v243, 1.0, v243
 v_mfma_f32_16x16x32_bf16 v[84:87], v[220:223], a[92:95], v[84:87]
 buffer_store_dwordx4 v[188:191], v1, s[40:43], s67 offen offset:3072 sc1
 v_rcp_f32 v240, v240
 v_fma_f32 v243, v243, v243, 1.0
 v_mfma_f32_16x16x32_bf16 v[88:91], v[208:211], a[96:99], v[88:91]
 ds_read_b64_tr_b16 v[236:237], v13 offset:28672
 v_add_f32 v244, 1.0, v244
 v_mfma_f32_16x16x32_bf16 v[88:91], v[212:215], a[100:103], v[88:91]
 ds_read_b64_tr_b16 v[238:239], v13 offset:29696
 v_fma_f32 v244, v244, v244, 1.0
 v_mfma_f32_16x16x32_bf16 v[88:91], v[216:219], a[104:107], v[88:91]
 v_rcp_f32 v241, v241
 v_mfma_f32_16x16x32_bf16 v[88:91], v[220:223], a[108:111], v[88:91]
 v_rcp_f32 v242, v242
 v_mfma_f32_16x16x32_bf16 v[92:95], v[208:211], a[112:115], v[92:95]
 s_xor_b32 m0, s88, 33792
 v_rcp_f32 v243, v243
 v_mfma_f32_16x16x32_bf16 v[92:95], v[212:215], a[116:119], v[92:95]
 s_xor_b32 s68, s63, 32896
 v_rcp_f32 v244, v244
 v_mfma_f32_16x16x32_bf16 v[92:95], v[216:219], a[120:123], v[92:95]
 buffer_load_dwordx4 v2, s[32:35], s68 offen lds
 v_mfma_f32_16x16x32_bf16 v[92:95], v[220:223], a[124:127], v[92:95]
 s_waitcnt lgkmcnt(0)
 v_add_f32 v245, 1.0, v245
 v_fma_f32 v245, v245, v245, 1.0
 v_mfma_f32_16x16x32_bf16 v[96:99], v[224:227], a[64:67], v[96:99]
 ds_read_b64_tr_b16 v[208:209], v14 offset:16384
 v_add_f32 v246, 1.0, v246
 v_mfma_f32_16x16x32_bf16 v[96:99], v[228:231], a[68:71], v[96:99]
 ds_read_b64_tr_b16 v[210:211], v14 offset:17408
 v_fma_f32 v246, v246, v246, 1.0
 v_mfma_f32_16x16x32_bf16 v[96:99], v[232:235], a[72:75], v[96:99]
 ds_read_b64_tr_b16 v[212:213], v14 offset:20480
 v_add_f32 v247, 1.0, v247
 v_mfma_f32_16x16x32_bf16 v[96:99], v[236:239], a[76:79], v[96:99]
 s_add_u32 s65, s100, 22042624
 v_rcp_f32 v245, v245
 v_mfma_f32_16x16x32_bf16 v[100:103], v[224:227], a[80:83], v[100:103]
 ds_read_b64_tr_b16 v[214:215], v14 offset:21504
 v_fma_f32 v247, v247, v247, 1.0
 v_mfma_f32_16x16x32_bf16 v[100:103], v[228:231], a[84:87], v[100:103]
 ds_read_b64_tr_b16 v[216:217], v14 offset:24576
 v_fma_f32 v240, v240, -2.0, 1.0
 v_mfma_f32_16x16x32_bf16 v[100:103], v[232:235], a[88:91], v[100:103]
 ds_read_b64_tr_b16 v[218:219], v14 offset:25600
 v_mul_f32 v240, v240, v24
 v_mfma_f32_16x16x32_bf16 v[100:103], v[236:239], a[92:95], v[100:103]
 buffer_store_dwordx4 v[192:195], v1, s[40:43], s65 offen offset:0 sc1
 v_rcp_f32 v246, v246
 v_fma_f32 v241, v241, -2.0, 1.0
 v_mfma_f32_16x16x32_bf16 v[104:107], v[224:227], a[96:99], v[104:107]
 ds_read_b64_tr_b16 v[220:221], v14 offset:28672
 v_mul_f32 v241, v241, v25
 v_mfma_f32_16x16x32_bf16 v[104:107], v[228:231], a[100:103], v[104:107]
 ds_read_b64_tr_b16 v[222:223], v14 offset:29696
 v_fma_f32 v242, v242, -2.0, 1.0
 v_mfma_f32_16x16x32_bf16 v[104:107], v[232:235], a[104:107], v[104:107]
 s_xor_b32 m0, s88, 34816
 v_rcp_f32 v247, v247
 v_mfma_f32_16x16x32_bf16 v[104:107], v[236:239], a[108:111], v[104:107]
 s_xor_b32 s66, s63, 131200
 v_mul_f32 v242, v242, v26
 v_fma_f32 v243, v243, -2.0, 1.0
 v_mfma_f32_16x16x32_bf16 v[108:111], v[224:227], a[112:115], v[108:111]
 buffer_load_dwordx4 v2, s[32:35], s66 offen lds
 v_mfma_f32_16x16x32_bf16 v[108:111], v[228:231], a[116:119], v[108:111]
 v_mul_f32 v243, v243, v27
 v_cvt_pk_bf16_f32 v24, v240, v241
 v_mfma_f32_16x16x32_bf16 v[108:111], v[232:235], a[120:123], v[108:111]
 v_cvt_pk_bf16_f32 v25, v242, v243
 v_fma_f32 v244, v244, -2.0, 1.0
 v_mfma_f32_16x16x32_bf16 v[108:111], v[236:239], a[124:127], v[108:111]
 s_waitcnt lgkmcnt(0)
 v_mul_f32 v244, v244, v40
 v_fma_f32 v245, v245, -2.0, 1.0
 v_mfma_f32_16x16x32_bf16 v[112:115], v[208:211], a[64:67], v[112:115]
 ds_read_b64_tr_b16 v[224:225], v15 offset:16384
 v_mul_f32 v245, v245, v41
 v_mfma_f32_16x16x32_bf16 v[112:115], v[212:215], a[68:71], v[112:115]
 ds_read_b64_tr_b16 v[226:227], v15 offset:17408
 v_fma_f32 v246, v246, -2.0, 1.0
 v_mfma_f32_16x16x32_bf16 v[112:115], v[216:219], a[72:75], v[112:115]
 ds_read_b64_tr_b16 v[228:229], v15 offset:20480
 v_mul_f32 v246, v246, v42
 v_mfma_f32_16x16x32_bf16 v[112:115], v[220:223], a[76:79], v[112:115]
 s_add_u32 s67, s101, 22042624
 v_fma_f32 v247, v247, -2.0, 1.0
 v_mul_f32 v247, v247, v43
 v_mfma_f32_16x16x32_bf16 v[116:119], v[208:211], a[80:83], v[116:119]
 ds_read_b64_tr_b16 v[230:231], v15 offset:21504
 v_cvt_pk_bf16_f32 v26, v244, v245
 v_mfma_f32_16x16x32_bf16 v[116:119], v[212:215], a[84:87], v[116:119]
 ds_read_b64_tr_b16 v[232:233], v15 offset:24576
 v_cvt_pk_bf16_f32 v27, v246, v247
 v_mfma_f32_16x16x32_bf16 v[116:119], v[216:219], a[88:91], v[116:119]
 ds_read_b64_tr_b16 v[234:235], v15 offset:25600
 v_mul_f32 v240, s30, v28
 v_mfma_f32_16x16x32_bf16 v[116:119], v[220:223], a[92:95], v[116:119]
L_st2_6:
 s_cbranch_execz L_warmed2
 buffer_store_dwordx4 v[196:199], v1, s[40:43], s67 offen offset:1024 sc1
 v_exp_f32 v240, v240
 v_mul_f32 v241, s30, v29
 v_mfma_f32_16x16x32_bf16 v[120:123], v[208:211], a[96:99], v[120:123]
 ds_read_b64_tr_b16 v[236:237], v15 offset:28672
 v_mul_f32 v242, s30, v30
 v_mfma_f32_16x16x32_bf16 v[120:123], v[212:215], a[100:103], v[120:123]
 ds_read_b64_tr_b16 v[238:239], v15 offset:29696
 v_mul_f32 v243, s30, v31
 v_mfma_f32_16x16x32_bf16 v[120:123], v[216:219], a[104:107], v[120:123]
 s_xor_b32 m0, s88, 35840
 s_xor_b32 s68, s63, 163968
 v_mul_f32 v244, s30, v44
 v_mfma_f32_16x16x32_bf16 v[120:123], v[220:223], a[108:111], v[120:123]
 buffer_load_dwordx4 v2, s[32:35], s68 offen lds
 v_mfma_f32_16x16x32_bf16 v[124:127], v[208:211], a[112:115], v[124:127]
 v_exp_f32 v241, v241
 v_mfma_f32_16x16x32_bf16 v[124:127], v[212:215], a[116:119], v[124:127]
 v_exp_f32 v242, v242
 v_mfma_f32_16x16x32_bf16 v[124:127], v[216:219], a[120:123], v[124:127]
 v_exp_f32 v243, v243
 v_mfma_f32_16x16x32_bf16 v[124:127], v[220:223], a[124:127], v[124:127]
 s_waitcnt vmcnt(9) lgkmcnt(0)
 s_barrier
 v_mfma_f32_16x16x32_bf16 v[128:131], v[224:227], a[64:67], v[128:131]
 ds_read_b64_tr_b16 v[208:209], v8 offset:0
 v_mul_f32 v245, s30, v45
 v_mfma_f32_16x16x32_bf16 v[128:131], v[228:231], a[68:71], v[128:131]
 ds_read_b64_tr_b16 v[210:211], v8 offset:1024
 v_mul_f32 v246, s30, v46
 v_mfma_f32_16x16x32_bf16 v[128:131], v[232:235], a[72:75], v[128:131]
 ds_read_b64_tr_b16 v[212:213], v8 offset:4096
 v_mul_f32 v247, s30, v47
 v_mfma_f32_16x16x32_bf16 v[128:131], v[236:239], a[76:79], v[128:131]
 s_add_u32 s65, s100, 22042624
 v_exp_f32 v244, v244
 v_mfma_f32_16x16x32_bf16 v[132:135], v[224:227], a[80:83], v[132:135]
 ds_read_b64_tr_b16 v[214:215], v8 offset:5120
 v_add_f32 v240, 1.0, v240
 v_mfma_f32_16x16x32_bf16 v[132:135], v[228:231], a[84:87], v[132:135]
 ds_read_b64_tr_b16 v[216:217], v8 offset:8192
 v_fma_f32 v240, v240, v240, 1.0
 v_mfma_f32_16x16x32_bf16 v[132:135], v[232:235], a[88:91], v[132:135]
 ds_read_b64_tr_b16 v[218:219], v8 offset:9216
 v_add_f32 v241, 1.0, v241
 v_mfma_f32_16x16x32_bf16 v[132:135], v[236:239], a[92:95], v[132:135]
 buffer_store_dwordx4 v[200:203], v1, s[40:43], s65 offen offset:2048 sc1
 v_exp_f32 v245, v245
 v_fma_f32 v241, v241, v241, 1.0
 v_mfma_f32_16x16x32_bf16 v[136:139], v[224:227], a[96:99], v[136:139]
 s_xor_b32 m0, s88, 36864
 ds_read_b64_tr_b16 v[220:221], v8 offset:12288
 v_add_f32 v242, 1.0, v242
 v_mfma_f32_16x16x32_bf16 v[136:139], v[228:231], a[100:103], v[136:139]
 s_xor_b32 s66, s63, 262272
 ds_read_b64_tr_b16 v[222:223], v8 offset:13312
 v_fma_f32 v242, v242, v242, 1.0
 v_mfma_f32_16x16x32_bf16 v[136:139], v[232:235], a[104:107], v[136:139]
 buffer_load_dwordx4 v2, s[32:35], s66 offen lds
 v_mfma_f32_16x16x32_bf16 v[136:139], v[236:239], a[108:111], v[136:139]
 v_exp_f32 v246, v246
 v_mfma_f32_16x16x32_bf16 v[140:143], v[224:227], a[112:115], v[140:143]
 v_exp_f32 v247, v247
 v_mfma_f32_16x16x32_bf16 v[140:143], v[228:231], a[116:119], v[140:143]
 v_rcp_f32 v240, v240
 v_mfma_f32_16x16x32_bf16 v[140:143], v[232:235], a[120:123], v[140:143]
 v_rcp_f32 v241, v241
 v_mfma_f32_16x16x32_bf16 v[140:143], v[236:239], a[124:127], v[140:143]
 s_waitcnt lgkmcnt(0)
 v_rcp_f32 v242, v242
 v_mfma_f32_16x16x32_bf16 v[80:83], v[208:211], a[128:131], v[80:83]
 ds_read_b64_tr_b16 v[224:225], v9 offset:0
 v_add_f32 v243, 1.0, v243
 v_mfma_f32_16x16x32_bf16 v[80:83], v[212:215], a[132:135], v[80:83]
 ds_read_b64_tr_b16 v[226:227], v9 offset:1024
 v_fma_f32 v243, v243, v243, 1.0
 v_mfma_f32_16x16x32_bf16 v[80:83], v[216:219], a[136:139], v[80:83]
 ds_read_b64_tr_b16 v[228:229], v9 offset:4096
 v_add_f32 v244, 1.0, v244
 v_mfma_f32_16x16x32_bf16 v[80:83], v[220:223], a[140:143], v[80:83]
 s_add_u32 s67, s101, 22042624
 v_rcp_f32 v243, v243
 v_mfma_f32_16x16x32_bf16 v[84:87], v[208:211], a[144:147], v[84:87]
 ds_read_b64_tr_b16 v[230:231], v9 offset:5120
 v_fma_f32 v244, v244, v244, 1.0
 v_mfma_f32_16x16x32_bf16 v[84:87], v[212:215], a[148:151], v[84:87]
 ds_read_b64_tr_b16 v[232:233], v9 offset:8192
 v_add_f32 v245, 1.0, v245
 v_mfma_f32_16x16x32_bf16 v[84:87], v[216:219], a[152:155], v[84:87]
 ds_read_b64_tr_b16 v[234:235], v9 offset:9216
 v_fma_f32 v245, v245, v245, 1.0
 v_mfma_f32_16x16x32_bf16 v[84:87], v[220:223], a[156:159], v[84:87]
 buffer_store_dwordx4 v[204:207], v1, s[40:43], s67 offen offset:3072 sc1
 v_rcp_f32 v244, v244
 v_add_f32 v246, 1.0, v246
 v_mfma_f32_16x16x32_bf16 v[88:91], v[208:211], a[160:163], v[88:91]
 s_xor_b32 m0, s88, 37888
 ds_read_b64_tr_b16 v[236:237], v9 offset:12288
 v_fma_f32 v246, v246, v246, 1.0
 v_mfma_f32_16x16x32_bf16 v[88:91], v[212:215], a[164:167], v[88:91]
 s_xor_b32 s68, s63, 295040
 ds_read_b64_tr_b16 v[238:239], v9 offset:13312
 v_add_f32 v247, 1.0, v247
 v_mfma_f32_16x16x32_bf16 v[88:91], v[216:219], a[168:171], v[88:91]
 buffer_load_dwordx4 v2, s[32:35], s68 offen lds
 v_mfma_f32_16x16x32_bf16 v[88:91], v[220:223], a[172:175], v[88:91]
 v_rcp_f32 v245, v245
 v_mfma_f32_16x16x32_bf16 v[92:95], v[208:211], a[176:179], v[92:95]
 v_rcp_f32 v246, v246
 v_mfma_f32_16x16x32_bf16 v[92:95], v[212:215], a[180:183], v[92:95]
 v_fma_f32 v247, v247, v247, 1.0
 v_fma_f32 v240, v240, -2.0, 1.0
 v_mfma_f32_16x16x32_bf16 v[92:95], v[216:219], a[184:187], v[92:95]
 s_xor_b32 m0, s88, 38912
 v_rcp_f32 v247, v247
 v_mfma_f32_16x16x32_bf16 v[92:95], v[220:223], a[188:191], v[92:95]
 s_waitcnt lgkmcnt(0)
 v_mul_f32 v240, v240, v28
 v_fma_f32 v241, v241, -2.0, 1.0
 v_mfma_f32_16x16x32_bf16 v[96:99], v[224:227], a[128:131], v[96:99]
 ds_read_b64_tr_b16 v[208:209], v10 offset:0
 v_mul_f32 v241, v241, v29
 v_mfma_f32_16x16x32_bf16 v[96:99], v[228:231], a[132:135], v[96:99]
 ds_read_b64_tr_b16 v[210:211], v10 offset:1024
 v_fma_f32 v242, v242, -2.0, 1.0
 v_mfma_f32_16x16x32_bf16 v[96:99], v[232:235], a[136:139], v[96:99]
 ds_read_b64_tr_b16 v[212:213], v10 offset:4096
 v_mul_f32 v242, v242, v30
 v_mfma_f32_16x16x32_bf16 v[96:99], v[236:239], a[140:143], v[96:99]
 s_xor_b32 s65, s63, 393344
 v_fma_f32 v243, v243, -2.0, 1.0
 v_mul_f32 v243, v243, v31
 v_mfma_f32_16x16x32_bf16 v[100:103], v[224:227], a[144:147], v[100:103]
 ds_read_b64_tr_b16 v[214:215], v10 offset:5120
 v_cvt_pk_bf16_f32 v28, v240, v241
 v_mfma_f32_16x16x32_bf16 v[100:103], v[228:231], a[148:151], v[100:103]
 ds_read_b64_tr_b16 v[216:217], v10 offset:8192
 v_cvt_pk_bf16_f32 v29, v242, v243
 v_mfma_f32_16x16x32_bf16 v[100:103], v[232:235], a[152:155], v[100:103]
 ds_read_b64_tr_b16 v[218:219], v10 offset:9216
 v_fma_f32 v244, v244, -2.0, 1.0
 v_mfma_f32_16x16x32_bf16 v[100:103], v[236:239], a[156:159], v[100:103]
 buffer_load_dwordx4 v2, s[32:35], s65 offen lds
 v_mfma_f32_16x16x32_bf16 v[104:107], v[224:227], a[160:163], v[104:107]
 ds_read_b64_tr_b16 v[220:221], v10 offset:12288
 v_mul_f32 v244, v244, v44
 v_mfma_f32_16x16x32_bf16 v[104:107], v[228:231], a[164:167], v[104:107]
 ds_read_b64_tr_b16 v[222:223], v10 offset:13312
 v_fma_f32 v245, v245, -2.0, 1.0
 v_mfma_f32_16x16x32_bf16 v[104:107], v[232:235], a[168:171], v[104:107]
 v_mul_f32 v245, v245, v45
 v_fma_f32 v246, v246, -2.0, 1.0
 v_mfma_f32_16x16x32_bf16 v[104:107], v[236:239], a[172:175], v[104:107]
 v_mul_f32 v246, v246, v46
 v_fma_f32 v247, v247, -2.0, 1.0
 v_mfma_f32_16x16x32_bf16 v[108:111], v[224:227], a[176:179], v[108:111]
 v_mul_f32 v247, v247, v47
 v_cvt_pk_bf16_f32 v30, v244, v245
 v_mfma_f32_16x16x32_bf16 v[108:111], v[228:231], a[180:183], v[108:111]
 v_cvt_pk_bf16_f32 v31, v246, v247
 v_mul_f32 v240, s30, v48
 v_mfma_f32_16x16x32_bf16 v[108:111], v[232:235], a[184:187], v[108:111]
 v_exp_f32 v240, v240
 v_mfma_f32_16x16x32_bf16 v[108:111], v[236:239], a[188:191], v[108:111]
 s_waitcnt lgkmcnt(0)
 v_mul_f32 v241, s30, v49
 v_mul_f32 v242, s30, v50
 v_mfma_f32_16x16x32_bf16 v[112:115], v[208:211], a[128:131], v[112:115]
 ds_read_b64_tr_b16 v[224:225], v11 offset:0
 v_mul_f32 v243, s30, v51
 v_mfma_f32_16x16x32_bf16 v[112:115], v[212:215], a[132:135], v[112:115]
 ds_read_b64_tr_b16 v[226:227], v11 offset:1024
 v_mov_b32 v32, -1
 v_mfma_f32_16x16x32_bf16 v[112:115], v[216:219], a[136:139], v[112:115]
 ds_read_b64_tr_b16 v[228:229], v11 offset:4096
 v_mov_b32 v33, -1
 v_mfma_f32_16x16x32_bf16 v[112:115], v[220:223], a[140:143], v[112:115]
 s_add_u32 s66, s31, s77
 v_mov_b32 v34, -1
 v_mov_b32 v35, -1
 v_mfma_f32_16x16x32_bf16 v[116:119], v[208:211], a[144:147], v[116:119]
 ds_read_b64_tr_b16 v[230:231], v11 offset:5120
 v_mul_f32 v244, s30, v64
 v_mfma_f32_16x16x32_bf16 v[116:119], v[212:215], a[148:151], v[116:119]
 ds_read_b64_tr_b16 v[232:233], v11 offset:8192
 v_mul_f32 v245, s30, v65
 v_mfma_f32_16x16x32_bf16 v[116:119], v[216:219], a[152:155], v[116:119]
 ds_read_b64_tr_b16 v[234:235], v11 offset:9216
 v_mul_f32 v246, s30, v66
 v_mfma_f32_16x16x32_bf16 v[116:119], v[220:223], a[156:159], v[116:119]
 buffer_store_dwordx4 v[16:19], v1, s[44:47], s66 offen sc1
 v_exp_f32 v241, v241
 v_mul_f32 v247, s30, v67
 v_mfma_f32_16x16x32_bf16 v[120:123], v[208:211], a[160:163], v[120:123]
 s_xor_b32 m0, s88, 39936
 ds_read_b64_tr_b16 v[236:237], v11 offset:12288
 v_add_f32 v240, 1.0, v240
 v_mfma_f32_16x16x32_bf16 v[120:123], v[212:215], a[164:167], v[120:123]
 s_xor_b32 s67, s63, 426112
 ds_read_b64_tr_b16 v[238:239], v11 offset:13312
 v_fma_f32 v240, v240, v240, 1.0
 v_mfma_f32_16x16x32_bf16 v[120:123], v[216:219], a[168:171], v[120:123]
 buffer_load_dwordx4 v2, s[32:35], s67 offen lds
 v_mfma_f32_16x16x32_bf16 v[120:123], v[220:223], a[172:175], v[120:123]
 v_exp_f32 v242, v242
 v_mfma_f32_16x16x32_bf16 v[124:127], v[208:211], a[176:179], v[124:127]
 v_exp_f32 v243, v243
 v_mfma_f32_16x16x32_bf16 v[124:127], v[212:215], a[180:183], v[124:127]
 v_exp_f32 v244, v244
 v_mfma_f32_16x16x32_bf16 v[124:127], v[216:219], a[184:187], v[124:127]
 v_exp_f32 v245, v245
 v_mfma_f32_16x16x32_bf16 v[124:127], v[220:223], a[188:191], v[124:127]
 s_waitcnt vmcnt(36) lgkmcnt(0)
 v_exp_f32 v246, v246
 v_mfma_f32_16x16x32_bf16 v[128:131], v[224:227], a[128:131], v[128:131]
 ds_read_b64_tr_b16 v[208:209], v8 offset:16384
 v_add_f32 v241, 1.0, v241
 v_mfma_f32_16x16x32_bf16 v[128:131], v[228:231], a[132:135], v[128:131]
 ds_read_b64_tr_b16 v[210:211], v8 offset:17408
 v_fma_f32 v241, v241, v241, 1.0
 v_mfma_f32_16x16x32_bf16 v[128:131], v[232:235], a[136:139], v[128:131]
 ds_read_b64_tr_b16 v[212:213], v8 offset:20480
 v_add_f32 v242, 1.0, v242
 v_mfma_f32_16x16x32_bf16 v[128:131], v[236:239], a[140:143], v[128:131]
 buffer_load_dword v251, v252, s[40:43], s3 offen sc1
 v_mfma_f32_16x16x32_bf16 v[132:135], v[224:227], a[144:147], v[132:135]
 ds_read_b64_tr_b16 v[214:215], v8 offset:21504
 v_fma_f32 v242, v242, v242, 1.0
 v_mfma_f32_16x16x32_bf16 v[132:135], v[228:231], a[148:151], v[132:135]
 ds_read_b64_tr_b16 v[216:217], v8 offset:24576
 v_add_f32 v243, 1.0, v243
 v_mfma_f32_16x16x32_bf16 v[132:135], v[232:235], a[152:155], v[132:135]
 ds_read_b64_tr_b16 v[218:219], v8 offset:25600
 v_fma_f32 v243, v243, v243, 1.0
 v_mfma_f32_16x16x32_bf16 v[132:135], v[236:239], a[156:159], v[132:135]
 s_lshl_b32 s68, s2, 2
 s_add_u32 s68, s68, s60
 v_add_f32 v244, 1.0, v244
 v_mfma_f32_16x16x32_bf16 v[136:139], v[224:227], a[160:163], v[136:139]
 s_mul_i32 s68, s68, 7168
 ds_read_b64_tr_b16 v[220:221], v8 offset:28672
 v_fma_f32 v244, v244, v244, 1.0
 v_mfma_f32_16x16x32_bf16 v[136:139], v[228:231], a[164:167], v[136:139]
 s_add_u32 s68, s68, 70254592
 ds_read_b64_tr_b16 v[222:223], v8 offset:29696
 v_add_f32 v245, 1.0, v245
 v_mfma_f32_16x16x32_bf16 v[136:139], v[232:235], a[168:171], v[136:139]
 buffer_store_dwordx4 v[32:35], v1, s[40:43], s68 offen sc1
 v_exp_f32 v247, v247
 v_fma_f32 v245, v245, v245, 1.0
 v_mfma_f32_16x16x32_bf16 v[136:139], v[236:239], a[172:175], v[136:139]
 v_rcp_f32 v240, v240
 v_mfma_f32_16x16x32_bf16 v[140:143], v[224:227], a[176:179], v[140:143]
 v_rcp_f32 v241, v241
 v_mfma_f32_16x16x32_bf16 v[140:143], v[228:231], a[180:183], v[140:143]
 s_xor_b32 m0, s88, 131072
 v_rcp_f32 v242, v242
 v_mfma_f32_16x16x32_bf16 v[140:143], v[232:235], a[184:187], v[140:143]
 s_xor_b32 s65, s63, 2097280
 v_rcp_f32 v243, v243
 v_mfma_f32_16x16x32_bf16 v[140:143], v[236:239], a[188:191], v[140:143]
 s_waitcnt lgkmcnt(0)
 v_rcp_f32 v244, v244
 v_mfma_f32_16x16x32_bf16 v[80:83], v[208:211], a[192:195], v[80:83]
 ds_read_b64_tr_b16 v[224:225], v9 offset:16384
 v_add_f32 v246, 1.0, v246
 v_mfma_f32_16x16x32_bf16 v[80:83], v[212:215], a[196:199], v[80:83]
 ds_read_b64_tr_b16 v[226:227], v9 offset:17408
 v_fma_f32 v246, v246, v246, 1.0
 v_mfma_f32_16x16x32_bf16 v[80:83], v[216:219], a[200:203], v[80:83]
 ds_read_b64_tr_b16 v[228:229], v9 offset:20480
 v_add_f32 v247, 1.0, v247
 v_mfma_f32_16x16x32_bf16 v[80:83], v[220:223], a[204:207], v[80:83]
 buffer_load_dwordx4 v2, s[32:35], s65 offen lds
 v_mfma_f32_16x16x32_bf16 v[84:87], v[208:211], a[208:211], v[84:87]
 ds_read_b64_tr_b16 v[230:231], v9 offset:21504
 v_fma_f32 v247, v247, v247, 1.0
 v_mfma_f32_16x16x32_bf16 v[84:87], v[212:215], a[212:215], v[84:87]
 ds_read_b64_tr_b16 v[232:233], v9 offset:24576
 v_fma_f32 v240, v240, -2.0, 1.0
 v_mfma_f32_16x16x32_bf16 v[84:87], v[216:219], a[216:219], v[84:87]
 ds_read_b64_tr_b16 v[234:235], v9 offset:25600
 v_mul_f32 v240, v240, v48
 v_mfma_f32_16x16x32_bf16 v[84:87], v[220:223], a[220:223], v[84:87]
 v_rcp_f32 v245, v245
 v_mfma_f32_16x16x32_bf16 v[88:91], v[208:211], a[224:227], v[88:91]
 ds_read_b64_tr_b16 v[236:237], v9 offset:28672
 v_fma_f32 v241, v241, -2.0, 1.0
 v_mfma_f32_16x16x32_bf16 v[88:91], v[212:215], a[228:231], v[88:91]
 ds_read_b64_tr_b16 v[238:239], v9 offset:29696
 v_mul_f32 v241, v241, v49
 v_mfma_f32_16x16x32_bf16 v[88:91], v[216:219], a[232:235], v[88:91]
 s_add_u32 s66, s31, s78
 v_rcp_f32 v246, v246
 v_mfma_f32_16x16x32_bf16 v[88:91], v[220:223], a[236:239], v[88:91]
 buffer_store_dwordx4 v[20:23], v1, s[44:47], s66 offen sc1
 v_rcp_f32 v247, v247
 v_fma_f32 v242, v242, -2.0, 1.0
 v_mfma_f32_16x16x32_bf16 v[92:95], v[208:211], a[240:243], v[92:95]
 s_xor_b32 m0, s88, 132096
 v_mul_f32 v242, v242, v50
 v_fma_f32 v243, v243, -2.0, 1.0
 v_mfma_f32_16x16x32_bf16 v[92:95], v[212:215], a[244:247], v[92:95]
 s_xor_b32 s67, s63, 2130048
 v_mul_f32 v243, v243, v51
 v_cvt_pk_bf16_f32 v48, v240, v241
 v_mfma_f32_16x16x32_bf16 v[92:95], v[216:219], a[248:251], v[92:95]
 buffer_load_dwordx4 v2, s[32:35], s67 offen lds
 v_mfma_f32_16x16x32_bf16 v[92:95], v[220:223], a[252:255], v[92:95]
 s_waitcnt lgkmcnt(0)
 v_cvt_pk_bf16_f32 v49, v242, v243
 v_fma_f32 v244, v244, -2.0, 1.0
 v_mfma_f32_16x16x32_bf16 v[96:99], v[224:227], a[192:195], v[96:99]
 ds_read_b64_tr_b16 v[208:209], v10 offset:16384
 v_mul_f32 v244, v244, v64
 v_mfma_f32_16x16x32_bf16 v[96:99], v[228:231], a[196:199], v[96:99]
 ds_read_b64_tr_b16 v[210:211], v10 offset:17408
 v_fma_f32 v245, v245, -2.0, 1.0
 v_mfma_f32_16x16x32_bf16 v[96:99], v[232:235], a[200:203], v[96:99]
 ds_read_b64_tr_b16 v[212:213], v10 offset:20480
 v_mul_f32 v245, v245, v65
 v_mfma_f32_16x16x32_bf16 v[96:99], v[236:239], a[204:207], v[96:99]
 s_xor_b32 m0, s88, 133120
 v_fma_f32 v246, v246, -2.0, 1.0
 v_mul_f32 v246, v246, v66
 v_mfma_f32_16x16x32_bf16 v[100:103], v[224:227], a[208:211], v[100:103]
 ds_read_b64_tr_b16 v[214:215], v10 offset:21504
 v_fma_f32 v247, v247, -2.0, 1.0
 v_mfma_f32_16x16x32_bf16 v[100:103], v[228:231], a[212:215], v[100:103]
 ds_read_b64_tr_b16 v[216:217], v10 offset:24576
 v_mul_f32 v247, v247, v67
 v_mfma_f32_16x16x32_bf16 v[100:103], v[232:235], a[216:219], v[100:103]
 ds_read_b64_tr_b16 v[218:219], v10 offset:25600
 v_cvt_pk_bf16_f32 v50, v244, v245
 v_mfma_f32_16x16x32_bf16 v[100:103], v[236:239], a[220:223], v[100:103]
 s_xor_b32 s68, s63, 2228352
 v_cvt_pk_bf16_f32 v51, v246, v247
 v_mul_f32 v240, s30, v52
 v_mfma_f32_16x16x32_bf16 v[104:107], v[224:227], a[224:227], v[104:107]
 ds_read_b64_tr_b16 v[220:221], v10 offset:28672
 v_mul_f32 v241, s30, v53
 v_mfma_f32_16x16x32_bf16 v[104:107], v[228:231], a[228:231], v[104:107]
 ds_read_b64_tr_b16 v[222:223], v10 offset:29696
 v_mul_f32 v242, s30, v54
 v_mfma_f32_16x16x32_bf16 v[104:107], v[232:235], a[232:235], v[104:107]
 buffer_load_dwordx4 v2, s[32:35], s68 offen lds
 v_mfma_f32_16x16x32_bf16 v[104:107], v[236:239], a[236:239], v[104:107]
 s_lshl_b32 s65, s2, 2
 v_exp_f32 v240, v240
 v_mfma_f32_16x16x32_bf16 v[108:111], v[224:227], a[240:243], v[108:111]
 s_add_u32 s65, s65, s60
 v_exp_f32 v241, v241
 v_mfma_f32_16x16x32_bf16 v[108:111], v[228:231], a[244:247], v[108:111]
 s_mul_i32 s65, s65, 7168
 v_exp_f32 v242, v242
 v_mfma_f32_16x16x32_bf16 v[108:111], v[232:235], a[248:251], v[108:111]
 s_add_u32 s65, s65, 70255616
 v_mul_f32 v243, s30, v55
 v_mul_f32 v244, s30, v68
 v_mfma_f32_16x16x32_bf16 v[108:111], v[236:239], a[252:255], v[108:111]
 s_waitcnt lgkmcnt(0)
 v_exp_f32 v243, v243
 v_mfma_f32_16x16x32_bf16 v[112:115], v[208:211], a[192:195], v[112:115]
 ds_read_b64_tr_b16 v[224:225], v11 offset:16384
 v_mul_f32 v245, s30, v69
 v_mfma_f32_16x16x32_bf16 v[112:115], v[212:215], a[196:199], v[112:115]
 ds_read_b64_tr_b16 v[226:227], v11 offset:17408
 v_mul_f32 v246, s30, v70
 v_mfma_f32_16x16x32_bf16 v[112:115], v[216:219], a[200:203], v[112:115]
 ds_read_b64_tr_b16 v[228:229], v11 offset:20480
 v_mul_f32 v247, s30, v71
 v_mfma_f32_16x16x32_bf16 v[112:115], v[220:223], a[204:207], v[112:115]
 buffer_store_dwordx4 v[32:35], v1, s[40:43], s65 offen sc1
 v_exp_f32 v244, v244
 v_add_f32 v240, 1.0, v240
 v_mfma_f32_16x16x32_bf16 v[116:119], v[208:211], a[208:211], v[116:119]
 ds_read_b64_tr_b16 v[230:231], v11 offset:21504
 v_fma_f32 v240, v240, v240, 1.0
 v_mfma_f32_16x16x32_bf16 v[116:119], v[212:215], a[212:215], v[116:119]
 s_xor_b32 m0, s88, 134144
 ds_read_b64_tr_b16 v[232:233], v11 offset:24576
 v_add_f32 v241, 1.0, v241
 v_mfma_f32_16x16x32_bf16 v[116:119], v[216:219], a[216:219], v[116:119]
 s_xor_b32 s66, s63, 2261120
 ds_read_b64_tr_b16 v[234:235], v11 offset:25600
 v_fma_f32 v241, v241, v241, 1.0
 v_mfma_f32_16x16x32_bf16 v[116:119], v[220:223], a[220:223], v[116:119]
 buffer_load_dwordx4 v2, s[32:35], s66 offen lds
 v_mfma_f32_16x16x32_bf16 v[120:123], v[208:211], a[224:227], v[120:123]
 ds_read_b64_tr_b16 v[236:237], v11 offset:28672
 v_add_f32 v242, 1.0, v242
 v_mfma_f32_16x16x32_bf16 v[120:123], v[212:215], a[228:231], v[120:123]
 ds_read_b64_tr_b16 v[238:239], v11 offset:29696
 v_fma_f32 v242, v242, v242, 1.0
 v_mfma_f32_16x16x32_bf16 v[120:123], v[216:219], a[232:235], v[120:123]
 v_exp_f32 v245, v245
 v_mfma_f32_16x16x32_bf16 v[120:123], v[220:223], a[236:239], v[120:123]
 v_exp_f32 v246, v246
 v_mfma_f32_16x16x32_bf16 v[124:127], v[208:211], a[240:243], v[124:127]
 v_exp_f32 v247, v247
 v_mfma_f32_16x16x32_bf16 v[124:127], v[212:215], a[244:247], v[124:127]
 v_rcp_f32 v240, v240
 v_mfma_f32_16x16x32_bf16 v[124:127], v[216:219], a[248:251], v[124:127]
 v_rcp_f32 v241, v241
 v_mfma_f32_16x16x32_bf16 v[124:127], v[220:223], a[252:255], v[124:127]
 s_waitcnt vmcnt(8) lgkmcnt(0)
 s_barrier
 v_mfma_f32_16x16x32_bf16 v[128:131], v[224:227], a[192:195], v[128:131]
 ds_read_b64_tr_b16 v[208:209], v8 offset:32768
 v_add_f32 v243, 1.0, v243
 v_mfma_f32_16x16x32_bf16 v[128:131], v[228:231], a[196:199], v[128:131]
 ds_read_b64_tr_b16 v[210:211], v8 offset:33792
 v_fma_f32 v243, v243, v243, 1.0
 v_mfma_f32_16x16x32_bf16 v[128:131], v[232:235], a[200:203], v[128:131]
 ds_read_b64_tr_b16 v[212:213], v8 offset:36864
 v_add_f32 v244, 1.0, v244
 v_mfma_f32_16x16x32_bf16 v[128:131], v[236:239], a[204:207], v[128:131]
 buffer_store_dword v12, v0, s[40:43], s81 offen offset:32 sc1
 v_fma_f32 v244, v244, v244, 1.0
 v_mfma_f32_16x16x32_bf16 v[132:135], v[224:227], a[208:211], v[132:135]
 ds_read_b64_tr_b16 v[214:215], v8 offset:37888
 v_add_f32 v245, 1.0, v245
 v_mfma_f32_16x16x32_bf16 v[132:135], v[228:231], a[212:215], v[132:135]
 s_xor_b32 m0, s88, 135168
 ds_read_b64_tr_b16 v[216:217], v8 offset:40960
 v_fma_f32 v245, v245, v245, 1.0
 v_mfma_f32_16x16x32_bf16 v[132:135], v[232:235], a[216:219], v[132:135]
 s_xor_b32 s67, s63, 2359424
 ds_read_b64_tr_b16 v[218:219], v8 offset:41984
 v_add_f32 v246, 1.0, v246
 v_mfma_f32_16x16x32_bf16 v[132:135], v[236:239], a[220:223], v[132:135]
 buffer_load_dwordx4 v2, s[32:35], s67 offen lds
 v_mfma_f32_16x16x32_bf16 v[136:139], v[224:227], a[224:227], v[136:139]
 ds_read_b64_tr_b16 v[220:221], v8 offset:45056
 v_fma_f32 v246, v246, v246, 1.0
 v_mfma_f32_16x16x32_bf16 v[136:139], v[228:231], a[228:231], v[136:139]
 s_add_u32 s68, s31, s79
 ds_read_b64_tr_b16 v[222:223], v8 offset:46080
 v_add_f32 v247, 1.0, v247
 v_mfma_f32_16x16x32_bf16 v[136:139], v[232:235], a[232:235], v[136:139]
 buffer_store_dwordx4 v[24:27], v1, s[44:47], s68 offen sc1
 v_rcp_f32 v242, v242
 v_fma_f32 v247, v247, v247, 1.0
 v_mfma_f32_16x16x32_bf16 v[136:139], v[236:239], a[236:239], v[136:139]
 s_xor_b32 m0, s88, 136192
 v_rcp_f32 v243, v243
 v_mfma_f32_16x16x32_bf16 v[140:143], v[224:227], a[240:243], v[140:143]
 s_waitcnt vmcnt(10)
 v_cmp_eq_u32 vcc, 0, v251
 v_fma_f32 v240, v240, -2.0, 1.0
 v_mfma_f32_16x16x32_bf16 v[140:143], v[228:231], a[244:247], v[140:143]
 s_cbranch_vccnz L_spin_k
L_back_k:
 v_rcp_f32 v244, v244
 v_mfma_f32_16x16x32_bf16 v[140:143], v[232:235], a[248:251], v[140:143]
 s_xor_b32 s65, s63, 2392192
 v_rcp_f32 v245, v245
 v_mfma_f32_16x16x32_bf16 v[140:143], v[236:239], a[252:255], v[140:143]
 s_waitcnt lgkmcnt(0)
 v_rcp_f32 v246, v246
 v_mfma_f32_16x16x32_bf16 v[144:147], v[208:211], a[0:3], 0
 ds_read_b64_tr_b16 v[224:225], v9 offset:32768
 v_mul_f32 v240, v240, v52
 v_mfma_f32_16x16x32_bf16 v[144:147], v[212:215], a[4:7], v[144:147]
 ds_read_b64_tr_b16 v[226:227], v9 offset:33792
 v_fma_f32 v241, v241, -2.0, 1.0
 v_mfma_f32_16x16x32_bf16 v[144:147], v[216:219], a[8:11], v[144:147]
 ds_read_b64_tr_b16 v[228:229], v9 offset:36864
 v_mul_f32 v241, v241, v53
 v_mfma_f32_16x16x32_bf16 v[144:147], v[220:223], a[12:15], v[144:147]
 buffer_load_dwordx4 v2, s[32:35], s65 offen lds
 v_mfma_f32_16x16x32_bf16 v[148:151], v[208:211], a[16:19], 0
 ds_read_b64_tr_b16 v[230:231], v9 offset:37888
 v_fma_f32 v242, v242, -2.0, 1.0
 v_mfma_f32_16x16x32_bf16 v[148:151], v[212:215], a[20:23], v[148:151]
 ds_read_b64_tr_b16 v[232:233], v9 offset:40960
 v_mul_f32 v242, v242, v54
 v_mfma_f32_16x16x32_bf16 v[148:151], v[216:219], a[24:27], v[148:151]
 s_add_u32 m0, s92, 65536
 ds_read_b64_tr_b16 v[234:235], v9 offset:41984
 v_fma_f32 v243, v243, -2.0, 1.0
 v_mfma_f32_16x16x32_bf16 v[148:151], v[220:223], a[28:31], v[148:151]
 buffer_load_dwordx4 v1, s[36:39], s90 offen offset:0 sc1 lds
 v_mfma_f32_16x16x32_bf16 v[152:155], v[208:211], a[32:35], 0
 ds_read_b64_tr_b16 v[236:237], v9 offset:45056
 v_mul_f32 v243, v243, v55
 v_mfma_f32_16x16x32_bf16 v[152:155], v[212:215], a[36:39], v[152:155]
 ds_read_b64_tr_b16 v[238:239], v9 offset:46080
 v_cvt_pk_bf16_f32 v52, v240, v241
 v_mfma_f32_16x16x32_bf16 v[152:155], v[216:219], a[40:43], v[152:155]
 buffer_load_dwordx4 v1, s[36:39], s90 offen offset:1024 sc1 lds
 v_mfma_f32_16x16x32_bf16 v[152:155], v[220:223], a[44:47], v[152:155]
 v_rcp_f32 v247, v247
 v_mfma_f32_16x16x32_bf16 v[156:159], v[208:211], a[48:51], 0
 v_cvt_pk_bf16_f32 v53, v242, v243
 v_fma_f32 v244, v244, -2.0, 1.0
 v_mfma_f32_16x16x32_bf16 v[156:159], v[212:215], a[52:55], v[156:159]
 buffer_load_dwordx4 v1, s[36:39], s90 offen offset:2048 sc1 lds
 v_mfma_f32_16x16x32_bf16 v[156:159], v[216:219], a[56:59], v[156:159]
 v_mul_f32 v244, v244, v68
 v_fma_f32 v245, v245, -2.0, 1.0
 v_mfma_f32_16x16x32_bf16 v[156:159], v[220:223], a[60:63], v[156:159]
 s_waitcnt lgkmcnt(0)
 v_mul_f32 v245, v245, v69
 v_fma_f32 v246, v246, -2.0, 1.0
 v_mfma_f32_16x16x32_bf16 v[160:163], v[224:227], a[0:3], 0
 ds_read_b64_tr_b16 v[208:209], v10 offset:32768
 v_mul_f32 v246, v246, v70
 v_mfma_f32_16x16x32_bf16 v[160:163], v[228:231], a[4:7], v[160:163]
 ds_read_b64_tr_b16 v[210:211], v10 offset:33792
 v_fma_f32 v247, v247, -2.0, 1.0
 v_mfma_f32_16x16x32_bf16 v[160:163], v[232:235], a[8:11], v[160:163]
 ds_read_b64_tr_b16 v[212:213], v10 offset:36864
 v_mul_f32 v247, v247, v71
 v_mfma_f32_16x16x32_bf16 v[160:163], v[236:239], a[12:15], v[160:163]
 buffer_load_dwordx4 v1, s[36:39], s90 offen offset:3072 sc1 lds
 v_mfma_f32_16x16x32_bf16 v[164:167], v[224:227], a[16:19], 0
 s_add_u32 s90, s90, 17408
 ds_read_b64_tr_b16 v[214:215], v10 offset:37888
 v_cvt_pk_bf16_f32 v54, v244, v245
 v_mfma_f32_16x16x32_bf16 v[164:167], v[228:231], a[20:23], v[164:167]
 ds_read_b64_tr_b16 v[216:217], v10 offset:40960
 v_cvt_pk_bf16_f32 v55, v246, v247
 v_mfma_f32_16x16x32_bf16 v[164:167], v[232:235], a[24:27], v[164:167]
 ds_read_b64_tr_b16 v[218:219], v10 offset:41984
 v_cvt_pk_bf16_f32 v80, v80, v81
 v_mfma_f32_16x16x32_bf16 v[164:167], v[236:239], a[28:31], v[164:167]
 s_lshl_b32 s66, s2, 2
 s_add_u32 s66, s66, s60
 v_cvt_pk_bf16_f32 v81, v82, v83
 v_mfma_f32_16x16x32_bf16 v[168:171], v[224:227], a[32:35], 0
 s_mul_i32 s66, s66, 7168
 ds_read_b64_tr_b16 v[220:221], v10 offset:45056
 v_cvt_pk_bf16_f32 v82, v96, v97
 v_mfma_f32_16x16x32_bf16 v[168:171], v[228:231], a[36:39], v[168:171]
 s_add_u32 s66, s66, 70256640
 ds_read_b64_tr_b16 v[222:223], v10 offset:46080
 v_cvt_pk_bf16_f32 v83, v98, v99
 v_mfma_f32_16x16x32_bf16 v[168:171], v[232:235], a[40:43], v[168:171]
 buffer_store_dwordx4 v[32:35], v1, s[40:43], s66 offen sc1
 v_cvt_pk_bf16_f32 v84, v84, v85
 v_cvt_pk_bf16_f32 v85, v86, v87
 v_cvt_pk_bf16_f32 v86, v100, v101
 v_mfma_f32_16x16x32_bf16 v[168:171], v[236:239], a[44:47], v[168:171]
 s_xor_b32 m0, s88, 137216
 v_cvt_pk_bf16_f32 v87, v102, v103
 v_cvt_pk_bf16_f32 v88, v88, v89
 v_mfma_f32_16x16x32_bf16 v[172:175], v[224:227], a[48:51], 0
 s_xor_b32 s67, s63, 2490496
 v_cvt_pk_bf16_f32 v89, v90, v91
 v_cvt_pk_bf16_f32 v90, v104, v105
 v_mfma_f32_16x16x32_bf16 v[172:175], v[228:231], a[52:55], v[172:175]
 buffer_load_dwordx4 v2, s[32:35], s67 offen lds
 v_mfma_f32_16x16x32_bf16 v[172:175], v[232:235], a[56:59], v[172:175]
 v_cvt_pk_bf16_f32 v91, v106, v107
 v_cvt_pk_bf16_f32 v92, v92, v93
 v_mfma_f32_16x16x32_bf16 v[172:175], v[236:239], a[60:63], v[172:175]
 s_waitcnt lgkmcnt(0)
 v_cvt_pk_bf16_f32 v93, v94, v95
 v_cvt_pk_bf16_f32 v94, v108, v109
 v_mfma_f32_16x16x32_bf16 v[176:179], v[208:211], a[0:3], 0
 ds_read_b64_tr_b16 v[224:225], v11 offset:32768
 v_cvt_pk_bf16_f32 v95, v110, v111
 v_mfma_f32_16x16x32_bf16 v[176:179], v[212:215], a[4:7], v[176:179]
 s_xor_b32 m0, s88, 138240
 ds_read_b64_tr_b16 v[226:227], v11 offset:33792
 v_cvt_pk_bf16_f32 v112, v112, v113
 v_mfma_f32_16x16x32_bf16 v[176:179], v[216:219], a[8:11], v[176:179]
 s_xor_b32 s68, s63, 2523264
 ds_read_b64_tr_b16 v[228:229], v11 offset:36864
 v_cvt_pk_bf16_f32 v113, v114, v115
 v_mfma_f32_16x16x32_bf16 v[176:179], v[220:223], a[12:15], v[176:179]
 buffer_load_dwordx4 v2, s[32:35], s68 offen lds
 v_mfma_f32_16x16x32_bf16 v[180:183], v[208:211], a[16:19], 0
 ds_read_b64_tr_b16 v[230:231], v11 offset:37888
 v_cvt_pk_bf16_f32 v114, v128, v129
 v_mfma_f32_16x16x32_bf16 v[180:183], v[212:215], a[20:23], v[180:183]
 ds_read_b64_tr_b16 v[232:233], v11 offset:40960
 v_cvt_pk_bf16_f32 v115, v130, v131
 v_mfma_f32_16x16x32_bf16 v[180:183], v[216:219], a[24:27], v[180:183]
 s_add_u32 s65, s31, s80
 ds_read_b64_tr_b16 v[234:235], v11 offset:41984
 v_cvt_pk_bf16_f32 v116, v116, v117
 v_mfma_f32_16x16x32_bf16 v[180:183], v[220:223], a[28:31], v[180:183]
 buffer_store_dwordx4 v[28:31], v1, s[44:47], s65 offen sc1
 v_cvt_pk_bf16_f32 v117, v118, v119
 v_cvt_pk_bf16_f32 v118, v132, v133
 v_cvt_pk_bf16_f32 v119, v134, v135
 v_mfma_f32_16x16x32_bf16 v[184:187], v[208:211], a[32:35], 0
 s_add_u32 s31, s31, 4096
 ds_read_b64_tr_b16 v[236:237], v11 offset:45056
L_st2_7:
 s_cbranch_execz L_warmed2
 v_cvt_pk_bf16_f32 v120, v120, v121
 v_mfma_f32_16x16x32_bf16 v[184:187], v[212:215], a[36:39], v[184:187]
 ds_read_b64_tr_b16 v[238:239], v11 offset:46080
 v_cvt_pk_bf16_f32 v121, v122, v123
 v_mfma_f32_16x16x32_bf16 v[184:187], v[216:219], a[40:43], v[184:187]
 v_cvt_pk_bf16_f32 v122, v136, v137
 v_cvt_pk_bf16_f32 v123, v138, v139
 v_mfma_f32_16x16x32_bf16 v[184:187], v[220:223], a[44:47], v[184:187]
 v_cvt_pk_bf16_f32 v124, v124, v125
 v_cvt_pk_bf16_f32 v125, v126, v127
 v_mfma_f32_16x16x32_bf16 v[188:191], v[208:211], a[48:51], 0
 v_cvt_pk_bf16_f32 v126, v140, v141
 v_cvt_pk_bf16_f32 v127, v142, v143
 v_mfma_f32_16x16x32_bf16 v[188:191], v[212:215], a[52:55], v[188:191]
 v_mul_f32 v240, s30, v56
 v_mul_f32 v241, s30, v57
 v_mfma_f32_16x16x32_bf16 v[188:191], v[216:219], a[56:59], v[188:191]
 s_add_u32 m0, s92, 81920
 v_exp_f32 v240, v240
 v_mfma_f32_16x16x32_bf16 v[188:191], v[220:223], a[60:63], v[188:191]
 s_waitcnt vmcnt(36) lgkmcnt(0)
 v_exp_f32 v241, v241
 v_mfma_f32_16x16x32_bf16 v[192:195], v[224:227], a[0:3], 0
 ds_read_b64_tr_b16 v[208:209], v8 offset:49152
 v_mul_f32 v242, s30, v58
 v_mfma_f32_16x16x32_bf16 v[192:195], v[228:231], a[4:7], v[192:195]
 ds_read_b64_tr_b16 v[210:211], v8 offset:50176
 v_mul_f32 v243, s30, v59
 v_mfma_f32_16x16x32_bf16 v[192:195], v[232:235], a[8:11], v[192:195]
 ds_read_b64_tr_b16 v[212:213], v8 offset:53248
 v_mul_f32 v244, s30, v72
 v_mfma_f32_16x16x32_bf16 v[192:195], v[236:239], a[12:15], v[192:195]
 buffer_load_dwordx4 v1, s[36:39], s90 offen offset:0 sc1 lds
 v_mfma_f32_16x16x32_bf16 v[196:199], v[224:227], a[16:19], 0
 ds_read_b64_tr_b16 v[214:215], v8 offset:54272
 v_mul_f32 v245, s30, v73
 v_mfma_f32_16x16x32_bf16 v[196:199], v[228:231], a[20:23], v[196:199]
 ds_read_b64_tr_b16 v[216:217], v8 offset:57344
 v_mul_f32 v246, s30, v74
 v_mfma_f32_16x16x32_bf16 v[196:199], v[232:235], a[24:27], v[196:199]
 ds_read_b64_tr_b16 v[218:219], v8 offset:58368
 v_mul_f32 v247, s30, v75
 v_mfma_f32_16x16x32_bf16 v[196:199], v[236:239], a[28:31], v[196:199]
 buffer_load_dwordx4 v1, s[36:39], s90 offen offset:1024 sc1 lds
 v_mfma_f32_16x16x32_bf16 v[200:203], v[224:227], a[32:35], 0
 ds_read_b64_tr_b16 v[220:221], v8 offset:61440
 v_add_f32 v240, 1.0, v240
 v_mfma_f32_16x16x32_bf16 v[200:203], v[228:231], a[36:39], v[200:203]
 ds_read_b64_tr_b16 v[222:223], v8 offset:62464
 v_fma_f32 v240, v240, v240, 1.0
 v_mfma_f32_16x16x32_bf16 v[200:203], v[232:235], a[40:43], v[200:203]
 buffer_load_dwordx4 v1, s[36:39], s90 offen offset:2048 sc1 lds
 v_mfma_f32_16x16x32_bf16 v[200:203], v[236:239], a[44:47], v[200:203]
 v_exp_f32 v242, v242
 v_mfma_f32_16x16x32_bf16 v[204:207], v[224:227], a[48:51], 0
 v_exp_f32 v243, v243
 v_mfma_f32_16x16x32_bf16 v[204:207], v[228:231], a[52:55], v[204:207]
 buffer_load_dwordx4 v1, s[36:39], s90 offen offset:3072 sc1 lds
 v_mfma_f32_16x16x32_bf16 v[204:207], v[232:235], a[56:59], v[204:207]
 s_add_u32 s90, s90, 17408
 v_exp_f32 v244, v244
 v_mfma_f32_16x16x32_bf16 v[204:207], v[236:239], a[60:63], v[204:207]
 s_waitcnt lgkmcnt(0)
 s_lshl_b32 s66, s2, 2
 v_add_f32 v241, 1.0, v241
 v_mfma_f32_16x16x32_bf16 v[144:147], v[208:211], a[64:67], v[144:147]
 s_add_u32 s66, s66, s60
 ds_read_b64_tr_b16 v[224:225], v9 offset:49152
 v_fma_f32 v241, v241, v241, 1.0
 v_mfma_f32_16x16x32_bf16 v[144:147], v[212:215], a[68:71], v[144:147]
 s_mul_i32 s66, s66, 7168
 ds_read_b64_tr_b16 v[226:227], v9 offset:50176
 v_add_f32 v242, 1.0, v242
 v_mfma_f32_16x16x32_bf16 v[144:147], v[216:219], a[72:75], v[144:147]
 s_add_u32 s66, s66, 70257664
 ds_read_b64_tr_b16 v[228:229], v9 offset:53248
 v_fma_f32 v242, v242, v242, 1.0
 v_mfma_f32_16x16x32_bf16 v[144:147], v[220:223], a[76:79], v[144:147]
 buffer_store_dwordx4 v[32:35], v1, s[40:43], s66 offen sc1
 v_exp_f32 v245, v245
 v_add_f32 v243, 1.0, v243
 v_mfma_f32_16x16x32_bf16 v[148:151], v[208:211], a[80:83], v[148:151]
 ds_read_b64_tr_b16 v[230:231], v9 offset:54272
 v_fma_f32 v243, v243, v243, 1.0
 v_mfma_f32_16x16x32_bf16 v[148:151], v[212:215], a[84:87], v[148:151]
 ds_read_b64_tr_b16 v[232:233], v9 offset:57344
 v_add_f32 v244, 1.0, v244
 v_mfma_f32_16x16x32_bf16 v[148:151], v[216:219], a[88:91], v[148:151]
 ds_read_b64_tr_b16 v[234:235], v9 offset:58368
 v_fma_f32 v244, v244, v244, 1.0
 v_mfma_f32_16x16x32_bf16 v[148:151], v[220:223], a[92:95], v[148:151]
 v_exp_f32 v246, v246
 v_mfma_f32_16x16x32_bf16 v[152:155], v[208:211], a[96:99], v[152:155]
 ds_read_b64_tr_b16 v[236:237], v9 offset:61440
 v_add_f32 v245, 1.0, v245
 v_mfma_f32_16x16x32_bf16 v[152:155], v[212:215], a[100:103], v[152:155]
 ds_read_b64_tr_b16 v[238:239], v9 offset:62464
 v_fma_f32 v245, v245, v245, 1.0
 v_mfma_f32_16x16x32_bf16 v[152:155], v[216:219], a[104:107], v[152:155]
 v_exp_f32 v247, v247
 v_mfma_f32_16x16x32_bf16 v[152:155], v[220:223], a[108:111], v[152:155]
 s_add_u32 s67, s31, s77
 v_rcp_f32 v240, v240
 v_mfma_f32_16x16x32_bf16 v[156:159], v[208:211], a[112:115], v[156:159]
 buffer_store_dwordx4 v[48:51], v1, s[44:47], s67 offen sc1
 v_rcp_f32 v241, v241
 v_add_f32 v246, 1.0, v246
 v_mfma_f32_16x16x32_bf16 v[156:159], v[212:215], a[116:119], v[156:159]
 v_rcp_f32 v242, v242
 v_mfma_f32_16x16x32_bf16 v[156:159], v[216:219], a[120:123], v[156:159]
 v_rcp_f32 v243, v243
 v_mfma_f32_16x16x32_bf16 v[156:159], v[220:223], a[124:127], v[156:159]
 s_waitcnt lgkmcnt(0)
 v_rcp_f32 v244, v244
 v_mfma_f32_16x16x32_bf16 v[160:163], v[224:227], a[64:67], v[160:163]
 ds_read_b64_tr_b16 v[208:209], v10 offset:49152
 v_fma_f32 v246, v246, v246, 1.0
 v_mfma_f32_16x16x32_bf16 v[160:163], v[228:231], a[68:71], v[160:163]
 ds_read_b64_tr_b16 v[210:211], v10 offset:50176
 v_add_f32 v247, 1.0, v247
 v_mfma_f32_16x16x32_bf16 v[160:163], v[232:235], a[72:75], v[160:163]
 ds_read_b64_tr_b16 v[212:213], v10 offset:53248
 v_fma_f32 v247, v247, v247, 1.0
 v_mfma_f32_16x16x32_bf16 v[160:163], v[236:239], a[76:79], v[160:163]
 v_rcp_f32 v245, v245
 v_mfma_f32_16x16x32_bf16 v[164:167], v[224:227], a[80:83], v[164:167]
 ds_read_b64_tr_b16 v[214:215], v10 offset:54272
 v_fma_f32 v240, v240, -2.0, 1.0
 v_mfma_f32_16x16x32_bf16 v[164:167], v[228:231], a[84:87], v[164:167]
 ds_read_b64_tr_b16 v[216:217], v10 offset:57344
 v_mul_f32 v240, v240, v56
 v_mfma_f32_16x16x32_bf16 v[164:167], v[232:235], a[88:91], v[164:167]
 ds_read_b64_tr_b16 v[218:219], v10 offset:58368
 v_fma_f32 v241, v241, -2.0, 1.0
 v_mfma_f32_16x16x32_bf16 v[164:167], v[236:239], a[92:95], v[164:167]
 v_rcp_f32 v246, v246
 v_mfma_f32_16x16x32_bf16 v[168:171], v[224:227], a[96:99], v[168:171]
 ds_read_b64_tr_b16 v[220:221], v10 offset:61440
 v_mul_f32 v241, v241, v57
 v_mfma_f32_16x16x32_bf16 v[168:171], v[228:231], a[100:103], v[168:171]
 ds_read_b64_tr_b16 v[222:223], v10 offset:62464
 v_fma_f32 v242, v242, -2.0, 1.0
 v_mfma_f32_16x16x32_bf16 v[168:171], v[232:235], a[104:107], v[168:171]
 v_rcp_f32 v247, v247
 v_mfma_f32_16x16x32_bf16 v[168:171], v[236:239], a[108:111], v[168:171]
 v_mul_f32 v242, v242, v58
 v_fma_f32 v243, v243, -2.0, 1.0
 v_mfma_f32_16x16x32_bf16 v[172:175], v[224:227], a[112:115], v[172:175]
 v_mul_f32 v243, v243, v59
 v_cvt_pk_bf16_f32 v56, v240, v241
 v_mfma_f32_16x16x32_bf16 v[172:175], v[228:231], a[116:119], v[172:175]
 v_cvt_pk_bf16_f32 v57, v242, v243
 v_fma_f32 v244, v244, -2.0, 1.0
 v_mfma_f32_16x16x32_bf16 v[172:175], v[232:235], a[120:123], v[172:175]
 s_add_u32 m0, s93, 65536
 v_mul_f32 v244, v244, v72
 v_fma_f32 v245, v245, -2.0, 1.0
 v_mfma_f32_16x16x32_bf16 v[172:175], v[236:239], a[124:127], v[172:175]
 s_waitcnt lgkmcnt(0)
 v_mul_f32 v245, v245, v73
 v_fma_f32 v246, v246, -2.0, 1.0
 v_mfma_f32_16x16x32_bf16 v[176:179], v[208:211], a[64:67], v[176:179]
 ds_read_b64_tr_b16 v[224:225], v11 offset:49152
 v_mul_f32 v246, v246, v74
 v_mfma_f32_16x16x32_bf16 v[176:179], v[212:215], a[68:71], v[176:179]
 ds_read_b64_tr_b16 v[226:227], v11 offset:50176
 v_fma_f32 v247, v247, -2.0, 1.0
 v_mfma_f32_16x16x32_bf16 v[176:179], v[216:219], a[72:75], v[176:179]
 ds_read_b64_tr_b16 v[228:229], v11 offset:53248
 v_mul_f32 v247, v247, v75
 v_mfma_f32_16x16x32_bf16 v[176:179], v[220:223], a[76:79], v[176:179]
 buffer_load_dwordx4 v1, s[36:39], s90 offen offset:0 sc1 lds
 v_mfma_f32_16x16x32_bf16 v[180:183], v[208:211], a[80:83], v[180:183]
 ds_read_b64_tr_b16 v[230:231], v11 offset:54272
 v_cvt_pk_bf16_f32 v58, v244, v245
 v_mfma_f32_16x16x32_bf16 v[180:183], v[212:215], a[84:87], v[180:183]
 ds_read_b64_tr_b16 v[232:233], v11 offset:57344
 v_cvt_pk_bf16_f32 v59, v246, v247
 v_mfma_f32_16x16x32_bf16 v[180:183], v[216:219], a[88:91], v[180:183]
 ds_read_b64_tr_b16 v[234:235], v11 offset:58368
 v_mul_f32 v240, s30, v60
 v_mfma_f32_16x16x32_bf16 v[180:183], v[220:223], a[92:95], v[180:183]
 buffer_load_dwordx4 v1, s[36:39], s90 offen offset:1024 sc1 lds
 v_mfma_f32_16x16x32_bf16 v[184:187], v[208:211], a[96:99], v[184:187]
 ds_read_b64_tr_b16 v[236:237], v11 offset:61440
 v_mul_f32 v241, s30, v61
 v_mfma_f32_16x16x32_bf16 v[184:187], v[212:215], a[100:103], v[184:187]
 ds_read_b64_tr_b16 v[238:239], v11 offset:62464
 v_mul_f32 v242, s30, v62
 v_mfma_f32_16x16x32_bf16 v[184:187], v[216:219], a[104:107], v[184:187]
 buffer_load_dwordx4 v1, s[36:39], s90 offen offset:2048 sc1 lds
 v_mfma_f32_16x16x32_bf16 v[184:187], v[220:223], a[108:111], v[184:187]
 v_exp_f32 v240, v240
 v_mfma_f32_16x16x32_bf16 v[188:191], v[208:211], a[112:115], v[188:191]
 v_exp_f32 v241, v241
 v_mfma_f32_16x16x32_bf16 v[188:191], v[212:215], a[116:119], v[188:191]
 buffer_load_dwordx4 v1, s[36:39], s90 offen offset:3072 sc1 lds
 v_mfma_f32_16x16x32_bf16 v[188:191], v[216:219], a[120:123], v[188:191]
 s_add_u32 s90, s90, 17408
 s_lshl_b32 s68, s2, 2
 v_mul_f32 v243, s30, v63
 v_mfma_f32_16x16x32_bf16 v[188:191], v[220:223], a[124:127], v[188:191]
 s_waitcnt vmcnt(11) lgkmcnt(0)
 s_barrier
 v_mfma_f32_16x16x32_bf16 v[192:195], v[224:227], a[64:67], v[192:195]
 s_mov_b64 s[88:89], 0
 ds_read_b64_tr_b16 v[208:209], v12 offset:0
 s_add_u32 s68, s68, s60
 v_mfma_f32_16x16x32_bf16 v[192:195], v[228:231], a[68:71], v[192:195]
 s_mul_i32 s68, s68, 7168
 ds_read_b64_tr_b16 v[210:211], v12 offset:1024
 v_mul_f32 v244, s30, v76
 v_mfma_f32_16x16x32_bf16 v[192:195], v[232:235], a[72:75], v[192:195]
 s_add_u32 s68, s68, 70258688
 ds_read_b64_tr_b16 v[212:213], v12 offset:4096
 v_mul_f32 v245, s30, v77
 v_mfma_f32_16x16x32_bf16 v[192:195], v[236:239], a[76:79], v[192:195]
 buffer_store_dwordx4 v[32:35], v1, s[40:43], s68 offen sc1
 v_exp_f32 v242, v242
 v_mul_f32 v246, s30, v78
 v_mfma_f32_16x16x32_bf16 v[196:199], v[224:227], a[80:83], v[196:199]
 ds_read_b64_tr_b16 v[214:215], v12 offset:5120
 v_mul_f32 v247, s30, v79
 v_mfma_f32_16x16x32_bf16 v[196:199], v[228:231], a[84:87], v[196:199]
 ds_read_b64_tr_b16 v[216:217], v12 offset:8192
 v_add_f32 v240, 1.0, v240
 v_mfma_f32_16x16x32_bf16 v[196:199], v[232:235], a[88:91], v[196:199]
 ds_read_b64_tr_b16 v[218:219], v12 offset:9216
 v_fma_f32 v240, v240, v240, 1.0
 v_mfma_f32_16x16x32_bf16 v[196:199], v[236:239], a[92:95], v[196:199]
 s_add_u32 s65, s31, s78
 v_exp_f32 v243, v243
 v_mfma_f32_16x16x32_bf16 v[200:203], v[224:227], a[96:99], v[200:203]
 ds_read_b64_tr_b16 v[220:221], v12 offset:12288
 v_add_f32 v241, 1.0, v241
 v_mfma_f32_16x16x32_bf16 v[200:203], v[228:231], a[100:103], v[200:203]
 ds_read_b64_tr_b16 v[222:223], v12 offset:13312
 v_fma_f32 v241, v241, v241, 1.0
 v_mfma_f32_16x16x32_bf16 v[200:203], v[232:235], a[104:107], v[200:203]
 buffer_store_dwordx4 v[52:55], v1, s[44:47], s65 offen sc1
 v_exp_f32 v244, v244
 v_add_f32 v242, 1.0, v242
 v_mfma_f32_16x16x32_bf16 v[200:203], v[236:239], a[108:111], v[200:203]
 v_exp_f32 v245, v245
 v_mfma_f32_16x16x32_bf16 v[204:207], v[224:227], a[112:115], v[204:207]
 v_exp_f32 v246, v246
 v_mfma_f32_16x16x32_bf16 v[204:207], v[228:231], a[116:119], v[204:207]
 v_exp_f32 v247, v247
 v_mfma_f32_16x16x32_bf16 v[204:207], v[232:235], a[120:123], v[204:207]
 v_rcp_f32 v240, v240
 v_mfma_f32_16x16x32_bf16 v[204:207], v[236:239], a[124:127], v[204:207]
 s_waitcnt lgkmcnt(0)
 v_rcp_f32 v241, v241
 v_mfma_f32_16x16x32_bf16 v[144:147], v[208:211], a[128:131], v[144:147]
 ds_read_b64_tr_b16 v[224:225], v13 offset:0
 v_fma_f32 v242, v242, v242, 1.0
 v_mfma_f32_16x16x32_bf16 v[144:147], v[212:215], a[132:135], v[144:147]
 ds_read_b64_tr_b16 v[226:227], v13 offset:1024
 v_add_f32 v243, 1.0, v243
 v_mfma_f32_16x16x32_bf16 v[144:147], v[216:219], a[136:139], v[144:147]
 ds_read_b64_tr_b16 v[228:229], v13 offset:4096
 v_fma_f32 v243, v243, v243, 1.0
 v_mfma_f32_16x16x32_bf16 v[144:147], v[220:223], a[140:143], v[144:147]
 s_lshl_b32 s66, s2, 2
 v_rcp_f32 v242, v242
 v_mfma_f32_16x16x32_bf16 v[148:151], v[208:211], a[144:147], v[148:151]
 ds_read_b64_tr_b16 v[230:231], v13 offset:5120
 v_add_f32 v244, 1.0, v244
 v_mfma_f32_16x16x32_bf16 v[148:151], v[212:215], a[148:151], v[148:151]
 ds_read_b64_tr_b16 v[232:233], v13 offset:8192
 v_fma_f32 v244, v244, v244, 1.0
 v_mfma_f32_16x16x32_bf16 v[148:151], v[216:219], a[152:155], v[148:151]
 ds_read_b64_tr_b16 v[234:235], v13 offset:9216
 v_add_f32 v245, 1.0, v245
 v_mfma_f32_16x16x32_bf16 v[148:151], v[220:223], a[156:159], v[148:151]
 s_add_u32 s66, s66, s60
 v_rcp_f32 v243, v243
 v_mfma_f32_16x16x32_bf16 v[152:155], v[208:211], a[160:163], v[152:155]
 ds_read_b64_tr_b16 v[236:237], v13 offset:12288
 v_fma_f32 v245, v245, v245, 1.0
 v_mfma_f32_16x16x32_bf16 v[152:155], v[212:215], a[164:167], v[152:155]
 ds_read_b64_tr_b16 v[238:239], v13 offset:13312
 v_add_f32 v246, 1.0, v246
 v_mfma_f32_16x16x32_bf16 v[152:155], v[216:219], a[168:171], v[152:155]
 s_mul_i32 s66, s66, 7168
 v_rcp_f32 v244, v244
 v_mfma_f32_16x16x32_bf16 v[152:155], v[220:223], a[172:175], v[152:155]
 s_add_u32 s66, s66, 70259712
 v_rcp_f32 v245, v245
 v_mfma_f32_16x16x32_bf16 v[156:159], v[208:211], a[176:179], v[156:159]
 buffer_store_dwordx4 v[32:35], v1, s[40:43], s66 offen sc1
 v_fma_f32 v246, v246, v246, 1.0
 v_add_f32 v247, 1.0, v247
 v_fma_f32 v247, v247, v247, 1.0
 v_mfma_f32_16x16x32_bf16 v[156:159], v[212:215], a[180:183], v[156:159]
 v_rcp_f32 v246, v246
 v_mfma_f32_16x16x32_bf16 v[156:159], v[216:219], a[184:187], v[156:159]
 v_rcp_f32 v247, v247
 v_mfma_f32_16x16x32_bf16 v[156:159], v[220:223], a[188:191], v[156:159]
 s_waitcnt lgkmcnt(0)
 v_fma_f32 v240, v240, -2.0, 1.0
 v_mul_f32 v240, v240, v60
 v_mfma_f32_16x16x32_bf16 v[160:163], v[224:227], a[128:131], v[160:163]
 ds_read_b64_tr_b16 v[208:209], v14 offset:0
 v_fma_f32 v241, v241, -2.0, 1.0
 v_mfma_f32_16x16x32_bf16 v[160:163], v[228:231], a[132:135], v[160:163]
 ds_read_b64_tr_b16 v[210:211], v14 offset:1024
 v_mul_f32 v241, v241, v61
 v_mfma_f32_16x16x32_bf16 v[160:163], v[232:235], a[136:139], v[160:163]
 ds_read_b64_tr_b16 v[212:213], v14 offset:4096
 v_fma_f32 v242, v242, -2.0, 1.0
 v_mfma_f32_16x16x32_bf16 v[160:163], v[236:239], a[140:143], v[160:163]
 buffer_load_dword v251, v252, s[40:43], s3 offen offset:32 sc1
 v_mfma_f32_16x16x32_bf16 v[164:167], v[224:227], a[144:147], v[164:167]
 ds_read_b64_tr_b16 v[214:215], v14 offset:5120
 v_mul_f32 v242, v242, v62
 v_mfma_f32_16x16x32_bf16 v[164:167], v[228:231], a[148:151], v[164:167]
 ds_read_b64_tr_b16 v[216:217], v14 offset:8192
 v_fma_f32 v243, v243, -2.0, 1.0
 v_mfma_f32_16x16x32_bf16 v[164:167], v[232:235], a[152:155], v[164:167]
 ds_read_b64_tr_b16 v[218:219], v14 offset:9216
 v_mul_f32 v243, v243, v63
 v_mfma_f32_16x16x32_bf16 v[164:167], v[236:239], a[156:159], v[164:167]
 v_cvt_pk_bf16_f32 v60, v240, v241
 v_cvt_pk_bf16_f32 v61, v242, v243
 v_mfma_f32_16x16x32_bf16 v[168:171], v[224:227], a[160:163], v[168:171]
 ds_read_b64_tr_b16 v[220:221], v14 offset:12288
 v_fma_f32 v244, v244, -2.0, 1.0
 v_mfma_f32_16x16x32_bf16 v[168:171], v[228:231], a[164:167], v[168:171]
 ds_read_b64_tr_b16 v[222:223], v14 offset:13312
 v_mul_f32 v244, v244, v76
 v_mfma_f32_16x16x32_bf16 v[168:171], v[232:235], a[168:171], v[168:171]
 v_fma_f32 v245, v245, -2.0, 1.0
 v_mul_f32 v245, v245, v77
 v_mfma_f32_16x16x32_bf16 v[168:171], v[236:239], a[172:175], v[168:171]
 v_fma_f32 v246, v246, -2.0, 1.0
 v_mul_f32 v246, v246, v78
 v_mfma_f32_16x16x32_bf16 v[172:175], v[224:227], a[176:179], v[172:175]
 v_fma_f32 v247, v247, -2.0, 1.0
 v_mul_f32 v247, v247, v79
 v_mfma_f32_16x16x32_bf16 v[172:175], v[228:231], a[180:183], v[172:175]
 v_cvt_pk_bf16_f32 v62, v244, v245
 v_cvt_pk_bf16_f32 v63, v246, v247
 v_mfma_f32_16x16x32_bf16 v[172:175], v[232:235], a[184:187], v[172:175]
 s_add_u32 s67, s31, s79
 v_mfma_f32_16x16x32_bf16 v[172:175], v[236:239], a[188:191], v[172:175]
 s_waitcnt lgkmcnt(0)
 v_mfma_f32_16x16x32_bf16 v[176:179], v[208:211], a[128:131], v[176:179]
 ds_read_b64_tr_b16 v[224:225], v15 offset:0
 v_mfma_f32_16x16x32_bf16 v[176:179], v[212:215], a[132:135], v[176:179]
 ds_read_b64_tr_b16 v[226:227], v15 offset:1024
 v_mfma_f32_16x16x32_bf16 v[176:179], v[216:219], a[136:139], v[176:179]
 ds_read_b64_tr_b16 v[228:229], v15 offset:4096
 v_mfma_f32_16x16x32_bf16 v[176:179], v[220:223], a[140:143], v[176:179]
 buffer_store_dwordx4 v[56:59], v1, s[44:47], s67 offen sc1
 v_mfma_f32_16x16x32_bf16 v[180:183], v[208:211], a[144:147], v[180:183]
 ds_read_b64_tr_b16 v[230:231], v15 offset:5120
 v_mfma_f32_16x16x32_bf16 v[180:183], v[212:215], a[148:151], v[180:183]
 ds_read_b64_tr_b16 v[232:233], v15 offset:8192
 v_mfma_f32_16x16x32_bf16 v[180:183], v[216:219], a[152:155], v[180:183]
 ds_read_b64_tr_b16 v[234:235], v15 offset:9216
 v_mfma_f32_16x16x32_bf16 v[180:183], v[220:223], a[156:159], v[180:183]
 v_mfma_f32_16x16x32_bf16 v[184:187], v[208:211], a[160:163], v[184:187]
 ds_read_b64_tr_b16 v[236:237], v15 offset:12288
 v_mfma_f32_16x16x32_bf16 v[184:187], v[212:215], a[164:167], v[184:187]
 ds_read_b64_tr_b16 v[238:239], v15 offset:13312
 v_mfma_f32_16x16x32_bf16 v[184:187], v[216:219], a[168:171], v[184:187]
 v_mfma_f32_16x16x32_bf16 v[184:187], v[220:223], a[172:175], v[184:187]
 v_mfma_f32_16x16x32_bf16 v[188:191], v[208:211], a[176:179], v[188:191]
 v_mfma_f32_16x16x32_bf16 v[188:191], v[212:215], a[180:183], v[188:191]
 v_mfma_f32_16x16x32_bf16 v[188:191], v[216:219], a[184:187], v[188:191]
 v_mfma_f32_16x16x32_bf16 v[188:191], v[220:223], a[188:191], v[188:191]
 s_waitcnt vmcnt(36) lgkmcnt(0)
 v_mfma_f32_16x16x32_bf16 v[192:195], v[224:227], a[128:131], v[192:195]
 ds_read_b64_tr_b16 v[208:209], v12 offset:16384
 v_mfma_f32_16x16x32_bf16 v[192:195], v[228:231], a[132:135], v[192:195]
 ds_read_b64_tr_b16 v[210:211], v12 offset:17408
 v_mfma_f32_16x16x32_bf16 v[192:195], v[232:235], a[136:139], v[192:195]
 ds_read_b64_tr_b16 v[212:213], v12 offset:20480
 v_mfma_f32_16x16x32_bf16 v[192:195], v[236:239], a[140:143], v[192:195]
 v_mfma_f32_16x16x32_bf16 v[196:199], v[224:227], a[144:147], v[196:199]
 ds_read_b64_tr_b16 v[214:215], v12 offset:21504
 v_mfma_f32_16x16x32_bf16 v[196:199], v[228:231], a[148:151], v[196:199]
 ds_read_b64_tr_b16 v[216:217], v12 offset:24576
 v_mfma_f32_16x16x32_bf16 v[196:199], v[232:235], a[152:155], v[196:199]
 ds_read_b64_tr_b16 v[218:219], v12 offset:25600
 v_mfma_f32_16x16x32_bf16 v[196:199], v[236:239], a[156:159], v[196:199]
 v_mfma_f32_16x16x32_bf16 v[200:203], v[224:227], a[160:163], v[200:203]
 ds_read_b64_tr_b16 v[220:221], v12 offset:28672
 v_mfma_f32_16x16x32_bf16 v[200:203], v[228:231], a[164:167], v[200:203]
 ds_read_b64_tr_b16 v[222:223], v12 offset:29696
 v_mfma_f32_16x16x32_bf16 v[200:203], v[232:235], a[168:171], v[200:203]
 v_mfma_f32_16x16x32_bf16 v[200:203], v[236:239], a[172:175], v[200:203]
 v_mfma_f32_16x16x32_bf16 v[204:207], v[224:227], a[176:179], v[204:207]
 v_mfma_f32_16x16x32_bf16 v[204:207], v[228:231], a[180:183], v[204:207]
 v_mfma_f32_16x16x32_bf16 v[204:207], v[232:235], a[184:187], v[204:207]
 v_mfma_f32_16x16x32_bf16 v[204:207], v[236:239], a[188:191], v[204:207]
 s_waitcnt lgkmcnt(0)
 v_mfma_f32_16x16x32_bf16 v[144:147], v[208:211], a[192:195], v[144:147]
 ds_read_b64_tr_b16 v[224:225], v13 offset:16384
 v_mfma_f32_16x16x32_bf16 v[144:147], v[212:215], a[196:199], v[144:147]
 ds_read_b64_tr_b16 v[226:227], v13 offset:17408
 v_mfma_f32_16x16x32_bf16 v[144:147], v[216:219], a[200:203], v[144:147]
 ds_read_b64_tr_b16 v[228:229], v13 offset:20480
 v_mfma_f32_16x16x32_bf16 v[144:147], v[220:223], a[204:207], v[144:147]
 v_mfma_f32_16x16x32_bf16 v[148:151], v[208:211], a[208:211], v[148:151]
 ds_read_b64_tr_b16 v[230:231], v13 offset:21504
 v_mfma_f32_16x16x32_bf16 v[148:151], v[212:215], a[212:215], v[148:151]
 ds_read_b64_tr_b16 v[232:233], v13 offset:24576
 v_mfma_f32_16x16x32_bf16 v[148:151], v[216:219], a[216:219], v[148:151]
 ds_read_b64_tr_b16 v[234:235], v13 offset:25600
 v_cvt_pk_bf16_f32 v96, v144, v145
 v_mfma_f32_16x16x32_bf16 v[148:151], v[220:223], a[220:223], v[148:151]
 v_cvt_pk_bf16_f32 v97, v146, v147
 v_mfma_f32_16x16x32_bf16 v[152:155], v[208:211], a[224:227], v[152:155]
 ds_read_b64_tr_b16 v[236:237], v13 offset:28672
 v_mfma_f32_16x16x32_bf16 v[152:155], v[212:215], a[228:231], v[152:155]
 ds_read_b64_tr_b16 v[238:239], v13 offset:29696
 v_mfma_f32_16x16x32_bf16 v[152:155], v[216:219], a[232:235], v[152:155]
 v_cvt_pk_bf16_f32 v100, v148, v149
 v_cvt_pk_bf16_f32 v101, v150, v151
 v_mfma_f32_16x16x32_bf16 v[152:155], v[220:223], a[236:239], v[152:155]
 s_add_u32 s68, s31, s80
 v_mfma_f32_16x16x32_bf16 v[156:159], v[208:211], a[240:243], v[156:159]
 s_waitcnt vmcnt(1)
 v_cmp_eq_u32 vcc, 0, v251
 v_mfma_f32_16x16x32_bf16 v[156:159], v[212:215], a[244:247], v[156:159]
 s_cbranch_vccnz L_spin_v
L_back_v:
 v_mfma_f32_16x16x32_bf16 v[156:159], v[216:219], a[248:251], v[156:159]
 buffer_store_dwordx4 v[60:63], v1, s[44:47], s68 offen sc1
 v_cvt_pk_bf16_f32 v104, v152, v153
 v_cvt_pk_bf16_f32 v105, v154, v155
 v_mfma_f32_16x16x32_bf16 v[156:159], v[220:223], a[252:255], v[156:159]
 s_waitcnt lgkmcnt(0)
 v_mfma_f32_16x16x32_bf16 v[160:163], v[224:227], a[192:195], v[160:163]
 ds_read_b64_tr_b16 v[208:209], v14 offset:16384
 v_mfma_f32_16x16x32_bf16 v[160:163], v[228:231], a[196:199], v[160:163]
 ds_read_b64_tr_b16 v[210:211], v14 offset:17408
 v_mfma_f32_16x16x32_bf16 v[160:163], v[232:235], a[200:203], v[160:163]
 s_add_u32 m0, s92, 0
 ds_read_b64_tr_b16 v[212:213], v14 offset:20480
 v_cvt_pk_bf16_f32 v108, v156, v157
 v_mfma_f32_16x16x32_bf16 v[160:163], v[236:239], a[204:207], v[160:163]
 buffer_load_dwordx4 v1, s[56:59], s91 offen offset:0 sc1 lds
 v_mfma_f32_16x16x32_bf16 v[164:167], v[224:227], a[208:211], v[164:167]
 ds_read_b64_tr_b16 v[214:215], v14 offset:21504
 v_cvt_pk_bf16_f32 v109, v158, v159
 v_mfma_f32_16x16x32_bf16 v[164:167], v[228:231], a[212:215], v[164:167]
 ds_read_b64_tr_b16 v[216:217], v14 offset:24576
 v_mfma_f32_16x16x32_bf16 v[164:167], v[232:235], a[216:219], v[164:167]
 ds_read_b64_tr_b16 v[218:219], v14 offset:25600
 v_cvt_pk_bf16_f32 v98, v160, v161
 v_mfma_f32_16x16x32_bf16 v[164:167], v[236:239], a[220:223], v[164:167]
 buffer_load_dwordx4 v1, s[56:59], s91 offen offset:1024 sc1 lds
 v_mfma_f32_16x16x32_bf16 v[168:171], v[224:227], a[224:227], v[168:171]
 ds_read_b64_tr_b16 v[220:221], v14 offset:28672
 v_cvt_pk_bf16_f32 v99, v162, v163
 v_mfma_f32_16x16x32_bf16 v[168:171], v[228:231], a[228:231], v[168:171]
 ds_read_b64_tr_b16 v[222:223], v14 offset:29696
 v_mfma_f32_16x16x32_bf16 v[168:171], v[232:235], a[232:235], v[168:171]
 buffer_load_dwordx4 v1, s[56:59], s91 offen offset:2048 sc1 lds
 v_mfma_f32_16x16x32_bf16 v[168:171], v[236:239], a[236:239], v[168:171]
 v_cvt_pk_bf16_f32 v102, v164, v165
 v_cvt_pk_bf16_f32 v103, v166, v167
 v_mfma_f32_16x16x32_bf16 v[172:175], v[224:227], a[240:243], v[172:175]
 v_mfma_f32_16x16x32_bf16 v[172:175], v[228:231], a[244:247], v[172:175]
 buffer_load_dwordx4 v1, s[56:59], s91 offen offset:3072 sc1 lds
 v_mfma_f32_16x16x32_bf16 v[172:175], v[232:235], a[248:251], v[172:175]
 s_add_u32 s91, s91, 17408
 v_cvt_pk_bf16_f32 v106, v168, v169
 v_cvt_pk_bf16_f32 v107, v170, v171
 v_mfma_f32_16x16x32_bf16 v[172:175], v[236:239], a[252:255], v[172:175]
 s_waitcnt lgkmcnt(0)
 v_mfma_f32_16x16x32_bf16 v[176:179], v[208:211], a[192:195], v[176:179]
 ds_read_b64_tr_b16 v[224:225], v15 offset:16384
 v_mfma_f32_16x16x32_bf16 v[176:179], v[212:215], a[196:199], v[176:179]
 ds_read_b64_tr_b16 v[226:227], v15 offset:17408
 v_mfma_f32_16x16x32_bf16 v[176:179], v[216:219], a[200:203], v[176:179]
 s_add_u32 m0, s92, 16384
 ds_read_b64_tr_b16 v[228:229], v15 offset:20480
 v_cvt_pk_bf16_f32 v110, v172, v173
 v_mfma_f32_16x16x32_bf16 v[176:179], v[220:223], a[204:207], v[176:179]
 buffer_load_dwordx4 v1, s[56:59], s91 offen offset:0 sc1 lds
 v_mfma_f32_16x16x32_bf16 v[180:183], v[208:211], a[208:211], v[180:183]
 ds_read_b64_tr_b16 v[230:231], v15 offset:21504
 v_cvt_pk_bf16_f32 v111, v174, v175
 v_mfma_f32_16x16x32_bf16 v[180:183], v[212:215], a[212:215], v[180:183]
 ds_read_b64_tr_b16 v[232:233], v15 offset:24576
 v_mfma_f32_16x16x32_bf16 v[180:183], v[216:219], a[216:219], v[180:183]
 ds_read_b64_tr_b16 v[234:235], v15 offset:25600
 v_cvt_pk_bf16_f32 v128, v176, v177
 v_mfma_f32_16x16x32_bf16 v[180:183], v[220:223], a[220:223], v[180:183]
 buffer_load_dwordx4 v1, s[56:59], s91 offen offset:1024 sc1 lds
 v_mfma_f32_16x16x32_bf16 v[184:187], v[208:211], a[224:227], v[184:187]
 ds_read_b64_tr_b16 v[236:237], v15 offset:28672
 v_cvt_pk_bf16_f32 v129, v178, v179
 v_mfma_f32_16x16x32_bf16 v[184:187], v[212:215], a[228:231], v[184:187]
 ds_read_b64_tr_b16 v[238:239], v15 offset:29696
 v_mfma_f32_16x16x32_bf16 v[184:187], v[216:219], a[232:235], v[184:187]
 buffer_load_dwordx4 v1, s[56:59], s91 offen offset:2048 sc1 lds
 v_mfma_f32_16x16x32_bf16 v[184:187], v[220:223], a[236:239], v[184:187]
 v_cvt_pk_bf16_f32 v132, v180, v181
 v_cvt_pk_bf16_f32 v133, v182, v183
 v_mfma_f32_16x16x32_bf16 v[188:191], v[208:211], a[240:243], v[188:191]
 v_mfma_f32_16x16x32_bf16 v[188:191], v[212:215], a[244:247], v[188:191]
 buffer_load_dwordx4 v1, s[56:59], s91 offen offset:3072 sc1 lds
 v_mfma_f32_16x16x32_bf16 v[188:191], v[216:219], a[248:251], v[188:191]
 s_add_u32 s91, s91, 17408
 v_cvt_pk_bf16_f32 v136, v184, v185
 v_cvt_pk_bf16_f32 v137, v186, v187
 v_mfma_f32_16x16x32_bf16 v[188:191], v[220:223], a[252:255], v[188:191]
 s_waitcnt lgkmcnt(0)
 s_barrier
 v_mfma_f32_16x16x32_bf16 v[192:195], v[224:227], a[192:195], v[192:195]
 ds_read_b128 a[144:147], v4 offset:0
 v_mov_b32 v208, 0
 v_mov_b32 v209, 0
 v_mfma_f32_16x16x32_bf16 v[192:195], v[228:231], a[196:199], v[192:195]
 ds_read_b128 a[148:151], v4 offset:1024
 v_mov_b32 v210, 0
 v_mov_b32 v211, 0
 v_mfma_f32_16x16x32_bf16 v[192:195], v[232:235], a[200:203], v[192:195]
 ds_read_b128 a[152:155], v4 offset:2048
 v_mov_b32 v212, 0x3f803f80
 v_mov_b32 v213, 0x3f803f80
 v_mfma_f32_16x16x32_bf16 v[192:195], v[236:239], a[204:207], v[192:195]
 ds_read_b128 a[156:159], v4 offset:3072
 v_mov_b32 v214, 0x3f803f80
 v_mov_b32 v215, 0x3f803f80
 v_mfma_f32_16x16x32_bf16 v[196:199], v[224:227], a[208:211], v[196:199]
 ds_read_b128 a[160:163], v4 offset:4096
 v_cvt_pk_bf16_f32 v140, v188, v189
 v_mfma_f32_16x16x32_bf16 v[196:199], v[228:231], a[212:215], v[196:199]
 ds_read_b128 a[164:167], v4 offset:5120
 v_cvt_pk_bf16_f32 v141, v190, v191
 v_mfma_f32_16x16x32_bf16 v[196:199], v[232:235], a[216:219], v[196:199]
 v_cvt_pk_bf16_f32 v130, v192, v193
 v_cvt_pk_bf16_f32 v131, v194, v195
 v_mfma_f32_16x16x32_bf16 v[196:199], v[236:239], a[220:223], v[196:199]
 v_mfma_f32_16x16x32_bf16 v[200:203], v[224:227], a[224:227], v[200:203]
 v_mfma_f32_16x16x32_bf16 v[200:203], v[228:231], a[228:231], v[200:203]
 v_mfma_f32_16x16x32_bf16 v[200:203], v[232:235], a[232:235], v[200:203]
 v_cvt_pk_bf16_f32 v134, v196, v197
 v_cvt_pk_bf16_f32 v135, v198, v199
 v_mfma_f32_16x16x32_bf16 v[200:203], v[236:239], a[236:239], v[200:203]
 v_mfma_f32_16x16x32_bf16 v[204:207], v[224:227], a[240:243], v[204:207]
 v_mfma_f32_16x16x32_bf16 v[204:207], v[228:231], a[244:247], v[204:207]
 v_mfma_f32_16x16x32_bf16 v[204:207], v[232:235], a[248:251], v[204:207]
 v_cvt_pk_bf16_f32 v138, v200, v201
 v_cvt_pk_bf16_f32 v139, v202, v203
 v_mfma_f32_16x16x32_bf16 v[204:207], v[236:239], a[252:255], v[204:207]
 s_waitcnt lgkmcnt(2)
 v_mfma_f32_16x16x32_bf16 v[144:147], a[144:147], v[80:83], 0
 s_and_b32 s65, s2, 3
 s_bfe_u32 s66, s2, 0x30003
 v_mov_b32 v253, 1
 v_mfma_f32_16x16x32_bf16 v[144:147], a[148:151], v[112:115], v[144:147]
 s_and_b32 s85, s2, 4
 s_lshl_b32 s85, s85, 1
 s_add_u32 s66, s66, s85
 v_mfma_f32_16x16x32_bf16 v[144:147], a[152:155], v[96:99], v[144:147]
 s_and_b32 s67, s60, 1
 s_lshr_b32 s68, s60, 1
 s_lshr_b32 s74, s2, 6
 v_mfma_f32_16x16x32_bf16 v[144:147], a[156:159], v[128:131], v[144:147]
 s_lshl_b32 s74, s74, 1
 v_cvt_pk_bf16_f32 v142, v204, v205
 v_cvt_pk_bf16_f32 v143, v206, v207
 v_mfma_f32_16x16x32_bf16 v[148:151], a[144:147], v[84:87], 0
 s_add_u32 s74, s74, s67
 s_lshl_b32 s74, s74, 7
 s_lshl_b32 s73, s66, 1
 v_mfma_f32_16x16x32_bf16 v[148:151], a[148:151], v[116:119], v[148:151]
 s_add_u32 s85, s73, s67
 s_mul_i32 s75, s85, 791552
 s_lshl_b32 s85, s68, 12
 v_mfma_f32_16x16x32_bf16 v[148:151], a[152:155], v[100:103], v[148:151]
L_st2_8:
 s_cbranch_execz L_warmed2
 s_add_u32 s75, s75, s85
 s_mul_i32 s85, s65, 139264
 s_add_u32 s76, s75, s85
 v_mfma_f32_16x16x32_bf16 v[148:151], a[156:159], v[132:135], v[148:151]
 s_mul_i32 s85, s65, 57344
 v_cmp_le_i32 vcc, 0, v254
 v_cmp_le_i32 s[98:99], 1, v254
 v_mfma_f32_16x16x32_bf16 v[152:155], a[144:147], v[88:91], 0
 s_add_u32 s75, s75, s85
 v_cmp_le_i32 s[100:101], 2, v254
 v_cndmask_b32 v144, v250, v144, vcc
 v_mfma_f32_16x16x32_bf16 v[152:155], a[148:151], v[120:123], v[152:155]
 s_lshl_b32 s85, s68, 15
 v_cmp_le_i32 vcc, 3, v254
 v_cndmask_b32 v145, v250, v145, s[98:99]
 v_mfma_f32_16x16x32_bf16 v[152:155], a[152:155], v[104:107], v[152:155]
 s_add_u32 s85, s85, s74
 v_cndmask_b32 v146, v250, v146, s[100:101]
 v_cndmask_b32 v147, v250, v147, vcc
 v_mfma_f32_16x16x32_bf16 v[152:155], a[156:159], v[136:139], v[152:155]
 s_mul_i32 s63, s65, 458752
 s_add_u32 s63, s63, s85
 s_lshl_b32 s64, s65, 20
 v_mfma_f32_16x16x32_bf16 v[156:159], a[144:147], v[92:95], 0
 s_add_u32 s64, s64, s85
 s_lshl_b32 s69, s60, 12
 s_add_u32 s73, s73, s68
 v_mfma_f32_16x16x32_bf16 v[156:159], a[148:151], v[124:127], v[156:159]
 s_lshl_b32 s73, s73, 2
 s_add_u32 s73, s73, s65
 s_lshl_b32 s73, s73, 14
 v_mfma_f32_16x16x32_bf16 v[156:159], a[152:155], v[108:111], v[156:159]
 s_add_u32 s73, s73, s74
 s_sub_u32 s86, 15, s66
 s_min_u32 s85, s66, s86
 v_mfma_f32_16x16x32_bf16 v[156:159], a[156:159], v[140:143], v[156:159]
 s_lshl_b32 s85, s85, 2
 s_add_u32 s85, s85, s65
 s_lshl_b32 s85, s85, 7
 v_mfma_f32_32x32x16_bf16 a[0:15], v[208:211], v[208:211], 0
 s_add_u32 s85, s85, 69211136
 s_mov_b32 s32, s22
 s_mov_b32 s33, s23
 s_mov_b32 s34, 1835008
 s_mov_b32 s52, s14
 s_mov_b32 s53, s15
 s_mov_b32 s54, 4194304
 v_mfma_f32_32x32x16_bf16 a[16:31], v[208:211], v[208:211], 0
 s_mov_b32 s44, s24
 v_max3_f32 v196, v144, v145, v146
 v_max3_f32 v197, v148, v149, v150
 v_max3_f32 v198, v152, v153, v154
 v_max3_f32 v199, v156, v157, v158
 v_max_f32 v196, v196, v147
 v_max_f32 v197, v197, v151
 v_mfma_f32_32x32x16_bf16 a[32:47], v[208:211], v[208:211], 0
 s_mov_b32 s45, s25
 v_max_f32 v198, v198, v155
 v_max_f32 v199, v199, v159
 v_mov_b32 v200, v196
 v_mov_b32 v201, v197
 v_mov_b32 v202, v198
 v_mov_b32 v203, v199
 v_mfma_f32_32x32x16_bf16 a[48:63], v[208:211], v[208:211], 0
 s_mov_b32 s46, 2097152
 v_permlane16_swap_b32 v196, v200
 v_permlane16_swap_b32 v197, v201
 v_permlane16_swap_b32 v198, v202
 v_permlane16_swap_b32 v199, v203
 v_max_f32 v196, v196, v200
 v_max_f32 v197, v197, v201
 v_mfma_f32_32x32x16_bf16 a[64:79], v[208:211], v[208:211], 0
 s_mov_b32 s72, 69210112
 v_max_f32 v198, v198, v202
 v_max_f32 v199, v199, v203
 v_mov_b32 v200, v196
 v_mov_b32 v201, v197
 v_mov_b32 v202, v198
 v_mov_b32 v203, v199
 v_mfma_f32_32x32x16_bf16 a[80:95], v[208:211], v[208:211], 0
 v_permlane32_swap_b32 v196, v200
 v_permlane32_swap_b32 v197, v201
 v_permlane32_swap_b32 v198, v202
 v_permlane32_swap_b32 v199, v203
 v_max_f32 v196, v196, v200
 v_max_f32 v197, v197, v201
 v_mfma_f32_32x32x16_bf16 a[96:111], v[208:211], v[208:211], 0
 v_max_f32 v198, v198, v202
 v_max_f32 v199, v199, v203
 v_lshrrev_b32 v216, 9, v1
 v_lshlrev_b32 v216, 10, v216
 v_and_b32_e64 v217, 1, s60
 v_lshlrev_b32 v217, 12, v217
 v_mfma_f32_32x32x16_bf16 a[112:127], v[208:211], v[208:211], 0
 v_sub_u32 v216, v217, v216
 v_add_u32 v216, 16384, v216
 v_add_u32 v8, v8, v216
 v_add_u32 v9, v9, v216
 v_add_u32 v10, v10, v216
 v_add_u32 v11, v11, v216
 v_mfma_f32_32x32x16_bf16 a[128:143], v[208:211], v[208:211], 0
 s_add_u32 s70, s28, s85
 s_addc_u32 s71, s29, 0
 v_lshrrev_b32 v216, 7, v1
 v_and_b32 v217, 0x7f, v2
 v_lshl_add_u32 v12, v216, 10, v217
 v_add_u32 v13, 7168, v12
 v_add_u32 v14, 14336, v12
 v_add_u32 v15, 21504, v12
L_att_go:
 v_sub_f32 v188, 0, v199
 v_sub_f32 v189, 0, v199
 v_sub_f32 v190, 0, v199
 v_sub_f32 v191, 0, v199
 v_sub_f32 v192, 0, v196
 v_sub_f32 v180, 0, v198
 v_sub_f32 v181, 0, v198
 v_sub_f32 v182, 0, v198
 v_sub_f32 v183, 0, v198
 v_mfma_f32_16x16x32_bf16 v[144:147], a[144:147], v[92:95], v[188:191]
 v_sub_f32 v176, 0, v197
 v_sub_f32 v177, 0, v197
 v_mfma_f32_16x16x32_bf16 v[144:147], a[148:151], v[124:127], v[144:147]
 v_sub_f32 v178, 0, v197
 v_sub_f32 v179, 0, v197
 v_mfma_f32_16x16x32_bf16 v[144:147], a[152:155], v[108:111], v[144:147]
 v_sub_f32 v184, 0, v199
 v_sub_f32 v185, 0, v199
 v_mfma_f32_16x16x32_bf16 v[144:147], a[156:159], v[140:143], v[144:147]
 v_sub_f32 v186, 0, v199
 v_sub_f32 v187, 0, v199
 v_cmp_le_i32 vcc, 0, v254
 v_cmp_le_i32 s[98:99], 1, v254
 v_cmp_le_i32 s[100:101], 2, v254
 v_cndmask_b32 v160, v250, v192, vcc
 v_cmp_le_i32 vcc, 3, v254
 v_cndmask_b32 v161, v250, v192, s[98:99]
 v_cndmask_b32 v162, v250, v192, s[100:101]
 v_cndmask_b32 v163, v250, v192, vcc
 v_cmp_le_i32 vcc, 16, v254
 v_cmp_le_i32 s[98:99], 17, v254
 v_cmp_le_i32 s[100:101], 18, v254
 v_cndmask_b32 v164, v250, v192, vcc
 v_cmp_le_i32 vcc, 19, v254
 v_cndmask_b32 v165, v250, v192, s[98:99]
 v_cndmask_b32 v166, v250, v192, s[100:101]
 v_cndmask_b32 v167, v250, v192, vcc
 v_cmp_le_i32 vcc, 32, v254
 v_cmp_le_i32 s[98:99], 33, v254
 v_cmp_le_i32 s[100:101], 34, v254
 v_cndmask_b32 v168, v250, v192, vcc
 v_cmp_le_i32 vcc, 35, v254
 v_cndmask_b32 v169, v250, v192, s[98:99]
 v_cndmask_b32 v170, v250, v192, s[100:101]
 v_cndmask_b32 v171, v250, v192, vcc
 v_cmp_le_i32 vcc, 48, v254
 v_cmp_le_i32 s[98:99], 49, v254
 v_cmp_le_i32 s[100:101], 50, v254
 v_cndmask_b32 v172, v250, v192, vcc
 v_cmp_le_i32 vcc, 51, v254
 v_cndmask_b32 v173, v250, v192, s[98:99]
 v_cndmask_b32 v174, v250, v192, s[100:101]
 v_cndmask_b32 v175, v250, v192, vcc
 s_mov_b32 s94, s62
 v_mfma_f32_16x16x32_bf16 v[148:151], a[144:147], v[88:91], v[180:183]
 s_add_u32 m0, s93, 81920
 ds_read_b128 a[168:171], v4 offset:6144
 ds_read_b128 a[172:175], v4 offset:7168
 v_mfma_f32_16x16x32_bf16 v[148:151], a[148:151], v[120:123], v[148:151]
 buffer_load_dwordx4 v1, s[36:39], s90 offen offset:0 sc1 lds
 v_mfma_f32_16x16x32_bf16 v[148:151], a[152:155], v[104:107], v[148:151]
 v_exp_f32 v144, v144
 v_mfma_f32_16x16x32_bf16 v[148:151], a[156:159], v[136:139], v[148:151]
 v_exp_f32 v145, v145
 v_mfma_f32_16x16x32_bf16 v[152:155], a[144:147], v[84:87], v[176:179]
 v_exp_f32 v146, v146
 v_mfma_f32_16x16x32_bf16 v[152:155], a[148:151], v[116:119], v[152:155]
 v_exp_f32 v147, v147
 v_mfma_f32_16x16x32_bf16 v[152:155], a[152:155], v[100:103], v[152:155]
 v_exp_f32 v148, v148
 v_mfma_f32_16x16x32_bf16 v[152:155], a[156:159], v[132:135], v[152:155]
 v_exp_f32 v149, v149
 v_mfma_f32_16x16x32_bf16 v[156:159], a[144:147], v[80:83], v[160:163]
 ds_read_b128 a[144:147], v4 offset:8192
 v_cvt_pk_bf16_f32 v41, v146, v147
 v_mfma_f32_16x16x32_bf16 v[156:159], a[148:151], v[112:115], v[156:159]
 v_exp_f32 v150, v150
 v_mfma_f32_16x16x32_bf16 v[156:159], a[152:155], v[96:99], v[156:159]
 s_nop 0
 ds_read_b128 a[148:151], v4 offset:9216
 ds_read_b128 a[152:155], v4 offset:10240
 v_mfma_f32_16x16x32_bf16 v[156:159], a[156:159], v[128:131], v[156:159]
 s_waitcnt lgkmcnt(3)
 ds_read_b128 a[156:159], v4 offset:11264
 v_cvt_pk_bf16_f32 v40, v144, v145
 v_mfma_f32_16x16x32_bf16 v[144:147], a[160:163], v[92:95], v[184:187]
 v_exp_f32 v151, v151
 v_mfma_f32_16x16x32_bf16 v[144:147], a[164:167], v[124:127], v[144:147]
 v_exp_f32 v152, v152
 v_mfma_f32_16x16x32_bf16 v[144:147], a[168:171], v[108:111], v[144:147]
 v_exp_f32 v153, v153
 v_mfma_f32_16x16x32_bf16 v[144:147], a[172:175], v[140:143], v[144:147]
 v_cvt_pk_bf16_f32 v33, v150, v151
 v_cvt_pk_bf16_f32 v32, v148, v149
 v_mfma_f32_16x16x32_bf16 v[148:151], a[160:163], v[88:91], v[180:183]
 v_exp_f32 v154, v154
 v_mfma_f32_16x16x32_bf16 v[148:151], a[164:167], v[120:123], v[148:151]
 v_exp_f32 v155, v155
 v_mfma_f32_16x16x32_bf16 v[148:151], a[168:171], v[104:107], v[148:151]
 buffer_load_dwordx4 v1, s[36:39], s90 offen offset:1024 sc1 lds
 v_mfma_f32_16x16x32_bf16 v[148:151], a[172:175], v[136:139], v[148:151]
 v_cvt_pk_bf16_f32 v25, v154, v155
 v_cvt_pk_bf16_f32 v24, v152, v153
 v_mfma_f32_16x16x32_bf16 v[152:155], a[160:163], v[84:87], v[176:179]
 v_exp_f32 v156, v156
 v_mfma_f32_16x16x32_bf16 v[152:155], a[164:167], v[116:119], v[152:155]
 v_exp_f32 v157, v157
 v_mfma_f32_16x16x32_bf16 v[152:155], a[168:171], v[100:103], v[152:155]
 v_exp_f32 v158, v158
 v_exp_f32 v159, v159
 v_mfma_f32_16x16x32_bf16 v[152:155], a[172:175], v[132:135], v[152:155]
 v_cvt_pk_bf16_f32 v17, v158, v159
 v_cvt_pk_bf16_f32 v16, v156, v157
 v_mfma_f32_16x16x32_bf16 v[156:159], a[160:163], v[80:83], v[164:167]
 ds_read_b128 a[160:163], v4 offset:12288
 v_exp_f32 v144, v144
 v_mfma_f32_16x16x32_bf16 v[156:159], a[164:167], v[112:115], v[156:159]
 v_exp_f32 v145, v145
 v_mfma_f32_16x16x32_bf16 v[156:159], a[168:171], v[96:99], v[156:159]
 v_exp_f32 v146, v146
 v_exp_f32 v147, v147
 v_mfma_f32_16x16x32_bf16 v[156:159], a[172:175], v[128:131], v[156:159]
 s_waitcnt lgkmcnt(1)
 ds_read_b128 a[164:167], v4 offset:13312
 v_cvt_pk_bf16_f32 v43, v146, v147
 v_cvt_pk_bf16_f32 v42, v144, v145
 v_mfma_f32_16x16x32_bf16 v[144:147], a[144:147], v[92:95], v[184:187]
 buffer_load_dwordx4 v1, s[36:39], s90 offen offset:2048 sc1 lds
 v_mfma_f32_16x16x32_bf16 v[144:147], a[148:151], v[124:127], v[144:147]
 v_exp_f32 v152, v152
 v_mfma_f32_16x16x32_bf16 v[144:147], a[152:155], v[108:111], v[144:147]
 v_exp_f32 v148, v148
 v_exp_f32 v149, v149
 v_exp_f32 v150, v150
 v_exp_f32 v151, v151
 v_mfma_f32_16x16x32_bf16 v[144:147], a[156:159], v[140:143], v[144:147]
 ds_read_b128 a[168:171], v4 offset:14336
 v_cvt_pk_bf16_f32 v35, v150, v151
 v_cvt_pk_bf16_f32 v34, v148, v149
 v_mfma_f32_16x16x32_bf16 v[148:151], a[144:147], v[88:91], v[180:183]
 ds_read_b128 a[172:175], v4 offset:15360
 v_exp_f32 v153, v153
 v_mfma_f32_16x16x32_bf16 v[148:151], a[148:151], v[120:123], v[148:151]
 v_exp_f32 v154, v154
 v_mfma_f32_16x16x32_bf16 v[148:151], a[152:155], v[104:107], v[148:151]
 v_exp_f32 v155, v155
 v_mfma_f32_16x16x32_bf16 v[148:151], a[156:159], v[136:139], v[148:151]
 v_cvt_pk_bf16_f32 v26, v152, v153
 v_cvt_pk_bf16_f32 v27, v154, v155
 v_mfma_f32_16x16x32_bf16 v[152:155], a[144:147], v[84:87], v[176:179]
 v_exp_f32 v156, v156
 v_mfma_f32_16x16x32_bf16 v[152:155], a[148:151], v[116:119], v[152:155]
 v_exp_f32 v157, v157
 v_mfma_f32_16x16x32_bf16 v[152:155], a[152:155], v[100:103], v[152:155]
 v_exp_f32 v158, v158
 v_exp_f32 v159, v159
 v_mfma_f32_16x16x32_bf16 v[152:155], a[156:159], v[132:135], v[152:155]
 v_cvt_pk_bf16_f32 v19, v158, v159
 v_cvt_pk_bf16_f32 v18, v156, v157
 v_mfma_f32_16x16x32_bf16 v[156:159], a[144:147], v[80:83], v[168:171]
 buffer_load_dwordx4 v1, s[36:39], s90 offen offset:3072 sc1 lds
 v_mfma_f32_16x16x32_bf16 v[156:159], a[148:151], v[112:115], v[156:159]
 s_add_u32 m0, s93, 0
 v_exp_f32 v144, v144
 v_mfma_f32_16x16x32_bf16 v[156:159], a[152:155], v[96:99], v[156:159]
 s_add_u32 s90, s90, 17408
 v_exp_f32 v145, v145
 v_exp_f32 v146, v146
 v_exp_f32 v147, v147
 v_mfma_f32_16x16x32_bf16 v[156:159], a[156:159], v[128:131], v[156:159]
 s_waitcnt lgkmcnt(1)
 v_cvt_pk_bf16_f32 v44, v144, v145
 v_cvt_pk_bf16_f32 v45, v146, v147
 v_mfma_f32_16x16x32_bf16 v[144:147], a[160:163], v[92:95], v[184:187]
 v_exp_f32 v148, v148
 v_mfma_f32_16x16x32_bf16 v[144:147], a[164:167], v[124:127], v[144:147]
 v_exp_f32 v149, v149
 v_mfma_f32_16x16x32_bf16 v[144:147], a[168:171], v[108:111], v[144:147]
 s_waitcnt vmcnt(8) lgkmcnt(0)
 v_exp_f32 v150, v150
 v_exp_f32 v151, v151
 v_mfma_f32_16x16x32_bf16 v[144:147], a[172:175], v[140:143], v[144:147]
 s_barrier
 v_cvt_pk_bf16_f32 v36, v148, v149
 v_cvt_pk_bf16_f32 v37, v150, v151
 v_mfma_f32_16x16x32_bf16 v[148:151], a[160:163], v[88:91], v[180:183]
 buffer_load_dwordx4 v1, s[56:59], s91 offen offset:0 sc1 lds
 ds_read_b128 a[144:147], v4 offset:16384
 v_mfma_f32_16x16x32_bf16 v[148:151], a[164:167], v[120:123], v[148:151]
 ds_read_b128 a[148:151], v4 offset:17408
 v_exp_f32 v152, v152
 v_mfma_f32_16x16x32_bf16 v[148:151], a[168:171], v[104:107], v[148:151]
 v_exp_f32 v153, v153
 v_exp_f32 v154, v154
 v_exp_f32 v155, v155
 v_mfma_f32_16x16x32_bf16 v[148:151], a[172:175], v[136:139], v[148:151]
 ds_read_b128 a[152:155], v4 offset:18432
 v_cvt_pk_bf16_f32 v28, v152, v153
 v_cvt_pk_bf16_f32 v29, v154, v155
 v_mfma_f32_16x16x32_bf16 v[152:155], a[160:163], v[84:87], v[176:179]
 buffer_load_dwordx4 v1, s[56:59], s91 offen offset:1024 sc1 lds
 ds_read_b128 a[156:159], v4 offset:19456
 v_mfma_f32_16x16x32_bf16 v[152:155], a[164:167], v[116:119], v[152:155]
 v_exp_f32 v156, v156
 v_mfma_f32_16x16x32_bf16 v[152:155], a[168:171], v[100:103], v[152:155]
 v_exp_f32 v157, v157
 v_exp_f32 v158, v158
 v_exp_f32 v159, v159
 v_mfma_f32_16x16x32_bf16 v[152:155], a[172:175], v[132:135], v[152:155]
 ds_read_b128 a[176:179], v6 offset:0
 v_cvt_pk_bf16_f32 v20, v156, v157
 v_cvt_pk_bf16_f32 v21, v158, v159
 v_mfma_f32_16x16x32_bf16 v[156:159], a[160:163], v[80:83], v[172:175]
 ds_read_b128 a[180:183], v6 offset:1024
 v_exp_f32 v144, v144
 v_mfma_f32_16x16x32_bf16 v[156:159], a[164:167], v[112:115], v[156:159]
 v_exp_f32 v145, v145
 v_mfma_f32_16x16x32_bf16 v[156:159], a[168:171], v[96:99], v[156:159]
 buffer_load_dwordx4 v1, s[56:59], s91 offen offset:2048 sc1 lds
 v_exp_f32 v146, v146
 v_exp_f32 v147, v147
 v_mfma_f32_16x16x32_bf16 v[156:159], a[172:175], v[128:131], v[156:159]
 s_waitcnt lgkmcnt(2)
 ds_read_b128 a[160:163], v4 offset:20480
 v_cvt_pk_bf16_f32 v46, v144, v145
 v_cvt_pk_bf16_f32 v47, v146, v147
 v_mfma_f32_16x16x32_bf16 v[144:147], a[144:147], v[92:95], v[188:191]
 v_exp_f32 v152, v152
 v_mfma_f32_16x16x32_bf16 v[144:147], a[148:151], v[124:127], v[144:147]
 buffer_load_dwordx4 v1, s[56:59], s91 offen offset:3072 sc1 lds
 v_mfma_f32_16x16x32_bf16 v[144:147], a[152:155], v[108:111], v[144:147]
 s_add_u32 s91, s91, 17408
 v_exp_f32 v148, v148
 v_exp_f32 v149, v149
 v_exp_f32 v150, v150
 v_exp_f32 v151, v151
 v_exp_f32 v153, v153
 v_exp_f32 v154, v154
 v_exp_f32 v155, v155
 v_mfma_f32_16x16x32_bf16 v[144:147], a[156:159], v[140:143], v[144:147]
 s_cmp_lg_u32 s94, 0
 ds_read_b128 a[164:167], v4 offset:21504
 buffer_store_dword v253, v0, s[40:43], s82 offen sc1
 v_cvt_pk_bf16_f32 v30, v152, v153
 v_cvt_pk_bf16_f32 v39, v150, v151
 v_cvt_pk_bf16_f32 v31, v154, v155
 v_cvt_pk_bf16_f32 v38, v148, v149
 v_exp_f32 v156, v156
 v_exp_f32 v157, v157
 v_exp_f32 v158, v158
 v_exp_f32 v159, v159
 v_cvt_pk_bf16_f32 v22, v156, v157
 v_cvt_pk_bf16_f32 v23, v158, v159
 s_cbranch_scc1 L_dloop
L_three:
 v_mfma_f32_16x16x32_bf16 v[148:151], a[144:147], v[88:91], v[180:183]
 s_add_u32 m0, s92, 65536
 ds_read_b128 a[184:187], v6 offset:2048
 v_cmp_le_i32 vcc, 0, v249
 v_mfma_f32_16x16x32_bf16 v[148:151], a[148:151], v[120:123], v[148:151]
L_st2_9:
 s_cbranch_execz L_warmed2
 buffer_load_dwordx4 v1, s[36:39], s90 offen offset:0 sc1 lds
 v_mfma_f32_16x16x32_bf16 v[148:151], a[152:155], v[104:107], v[148:151]
 ds_read_b128 a[188:191], v6 offset:3072
 v_cmp_le_i32 s[98:99], 1, v249
 v_mfma_f32_16x16x32_bf16 v[148:151], a[156:159], v[136:139], v[148:151]
 s_waitcnt lgkmcnt(4)
 v_exp_f32 v144, v144
 v_mfma_f32_16x16x32_bf16 a[96:99], a[176:179], v[40:43], a[96:99]
 ds_read_b128 a[168:171], v4 offset:22528
 v_cmp_le_i32 s[100:101], 2, v249
 v_mfma_f32_16x16x32_bf16 a[96:99], a[180:183], v[44:47], a[96:99]
 v_exp_f32 v145, v145
 v_mfma_f32_16x16x32_bf16 a[64:67], a[176:179], v[32:35], a[64:67]
 ds_read_b128 a[172:175], v4 offset:23552
 v_cndmask_b32 v160, v250, v176, vcc
 v_mfma_f32_16x16x32_bf16 a[64:67], a[180:183], v[36:39], a[64:67]
 v_exp_f32 v146, v146
 v_mfma_f32_16x16x32_bf16 a[32:35], a[176:179], v[24:27], a[32:35]
 v_cmp_le_i32 vcc, 3, v249
 v_cndmask_b32 v161, v250, v176, s[98:99]
 v_cndmask_b32 v162, v250, v176, s[100:101]
 v_cndmask_b32 v163, v250, v176, vcc
 v_mfma_f32_16x16x32_bf16 a[32:35], a[180:183], v[28:31], a[32:35]
 ds_read_b128 a[192:195], v6 offset:4096
 v_cvt_pk_bf16_f32 v72, v144, v145
 v_mfma_f32_16x16x32_bf16 v[152:155], a[144:147], v[84:87], v[160:163]
 v_exp_f32 v147, v147
 v_mfma_f32_16x16x32_bf16 v[152:155], a[148:151], v[116:119], v[152:155]
 ds_read_b128 a[196:199], v6 offset:5120
 v_cvt_pk_bf16_f32 v73, v146, v147
 v_mfma_f32_16x16x32_bf16 v[152:155], a[152:155], v[100:103], v[152:155]
 v_exp_f32 v148, v148
 v_mfma_f32_16x16x32_bf16 v[152:155], a[156:159], v[132:135], v[152:155]
 ds_read_b128 a[200:203], v6 offset:6144
 v_sub_u32_e64 v255, 7, s62
 v_mfma_f32_16x16x32_bf16 a[0:3], a[176:179], v[16:19], a[0:3]
 v_exp_f32 v149, v149
 v_mfma_f32_16x16x32_bf16 a[0:3], a[180:183], v[20:23], a[0:3]
 s_waitcnt lgkmcnt(2)
 ds_read_b128 a[204:207], v6 offset:7168
 v_lshlrev_b32 v255, 7, v255
 v_mfma_f32_16x16x32_bf16 a[100:103], a[184:187], v[40:43], a[100:103]
 v_exp_f32 v150, v150
 v_mfma_f32_16x16x32_bf16 a[100:103], a[188:191], v[44:47], a[100:103]
 ds_read_b128 a[144:147], v4 offset:24576
 v_add_u32 v254, v255, v248
 v_mfma_f32_16x16x32_bf16 a[68:71], a[184:187], v[32:35], a[68:71]
 v_exp_f32 v151, v151
 v_mfma_f32_16x16x32_bf16 a[68:71], a[188:191], v[36:39], a[68:71]
 ds_read_b128 a[148:151], v4 offset:25600
 v_add_u32 v255, v255, v249
 v_mfma_f32_16x16x32_bf16 v[156:159], a[160:163], v[92:95], v[184:187]
 v_exp_f32 v152, v152
 v_mfma_f32_16x16x32_bf16 v[156:159], a[164:167], v[124:127], v[156:159]
 ds_read_b128 a[152:155], v4 offset:26624
 v_cmp_le_i32 vcc, 16, v249
 v_mfma_f32_16x16x32_bf16 v[156:159], a[168:171], v[108:111], v[156:159]
 buffer_load_dwordx4 v1, s[36:39], s90 offen offset:1024 sc1 lds
 v_mfma_f32_16x16x32_bf16 v[156:159], a[172:175], v[140:143], v[156:159]
 ds_read_b128 a[156:159], v4 offset:27648
 v_cmp_le_i32 s[98:99], 17, v249
 v_mfma_f32_16x16x32_bf16 a[36:39], a[184:187], v[24:27], a[36:39]
 v_exp_f32 v153, v153
 v_mfma_f32_16x16x32_bf16 a[36:39], a[188:191], v[28:31], a[36:39]
 ds_read_b128 a[176:179], v6 offset:8192
 v_cmp_le_i32 s[100:101], 18, v249
 v_mfma_f32_16x16x32_bf16 a[4:7], a[184:187], v[16:19], a[4:7]
 v_exp_f32 v154, v154
 v_mfma_f32_16x16x32_bf16 a[4:7], a[188:191], v[20:23], a[4:7]
 ds_read_b128 a[180:183], v6 offset:9216
 v_cndmask_b32 v164, v250, v176, vcc
 v_mfma_f32_16x16x32_bf16 a[104:107], a[192:195], v[40:43], a[104:107]
 s_waitcnt lgkmcnt(2)
 v_exp_f32 v155, v155
 v_mfma_f32_16x16x32_bf16 a[104:107], a[196:199], v[44:47], a[104:107]
 ds_read_b128 a[184:187], v6 offset:10240
 v_cmp_le_i32 vcc, 19, v249
 v_mfma_f32_16x16x32_bf16 v[144:147], a[160:163], v[88:91], v[180:183]
 v_exp_f32 v156, v156
 v_mfma_f32_16x16x32_bf16 v[144:147], a[164:167], v[120:123], v[144:147]
 ds_read_b128 a[188:191], v6 offset:11264
 v_cndmask_b32 v165, v250, v176, s[98:99]
 v_mfma_f32_16x16x32_bf16 v[144:147], a[168:171], v[104:107], v[144:147]
 v_exp_f32 v157, v157
 v_mfma_f32_16x16x32_bf16 v[144:147], a[172:175], v[136:139], v[144:147]
 v_exp_f32 v158, v158
 v_mfma_f32_16x16x32_bf16 a[72:75], a[192:195], v[32:35], a[72:75]
 v_exp_f32 v159, v159
 v_mfma_f32_16x16x32_bf16 a[72:75], a[196:199], v[36:39], a[72:75]
 v_cndmask_b32 v166, v250, v176, s[100:101]
 v_cndmask_b32 v167, v250, v176, vcc
 v_mfma_f32_16x16x32_bf16 a[40:43], a[192:195], v[24:27], a[40:43]
 v_exp_f32 v144, v144
 v_mfma_f32_16x16x32_bf16 a[40:43], a[196:199], v[28:31], a[40:43]
 v_exp_f32 v145, v145
 v_mfma_f32_16x16x32_bf16 a[8:11], a[192:195], v[16:19], a[8:11]
 v_exp_f32 v146, v146
 v_mfma_f32_16x16x32_bf16 a[8:11], a[196:199], v[20:23], a[8:11]
 v_cvt_pk_bf16_f32 v64, v148, v149
 v_cvt_pk_bf16_f32 v65, v150, v151
 v_mfma_f32_16x16x32_bf16 v[148:151], a[160:163], v[84:87], v[164:167]
 ds_read_b128 a[160:163], v4 offset:28672
 v_cvt_pk_bf16_f32 v56, v152, v153
 v_mfma_f32_16x16x32_bf16 v[148:151], a[164:167], v[116:119], v[148:151]
 buffer_load_dwordx4 v1, s[36:39], s90 offen offset:2048 sc1 lds
 v_mfma_f32_16x16x32_bf16 v[148:151], a[168:171], v[100:103], v[148:151]
 ds_read_b128 a[164:167], v4 offset:29696
 v_cvt_pk_bf16_f32 v57, v154, v155
 v_mfma_f32_16x16x32_bf16 v[148:151], a[172:175], v[132:135], v[148:151]
 v_exp_f32 v147, v147
 v_mfma_f32_16x16x32_bf16 a[108:111], a[200:203], v[40:43], a[108:111]
 ds_read_b128 a[168:171], v4 offset:30720
 v_cvt_pk_bf16_f32 v74, v156, v157
 v_mfma_f32_16x16x32_bf16 a[108:111], a[204:207], v[44:47], a[108:111]
 ds_read_b128 a[172:175], v4 offset:31744
 v_cvt_pk_bf16_f32 v75, v158, v159
 v_mfma_f32_16x16x32_bf16 a[76:79], a[200:203], v[32:35], a[76:79]
 v_exp_f32 v148, v148
 v_mfma_f32_16x16x32_bf16 a[76:79], a[204:207], v[36:39], a[76:79]
 ds_read_b128 a[192:195], v6 offset:12288
 v_cmp_le_i32 vcc, 32, v249
 v_mfma_f32_16x16x32_bf16 a[44:47], a[200:203], v[24:27], a[44:47]
 v_exp_f32 v149, v149
 v_mfma_f32_16x16x32_bf16 a[44:47], a[204:207], v[28:31], a[44:47]
 ds_read_b128 a[196:199], v6 offset:13312
 v_cmp_le_i32 s[98:99], 33, v249
 v_mfma_f32_16x16x32_bf16 v[152:155], a[144:147], v[92:95], v[184:187]
 v_exp_f32 v150, v150
 v_mfma_f32_16x16x32_bf16 v[152:155], a[148:151], v[124:127], v[152:155]
 v_exp_f32 v151, v151
 v_mfma_f32_16x16x32_bf16 v[152:155], a[152:155], v[108:111], v[152:155]
 v_cmp_le_i32 s[100:101], 34, v249
 v_cndmask_b32 v168, v250, v176, vcc
 v_mfma_f32_16x16x32_bf16 v[152:155], a[156:159], v[140:143], v[152:155]
 v_cmp_le_i32 vcc, 35, v249
 v_cndmask_b32 v169, v250, v176, s[98:99]
 v_mfma_f32_16x16x32_bf16 a[12:15], a[200:203], v[16:19], a[12:15]
 v_cndmask_b32 v170, v250, v176, s[100:101]
 v_cndmask_b32 v171, v250, v176, vcc
 v_mfma_f32_16x16x32_bf16 a[12:15], a[204:207], v[20:23], a[12:15]
 s_waitcnt lgkmcnt(3)
 ds_read_b128 a[200:203], v6 offset:14336
 v_cvt_pk_bf16_f32 v66, v144, v145
 v_mfma_f32_16x16x32_bf16 a[112:115], a[176:179], v[40:43], a[112:115]
 v_exp_f32 v152, v152
 v_mfma_f32_16x16x32_bf16 a[112:115], a[180:183], v[44:47], a[112:115]
 ds_read_b128 a[204:207], v6 offset:15360
 v_cvt_pk_bf16_f32 v67, v146, v147
 v_mfma_f32_16x16x32_bf16 a[80:83], a[176:179], v[32:35], a[80:83]
 v_exp_f32 v153, v153
 v_mfma_f32_16x16x32_bf16 a[80:83], a[180:183], v[36:39], a[80:83]
 v_exp_f32 v154, v154
 v_mfma_f32_16x16x32_bf16 v[156:159], a[144:147], v[88:91], v[180:183]
 v_exp_f32 v155, v155
 v_mfma_f32_16x16x32_bf16 v[156:159], a[148:151], v[120:123], v[156:159]
 buffer_load_dwordx4 v1, s[36:39], s90 offen offset:3072 sc1 lds
 v_mfma_f32_16x16x32_bf16 v[156:159], a[152:155], v[104:107], v[156:159]
 s_add_u32 m0, s93, 16384
 v_cvt_pk_bf16_f32 v58, v148, v149
 v_cvt_pk_bf16_f32 v59, v150, v151
 v_mfma_f32_16x16x32_bf16 v[156:159], a[156:159], v[136:139], v[156:159]
 s_add_u32 s90, s90, 17408
 v_cvt_pk_bf16_f32 v76, v152, v153
 v_cvt_pk_bf16_f32 v77, v154, v155
 v_mfma_f32_16x16x32_bf16 a[48:51], a[176:179], v[24:27], a[48:51]
 v_cmp_le_i32 vcc, 48, v249
 v_cmp_le_i32 s[98:99], 49, v249
 v_mfma_f32_16x16x32_bf16 a[48:51], a[180:183], v[28:31], a[48:51]
 v_cmp_le_i32 s[100:101], 50, v249
 v_cndmask_b32 v172, v250, v176, vcc
 v_mfma_f32_16x16x32_bf16 a[16:19], a[176:179], v[16:19], a[16:19]
 v_exp_f32 v156, v156
 v_mfma_f32_16x16x32_bf16 a[16:19], a[180:183], v[20:23], a[16:19]
 v_exp_f32 v157, v157
 v_mfma_f32_16x16x32_bf16 a[116:119], a[184:187], v[40:43], a[116:119]
 v_exp_f32 v158, v158
 v_mfma_f32_16x16x32_bf16 a[116:119], a[188:191], v[44:47], a[116:119]
 v_exp_f32 v159, v159
 v_mfma_f32_16x16x32_bf16 v[144:147], a[144:147], v[84:87], v[168:171]
 v_cmp_le_i32 vcc, 51, v249
 v_cndmask_b32 v173, v250, v176, s[98:99]
 v_mfma_f32_16x16x32_bf16 v[144:147], a[148:151], v[116:119], v[144:147]
 v_cndmask_b32 v174, v250, v176, s[100:101]
 v_cndmask_b32 v175, v250, v176, vcc
 v_mfma_f32_16x16x32_bf16 v[144:147], a[152:155], v[100:103], v[144:147]
 v_cvt_pk_bf16_f32 v68, v156, v157
 v_cvt_pk_bf16_f32 v69, v158, v159
 v_mfma_f32_16x16x32_bf16 v[144:147], a[156:159], v[132:135], v[144:147]
 v_cmp_le_i32 vcc, 0, v254
 v_cmp_le_i32 s[98:99], 1, v254
 v_mfma_f32_16x16x32_bf16 a[84:87], a[184:187], v[32:35], a[84:87]
 v_cmp_le_i32 s[100:101], 2, v254
 v_cndmask_b32 v160, v250, v180, vcc
 v_mfma_f32_16x16x32_bf16 a[84:87], a[188:191], v[36:39], a[84:87]
 v_cmp_le_i32 vcc, 3, v254
 v_cndmask_b32 v161, v250, v180, s[98:99]
 v_mfma_f32_16x16x32_bf16 a[52:55], a[184:187], v[24:27], a[52:55]
 v_exp_f32 v144, v144
 v_mfma_f32_16x16x32_bf16 a[52:55], a[188:191], v[28:31], a[52:55]
 v_exp_f32 v145, v145
 v_mfma_f32_16x16x32_bf16 a[20:23], a[184:187], v[16:19], a[20:23]
 v_exp_f32 v146, v146
 v_mfma_f32_16x16x32_bf16 a[20:23], a[188:191], v[20:23], a[20:23]
 v_exp_f32 v147, v147
 v_mfma_f32_16x16x32_bf16 v[148:151], a[160:163], v[92:95], v[184:187]
 v_cvt_pk_bf16_f32 v60, v144, v145
 v_cvt_pk_bf16_f32 v61, v146, v147
 v_mfma_f32_16x16x32_bf16 v[148:151], a[164:167], v[124:127], v[148:151]
 v_cndmask_b32 v162, v250, v180, s[100:101]
 v_cndmask_b32 v163, v250, v180, vcc
 v_mfma_f32_16x16x32_bf16 v[148:151], a[168:171], v[108:111], v[148:151]
 s_waitcnt vmcnt(13) lgkmcnt(0)
 v_cmp_le_i32 vcc, 16, v254
 v_cmp_le_i32 s[98:99], 17, v254
 v_mfma_f32_16x16x32_bf16 v[148:151], a[172:175], v[140:143], v[148:151]
 s_barrier
 v_cmp_le_i32 s[100:101], 18, v254
 v_mfma_f32_16x16x32_bf16 a[120:123], a[192:195], v[40:43], a[120:123]
 ds_read_b128 a[144:147], v5 offset:0
 v_cndmask_b32 v164, v250, v180, vcc
 v_mfma_f32_16x16x32_bf16 a[120:123], a[196:199], v[44:47], a[120:123]
 buffer_load_dwordx4 v1, s[56:59], s91 offen offset:0 sc1 lds
 v_mfma_f32_16x16x32_bf16 a[88:91], a[192:195], v[32:35], a[88:91]
 ds_read_b128 a[148:151], v5 offset:1024
 v_cmp_le_i32 vcc, 19, v254
 v_mfma_f32_16x16x32_bf16 a[88:91], a[196:199], v[36:39], a[88:91]
 v_exp_f32 v148, v148
 v_mfma_f32_16x16x32_bf16 a[56:59], a[192:195], v[24:27], a[56:59]
 ds_read_b128 a[152:155], v5 offset:2048
 v_cndmask_b32 v165, v250, v180, s[98:99]
 v_mfma_f32_16x16x32_bf16 a[56:59], a[196:199], v[28:31], a[56:59]
 v_exp_f32 v149, v149
 v_mfma_f32_16x16x32_bf16 v[152:155], a[160:163], v[88:91], v[180:183]
 ds_read_b128 a[156:159], v5 offset:3072
 v_cndmask_b32 v166, v250, v180, s[100:101]
 v_mfma_f32_16x16x32_bf16 v[152:155], a[164:167], v[120:123], v[152:155]
 v_exp_f32 v150, v150
 v_mfma_f32_16x16x32_bf16 v[152:155], a[168:171], v[104:107], v[152:155]
 ds_read_b128 a[176:179], v6 offset:16384
 v_cndmask_b32 v167, v250, v180, vcc
 v_mfma_f32_16x16x32_bf16 v[152:155], a[172:175], v[136:139], v[152:155]
 buffer_load_dwordx4 v1, s[56:59], s91 offen offset:1024 sc1 lds
 v_mfma_f32_16x16x32_bf16 a[24:27], a[192:195], v[16:19], a[24:27]
 ds_read_b128 a[180:183], v6 offset:17408
 v_cmp_le_i32 vcc, 32, v254
 v_mfma_f32_16x16x32_bf16 a[24:27], a[196:199], v[20:23], a[24:27]
 v_exp_f32 v151, v151
 v_mfma_f32_16x16x32_bf16 a[124:127], a[200:203], v[40:43], a[124:127]
 v_exp_f32 v152, v152
 v_mfma_f32_16x16x32_bf16 a[124:127], a[204:207], v[44:47], a[124:127]
 v_exp_f32 v153, v153
 v_mfma_f32_16x16x32_bf16 a[92:95], a[200:203], v[32:35], a[92:95]
 v_exp_f32 v154, v154
 v_mfma_f32_16x16x32_bf16 a[92:95], a[204:207], v[36:39], a[92:95]
 v_exp_f32 v155, v155
 v_mfma_f32_16x16x32_bf16 v[156:159], a[160:163], v[84:87], v[172:175]
 ds_read_b128 a[160:163], v5 offset:4096
 v_cmp_le_i32 s[98:99], 33, v254
 v_mfma_f32_16x16x32_bf16 v[156:159], a[164:167], v[116:119], v[156:159]
 buffer_load_dwordx4 v1, s[56:59], s91 offen offset:2048 sc1 lds
 v_mfma_f32_16x16x32_bf16 v[156:159], a[168:171], v[100:103], v[156:159]
 ds_read_b128 a[164:167], v5 offset:5120
 v_cmp_le_i32 s[100:101], 34, v254
 v_mfma_f32_16x16x32_bf16 v[156:159], a[172:175], v[132:135], v[156:159]
L_w0_0:
L_st0_0:
 s_cbranch_execz L_st0_4
 v_cndmask_b32 v168, v250, v180, vcc
 v_cmp_le_i32 vcc, 35, v254
 v_mfma_f32_16x16x32_bf16 a[60:63], a[200:203], v[24:27], a[60:63]
 v_cndmask_b32 v169, v250, v180, s[98:99]
 v_cndmask_b32 v170, v250, v180, s[100:101]
 v_mfma_f32_16x16x32_bf16 a[60:63], a[204:207], v[28:31], a[60:63]
 v_cndmask_b32 v171, v250, v180, vcc
 v_cmp_le_i32 vcc, 48, v254
 v_mfma_f32_16x16x32_bf16 a[28:31], a[200:203], v[16:19], a[28:31]
 v_exp_f32 v156, v156
 v_mfma_f32_16x16x32_bf16 a[28:31], a[204:207], v[20:23], a[28:31]
 v_exp_f32 v157, v157
 v_mfma_f32_16x16x32_bf16 a[140:143], v[212:215], v[40:43], a[140:143]
 v_exp_f32 v158, v158
 v_mfma_f32_16x16x32_bf16 a[140:143], v[212:215], v[44:47], a[140:143]
 s_waitcnt lgkmcnt(4)
 v_exp_f32 v159, v159
 v_mfma_f32_16x16x32_bf16 v[144:147], a[144:147], v[92:95], v[188:191]
 buffer_load_dwordx4 v1, s[56:59], s91 offen offset:3072 sc1 lds
 v_mfma_f32_16x16x32_bf16 v[144:147], a[148:151], v[124:127], v[144:147]
 s_add_u32 s91, s91, 17408
 v_cmp_le_i32 s[98:99], 49, v254
 v_cmp_le_i32 s[100:101], 50, v254
 v_mfma_f32_16x16x32_bf16 v[144:147], a[152:155], v[108:111], v[144:147]
 v_cndmask_b32 v172, v250, v180, vcc
 v_cmp_le_i32 vcc, 51, v254
 v_mfma_f32_16x16x32_bf16 v[144:147], a[156:159], v[140:143], v[144:147]
 v_cndmask_b32 v173, v250, v180, s[98:99]
 v_cndmask_b32 v174, v250, v180, s[100:101]
 v_mfma_f32_16x16x32_bf16 a[136:139], v[212:215], v[32:35], a[136:139]
 v_cndmask_b32 v175, v250, v180, vcc
 v_cvt_pk_bf16_f32 v78, v148, v149
 v_mfma_f32_16x16x32_bf16 a[136:139], v[212:215], v[36:39], a[136:139]
 v_cvt_pk_bf16_f32 v79, v150, v151
 v_cvt_pk_bf16_f32 v70, v152, v153
 v_mfma_f32_16x16x32_bf16 a[132:135], v[212:215], v[24:27], a[132:135]
 v_cvt_pk_bf16_f32 v71, v154, v155
 v_cvt_pk_bf16_f32 v62, v156, v157
 v_mfma_f32_16x16x32_bf16 a[132:135], v[212:215], v[28:31], a[132:135]
 v_cvt_pk_bf16_f32 v63, v158, v159
 v_xor_b32 v7, 0x8000, v7
 v_mfma_f32_16x16x32_bf16 a[128:131], v[212:215], v[16:19], a[128:131]
 v_xor_b32 v4, 0x8000, v4
 v_mfma_f32_16x16x32_bf16 a[128:131], v[212:215], v[20:23], a[128:131]
 v_mfma_f32_16x16x32_bf16 v[148:151], a[144:147], v[88:91], v[160:163]
 s_add_u32 m0, s92, 81920
 ds_read_b128 a[168:171], v4 offset:6144
 v_xor_b32 v6, 0x8000, v6
 v_mfma_f32_16x16x32_bf16 v[148:151], a[148:151], v[120:123], v[148:151]
 s_sub_u32 s94, 7, s62
 v_exp_f32 v144, v144
 v_mfma_f32_16x16x32_bf16 v[148:151], a[152:155], v[104:107], v[148:151]
 s_getpc_b64 s[16:17]
L_pc1:
 ds_read_b128 a[172:175], v4 offset:7168
 v_cmp_le_i32 vcc, 0, v255
 v_mfma_f32_16x16x32_bf16 v[148:151], a[156:159], v[136:139], v[148:151]
 s_lshr_b32 s10, s2, 6
 v_exp_f32 v145, v145
 v_mfma_f32_16x16x32_bf16 a[140:143], v[212:215], v[72:75], a[140:143]
 s_bfe_u32 s11, s2, 0x20003
 ds_read_b128 a[184:187], v7 offset:18432
 v_cvt_pk_bf16_f32 v40, v144, v145
 v_mfma_f32_16x16x32_bf16 a[140:143], v[212:215], v[76:79], a[140:143]
 s_mul_i32 s11, s11, 0
 v_exp_f32 v146, v146
 v_mfma_f32_16x16x32_bf16 a[136:139], v[212:215], v[64:67], a[136:139]
 s_xor_b32 s93, s93, 0x8000
 ds_read_b128 a[188:191], v7 offset:19456
 v_cmp_le_i32 s[98:99], 1, v255
 v_mfma_f32_16x16x32_bf16 a[136:139], v[212:215], v[68:71], a[136:139]
 s_lshr_b32 s13, s2, 3
 v_exp_f32 v147, v147
 v_mfma_f32_16x16x32_bf16 a[132:135], v[212:215], v[56:59], a[132:135]
 s_lshl_b32 s13, s13, 2
 ds_read_b128 a[192:195], v7 offset:20480
 v_cvt_pk_bf16_f32 v41, v146, v147
 v_mfma_f32_16x16x32_bf16 a[132:135], v[212:215], v[60:63], a[132:135]
 s_waitcnt lgkmcnt(2)
 buffer_load_dwordx4 v1, s[36:39], s90 offen offset:0 sc1 lds
 v_mfma_f32_16x16x32_bf16 v[152:155], a[160:163], v[92:95], v[184:187]
 s_add_u32 s13, s13, s60
 ds_read_b128 a[196:199], v7 offset:21504
 v_cmp_le_i32 s[100:101], 2, v255
 v_mfma_f32_16x16x32_bf16 v[152:155], a[164:167], v[124:127], v[152:155]
 s_mul_i32 s13, s13, 4736
 v_exp_f32 v148, v148
 v_mfma_f32_16x16x32_bf16 v[152:155], a[168:171], v[108:111], v[152:155]
 s_and_b32 s12, s2, 3
 ds_read_b128 a[144:147], v4 offset:8192
 v_cndmask_b32 v188, v250, v184, vcc
 v_mfma_f32_16x16x32_bf16 v[152:155], a[172:175], v[140:143], v[152:155]
 s_lshl_b32 s12, s12, 20
 v_exp_f32 v149, v149
 v_mfma_f32_16x16x32_bf16 a[96:99], a[176:179], v[72:75], a[96:99]
 s_add_u32 s13, s13, s12
 ds_read_b128 a[148:151], v4 offset:9216
 v_cvt_pk_bf16_f32 v32, v148, v149
 v_mfma_f32_16x16x32_bf16 a[96:99], a[180:183], v[76:79], a[96:99]
 v_exp_f32 v150, v150
 v_mfma_f32_16x16x32_bf16 a[64:67], a[176:179], v[64:67], a[64:67]
 ds_read_b128 a[152:155], v4 offset:10240
 v_cmp_le_i32 vcc, 3, v255
 v_mfma_f32_16x16x32_bf16 a[64:67], a[180:183], v[68:71], a[64:67]
 v_exp_f32 v151, v151
 v_mfma_f32_16x16x32_bf16 a[32:35], a[176:179], v[56:59], a[32:35]
 ds_read_b128 a[156:159], v4 offset:11264
 v_cvt_pk_bf16_f32 v33, v150, v151
 v_mfma_f32_16x16x32_bf16 a[32:35], a[180:183], v[60:63], a[32:35]
 buffer_load_dwordx4 v1, s[36:39], s90 offen offset:1024 sc1 lds
 v_mfma_f32_16x16x32_bf16 v[156:159], a[160:163], v[88:91], v[164:167]
 ds_read_b128 a[200:203], v7 offset:22528
 v_cndmask_b32 v189, v250, v184, s[98:99]
 v_mfma_f32_16x16x32_bf16 v[156:159], a[164:167], v[120:123], v[156:159]
 v_exp_f32 v152, v152
 v_mfma_f32_16x16x32_bf16 v[156:159], a[168:171], v[104:107], v[156:159]
 ds_read_b128 a[204:207], v7 offset:23552
 v_cndmask_b32 v190, v250, v184, s[100:101]
 v_mfma_f32_16x16x32_bf16 v[156:159], a[172:175], v[136:139], v[156:159]
 v_exp_f32 v153, v153
 v_mfma_f32_16x16x32_bf16 a[100:103], a[184:187], v[72:75], a[100:103]
 s_waitcnt lgkmcnt(2)
 ds_read_b128 a[176:179], v7 offset:24576
 v_cvt_pk_bf16_f32 v42, v152, v153
 v_mfma_f32_16x16x32_bf16 a[100:103], a[188:191], v[76:79], a[100:103]
 v_exp_f32 v154, v154
 v_mfma_f32_16x16x32_bf16 a[68:71], a[184:187], v[64:67], a[68:71]
 ds_read_b128 a[180:183], v7 offset:25600
 v_cndmask_b32 v191, v250, v184, vcc
 v_mfma_f32_16x16x32_bf16 a[68:71], a[188:191], v[68:71], a[68:71]
 v_exp_f32 v155, v155
 v_mfma_f32_16x16x32_bf16 a[36:39], a[184:187], v[56:59], a[36:39]
 ds_read_b128 a[160:163], v4 offset:12288
 v_cvt_pk_bf16_f32 v43, v154, v155
 v_mfma_f32_16x16x32_bf16 a[36:39], a[188:191], v[60:63], a[36:39]
 buffer_load_dwordx4 v1, s[36:39], s90 offen offset:2048 sc1 lds
 v_mfma_f32_16x16x32_bf16 a[104:107], a[192:195], v[72:75], a[104:107]
 ds_read_b128 a[164:167], v4 offset:13312
 v_lshrrev_b32 v2, 9, v1
 v_mfma_f32_16x16x32_bf16 a[104:107], a[196:199], v[76:79], a[104:107]
 v_exp_f32 v156, v156
 v_mfma_f32_16x16x32_bf16 v[144:147], a[144:147], v[92:95], v[184:187]
 ds_read_b128 a[168:171], v4 offset:14336
 v_xor_b32 v5, 0x8000, v5
 v_mfma_f32_16x16x32_bf16 v[144:147], a[148:151], v[124:127], v[144:147]
 v_exp_f32 v157, v157
 v_mfma_f32_16x16x32_bf16 v[144:147], a[152:155], v[108:111], v[144:147]
 ds_read_b128 a[172:175], v4 offset:15360
 v_cvt_pk_bf16_f32 v34, v156, v157
 v_mfma_f32_16x16x32_bf16 v[144:147], a[156:159], v[140:143], v[144:147]
 v_exp_f32 v158, v158
 v_mfma_f32_16x16x32_bf16 a[72:75], a[192:195], v[64:67], a[72:75]
 ds_read_b128 a[184:187], v7 offset:26624
 v_lshlrev_b32 v2, 14, v2
 v_mfma_f32_16x16x32_bf16 a[72:75], a[196:199], v[68:71], a[72:75]
 v_exp_f32 v159, v159
 v_mfma_f32_16x16x32_bf16 a[40:43], a[192:195], v[56:59], a[40:43]
 ds_read_b128 a[188:191], v7 offset:27648
 v_cvt_pk_bf16_f32 v35, v158, v159
 v_mfma_f32_16x16x32_bf16 a[40:43], a[196:199], v[60:63], a[40:43]
 s_waitcnt lgkmcnt(3)
 v_exp_f32 v144, v144
 v_mfma_f32_16x16x32_bf16 a[108:111], a[200:203], v[72:75], a[108:111]
 ds_read_b128 a[192:195], v7 offset:28672
 v_min_u32 v199, 576, v1
 v_mfma_f32_16x16x32_bf16 a[108:111], a[204:207], v[76:79], a[108:111]
 v_exp_f32 v145, v145
 v_mfma_f32_16x16x32_bf16 v[148:151], a[144:147], v[88:91], v[168:171]
 ds_read_b128 a[196:199], v7 offset:29696
 v_cvt_pk_bf16_f32 v44, v144, v145
 v_mfma_f32_16x16x32_bf16 v[148:151], a[148:151], v[120:123], v[148:151]
 v_exp_f32 v146, v146
 v_mfma_f32_16x16x32_bf16 v[148:151], a[152:155], v[104:107], v[148:151]
 v_exp_f32 v147, v147
 v_mfma_f32_16x16x32_bf16 v[148:151], a[156:159], v[136:139], v[148:151]
 buffer_load_dwordx4 v1, s[36:39], s90 offen offset:3072 sc1 lds
 v_mfma_f32_16x16x32_bf16 a[76:79], a[200:203], v[64:67], a[76:79]
 s_add_u32 m0, s92, 0
 s_add_u32 s90, s90, 17408
 v_cvt_pk_bf16_f32 v45, v146, v147
 v_mfma_f32_16x16x32_bf16 a[76:79], a[204:207], v[68:71], a[76:79]
 s_xor_b32 s92, s92, 0x8000
 v_lshlrev_b32 v199, 3, v199
 v_lshl_add_u32 v2, s60, 7, v2
 v_mfma_f32_16x16x32_bf16 a[44:47], a[200:203], v[56:59], a[44:47]
 v_exp_f32 v148, v148
 v_mfma_f32_16x16x32_bf16 a[44:47], a[204:207], v[60:63], a[44:47]
 v_exp_f32 v149, v149
 v_mfma_f32_16x16x32_bf16 a[112:115], a[176:179], v[72:75], a[112:115]
 v_exp_f32 v150, v150
 v_mfma_f32_16x16x32_bf16 a[112:115], a[180:183], v[76:79], a[112:115]
 v_exp_f32 v151, v151
 v_mfma_f32_16x16x32_bf16 v[152:155], a[160:163], v[92:95], v[184:187]
 v_cvt_pk_bf16_f32 v36, v148, v149
 v_cvt_pk_bf16_f32 v37, v150, v151
 v_mfma_f32_16x16x32_bf16 v[152:155], a[164:167], v[124:127], v[152:155]
 v_lshrrev_b32 v3, 3, s2
 v_lshl_add_u32 v2, v3, 9, v2
 v_mfma_f32_16x16x32_bf16 v[152:155], a[168:171], v[108:111], v[152:155]
 s_waitcnt vmcnt(12) lgkmcnt(0)
 v_add_u32 v2, L_one-L_pc1, v2
 v_min_u32 v2, L_code_end-L_pc1-4, v2
 v_mfma_f32_16x16x32_bf16 v[152:155], a[172:175], v[140:143], v[152:155]
 s_barrier
 v_mfma_f32_16x16x32_bf16 a[80:83], a[176:179], v[64:67], a[80:83]
 ds_read_b128 a[144:147], v4 offset:16384
 v_mfma_f32_16x16x32_bf16 a[80:83], a[180:183], v[68:71], a[80:83]
 buffer_load_dwordx4 v1, s[56:59], s91 offen offset:0 sc1 lds
 v_mfma_f32_16x16x32_bf16 a[48:51], a[176:179], v[56:59], a[48:51]
 ds_read_b128 a[148:151], v4 offset:17408
 v_mfma_f32_16x16x32_bf16 a[48:51], a[180:183], v[60:63], a[48:51]
 v_exp_f32 v152, v152
 v_mfma_f32_16x16x32_bf16 a[116:119], a[184:187], v[72:75], a[116:119]
 ds_read_b128 a[152:155], v4 offset:18432
 v_mfma_f32_16x16x32_bf16 a[116:119], a[188:191], v[76:79], a[116:119]
 v_exp_f32 v153, v153
 v_mfma_f32_16x16x32_bf16 a[84:87], a[184:187], v[64:67], a[84:87]
 ds_read_b128 a[156:159], v4 offset:19456
 v_cvt_pk_bf16_f32 v46, v152, v153
 v_mfma_f32_16x16x32_bf16 a[84:87], a[188:191], v[68:71], a[84:87]
 buffer_load_dwordx4 v1, s[56:59], s91 offen offset:1024 sc1 lds
 v_mfma_f32_16x16x32_bf16 v[156:159], a[160:163], v[88:91], v[172:175]
 ds_read_b128 a[200:203], v7 offset:30720
 v_mfma_f32_16x16x32_bf16 v[156:159], a[164:167], v[120:123], v[156:159]
 v_exp_f32 v154, v154
 v_mfma_f32_16x16x32_bf16 v[156:159], a[168:171], v[104:107], v[156:159]
 ds_read_b128 a[204:207], v7 offset:31744
 v_mfma_f32_16x16x32_bf16 v[156:159], a[172:175], v[136:139], v[156:159]
 v_exp_f32 v155, v155
 v_mfma_f32_16x16x32_bf16 a[52:55], a[184:187], v[56:59], a[52:55]
 v_cvt_pk_bf16_f32 v47, v154, v155
 v_mfma_f32_16x16x32_bf16 a[52:55], a[188:191], v[60:63], a[52:55]
 v_mfma_f32_16x16x32_bf16 a[120:123], a[192:195], v[72:75], a[120:123]
 buffer_load_dwordx4 v1, s[56:59], s91 offen offset:2048 sc1 lds
 v_mfma_f32_16x16x32_bf16 a[120:123], a[196:199], v[76:79], a[120:123]
 v_exp_f32 v156, v156
 v_mfma_f32_16x16x32_bf16 a[88:91], a[192:195], v[64:67], a[88:91]
 v_exp_f32 v157, v157
 v_mfma_f32_16x16x32_bf16 a[88:91], a[196:199], v[68:71], a[88:91]
 s_waitcnt lgkmcnt(0)
 v_exp_f32 v158, v158
 v_mfma_f32_16x16x32_bf16 v[144:147], a[144:147], v[92:95], v[188:191]
 v_exp_f32 v159, v159
 v_mfma_f32_16x16x32_bf16 v[144:147], a[148:151], v[124:127], v[144:147]
 v_cvt_pk_bf16_f32 v38, v156, v157
 v_cvt_pk_bf16_f32 v39, v158, v159
 v_mfma_f32_16x16x32_bf16 v[144:147], a[152:155], v[108:111], v[144:147]
 v_mfma_f32_16x16x32_bf16 v[144:147], a[156:159], v[140:143], v[144:147]
 buffer_load_dwordx4 v1, s[56:59], s91 offen offset:3072 sc1 lds
 v_mfma_f32_16x16x32_bf16 a[56:59], a[192:195], v[56:59], a[56:59]
 s_add_u32 s91, s91, 17408
 ds_read_b128 a[176:179], v6 offset:0
 v_mfma_f32_16x16x32_bf16 a[56:59], a[196:199], v[60:63], a[56:59]
 buffer_load_dwordx4 v[200:203], v1, s[40:43], s72 offen sc1
 v_mfma_f32_16x16x32_bf16 a[124:127], a[200:203], v[72:75], a[124:127]
 v_mfma_f32_16x16x32_bf16 a[124:127], a[204:207], v[76:79], a[124:127]
 ds_read_b128 a[180:183], v6 offset:1024
 v_mfma_f32_16x16x32_bf16 a[92:95], a[200:203], v[64:67], a[92:95]
 v_mfma_f32_16x16x32_bf16 a[92:95], a[204:207], v[68:71], a[92:95]
 v_mfma_f32_16x16x32_bf16 a[60:63], a[200:203], v[56:59], a[60:63]
 ds_read_b128 a[160:163], v4 offset:20480
 v_mfma_f32_16x16x32_bf16 a[60:63], a[204:207], v[60:63], a[60:63]
 ds_read_b128 a[164:167], v4 offset:21504
 v_accvgpr_read_b32 v216, a128
 v_accvgpr_read_b32 v218, a132
 v_add_f32 v219, v216, v218
 v_rcp_f32 v216, v216
 v_cmp_ngt_f32 vcc, 0x5f800000, v219
 v_rcp_f32 v218, v218
 s_or_b64 s[88:89], s[88:89], vcc
 s_mul_i32 s86, s61, 17408
 s_add_u32 s85, s86, s77
 v_accvgpr_read_b32 v220, a0
 v_accvgpr_read_b32 v221, a1
 v_accvgpr_read_b32 v222, a2
 v_accvgpr_read_b32 v223, a3
 v_accvgpr_read_b32 v224, a4
 v_accvgpr_read_b32 v225, a5
 v_accvgpr_read_b32 v226, a6
 v_accvgpr_read_b32 v227, a7
 v_pk_mul_f32 v[220:221], v[220:221], v[216:217] op_sel_hi:[1,0]
 v_pk_mul_f32 v[222:223], v[222:223], v[216:217] op_sel_hi:[1,0]
 v_pk_mul_f32 v[224:225], v[224:225], v[216:217] op_sel_hi:[1,0]
 v_pk_mul_f32 v[226:227], v[226:227], v[216:217] op_sel_hi:[1,0]
 v_cvt_pk_bf16_f32 v228, v220, v221
 v_cvt_pk_bf16_f32 v229, v222, v223
 v_cvt_pk_bf16_f32 v230, v224, v225
 v_cvt_pk_bf16_f32 v231, v226, v227
 buffer_store_dwordx4 v[228:231], v1, s[40:43], s85 offen sc1
 s_add_u32 s85, s85, 4096
 v_accvgpr_read_b32 v220, a8
 v_accvgpr_read_b32 v221, a9
 v_accvgpr_read_b32 v222, a10
 v_accvgpr_read_b32 v223, a11
 v_accvgpr_read_b32 v224, a12
 v_accvgpr_read_b32 v225, a13
 v_accvgpr_read_b32 v226, a14
 v_accvgpr_read_b32 v227, a15
 v_pk_mul_f32 v[220:221], v[220:221], v[216:217] op_sel_hi:[1,0]
 v_pk_mul_f32 v[222:223], v[222:223], v[216:217] op_sel_hi:[1,0]
 v_pk_mul_f32 v[224:225], v[224:225], v[216:217] op_sel_hi:[1,0]
 v_pk_mul_f32 v[226:227], v[226:227], v[216:217] op_sel_hi:[1,0]
 v_cvt_pk_bf16_f32 v232, v220, v221
 v_cvt_pk_bf16_f32 v233, v222, v223
 v_cvt_pk_bf16_f32 v234, v224, v225
 v_cvt_pk_bf16_f32 v235, v226, v227
 buffer_store_dwordx4 v[232:235], v1, s[40:43], s85 offen sc1
 s_add_u32 s85, s85, 4096
 v_accvgpr_read_b32 v220, a16
 v_accvgpr_read_b32 v221, a17
 v_accvgpr_read_b32 v222, a18
 v_accvgpr_read_b32 v223, a19
 v_accvgpr_read_b32 v224, a20
 v_accvgpr_read_b32 v225, a21
 v_accvgpr_read_b32 v226, a22
 v_accvgpr_read_b32 v227, a23
 v_pk_mul_f32 v[220:221], v[220:221], v[216:217] op_sel_hi:[1,0]
 v_pk_mul_f32 v[222:223], v[222:223], v[216:217] op_sel_hi:[1,0]
 v_pk_mul_f32 v[224:225], v[224:225], v[216:217] op_sel_hi:[1,0]
 v_pk_mul_f32 v[226:227], v[226:227], v[216:217] op_sel_hi:[1,0]
 v_cvt_pk_bf16_f32 v236, v220, v221
 v_cvt_pk_bf16_f32 v237, v222, v223
 v_cvt_pk_bf16_f32 v238, v224, v225
 v_cvt_pk_bf16_f32 v239, v226, v227
 buffer_store_dwordx4 v[236:239], v1, s[40:43], s85 offen sc1
 s_add_u32 s85, s85, 4096
 v_accvgpr_read_b32 v220, a24
 v_accvgpr_read_b32 v221, a25
 v_accvgpr_read_b32 v222, a26
 v_accvgpr_read_b32 v223, a27
 v_accvgpr_read_b32 v224, a28
 v_accvgpr_read_b32 v225, a29
 v_accvgpr_read_b32 v226, a30
 v_accvgpr_read_b32 v227, a31
 v_pk_mul_f32 v[220:221], v[220:221], v[216:217] op_sel_hi:[1,0]
 v_pk_mul_f32 v[222:223], v[222:223], v[216:217] op_sel_hi:[1,0]
 v_pk_mul_f32 v[224:225], v[224:225], v[216:217] op_sel_hi:[1,0]
 v_pk_mul_f32 v[226:227], v[226:227], v[216:217] op_sel_hi:[1,0]
 v_cvt_pk_bf16_f32 v228, v220, v221
 v_cvt_pk_bf16_f32 v229, v222, v223
 v_cvt_pk_bf16_f32 v230, v224, v225
 v_cvt_pk_bf16_f32 v231, v226, v227
 buffer_store_dwordx4 v[228:231], v1, s[40:43], s85 offen sc1
 s_add_u32 s85, s86, s78
 v_accvgpr_read_b32 v220, a32
 v_accvgpr_read_b32 v221, a33
 v_accvgpr_read_b32 v222, a34
 v_accvgpr_read_b32 v223, a35
 v_accvgpr_read_b32 v224, a36
 v_accvgpr_read_b32 v225, a37
 v_accvgpr_read_b32 v226, a38
 v_accvgpr_read_b32 v227, a39
 v_pk_mul_f32 v[220:221], v[220:221], v[218:219] op_sel_hi:[1,0]
 v_pk_mul_f32 v[222:223], v[222:223], v[218:219] op_sel_hi:[1,0]
 v_pk_mul_f32 v[224:225], v[224:225], v[218:219] op_sel_hi:[1,0]
 v_pk_mul_f32 v[226:227], v[226:227], v[218:219] op_sel_hi:[1,0]
 v_cvt_pk_bf16_f32 v232, v220, v221
 v_cvt_pk_bf16_f32 v233, v222, v223
 v_cvt_pk_bf16_f32 v234, v224, v225
 v_cvt_pk_bf16_f32 v235, v226, v227
 buffer_store_dwordx4 v[232:235], v1, s[40:43], s85 offen sc1
 s_add_u32 s85, s85, 4096
 v_accvgpr_read_b32 v220, a40
 v_accvgpr_read_b32 v221, a41
 v_accvgpr_read_b32 v222, a42
 v_accvgpr_read_b32 v223, a43
 v_accvgpr_read_b32 v224, a44
 v_accvgpr_read_b32 v225, a45
 v_accvgpr_read_b32 v226, a46
 v_accvgpr_read_b32 v227, a47
 v_pk_mul_f32 v[220:221], v[220:221], v[218:219] op_sel_hi:[1,0]
 v_pk_mul_f32 v[222:223], v[222:223], v[218:219] op_sel_hi:[1,0]
 v_pk_mul_f32 v[224:225], v[224:225], v[218:219] op_sel_hi:[1,0]
 v_pk_mul_f32 v[226:227], v[226:227], v[218:219] op_sel_hi:[1,0]
 v_cvt_pk_bf16_f32 v236, v220, v221
 v_cvt_pk_bf16_f32 v237, v222, v223
 v_cvt_pk_bf16_f32 v238, v224, v225
 v_cvt_pk_bf16_f32 v239, v226, v227
 buffer_store_dwordx4 v[236:239], v1, s[40:43], s85 offen sc1
 s_add_u32 s85, s85, 4096
 v_accvgpr_read_b32 v220, a48
 v_accvgpr_read_b32 v221, a49
 v_accvgpr_read_b32 v222, a50
 v_accvgpr_read_b32 v223, a51
 v_accvgpr_read_b32 v224, a52
 v_accvgpr_read_b32 v225, a53
 v_accvgpr_read_b32 v226, a54
 v_accvgpr_read_b32 v227, a55
 v_pk_mul_f32 v[220:221], v[220:221], v[218:219] op_sel_hi:[1,0]
 v_pk_mul_f32 v[222:223], v[222:223], v[218:219] op_sel_hi:[1,0]
 v_pk_mul_f32 v[224:225], v[224:225], v[218:219] op_sel_hi:[1,0]
 v_pk_mul_f32 v[226:227], v[226:227], v[218:219] op_sel_hi:[1,0]
 v_cvt_pk_bf16_f32 v228, v220, v221
 v_cvt_pk_bf16_f32 v229, v222, v223
 v_cvt_pk_bf16_f32 v230, v224, v225
 v_cvt_pk_bf16_f32 v231, v226, v227
 buffer_store_dwordx4 v[228:231], v1, s[40:43], s85 offen sc1
 s_add_u32 s85, s85, 4096
 v_accvgpr_read_b32 v220, a56
 v_accvgpr_read_b32 v221, a57
 v_accvgpr_read_b32 v222, a58
 v_accvgpr_read_b32 v223, a59
 v_accvgpr_read_b32 v224, a60
 v_accvgpr_read_b32 v225, a61
 v_accvgpr_read_b32 v226, a62
 v_accvgpr_read_b32 v227, a63
 v_pk_mul_f32 v[220:221], v[220:221], v[218:219] op_sel_hi:[1,0]
 v_pk_mul_f32 v[222:223], v[222:223], v[218:219] op_sel_hi:[1,0]
 v_pk_mul_f32 v[224:225], v[224:225], v[218:219] op_sel_hi:[1,0]
 v_pk_mul_f32 v[226:227], v[226:227], v[218:219] op_sel_hi:[1,0]
 v_cvt_pk_bf16_f32 v232, v220, v221
 v_cvt_pk_bf16_f32 v233, v222, v223
 v_cvt_pk_bf16_f32 v234, v224, v225
 v_cvt_pk_bf16_f32 v235, v226, v227
 buffer_store_dwordx4 v[232:235], v1, s[40:43], s85 offen sc1
 s_waitcnt vmcnt(8)
 v_min_u32 v251, v200, v201
 v_min3_u32 v251, v251, v202, v203
 v_cmp_eq_u32 vcc, 0, v251
 s_nop 0
 s_cbranch_vccnz L_spin_h
L_back_h:
 s_cmp_eq_u32 s94, 0
 s_cbranch_scc1 L_one
.p2alignl 5, 0x7e020301
L_sloop:
 v_mfma_f32_16x16x32_bf16 v[148:151], a[144:147], v[88:91], v[160:163]
 s_add_u32 m0, s92, 65536
 ds_read_b128 a[168:171], v4 offset:22528
 ds_read_b128 a[172:175], v4 offset:23552
 v_mfma_f32_16x16x32_bf16 v[148:151], a[148:151], v[120:123], v[148:151]
 buffer_load_dwordx4 v1, s[36:39], s90 offen offset:0 sc1 lds
 v_mfma_f32_16x16x32_bf16 v[148:151], a[152:155], v[104:107], v[148:151]
 ds_read_b128 a[184:187], v6 offset:2048
 v_mfma_f32_16x16x32_bf16 v[148:151], a[156:159], v[136:139], v[148:151]
 s_waitcnt lgkmcnt(5)
 v_exp_f32 v144, v144
 v_mfma_f32_16x16x32_bf16 a[96:99], a[176:179], v[40:43], a[96:99]
 ds_read_b128 a[188:191], v6 offset:3072
 v_mfma_f32_16x16x32_bf16 a[96:99], a[180:183], v[44:47], a[96:99]
 v_exp_f32 v145, v145
 v_mfma_f32_16x16x32_bf16 a[64:67], a[176:179], v[32:35], a[64:67]
 s_nop 0
 ds_read_b128 a[192:195], v6 offset:4096
 ds_read_b128 a[196:199], v6 offset:5120
 v_mfma_f32_16x16x32_bf16 a[64:67], a[180:183], v[36:39], a[64:67]
 s_waitcnt lgkmcnt(3)
 v_exp_f32 v146, v146
 v_mfma_f32_16x16x32_bf16 v[152:155], a[160:163], v[92:95], v[184:187]
 ds_read_b128 a[144:147], v4 offset:24576
 v_cvt_pk_bf16_f32 v72, v144, v145
 v_mfma_f32_16x16x32_bf16 v[152:155], a[164:167], v[124:127], v[152:155]
 v_exp_f32 v147, v147
 v_mfma_f32_16x16x32_bf16 v[152:155], a[168:171], v[108:111], v[152:155]
 ds_read_b128 a[148:151], v4 offset:25600
 v_cvt_pk_bf16_f32 v73, v146, v147
 v_mfma_f32_16x16x32_bf16 v[152:155], a[172:175], v[140:143], v[152:155]
 buffer_load_dwordx4 v1, s[36:39], s90 offen offset:1024 sc1 lds
 v_mfma_f32_16x16x32_bf16 a[100:103], a[184:187], v[40:43], a[100:103]
 s_waitcnt lgkmcnt(2)
 ds_read_b128 a[152:155], v4 offset:26624
 v_mfma_f32_16x16x32_bf16 a[100:103], a[188:191], v[44:47], a[100:103]
 v_exp_f32 v148, v148
 v_mfma_f32_16x16x32_bf16 a[68:71], a[184:187], v[32:35], a[68:71]
 s_nop 0
 ds_read_b128 a[156:159], v4 offset:27648
 ds_read_b128 a[200:203], v6 offset:6144
 v_mfma_f32_16x16x32_bf16 a[68:71], a[188:191], v[36:39], a[68:71]
 v_exp_f32 v149, v149
 v_mfma_f32_16x16x32_bf16 v[156:159], a[160:163], v[88:91], v[164:167]
 ds_read_b128 a[204:207], v6 offset:7168
 v_cvt_pk_bf16_f32 v64, v148, v149
 v_mfma_f32_16x16x32_bf16 v[156:159], a[164:167], v[120:123], v[156:159]
 v_exp_f32 v150, v150
 v_mfma_f32_16x16x32_bf16 v[156:159], a[168:171], v[104:107], v[156:159]
 ds_read_b128 a[176:179], v6 offset:8192
 v_mfma_f32_16x16x32_bf16 v[156:159], a[172:175], v[136:139], v[156:159]
 v_exp_f32 v151, v151
 v_mfma_f32_16x16x32_bf16 a[104:107], a[192:195], v[40:43], a[104:107]
 ds_read_b128 a[180:183], v6 offset:9216
 v_cvt_pk_bf16_f32 v65, v150, v151
 v_mfma_f32_16x16x32_bf16 a[104:107], a[196:199], v[44:47], a[104:107]
 v_exp_f32 v152, v152
 v_mfma_f32_16x16x32_bf16 a[72:75], a[192:195], v[32:35], a[72:75]
 ds_read_b128 a[184:187], v6 offset:10240
 v_mfma_f32_16x16x32_bf16 a[72:75], a[196:199], v[36:39], a[72:75]
 s_waitcnt lgkmcnt(2)
 buffer_load_dwordx4 v1, s[36:39], s90 offen offset:2048 sc1 lds
 v_mfma_f32_16x16x32_bf16 v[144:147], a[144:147], v[92:95], v[184:187]
 ds_read_b128 a[188:191], v6 offset:11264
 v_mfma_f32_16x16x32_bf16 v[144:147], a[148:151], v[124:127], v[144:147]
 v_exp_f32 v153, v153
 v_mfma_f32_16x16x32_bf16 v[144:147], a[152:155], v[108:111], v[144:147]
 s_nop 0
 ds_read_b128 a[160:163], v4 offset:28672
 ds_read_b128 a[164:167], v4 offset:29696
 v_mfma_f32_16x16x32_bf16 v[144:147], a[156:159], v[140:143], v[144:147]
 v_exp_f32 v154, v154
 v_mfma_f32_16x16x32_bf16 a[108:111], a[200:203], v[40:43], a[108:111]
 ds_read_b128 a[168:171], v4 offset:30720
 v_cvt_pk_bf16_f32 v74, v152, v153
 v_mfma_f32_16x16x32_bf16 a[108:111], a[204:207], v[44:47], a[108:111]
 v_exp_f32 v155, v155
 v_mfma_f32_16x16x32_bf16 a[76:79], a[200:203], v[32:35], a[76:79]
 ds_read_b128 a[172:175], v4 offset:31744
 v_cvt_pk_bf16_f32 v75, v154, v155
 v_mfma_f32_16x16x32_bf16 a[76:79], a[204:207], v[36:39], a[76:79]
 v_exp_f32 v156, v156
 v_mfma_f32_16x16x32_bf16 a[112:115], a[176:179], v[40:43], a[112:115]
 s_waitcnt lgkmcnt(2)
 ds_read_b128 a[192:195], v6 offset:12288
 v_mfma_f32_16x16x32_bf16 a[112:115], a[180:183], v[44:47], a[112:115]
 v_exp_f32 v157, v157
 v_mfma_f32_16x16x32_bf16 v[148:151], a[144:147], v[88:91], v[168:171]
 ds_read_b128 a[196:199], v6 offset:13312
 v_cvt_pk_bf16_f32 v66, v156, v157
 v_mfma_f32_16x16x32_bf16 v[148:151], a[148:151], v[120:123], v[148:151]
 v_exp_f32 v158, v158
 v_mfma_f32_16x16x32_bf16 v[148:151], a[152:155], v[104:107], v[148:151]
 ds_read_b128 a[200:203], v6 offset:14336
 v_mfma_f32_16x16x32_bf16 v[148:151], a[156:159], v[136:139], v[148:151]
 v_exp_f32 v159, v159
 v_mfma_f32_16x16x32_bf16 a[80:83], a[176:179], v[32:35], a[80:83]
 ds_read_b128 a[204:207], v6 offset:15360
 v_cvt_pk_bf16_f32 v67, v158, v159
 v_mfma_f32_16x16x32_bf16 a[80:83], a[180:183], v[36:39], a[80:83]
 buffer_load_dwordx4 v1, s[36:39], s90 offen offset:3072 sc1 lds
 v_mfma_f32_16x16x32_bf16 a[116:119], a[184:187], v[40:43], a[116:119]
 s_add_u32 m0, s93, 16384
 v_exp_f32 v144, v144
 v_mfma_f32_16x16x32_bf16 a[116:119], a[188:191], v[44:47], a[116:119]
 s_add_u32 s90, s90, 17408
 v_exp_f32 v145, v145
 v_mfma_f32_16x16x32_bf16 v[152:155], a[160:163], v[92:95], v[184:187]
 v_exp_f32 v146, v146
 v_mfma_f32_16x16x32_bf16 v[152:155], a[164:167], v[124:127], v[152:155]
 s_waitcnt lgkmcnt(5)
 v_exp_f32 v147, v147
 v_mfma_f32_16x16x32_bf16 v[152:155], a[168:171], v[108:111], v[152:155]
 s_waitcnt vmcnt(12) lgkmcnt(0)
 v_exp_f32 v148, v148
 v_mfma_f32_16x16x32_bf16 v[152:155], a[172:175], v[140:143], v[152:155]
 s_barrier
 v_cvt_pk_bf16_f32 v77, v146, v147
 v_mfma_f32_16x16x32_bf16 a[84:87], a[184:187], v[32:35], a[84:87]
 s_nop 0
 ds_read_b128 a[144:147], v5 offset:0
 ds_read_b128 a[148:151], v5 offset:1024
 v_mfma_f32_16x16x32_bf16 a[84:87], a[188:191], v[36:39], a[84:87]
 buffer_load_dwordx4 v1, s[56:59], s91 offen offset:0 sc1 lds
 v_mfma_f32_16x16x32_bf16 a[120:123], a[192:195], v[40:43], a[120:123]
 ds_read_b128 a[152:155], v5 offset:2048
 v_cvt_pk_bf16_f32 v76, v144, v145
 v_mfma_f32_16x16x32_bf16 a[120:123], a[196:199], v[44:47], a[120:123]
 v_exp_f32 v149, v149
 v_mfma_f32_16x16x32_bf16 v[156:159], a[160:163], v[88:91], v[172:175]
 ds_read_b128 a[156:159], v5 offset:3072
 v_cvt_pk_bf16_f32 v68, v148, v149
 v_mfma_f32_16x16x32_bf16 v[156:159], a[164:167], v[120:123], v[156:159]
 buffer_load_dwordx4 v1, s[56:59], s91 offen offset:1024 sc1 lds
 v_mfma_f32_16x16x32_bf16 v[156:159], a[168:171], v[104:107], v[156:159]
 v_exp_f32 v150, v150
 v_mfma_f32_16x16x32_bf16 v[156:159], a[172:175], v[136:139], v[156:159]
 v_exp_f32 v151, v151
 v_mfma_f32_16x16x32_bf16 a[88:91], a[192:195], v[32:35], a[88:91]
 v_exp_f32 v152, v152
 v_mfma_f32_16x16x32_bf16 a[88:91], a[196:199], v[36:39], a[88:91]
 ds_read_b128 a[176:179], v6 offset:16384
 v_cvt_pk_bf16_f32 v69, v150, v151
 v_mfma_f32_16x16x32_bf16 a[124:127], a[200:203], v[40:43], a[124:127]
 buffer_load_dwordx4 v1, s[56:59], s91 offen offset:2048 sc1 lds
 v_mfma_f32_16x16x32_bf16 a[124:127], a[204:207], v[44:47], a[124:127]
 s_waitcnt lgkmcnt(1)
 v_exp_f32 v153, v153
 v_mfma_f32_16x16x32_bf16 v[144:147], a[144:147], v[92:95], v[188:191]
L_w0_1:
L_st0_1:
 s_cbranch_execz L_st0_5
 v_exp_f32 v154, v154
 v_mfma_f32_16x16x32_bf16 v[144:147], a[148:151], v[124:127], v[144:147]
 v_exp_f32 v155, v155
 v_mfma_f32_16x16x32_bf16 v[144:147], a[152:155], v[108:111], v[144:147]
 ds_read_b128 a[180:183], v6 offset:17408
 v_cvt_pk_bf16_f32 v78, v152, v153
 v_mfma_f32_16x16x32_bf16 v[144:147], a[156:159], v[140:143], v[144:147]
 buffer_load_dwordx4 v1, s[56:59], s91 offen offset:3072 sc1 lds
 v_mfma_f32_16x16x32_bf16 a[92:95], a[200:203], v[32:35], a[92:95]
 s_add_u32 s91, s91, 17408
 v_exp_f32 v156, v156
 v_mfma_f32_16x16x32_bf16 a[92:95], a[204:207], v[36:39], a[92:95]
 v_exp_f32 v157, v157
 v_mfma_f32_16x16x32_bf16 a[140:143], v[212:215], v[40:43], a[140:143]
 ds_read_b128 a[160:163], v5 offset:4096
 v_cvt_pk_bf16_f32 v79, v154, v155
 v_mfma_f32_16x16x32_bf16 a[140:143], v[212:215], v[44:47], a[140:143]
 v_exp_f32 v158, v158
 v_mfma_f32_16x16x32_bf16 a[136:139], v[212:215], v[32:35], a[136:139]
 v_exp_f32 v159, v159
 v_mfma_f32_16x16x32_bf16 a[136:139], v[212:215], v[36:39], a[136:139]
 ds_read_b128 a[164:167], v5 offset:5120
 v_cvt_pk_bf16_f32 v71, v158, v159
 v_cvt_pk_bf16_f32 v70, v156, v157
 v_mfma_f32_16x16x32_bf16 v[148:151], a[144:147], v[88:91], v[160:163]
 s_add_u32 m0, s92, 81920
 ds_read_b128 a[168:171], v5 offset:6144
 ds_read_b128 a[172:175], v5 offset:7168
 v_mfma_f32_16x16x32_bf16 v[148:151], a[148:151], v[120:123], v[148:151]
 buffer_load_dwordx4 v1, s[36:39], s90 offen offset:0 sc1 lds
 v_mfma_f32_16x16x32_bf16 v[148:151], a[152:155], v[104:107], v[148:151]
 ds_read_b128 a[184:187], v6 offset:18432
 v_mfma_f32_16x16x32_bf16 v[148:151], a[156:159], v[136:139], v[148:151]
 s_waitcnt lgkmcnt(5)
 v_exp_f32 v144, v144
 v_mfma_f32_16x16x32_bf16 a[96:99], a[176:179], v[72:75], a[96:99]
 ds_read_b128 a[188:191], v6 offset:19456
 v_mfma_f32_16x16x32_bf16 a[96:99], a[180:183], v[76:79], a[96:99]
 v_exp_f32 v145, v145
 v_mfma_f32_16x16x32_bf16 a[64:67], a[176:179], v[64:67], a[64:67]
 s_nop 0
 ds_read_b128 a[192:195], v6 offset:20480
 ds_read_b128 a[196:199], v6 offset:21504
 v_mfma_f32_16x16x32_bf16 a[64:67], a[180:183], v[68:71], a[64:67]
 s_waitcnt lgkmcnt(3)
 v_exp_f32 v146, v146
 v_mfma_f32_16x16x32_bf16 v[152:155], a[160:163], v[92:95], v[184:187]
 ds_read_b128 a[144:147], v5 offset:8192
 v_cvt_pk_bf16_f32 v40, v144, v145
 v_mfma_f32_16x16x32_bf16 v[152:155], a[164:167], v[124:127], v[152:155]
 v_exp_f32 v147, v147
 v_mfma_f32_16x16x32_bf16 v[152:155], a[168:171], v[108:111], v[152:155]
 ds_read_b128 a[148:151], v5 offset:9216
 v_cvt_pk_bf16_f32 v41, v146, v147
 v_mfma_f32_16x16x32_bf16 v[152:155], a[172:175], v[140:143], v[152:155]
 buffer_load_dwordx4 v1, s[36:39], s90 offen offset:1024 sc1 lds
 v_mfma_f32_16x16x32_bf16 a[100:103], a[184:187], v[72:75], a[100:103]
 s_waitcnt lgkmcnt(2)
 ds_read_b128 a[152:155], v5 offset:10240
 v_mfma_f32_16x16x32_bf16 a[100:103], a[188:191], v[76:79], a[100:103]
 v_exp_f32 v148, v148
 v_mfma_f32_16x16x32_bf16 a[68:71], a[184:187], v[64:67], a[68:71]
 s_nop 0
 ds_read_b128 a[156:159], v5 offset:11264
 ds_read_b128 a[200:203], v6 offset:22528
 v_mfma_f32_16x16x32_bf16 a[68:71], a[188:191], v[68:71], a[68:71]
 v_exp_f32 v149, v149
 v_mfma_f32_16x16x32_bf16 v[156:159], a[160:163], v[88:91], v[164:167]
 ds_read_b128 a[204:207], v6 offset:23552
 v_cvt_pk_bf16_f32 v32, v148, v149
 v_mfma_f32_16x16x32_bf16 v[156:159], a[164:167], v[120:123], v[156:159]
 v_exp_f32 v150, v150
 v_mfma_f32_16x16x32_bf16 v[156:159], a[168:171], v[104:107], v[156:159]
 ds_read_b128 a[176:179], v6 offset:24576
 v_mfma_f32_16x16x32_bf16 v[156:159], a[172:175], v[136:139], v[156:159]
 v_exp_f32 v151, v151
 v_mfma_f32_16x16x32_bf16 a[104:107], a[192:195], v[72:75], a[104:107]
 ds_read_b128 a[180:183], v6 offset:25600
 v_cvt_pk_bf16_f32 v33, v150, v151
 v_mfma_f32_16x16x32_bf16 a[104:107], a[196:199], v[76:79], a[104:107]
 v_exp_f32 v152, v152
 v_mfma_f32_16x16x32_bf16 a[72:75], a[192:195], v[64:67], a[72:75]
 ds_read_b128 a[184:187], v6 offset:26624
 v_mfma_f32_16x16x32_bf16 a[72:75], a[196:199], v[68:71], a[72:75]
 s_waitcnt lgkmcnt(2)
 buffer_load_dwordx4 v1, s[36:39], s90 offen offset:2048 sc1 lds
 v_mfma_f32_16x16x32_bf16 v[144:147], a[144:147], v[92:95], v[184:187]
 ds_read_b128 a[188:191], v6 offset:27648
 v_mfma_f32_16x16x32_bf16 v[144:147], a[148:151], v[124:127], v[144:147]
 v_exp_f32 v153, v153
 v_mfma_f32_16x16x32_bf16 v[144:147], a[152:155], v[108:111], v[144:147]
 s_nop 0
 ds_read_b128 a[160:163], v5 offset:12288
 ds_read_b128 a[164:167], v5 offset:13312
 v_mfma_f32_16x16x32_bf16 v[144:147], a[156:159], v[140:143], v[144:147]
 v_exp_f32 v154, v154
 v_mfma_f32_16x16x32_bf16 a[108:111], a[200:203], v[72:75], a[108:111]
 ds_read_b128 a[168:171], v5 offset:14336
 v_cvt_pk_bf16_f32 v42, v152, v153
 v_mfma_f32_16x16x32_bf16 a[108:111], a[204:207], v[76:79], a[108:111]
 v_exp_f32 v155, v155
 v_mfma_f32_16x16x32_bf16 a[76:79], a[200:203], v[64:67], a[76:79]
 ds_read_b128 a[172:175], v5 offset:15360
 v_cvt_pk_bf16_f32 v43, v154, v155
 v_mfma_f32_16x16x32_bf16 a[76:79], a[204:207], v[68:71], a[76:79]
 v_exp_f32 v156, v156
 v_mfma_f32_16x16x32_bf16 a[112:115], a[176:179], v[72:75], a[112:115]
 s_waitcnt lgkmcnt(2)
 ds_read_b128 a[192:195], v6 offset:28672
 v_mfma_f32_16x16x32_bf16 a[112:115], a[180:183], v[76:79], a[112:115]
 v_exp_f32 v157, v157
 v_mfma_f32_16x16x32_bf16 v[148:151], a[144:147], v[88:91], v[168:171]
 ds_read_b128 a[196:199], v6 offset:29696
 v_cvt_pk_bf16_f32 v34, v156, v157
 v_mfma_f32_16x16x32_bf16 v[148:151], a[148:151], v[120:123], v[148:151]
 v_exp_f32 v158, v158
 v_mfma_f32_16x16x32_bf16 v[148:151], a[152:155], v[104:107], v[148:151]
 ds_read_b128 a[200:203], v6 offset:30720
 v_mfma_f32_16x16x32_bf16 v[148:151], a[156:159], v[136:139], v[148:151]
 v_exp_f32 v159, v159
 v_mfma_f32_16x16x32_bf16 a[80:83], a[176:179], v[64:67], a[80:83]
 ds_read_b128 a[204:207], v6 offset:31744
 v_cvt_pk_bf16_f32 v35, v158, v159
 v_mfma_f32_16x16x32_bf16 a[80:83], a[180:183], v[68:71], a[80:83]
 buffer_load_dwordx4 v1, s[36:39], s90 offen offset:3072 sc1 lds
 v_mfma_f32_16x16x32_bf16 a[116:119], a[184:187], v[72:75], a[116:119]
 s_add_u32 m0, s92, 0
 v_exp_f32 v144, v144
 v_mfma_f32_16x16x32_bf16 a[116:119], a[188:191], v[76:79], a[116:119]
 s_add_u32 s90, s90, 17408
 v_exp_f32 v145, v145
 v_mfma_f32_16x16x32_bf16 v[152:155], a[160:163], v[92:95], v[184:187]
 v_exp_f32 v146, v146
 v_mfma_f32_16x16x32_bf16 v[152:155], a[164:167], v[124:127], v[152:155]
 s_waitcnt lgkmcnt(5)
 v_exp_f32 v147, v147
 v_mfma_f32_16x16x32_bf16 v[152:155], a[168:171], v[108:111], v[152:155]
 s_waitcnt vmcnt(12) lgkmcnt(0)
 v_exp_f32 v148, v148
 v_mfma_f32_16x16x32_bf16 v[152:155], a[172:175], v[140:143], v[152:155]
 s_barrier
 v_cvt_pk_bf16_f32 v45, v146, v147
 v_mfma_f32_16x16x32_bf16 a[84:87], a[184:187], v[64:67], a[84:87]
 s_nop 0
 ds_read_b128 a[144:147], v5 offset:16384
 ds_read_b128 a[148:151], v5 offset:17408
 v_mfma_f32_16x16x32_bf16 a[84:87], a[188:191], v[68:71], a[84:87]
 buffer_load_dwordx4 v1, s[56:59], s91 offen offset:0 sc1 lds
 v_mfma_f32_16x16x32_bf16 a[120:123], a[192:195], v[72:75], a[120:123]
 ds_read_b128 a[152:155], v5 offset:18432
 v_cvt_pk_bf16_f32 v44, v144, v145
 v_mfma_f32_16x16x32_bf16 a[120:123], a[196:199], v[76:79], a[120:123]
 v_exp_f32 v149, v149
 v_mfma_f32_16x16x32_bf16 v[156:159], a[160:163], v[88:91], v[172:175]
 ds_read_b128 a[156:159], v5 offset:19456
 v_cvt_pk_bf16_f32 v36, v148, v149
 v_mfma_f32_16x16x32_bf16 v[156:159], a[164:167], v[120:123], v[156:159]
 buffer_load_dwordx4 v1, s[56:59], s91 offen offset:1024 sc1 lds
 v_mfma_f32_16x16x32_bf16 v[156:159], a[168:171], v[104:107], v[156:159]
 v_exp_f32 v150, v150
 v_mfma_f32_16x16x32_bf16 v[156:159], a[172:175], v[136:139], v[156:159]
 v_exp_f32 v151, v151
 v_mfma_f32_16x16x32_bf16 a[88:91], a[192:195], v[64:67], a[88:91]
 v_exp_f32 v152, v152
 v_mfma_f32_16x16x32_bf16 a[88:91], a[196:199], v[68:71], a[88:91]
 ds_read_b128 a[176:179], v7 offset:0
 v_cvt_pk_bf16_f32 v37, v150, v151
 v_mfma_f32_16x16x32_bf16 a[124:127], a[200:203], v[72:75], a[124:127]
 buffer_load_dwordx4 v1, s[56:59], s91 offen offset:2048 sc1 lds
 v_mfma_f32_16x16x32_bf16 a[124:127], a[204:207], v[76:79], a[124:127]
 s_waitcnt lgkmcnt(1)
 v_exp_f32 v153, v153
 v_mfma_f32_16x16x32_bf16 v[144:147], a[144:147], v[92:95], v[188:191]
 v_exp_f32 v154, v154
 v_mfma_f32_16x16x32_bf16 v[144:147], a[148:151], v[124:127], v[144:147]
 v_exp_f32 v155, v155
 v_mfma_f32_16x16x32_bf16 v[144:147], a[152:155], v[108:111], v[144:147]
 ds_read_b128 a[180:183], v7 offset:1024
 v_cvt_pk_bf16_f32 v46, v152, v153
 v_mfma_f32_16x16x32_bf16 v[144:147], a[156:159], v[140:143], v[144:147]
 buffer_load_dwordx4 v1, s[56:59], s91 offen offset:3072 sc1 lds
 v_mfma_f32_16x16x32_bf16 a[92:95], a[200:203], v[64:67], a[92:95]
 s_add_u32 s91, s91, 17408
 v_exp_f32 v156, v156
 v_mfma_f32_16x16x32_bf16 a[92:95], a[204:207], v[68:71], a[92:95]
 v_exp_f32 v157, v157
 v_mfma_f32_16x16x32_bf16 a[140:143], v[212:215], v[72:75], a[140:143]
 ds_read_b128 a[160:163], v5 offset:20480
 v_cvt_pk_bf16_f32 v47, v154, v155
 v_mfma_f32_16x16x32_bf16 a[140:143], v[212:215], v[76:79], a[140:143]
 v_exp_f32 v158, v158
 v_mfma_f32_16x16x32_bf16 a[136:139], v[212:215], v[64:67], a[136:139]
 v_exp_f32 v159, v159
 v_mfma_f32_16x16x32_bf16 a[136:139], v[212:215], v[68:71], a[136:139]
 ds_read_b128 a[164:167], v5 offset:21504
 v_cvt_pk_bf16_f32 v39, v158, v159
 v_cvt_pk_bf16_f32 v38, v156, v157
 v_mfma_f32_16x16x32_bf16 v[148:151], a[144:147], v[88:91], v[160:163]
 s_add_u32 m0, s93, 65536
 ds_read_b128 a[168:171], v5 offset:22528
 ds_read_b128 a[172:175], v5 offset:23552
 v_mfma_f32_16x16x32_bf16 v[148:151], a[148:151], v[120:123], v[148:151]
 buffer_load_dwordx4 v1, s[36:39], s90 offen offset:0 sc1 lds
 v_mfma_f32_16x16x32_bf16 v[148:151], a[152:155], v[104:107], v[148:151]
 s_sub_u32 s94, s94, 1
 ds_read_b128 a[184:187], v7 offset:2048
 v_mfma_f32_16x16x32_bf16 v[148:151], a[156:159], v[136:139], v[148:151]
 s_waitcnt lgkmcnt(5)
 v_exp_f32 v144, v144
 v_mfma_f32_16x16x32_bf16 a[96:99], a[176:179], v[40:43], a[96:99]
 ds_read_b128 a[188:191], v7 offset:3072
 v_mfma_f32_16x16x32_bf16 a[96:99], a[180:183], v[44:47], a[96:99]
 v_exp_f32 v145, v145
 v_mfma_f32_16x16x32_bf16 a[64:67], a[176:179], v[32:35], a[64:67]
 s_nop 0
 ds_read_b128 a[192:195], v7 offset:4096
 ds_read_b128 a[196:199], v7 offset:5120
 v_mfma_f32_16x16x32_bf16 a[64:67], a[180:183], v[36:39], a[64:67]
 s_waitcnt lgkmcnt(3)
 v_exp_f32 v146, v146
 v_mfma_f32_16x16x32_bf16 v[152:155], a[160:163], v[92:95], v[184:187]
 ds_read_b128 a[144:147], v5 offset:24576
 v_cvt_pk_bf16_f32 v72, v144, v145
 v_mfma_f32_16x16x32_bf16 v[152:155], a[164:167], v[124:127], v[152:155]
 v_exp_f32 v147, v147
 v_mfma_f32_16x16x32_bf16 v[152:155], a[168:171], v[108:111], v[152:155]
 ds_read_b128 a[148:151], v5 offset:25600
 v_cvt_pk_bf16_f32 v73, v146, v147
 v_mfma_f32_16x16x32_bf16 v[152:155], a[172:175], v[140:143], v[152:155]
 buffer_load_dwordx4 v1, s[36:39], s90 offen offset:1024 sc1 lds
 v_mfma_f32_16x16x32_bf16 a[100:103], a[184:187], v[40:43], a[100:103]
 s_waitcnt lgkmcnt(2)
 ds_read_b128 a[152:155], v5 offset:26624
 v_mfma_f32_16x16x32_bf16 a[100:103], a[188:191], v[44:47], a[100:103]
 v_exp_f32 v148, v148
 v_mfma_f32_16x16x32_bf16 a[68:71], a[184:187], v[32:35], a[68:71]
 s_nop 0
 ds_read_b128 a[156:159], v5 offset:27648
 ds_read_b128 a[200:203], v7 offset:6144
 v_mfma_f32_16x16x32_bf16 a[68:71], a[188:191], v[36:39], a[68:71]
 v_exp_f32 v149, v149
 v_mfma_f32_16x16x32_bf16 v[156:159], a[160:163], v[88:91], v[164:167]
 ds_read_b128 a[204:207], v7 offset:7168
 v_cvt_pk_bf16_f32 v64, v148, v149
 v_mfma_f32_16x16x32_bf16 v[156:159], a[164:167], v[120:123], v[156:159]
 v_exp_f32 v150, v150
 v_mfma_f32_16x16x32_bf16 v[156:159], a[168:171], v[104:107], v[156:159]
 ds_read_b128 a[176:179], v7 offset:8192
 v_mfma_f32_16x16x32_bf16 v[156:159], a[172:175], v[136:139], v[156:159]
 v_exp_f32 v151, v151
 v_mfma_f32_16x16x32_bf16 a[104:107], a[192:195], v[40:43], a[104:107]
 ds_read_b128 a[180:183], v7 offset:9216
 v_cvt_pk_bf16_f32 v65, v150, v151
 v_mfma_f32_16x16x32_bf16 a[104:107], a[196:199], v[44:47], a[104:107]
 v_exp_f32 v152, v152
 v_mfma_f32_16x16x32_bf16 a[72:75], a[192:195], v[32:35], a[72:75]
 ds_read_b128 a[184:187], v7 offset:10240
 v_mfma_f32_16x16x32_bf16 a[72:75], a[196:199], v[36:39], a[72:75]
 s_waitcnt lgkmcnt(2)
 v_exp_f32 v153, v153
 v_mfma_f32_16x16x32_bf16 v[144:147], a[144:147], v[92:95], v[184:187]
 ds_read_b128 a[188:191], v7 offset:11264
 v_cvt_pk_bf16_f32 v74, v152, v153
 v_mfma_f32_16x16x32_bf16 v[144:147], a[148:151], v[124:127], v[144:147]
 v_exp_f32 v154, v154
 v_mfma_f32_16x16x32_bf16 v[144:147], a[152:155], v[108:111], v[144:147]
 s_nop 0
 ds_read_b128 a[160:163], v5 offset:28672
 ds_read_b128 a[164:167], v5 offset:29696
 v_mfma_f32_16x16x32_bf16 v[144:147], a[156:159], v[140:143], v[144:147]
 buffer_load_dwordx4 v1, s[36:39], s90 offen offset:2048 sc1 lds
 v_mfma_f32_16x16x32_bf16 a[108:111], a[200:203], v[40:43], a[108:111]
 ds_read_b128 a[168:171], v5 offset:30720
 v_mfma_f32_16x16x32_bf16 a[108:111], a[204:207], v[44:47], a[108:111]
 v_exp_f32 v155, v155
 v_mfma_f32_16x16x32_bf16 a[76:79], a[200:203], v[32:35], a[76:79]
 ds_read_b128 a[172:175], v5 offset:31744
 v_cvt_pk_bf16_f32 v75, v154, v155
 v_mfma_f32_16x16x32_bf16 a[76:79], a[204:207], v[36:39], a[76:79]
 v_exp_f32 v156, v156
 v_mfma_f32_16x16x32_bf16 a[112:115], a[176:179], v[40:43], a[112:115]
 s_waitcnt lgkmcnt(2)
 ds_read_b128 a[192:195], v7 offset:12288
 v_mfma_f32_16x16x32_bf16 a[112:115], a[180:183], v[44:47], a[112:115]
 v_exp_f32 v157, v157
 v_mfma_f32_16x16x32_bf16 v[148:151], a[144:147], v[88:91], v[168:171]
 ds_read_b128 a[196:199], v7 offset:13312
 v_cvt_pk_bf16_f32 v66, v156, v157
 v_mfma_f32_16x16x32_bf16 v[148:151], a[148:151], v[120:123], v[148:151]
 v_exp_f32 v158, v158
 v_mfma_f32_16x16x32_bf16 v[148:151], a[152:155], v[104:107], v[148:151]
 ds_read_b128 a[200:203], v7 offset:14336
 v_mfma_f32_16x16x32_bf16 v[148:151], a[156:159], v[136:139], v[148:151]
 v_exp_f32 v159, v159
 v_mfma_f32_16x16x32_bf16 a[80:83], a[176:179], v[32:35], a[80:83]
 ds_read_b128 a[204:207], v7 offset:15360
 v_cvt_pk_bf16_f32 v67, v158, v159
 v_mfma_f32_16x16x32_bf16 a[80:83], a[180:183], v[36:39], a[80:83]
 buffer_load_dwordx4 v1, s[36:39], s90 offen offset:3072 sc1 lds
 v_mfma_f32_16x16x32_bf16 a[116:119], a[184:187], v[40:43], a[116:119]
 s_add_u32 m0, s92, 16384
 v_exp_f32 v144, v144
 v_mfma_f32_16x16x32_bf16 a[116:119], a[188:191], v[44:47], a[116:119]
 s_add_u32 s90, s90, 17408
 v_exp_f32 v145, v145
 v_mfma_f32_16x16x32_bf16 v[152:155], a[160:163], v[92:95], v[184:187]
 v_exp_f32 v146, v146
 v_mfma_f32_16x16x32_bf16 v[152:155], a[164:167], v[124:127], v[152:155]
 s_waitcnt lgkmcnt(5)
 v_exp_f32 v147, v147
 v_mfma_f32_16x16x32_bf16 v[152:155], a[168:171], v[108:111], v[152:155]
 s_waitcnt vmcnt(12) lgkmcnt(0)
 v_exp_f32 v148, v148
 v_mfma_f32_16x16x32_bf16 v[152:155], a[172:175], v[140:143], v[152:155]
 s_barrier
 v_cvt_pk_bf16_f32 v76, v144, v145
 v_mfma_f32_16x16x32_bf16 a[84:87], a[184:187], v[32:35], a[84:87]
 s_nop 0
 ds_read_b128 a[144:147], v4 offset:0
 ds_read_b128 a[148:151], v4 offset:1024
 v_mfma_f32_16x16x32_bf16 a[84:87], a[188:191], v[36:39], a[84:87]
 buffer_load_dwordx4 v1, s[56:59], s91 offen offset:0 sc1 lds
 v_mfma_f32_16x16x32_bf16 a[120:123], a[192:195], v[40:43], a[120:123]
 ds_read_b128 a[152:155], v4 offset:2048
 v_cvt_pk_bf16_f32 v77, v146, v147
 v_mfma_f32_16x16x32_bf16 a[120:123], a[196:199], v[44:47], a[120:123]
 v_exp_f32 v149, v149
 v_mfma_f32_16x16x32_bf16 v[156:159], a[160:163], v[88:91], v[172:175]
 ds_read_b128 a[156:159], v4 offset:3072
 v_cvt_pk_bf16_f32 v68, v148, v149
 v_mfma_f32_16x16x32_bf16 v[156:159], a[164:167], v[120:123], v[156:159]
 buffer_load_dwordx4 v1, s[56:59], s91 offen offset:1024 sc1 lds
 v_mfma_f32_16x16x32_bf16 v[156:159], a[168:171], v[104:107], v[156:159]
 v_exp_f32 v150, v150
 v_mfma_f32_16x16x32_bf16 v[156:159], a[172:175], v[136:139], v[156:159]
 v_exp_f32 v151, v151
 v_mfma_f32_16x16x32_bf16 a[88:91], a[192:195], v[32:35], a[88:91]
 v_exp_f32 v152, v152
 v_mfma_f32_16x16x32_bf16 a[88:91], a[196:199], v[36:39], a[88:91]
 ds_read_b128 a[176:179], v7 offset:16384
 v_cvt_pk_bf16_f32 v69, v150, v151
 v_mfma_f32_16x16x32_bf16 a[124:127], a[200:203], v[40:43], a[124:127]
 buffer_load_dwordx4 v1, s[56:59], s91 offen offset:2048 sc1 lds
 v_mfma_f32_16x16x32_bf16 a[124:127], a[204:207], v[44:47], a[124:127]
 s_waitcnt lgkmcnt(1)
 v_exp_f32 v156, v156
 v_mfma_f32_16x16x32_bf16 v[144:147], a[144:147], v[92:95], v[188:191]
 v_exp_f32 v153, v153
 v_mfma_f32_16x16x32_bf16 v[144:147], a[148:151], v[124:127], v[144:147]
 v_exp_f32 v154, v154
 v_mfma_f32_16x16x32_bf16 v[144:147], a[152:155], v[108:111], v[144:147]
 ds_read_b128 a[180:183], v7 offset:17408
 v_cvt_pk_bf16_f32 v78, v152, v153
 v_mfma_f32_16x16x32_bf16 v[144:147], a[156:159], v[140:143], v[144:147]
 v_exp_f32 v157, v157
 v_mfma_f32_16x16x32_bf16 a[92:95], a[200:203], v[32:35], a[92:95]
 v_exp_f32 v158, v158
 v_mfma_f32_16x16x32_bf16 a[92:95], a[204:207], v[36:39], a[92:95]
 v_exp_f32 v155, v155
 v_mfma_f32_16x16x32_bf16 a[140:143], v[212:215], v[40:43], a[140:143]
 ds_read_b128 a[160:163], v4 offset:4096
 v_cvt_pk_bf16_f32 v70, v156, v157
 v_mfma_f32_16x16x32_bf16 a[140:143], v[212:215], v[44:47], a[140:143]
 buffer_load_dwordx4 v1, s[56:59], s91 offen offset:3072 sc1 lds
 v_mfma_f32_16x16x32_bf16 a[136:139], v[212:215], v[32:35], a[136:139]
 s_add_u32 s91, s91, 17408
 v_exp_f32 v159, v159
 v_mfma_f32_16x16x32_bf16 a[136:139], v[212:215], v[36:39], a[136:139]
 s_cmp_eq_u32 s94, 0
 ds_read_b128 a[164:167], v4 offset:5120
 v_cvt_pk_bf16_f32 v79, v154, v155
 v_cvt_pk_bf16_f32 v71, v158, v159
 s_cbranch_scc1 L_slast
 v_mfma_f32_16x16x32_bf16 v[148:151], a[144:147], v[88:91], v[160:163]
 s_add_u32 m0, s93, 81920
 ds_read_b128 a[168:171], v4 offset:6144
 ds_read_b128 a[172:175], v4 offset:7168
 v_mfma_f32_16x16x32_bf16 v[148:151], a[148:151], v[120:123], v[148:151]
 buffer_load_dwordx4 v1, s[36:39], s90 offen offset:0 sc1 lds
 v_mfma_f32_16x16x32_bf16 v[148:151], a[152:155], v[104:107], v[148:151]
 ds_read_b128 a[184:187], v7 offset:18432
 v_mfma_f32_16x16x32_bf16 v[148:151], a[156:159], v[136:139], v[148:151]
 s_waitcnt lgkmcnt(5)
 v_exp_f32 v144, v144
 v_mfma_f32_16x16x32_bf16 a[96:99], a[176:179], v[72:75], a[96:99]
 ds_read_b128 a[188:191], v7 offset:19456
 v_mfma_f32_16x16x32_bf16 a[96:99], a[180:183], v[76:79], a[96:99]
 v_exp_f32 v145, v145
 v_mfma_f32_16x16x32_bf16 a[64:67], a[176:179], v[64:67], a[64:67]
 s_nop 0
 ds_read_b128 a[192:195], v7 offset:20480
 ds_read_b128 a[196:199], v7 offset:21504
 v_mfma_f32_16x16x32_bf16 a[64:67], a[180:183], v[68:71], a[64:67]
 s_waitcnt lgkmcnt(3)
 v_exp_f32 v146, v146
 v_mfma_f32_16x16x32_bf16 v[152:155], a[160:163], v[92:95], v[184:187]
 ds_read_b128 a[144:147], v4 offset:8192
 v_cvt_pk_bf16_f32 v40, v144, v145
 v_mfma_f32_16x16x32_bf16 v[152:155], a[164:167], v[124:127], v[152:155]
 v_exp_f32 v147, v147
 v_mfma_f32_16x16x32_bf16 v[152:155], a[168:171], v[108:111], v[152:155]
 ds_read_b128 a[148:151], v4 offset:9216
 v_cvt_pk_bf16_f32 v41, v146, v147
 v_mfma_f32_16x16x32_bf16 v[152:155], a[172:175], v[140:143], v[152:155]
 buffer_load_dwordx4 v1, s[36:39], s90 offen offset:1024 sc1 lds
 v_mfma_f32_16x16x32_bf16 a[100:103], a[184:187], v[72:75], a[100:103]
 s_waitcnt lgkmcnt(2)
 ds_read_b128 a[152:155], v4 offset:10240
 v_mfma_f32_16x16x32_bf16 a[100:103], a[188:191], v[76:79], a[100:103]
 v_exp_f32 v148, v148
 v_mfma_f32_16x16x32_bf16 a[68:71], a[184:187], v[64:67], a[68:71]
 s_nop 0
 ds_read_b128 a[156:159], v4 offset:11264
 ds_read_b128 a[200:203], v7 offset:22528
 v_mfma_f32_16x16x32_bf16 a[68:71], a[188:191], v[68:71], a[68:71]
 v_exp_f32 v149, v149
 v_mfma_f32_16x16x32_bf16 v[156:159], a[160:163], v[88:91], v[164:167]
 ds_read_b128 a[204:207], v7 offset:23552
 v_cvt_pk_bf16_f32 v32, v148, v149
 v_mfma_f32_16x16x32_bf16 v[156:159], a[164:167], v[120:123], v[156:159]
 v_exp_f32 v150, v150
 v_mfma_f32_16x16x32_bf16 v[156:159], a[168:171], v[104:107], v[156:159]
 ds_read_b128 a[176:179], v7 offset:24576
 v_mfma_f32_16x16x32_bf16 v[156:159], a[172:175], v[136:139], v[156:159]
 v_exp_f32 v151, v151
 v_mfma_f32_16x16x32_bf16 a[104:107], a[192:195], v[72:75], a[104:107]
 ds_read_b128 a[180:183], v7 offset:25600
 v_cvt_pk_bf16_f32 v33, v150, v151
 v_mfma_f32_16x16x32_bf16 a[104:107], a[196:199], v[76:79], a[104:107]
 v_exp_f32 v152, v152
 v_mfma_f32_16x16x32_bf16 a[72:75], a[192:195], v[64:67], a[72:75]
 ds_read_b128 a[184:187], v7 offset:26624
 v_mfma_f32_16x16x32_bf16 a[72:75], a[196:199], v[68:71], a[72:75]
 s_waitcnt lgkmcnt(2)
 buffer_load_dwordx4 v1, s[36:39], s90 offen offset:2048 sc1 lds
 v_mfma_f32_16x16x32_bf16 v[144:147], a[144:147], v[92:95], v[184:187]
 ds_read_b128 a[188:191], v7 offset:27648
 v_mfma_f32_16x16x32_bf16 v[144:147], a[148:151], v[124:127], v[144:147]
 v_exp_f32 v153, v153
 v_mfma_f32_16x16x32_bf16 v[144:147], a[152:155], v[108:111], v[144:147]
 s_nop 0
 ds_read_b128 a[160:163], v4 offset:12288
 ds_read_b128 a[164:167], v4 offset:13312
 v_mfma_f32_16x16x32_bf16 v[144:147], a[156:159], v[140:143], v[144:147]
 v_exp_f32 v154, v154
 v_mfma_f32_16x16x32_bf16 a[108:111], a[200:203], v[72:75], a[108:111]
 ds_read_b128 a[168:171], v4 offset:14336
 v_cvt_pk_bf16_f32 v42, v152, v153
 v_mfma_f32_16x16x32_bf16 a[108:111], a[204:207], v[76:79], a[108:111]
 v_exp_f32 v155, v155
 v_mfma_f32_16x16x32_bf16 a[76:79], a[200:203], v[64:67], a[76:79]
 ds_read_b128 a[172:175], v4 offset:15360
 v_cvt_pk_bf16_f32 v43, v154, v155
 v_mfma_f32_16x16x32_bf16 a[76:79], a[204:207], v[68:71], a[76:79]
 v_exp_f32 v156, v156
 v_mfma_f32_16x16x32_bf16 a[112:115], a[176:179], v[72:75], a[112:115]
 s_waitcnt lgkmcnt(2)
 ds_read_b128 a[192:195], v7 offset:28672
 v_mfma_f32_16x16x32_bf16 a[112:115], a[180:183], v[76:79], a[112:115]
 v_exp_f32 v157, v157
 v_mfma_f32_16x16x32_bf16 v[148:151], a[144:147], v[88:91], v[168:171]
 ds_read_b128 a[196:199], v7 offset:29696
 v_cvt_pk_bf16_f32 v34, v156, v157
 v_mfma_f32_16x16x32_bf16 v[148:151], a[148:151], v[120:123], v[148:151]
 v_exp_f32 v158, v158
 v_mfma_f32_16x16x32_bf16 v[148:151], a[152:155], v[104:107], v[148:151]
 ds_read_b128 a[200:203], v7 offset:30720
 v_mfma_f32_16x16x32_bf16 v[148:151], a[156:159], v[136:139], v[148:151]
 v_exp_f32 v159, v159
 v_mfma_f32_16x16x32_bf16 a[80:83], a[176:179], v[64:67], a[80:83]
 ds_read_b128 a[204:207], v7 offset:31744
 v_cvt_pk_bf16_f32 v35, v158, v159
 v_mfma_f32_16x16x32_bf16 a[80:83], a[180:183], v[68:71], a[80:83]
 buffer_load_dwordx4 v1, s[36:39], s90 offen offset:3072 sc1 lds
 v_mfma_f32_16x16x32_bf16 a[116:119], a[184:187], v[72:75], a[116:119]
 s_add_u32 m0, s93, 0
 v_exp_f32 v144, v144
 v_mfma_f32_16x16x32_bf16 a[116:119], a[188:191], v[76:79], a[116:119]
 s_add_u32 s90, s90, 17408
 v_exp_f32 v145, v145
 v_mfma_f32_16x16x32_bf16 v[152:155], a[160:163], v[92:95], v[184:187]
 v_exp_f32 v146, v146
 v_mfma_f32_16x16x32_bf16 v[152:155], a[164:167], v[124:127], v[152:155]
 s_waitcnt lgkmcnt(5)
 v_exp_f32 v147, v147
 v_mfma_f32_16x16x32_bf16 v[152:155], a[168:171], v[108:111], v[152:155]
 s_waitcnt vmcnt(12) lgkmcnt(0)
 v_exp_f32 v148, v148
 v_mfma_f32_16x16x32_bf16 v[152:155], a[172:175], v[140:143], v[152:155]
 s_barrier
 v_cvt_pk_bf16_f32 v45, v146, v147
 v_mfma_f32_16x16x32_bf16 a[84:87], a[184:187], v[64:67], a[84:87]
 s_nop 0
 ds_read_b128 a[144:147], v4 offset:16384
 ds_read_b128 a[148:151], v4 offset:17408
 v_mfma_f32_16x16x32_bf16 a[84:87], a[188:191], v[68:71], a[84:87]
 buffer_load_dwordx4 v1, s[56:59], s91 offen offset:0 sc1 lds
 v_mfma_f32_16x16x32_bf16 a[120:123], a[192:195], v[72:75], a[120:123]
 ds_read_b128 a[152:155], v4 offset:18432
 v_cvt_pk_bf16_f32 v44, v144, v145
 v_mfma_f32_16x16x32_bf16 a[120:123], a[196:199], v[76:79], a[120:123]
 v_exp_f32 v149, v149
 v_mfma_f32_16x16x32_bf16 v[156:159], a[160:163], v[88:91], v[172:175]
 ds_read_b128 a[156:159], v4 offset:19456
 v_cvt_pk_bf16_f32 v36, v148, v149
 v_mfma_f32_16x16x32_bf16 v[156:159], a[164:167], v[120:123], v[156:159]
 buffer_load_dwordx4 v1, s[56:59], s91 offen offset:1024 sc1 lds
 v_mfma_f32_16x16x32_bf16 v[156:159], a[168:171], v[104:107], v[156:159]
 v_exp_f32 v150, v150
 v_mfma_f32_16x16x32_bf16 v[156:159], a[172:175], v[136:139], v[156:159]
 v_exp_f32 v151, v151
 v_mfma_f32_16x16x32_bf16 a[88:91], a[192:195], v[64:67], a[88:91]
 v_exp_f32 v152, v152
 v_mfma_f32_16x16x32_bf16 a[88:91], a[196:199], v[68:71], a[88:91]
 ds_read_b128 a[176:179], v6 offset:0
 v_cvt_pk_bf16_f32 v37, v150, v151
 v_mfma_f32_16x16x32_bf16 a[124:127], a[200:203], v[72:75], a[124:127]
 buffer_load_dwordx4 v1, s[56:59], s91 offen offset:2048 sc1 lds
 v_mfma_f32_16x16x32_bf16 a[124:127], a[204:207], v[76:79], a[124:127]
 s_waitcnt lgkmcnt(1)
 v_exp_f32 v153, v153
 v_mfma_f32_16x16x32_bf16 v[144:147], a[144:147], v[92:95], v[188:191]
 v_exp_f32 v154, v154
 v_mfma_f32_16x16x32_bf16 v[144:147], a[148:151], v[124:127], v[144:147]
 v_exp_f32 v155, v155
 v_mfma_f32_16x16x32_bf16 v[144:147], a[152:155], v[108:111], v[144:147]
 ds_read_b128 a[180:183], v6 offset:1024
 v_cvt_pk_bf16_f32 v46, v152, v153
 v_mfma_f32_16x16x32_bf16 v[144:147], a[156:159], v[140:143], v[144:147]
 buffer_load_dwordx4 v1, s[56:59], s91 offen offset:3072 sc1 lds
 v_mfma_f32_16x16x32_bf16 a[92:95], a[200:203], v[64:67], a[92:95]
 s_add_u32 s91, s91, 17408
 v_exp_f32 v156, v156
 v_mfma_f32_16x16x32_bf16 a[92:95], a[204:207], v[68:71], a[92:95]
 v_exp_f32 v157, v157
 v_mfma_f32_16x16x32_bf16 a[140:143], v[212:215], v[72:75], a[140:143]
 ds_read_b128 a[160:163], v4 offset:20480
 v_cvt_pk_bf16_f32 v47, v154, v155
 v_mfma_f32_16x16x32_bf16 a[140:143], v[212:215], v[76:79], a[140:143]
 v_exp_f32 v158, v158
 v_mfma_f32_16x16x32_bf16 a[136:139], v[212:215], v[64:67], a[136:139]
 v_exp_f32 v159, v159
 v_mfma_f32_16x16x32_bf16 a[136:139], v[212:215], v[68:71], a[136:139]
 ds_read_b128 a[164:167], v4 offset:21504
 v_cvt_pk_bf16_f32 v39, v158, v159
 v_cvt_pk_bf16_f32 v38, v156, v157
 s_branch L_sloop
.p2align 5
L_slast:
 v_cmp_le_i32 vcc, 0, v248
 v_cmp_le_i32 s[98:99], 1, v248
 v_cmp_le_i32 s[100:101], 2, v248
 v_cndmask_b32 v160, v250, v180, vcc
 v_cmp_le_i32 vcc, 3, v248
 v_cndmask_b32 v161, v250, v180, s[98:99]
 v_cndmask_b32 v162, v250, v180, s[100:101]
L_w0_2:
L_st0_2:
 s_cbranch_execz L_st0_6
 v_cndmask_b32 v163, v250, v180, vcc
 v_cmp_le_i32 vcc, 16, v248
 v_cmp_le_i32 s[98:99], 17, v248
 v_mfma_f32_16x16x32_bf16 v[148:151], a[144:147], v[88:91], v[160:163]
 ds_read_b128 a[168:171], v4 offset:6144
 v_cmp_le_i32 s[100:101], 18, v248
 v_mfma_f32_16x16x32_bf16 v[148:151], a[148:151], v[120:123], v[148:151]
 v_exp_f32 v144, v144
 v_mfma_f32_16x16x32_bf16 v[148:151], a[152:155], v[104:107], v[148:151]
 ds_read_b128 a[172:175], v4 offset:7168
 v_cndmask_b32 v164, v250, v180, vcc
 v_mfma_f32_16x16x32_bf16 v[148:151], a[156:159], v[136:139], v[148:151]
 s_waitcnt lgkmcnt(4)
 buffer_load_dword v198, v199, s[52:55], s13 offen
 v_mfma_f32_16x16x32_bf16 a[96:99], a[176:179], v[72:75], a[96:99]
 s_add_u32 s13, s13, 530432
 ds_read_b128 a[184:187], v7 offset:18432
 v_cmp_le_i32 vcc, 19, v248
 v_mfma_f32_16x16x32_bf16 a[96:99], a[180:183], v[76:79], a[96:99]
 s_min_u32 s13, s13, 4189568
 v_exp_f32 v145, v145
 v_mfma_f32_16x16x32_bf16 a[64:67], a[176:179], v[64:67], a[64:67]
 s_nop 0
 ds_read_b128 a[188:191], v7 offset:19456
 ds_read_b128 a[192:195], v7 offset:20480
 v_mfma_f32_16x16x32_bf16 a[64:67], a[180:183], v[68:71], a[64:67]
 s_waitcnt lgkmcnt(3)
 v_exp_f32 v146, v146
 v_mfma_f32_16x16x32_bf16 v[152:155], a[160:163], v[92:95], v[184:187]
 ds_read_b128 a[196:199], v7 offset:21504
 v_cndmask_b32 v165, v250, v180, s[98:99]
 v_mfma_f32_16x16x32_bf16 v[152:155], a[164:167], v[124:127], v[152:155]
 v_exp_f32 v147, v147
 v_mfma_f32_16x16x32_bf16 v[152:155], a[168:171], v[108:111], v[152:155]
 ds_read_b128 a[144:147], v4 offset:8192
 v_cndmask_b32 v166, v250, v180, s[100:101]
 v_mfma_f32_16x16x32_bf16 v[152:155], a[172:175], v[140:143], v[152:155]
 s_waitcnt lgkmcnt(2)
 v_exp_f32 v148, v148
 v_mfma_f32_16x16x32_bf16 a[100:103], a[184:187], v[72:75], a[100:103]
L_w0_3:
L_st0_3:
 s_cbranch_execz L_st0_7
 ds_read_b128 a[148:151], v4 offset:9216
 v_cndmask_b32 v167, v250, v180, vcc
 v_mfma_f32_16x16x32_bf16 a[100:103], a[188:191], v[76:79], a[100:103]
 v_exp_f32 v149, v149
 v_mfma_f32_16x16x32_bf16 a[68:71], a[184:187], v[64:67], a[68:71]
 ds_read_b128 a[152:155], v4 offset:10240
 v_cvt_pk_bf16_f32 v40, v144, v145
 v_mfma_f32_16x16x32_bf16 a[68:71], a[188:191], v[68:71], a[68:71]
 v_exp_f32 v150, v150
 v_mfma_f32_16x16x32_bf16 v[156:159], a[160:163], v[88:91], v[164:167]
 ds_read_b128 a[156:159], v4 offset:11264
 v_cvt_pk_bf16_f32 v41, v146, v147
 v_mfma_f32_16x16x32_bf16 v[156:159], a[164:167], v[120:123], v[156:159]
 v_exp_f32 v151, v151
 v_mfma_f32_16x16x32_bf16 v[156:159], a[168:171], v[104:107], v[156:159]
 ds_read_b128 a[200:203], v7 offset:22528
 v_cmp_le_i32 vcc, 32, v248
 v_mfma_f32_16x16x32_bf16 v[156:159], a[172:175], v[136:139], v[156:159]
 v_exp_f32 v152, v152
 v_mfma_f32_16x16x32_bf16 a[104:107], a[192:195], v[72:75], a[104:107]
 s_waitcnt lgkmcnt(2)
 ds_read_b128 a[204:207], v7 offset:23552
 v_cmp_le_i32 s[98:99], 33, v248
 v_mfma_f32_16x16x32_bf16 a[104:107], a[196:199], v[76:79], a[104:107]
 v_exp_f32 v153, v153
 v_mfma_f32_16x16x32_bf16 a[72:75], a[192:195], v[64:67], a[72:75]
 ds_read_b128 a[176:179], v7 offset:24576
 v_cmp_le_i32 s[100:101], 34, v248
 v_mfma_f32_16x16x32_bf16 a[72:75], a[196:199], v[68:71], a[72:75]
 v_exp_f32 v154, v154
 v_mfma_f32_16x16x32_bf16 v[144:147], a[144:147], v[92:95], v[184:187]
 ds_read_b128 a[180:183], v7 offset:25600
 v_cndmask_b32 v168, v250, v180, vcc
 v_mfma_f32_16x16x32_bf16 v[144:147], a[148:151], v[124:127], v[144:147]
 v_exp_f32 v155, v155
 v_mfma_f32_16x16x32_bf16 v[144:147], a[152:155], v[108:111], v[144:147]
 s_waitcnt lgkmcnt(2)
 ds_read_b128 a[184:187], v7 offset:26624
 v_cmp_le_i32 vcc, 35, v248
 v_mfma_f32_16x16x32_bf16 v[144:147], a[156:159], v[140:143], v[144:147]
 v_exp_f32 v156, v156
 v_mfma_f32_16x16x32_bf16 a[108:111], a[200:203], v[72:75], a[108:111]
 ds_read_b128 a[188:191], v7 offset:27648
 v_cndmask_b32 v169, v250, v180, s[98:99]
 v_mfma_f32_16x16x32_bf16 a[108:111], a[204:207], v[76:79], a[108:111]
 v_exp_f32 v157, v157
 v_mfma_f32_16x16x32_bf16 a[76:79], a[200:203], v[64:67], a[76:79]
 ds_read_b128 a[160:163], v4 offset:12288
 v_cndmask_b32 v170, v250, v180, s[100:101]
 v_mfma_f32_16x16x32_bf16 a[76:79], a[204:207], v[68:71], a[76:79]
 s_waitcnt lgkmcnt(2)
 v_exp_f32 v158, v158
 v_mfma_f32_16x16x32_bf16 a[112:115], a[176:179], v[72:75], a[112:115]
 ds_read_b128 a[164:167], v4 offset:13312
 v_cndmask_b32 v171, v250, v180, vcc
 v_mfma_f32_16x16x32_bf16 a[112:115], a[180:183], v[76:79], a[112:115]
 v_cvt_pk_bf16_f32 v32, v148, v149
 v_cvt_pk_bf16_f32 v33, v150, v151
 v_mfma_f32_16x16x32_bf16 v[148:151], a[144:147], v[88:91], v[168:171]
 ds_read_b128 a[168:171], v4 offset:14336
 v_cvt_pk_bf16_f32 v42, v152, v153
 v_mfma_f32_16x16x32_bf16 v[148:151], a[148:151], v[120:123], v[148:151]
 v_exp_f32 v159, v159
 v_mfma_f32_16x16x32_bf16 v[148:151], a[152:155], v[104:107], v[148:151]
 ds_read_b128 a[172:175], v4 offset:15360
 v_cvt_pk_bf16_f32 v43, v154, v155
 v_mfma_f32_16x16x32_bf16 v[148:151], a[156:159], v[136:139], v[148:151]
 buffer_load_dword v198, v199, s[52:55], s13 offen
 v_mfma_f32_16x16x32_bf16 a[80:83], a[176:179], v[64:67], a[80:83]
 ds_read_b128 a[192:195], v7 offset:28672
 v_cmp_le_i32 vcc, 48, v248
 v_mfma_f32_16x16x32_bf16 a[80:83], a[180:183], v[68:71], a[80:83]
 v_exp_f32 v144, v144
 v_mfma_f32_16x16x32_bf16 a[116:119], a[184:187], v[72:75], a[116:119]
 s_waitcnt lgkmcnt(2)
 ds_read_b128 a[196:199], v7 offset:29696
 v_cmp_le_i32 s[98:99], 49, v248
 v_mfma_f32_16x16x32_bf16 a[116:119], a[188:191], v[76:79], a[116:119]
 v_exp_f32 v145, v145
 v_mfma_f32_16x16x32_bf16 v[152:155], a[160:163], v[92:95], v[184:187]
 ds_read_b128 a[200:203], v7 offset:30720
 v_cmp_le_i32 s[100:101], 50, v248
 v_mfma_f32_16x16x32_bf16 v[152:155], a[164:167], v[124:127], v[152:155]
 v_exp_f32 v146, v146
 v_mfma_f32_16x16x32_bf16 v[152:155], a[168:171], v[108:111], v[152:155]
 s_waitcnt vmcnt(10) lgkmcnt(2)
 ds_read_b128 a[204:207], v7 offset:31744
 v_cndmask_b32 v172, v250, v180, vcc
 v_mfma_f32_16x16x32_bf16 v[152:155], a[172:175], v[140:143], v[152:155]
 s_barrier
 v_cmp_le_i32 vcc, 51, v248
 v_mfma_f32_16x16x32_bf16 a[84:87], a[184:187], v[64:67], a[84:87]
 ds_read_b128 a[144:147], v4 offset:16384
 v_cndmask_b32 v173, v250, v180, s[98:99]
 v_mfma_f32_16x16x32_bf16 a[84:87], a[188:191], v[68:71], a[84:87]
 v_exp_f32 v147, v147
 v_mfma_f32_16x16x32_bf16 a[120:123], a[192:195], v[72:75], a[120:123]
 s_waitcnt lgkmcnt(2)
 v_cndmask_b32 v174, v250, v180, s[100:101]
 v_cndmask_b32 v175, v250, v180, vcc
 v_mfma_f32_16x16x32_bf16 a[120:123], a[196:199], v[76:79], a[120:123]
 v_cvt_pk_bf16_f32 v34, v156, v157
 v_cvt_pk_bf16_f32 v35, v158, v159
 v_mfma_f32_16x16x32_bf16 v[156:159], a[160:163], v[88:91], v[172:175]
 s_nop 0
 ds_read_b128 a[148:151], v4 offset:17408
 ds_read_b128 a[152:155], v4 offset:18432
 v_mfma_f32_16x16x32_bf16 v[156:159], a[164:167], v[120:123], v[156:159]
 v_exp_f32 v148, v148
 v_mfma_f32_16x16x32_bf16 v[156:159], a[168:171], v[104:107], v[156:159]
 ds_read_b128 a[156:159], v4 offset:19456
 v_cmp_le_i32 vcc, 0, v249
 v_mfma_f32_16x16x32_bf16 v[156:159], a[172:175], v[136:139], v[156:159]
 v_exp_f32 v149, v149
 v_mfma_f32_16x16x32_bf16 a[88:91], a[192:195], v[64:67], a[88:91]
 ds_read_b128 a[176:179], v6 offset:0
 v_cmp_le_i32 s[98:99], 1, v249
 v_mfma_f32_16x16x32_bf16 a[88:91], a[196:199], v[68:71], a[88:91]
 v_exp_f32 v150, v150
 v_mfma_f32_16x16x32_bf16 a[124:127], a[200:203], v[72:75], a[124:127]
 s_waitcnt lgkmcnt(2)
 v_cmp_le_i32 s[100:101], 2, v249
 v_cndmask_b32 v188, v250, v184, vcc
 v_cmp_le_i32 vcc, 3, v249
 v_cndmask_b32 v189, v250, v184, s[98:99]
 v_cndmask_b32 v190, v250, v184, s[100:101]
 v_cndmask_b32 v191, v250, v184, vcc
 v_mfma_f32_16x16x32_bf16 a[124:127], a[204:207], v[76:79], a[124:127]
 v_cvt_pk_bf16_f32 v44, v144, v145
 v_cvt_pk_bf16_f32 v45, v146, v147
 v_mfma_f32_16x16x32_bf16 v[144:147], a[144:147], v[92:95], v[188:191]
 s_nop 0
 ds_read_b128 a[180:183], v6 offset:1024
 ds_read_b128 a[160:163], v4 offset:20480
 v_mfma_f32_16x16x32_bf16 v[144:147], a[148:151], v[124:127], v[144:147]
 v_exp_f32 v151, v151
 v_mfma_f32_16x16x32_bf16 v[144:147], a[152:155], v[108:111], v[144:147]
 s_waitcnt lgkmcnt(3)
 v_exp_f32 v152, v152
 v_mfma_f32_16x16x32_bf16 v[144:147], a[156:159], v[140:143], v[144:147]
 v_exp_f32 v153, v153
 v_mfma_f32_16x16x32_bf16 a[92:95], a[200:203], v[64:67], a[92:95]
 v_exp_f32 v154, v154
 v_mfma_f32_16x16x32_bf16 a[92:95], a[204:207], v[68:71], a[92:95]
 v_exp_f32 v155, v155
 v_mfma_f32_16x16x32_bf16 a[140:143], v[212:215], v[72:75], a[140:143]
 v_exp_f32 v156, v156
 v_mfma_f32_16x16x32_bf16 a[140:143], v[212:215], v[76:79], a[140:143]
 v_exp_f32 v157, v157
 v_mfma_f32_16x16x32_bf16 a[136:139], v[212:215], v[64:67], a[136:139]
 v_exp_f32 v158, v158
 v_exp_f32 v159, v159
 v_mfma_f32_16x16x32_bf16 a[136:139], v[212:215], v[68:71], a[136:139]
 ds_read_b128 a[164:167], v4 offset:21504
 v_cvt_pk_bf16_f32 v36, v148, v149
 v_cvt_pk_bf16_f32 v37, v150, v151
 v_cvt_pk_bf16_f32 v46, v152, v153
 v_cvt_pk_bf16_f32 v47, v154, v155
 v_cvt_pk_bf16_f32 v38, v156, v157
 v_cvt_pk_bf16_f32 v39, v158, v159
L_one:
 s_waitcnt lgkmcnt(3)
 v_mfma_f32_16x16x32_bf16 a[96:99], a[176:179], v[40:43], a[96:99]
 s_waitcnt lgkmcnt(2)
 s_add_u32 m0, s69, 147456
 ds_read_b128 a[188:191], v6 offset:3072
 ds_read_b128 a[184:187], v6 offset:2048
L_st0_4:
 s_cbranch_execz L_warmed0
 v_mfma_f32_16x16x32_bf16 a[96:99], a[180:183], v[44:47], a[96:99]
 s_add_u32 s65, s63, 0
 v_exp_f32 v144, v144
 v_mfma_f32_16x16x32_bf16 a[64:67], a[176:179], v[32:35], a[64:67]
 s_nop 0
 ds_read_b128 a[168:171], v4 offset:22528
 ds_read_b128 a[172:175], v4 offset:23552
 v_mfma_f32_16x16x32_bf16 a[64:67], a[180:183], v[36:39], a[64:67]
 s_waitcnt lgkmcnt(2)
 buffer_load_dwordx4 v12, s[32:35], s65 offen offset:0 lds
 v_mfma_f32_16x16x32_bf16 a[100:103], a[184:187], v[40:43], a[100:103]
 s_nop 0
 ds_read_b128 a[192:195], v6 offset:4096
 v_cmp_le_i32 vcc, 16, v249
 v_mfma_f32_16x16x32_bf16 a[100:103], a[188:191], v[44:47], a[100:103]
 buffer_load_dwordx4 v13, s[32:35], s65 offen offset:1024 lds
 v_mfma_f32_16x16x32_bf16 a[68:71], a[184:187], v[32:35], a[68:71]
 ds_read_b128 a[196:199], v6 offset:5120
 v_cmp_le_i32 s[98:99], 17, v249
 v_cmp_le_i32 s[100:101], 18, v249
 v_cndmask_b32 v164, v250, v184, vcc
 v_cmp_le_i32 vcc, 19, v249
 v_cndmask_b32 v165, v250, v184, s[98:99]
 v_cndmask_b32 v166, v250, v184, s[100:101]
 v_cndmask_b32 v167, v250, v184, vcc
 v_mfma_f32_16x16x32_bf16 a[68:71], a[188:191], v[36:39], a[68:71]
 v_exp_f32 v145, v145
 v_mfma_f32_16x16x32_bf16 v[148:151], a[160:163], v[92:95], v[164:167]
 s_nop 0
 ds_read_b128 a[200:203], v6 offset:6144
 ds_read_b128 a[204:207], v6 offset:7168
 v_mfma_f32_16x16x32_bf16 v[148:151], a[164:167], v[124:127], v[148:151]
 s_waitcnt lgkmcnt(3)
 buffer_load_dwordx4 v14, s[32:35], s65 offen offset:2048 lds
 v_mfma_f32_16x16x32_bf16 v[148:151], a[168:171], v[108:111], v[148:151]
 ds_read_b128 a[176:179], v6 offset:8192
 v_cvt_pk_bf16_f32 v72, v144, v145
 v_mfma_f32_16x16x32_bf16 v[148:151], a[172:175], v[140:143], v[148:151]
 v_exp_f32 v146, v146
 v_mfma_f32_16x16x32_bf16 a[104:107], a[192:195], v[40:43], a[104:107]
 s_waitcnt lgkmcnt(3)
 v_exp_f32 v147, v147
 v_mfma_f32_16x16x32_bf16 a[104:107], a[196:199], v[44:47], a[104:107]
 ds_read_b128 a[180:183], v6 offset:9216
 v_cvt_pk_bf16_f32 v73, v146, v147
 v_mfma_f32_16x16x32_bf16 a[72:75], a[192:195], v[32:35], a[72:75]
 global_load_dword v3, v2, s[16:17]
 v_mfma_f32_16x16x32_bf16 a[72:75], a[196:199], v[36:39], a[72:75]
 s_waitcnt lgkmcnt(1)
 ds_read_b128 a[144:147], v4 offset:24576
 ds_read_b128 a[148:151], v4 offset:25600
 v_mfma_f32_16x16x32_bf16 a[108:111], a[200:203], v[40:43], a[108:111]
 buffer_load_dwordx4 v15, s[32:35], s65 offen offset:3072 lds
 v_mfma_f32_16x16x32_bf16 a[108:111], a[204:207], v[44:47], a[108:111]
 s_add_u32 m0, s69, 131072
 ds_read_b128 a[152:155], v4 offset:26624
 ds_read_b128 a[156:159], v4 offset:27648
 v_mfma_f32_16x16x32_bf16 a[76:79], a[200:203], v[32:35], a[76:79]
 s_add_u32 s66, s75, 41451520
 v_exp_f32 v148, v148
 v_mfma_f32_16x16x32_bf16 a[76:79], a[204:207], v[36:39], a[76:79]
 s_nop 0
 ds_read_b128 a[184:187], v6 offset:10240
 ds_read_b128 a[188:191], v6 offset:11264
 v_mfma_f32_16x16x32_bf16 a[112:115], a[176:179], v[40:43], a[112:115]
 s_waitcnt lgkmcnt(4)
 v_cmp_le_i32 vcc, 32, v249
 v_cmp_le_i32 s[98:99], 33, v249
 v_cmp_le_i32 s[100:101], 34, v249
 v_cndmask_b32 v168, v250, v184, vcc
 v_cmp_le_i32 vcc, 35, v249
 v_cndmask_b32 v169, v250, v184, s[98:99]
 v_cndmask_b32 v170, v250, v184, s[100:101]
 v_cndmask_b32 v171, v250, v184, vcc
 v_mfma_f32_16x16x32_bf16 a[112:115], a[180:183], v[44:47], a[112:115]
 buffer_load_dwordx4 v1, s[40:43], s66 offen offset:0 sc1 lds
 v_mfma_f32_16x16x32_bf16 v[152:155], a[144:147], v[92:95], v[168:171]
 s_nop 0
 ds_read_b128 a[192:195], v6 offset:12288
 ds_read_b128 a[196:199], v6 offset:13312
 v_mfma_f32_16x16x32_bf16 v[152:155], a[148:151], v[124:127], v[152:155]
 s_waitcnt lgkmcnt(4)
 buffer_load_dwordx4 v1, s[40:43], s66 offen offset:1024 sc1 lds
 v_mfma_f32_16x16x32_bf16 v[152:155], a[152:155], v[108:111], v[152:155]
 ds_read_b128 a[160:163], v4 offset:28672
 v_exp_f32 v149, v149
 v_mfma_f32_16x16x32_bf16 v[152:155], a[156:159], v[140:143], v[152:155]
 v_exp_f32 v150, v150
 v_mfma_f32_16x16x32_bf16 a[80:83], a[176:179], v[32:35], a[80:83]
 v_exp_f32 v151, v151
 v_mfma_f32_16x16x32_bf16 a[80:83], a[180:183], v[36:39], a[80:83]
 s_waitcnt lgkmcnt(3)
 v_cvt_pk_bf16_f32 v75, v150, v151
 v_cvt_pk_bf16_f32 v74, v148, v149
 v_mfma_f32_16x16x32_bf16 a[116:119], a[184:187], v[40:43], a[116:119]
 s_nop 0
 ds_read_b128 a[164:167], v4 offset:29696
 ds_read_b128 a[168:171], v4 offset:30720
 v_mfma_f32_16x16x32_bf16 a[116:119], a[188:191], v[44:47], a[116:119]
 buffer_load_dwordx4 v1, s[40:43], s66 offen offset:2048 sc1 lds
 v_mfma_f32_16x16x32_bf16 a[84:87], a[184:187], v[32:35], a[84:87]
 s_nop 0
 ds_read_b128 a[172:175], v4 offset:31744
 ds_read_b128 a[200:203], v6 offset:14336
 v_mfma_f32_16x16x32_bf16 a[84:87], a[188:191], v[36:39], a[84:87]
 s_waitcnt lgkmcnt(4)
 buffer_load_dwordx4 v1, s[40:43], s66 offen offset:3072 sc1 lds
 v_mfma_f32_16x16x32_bf16 a[120:123], a[192:195], v[40:43], a[120:123]
 s_add_u32 m0, s69, 81920
 v_cmp_le_i32 vcc, 48, v249
 v_cmp_le_i32 s[98:99], 49, v249
 v_cmp_le_i32 s[100:101], 50, v249
 v_cndmask_b32 v172, v250, v184, vcc
 v_cmp_le_i32 vcc, 51, v249
 v_cndmask_b32 v173, v250, v184, s[98:99]
 v_cndmask_b32 v174, v250, v184, s[100:101]
 v_cndmask_b32 v175, v250, v184, vcc
 v_mfma_f32_16x16x32_bf16 a[120:123], a[196:199], v[44:47], a[120:123]
 s_add_u32 s67, s63, 65536
 ds_read_b128 a[204:207], v6 offset:15360
 v_and_b32 v222, 0x8000, v7
 v_mfma_f32_16x16x32_bf16 v[156:159], a[160:163], v[92:95], v[172:175]
 s_waitcnt lgkmcnt(3)
 v_exp_f32 v152, v152
 v_mfma_f32_16x16x32_bf16 v[156:159], a[164:167], v[124:127], v[156:159]
 v_exp_f32 v153, v153
 v_mfma_f32_16x16x32_bf16 v[156:159], a[168:171], v[108:111], v[156:159]
 s_waitcnt vmcnt(11) lgkmcnt(1)
 v_exp_f32 v154, v154
 v_mfma_f32_16x16x32_bf16 v[156:159], a[172:175], v[140:143], v[156:159]
 s_barrier
 v_lshl_add_u32 v220, s60, 2, v222
 v_mfma_f32_16x16x32_bf16 a[88:91], a[192:195], v[32:35], a[88:91]
 ds_write_b32 v220, v208
 ds_read_b128 a[176:179], v6 offset:16384
 v_mfma_f32_16x16x32_bf16 a[88:91], a[196:199], v[36:39], a[88:91]
 buffer_load_dwordx4 v12, s[32:35], s67 offen offset:0 lds
 v_mfma_f32_16x16x32_bf16 a[124:127], a[200:203], v[40:43], a[124:127]
 s_waitcnt lgkmcnt(2)
 v_exp_f32 v155, v155
 v_mfma_f32_16x16x32_bf16 a[124:127], a[204:207], v[44:47], a[124:127]
 v_cvt_pk_bf16_f32 v77, v154, v155
 v_cvt_pk_bf16_f32 v76, v152, v153
 v_mfma_f32_16x16x32_bf16 a[92:95], a[200:203], v[32:35], a[92:95]
 buffer_load_dwordx4 v13, s[32:35], s67 offen offset:1024 lds
 ds_read_b128 a[180:183], v6 offset:17408
 v_mfma_f32_16x16x32_bf16 a[92:95], a[204:207], v[36:39], a[92:95]
 buffer_load_dwordx4 v14, s[32:35], s67 offen offset:2048 lds
 v_mfma_f32_16x16x32_bf16 a[140:143], v[212:215], v[40:43], a[140:143]
 v_exp_f32 v156, v156
 v_mfma_f32_16x16x32_bf16 a[140:143], v[212:215], v[44:47], a[140:143]
 buffer_load_dwordx4 v15, s[32:35], s67 offen offset:3072 lds
 v_mfma_f32_16x16x32_bf16 a[136:139], v[212:215], v[32:35], a[136:139]
 v_exp_f32 v157, v157
 v_exp_f32 v158, v158
 v_exp_f32 v159, v159
 v_mfma_f32_16x16x32_bf16 a[136:139], v[212:215], v[36:39], a[136:139]
 v_cvt_pk_bf16_f32 v78, v156, v157
 v_cvt_pk_bf16_f32 v79, v158, v159
 s_nop 1
 v_mfma_f32_16x16x32_bf16 a[140:143], v[212:215], v[72:75], a[140:143]
 s_add_u32 m0, s69, 65536
 ds_read_b128 a[184:187], v6 offset:18432
 ds_read_b128 a[188:191], v6 offset:19456
 ds_read_b128 a[192:195], v6 offset:20480
 ds_read_b128 a[196:199], v6 offset:21504
 v_mfma_f32_16x16x32_bf16 a[140:143], v[212:215], v[76:79], a[140:143]
 s_waitcnt lgkmcnt(4)
 s_add_u32 s68, s75, 41459712
 ds_read_b128 a[200:203], v6 offset:22528
 ds_read_b128 a[204:207], v6 offset:23552
 v_mfma_f32_16x16x32_bf16 a[96:99], a[176:179], v[72:75], a[96:99]
 buffer_load_dwordx4 v1, s[40:43], s68 offen offset:0 sc1 lds
 v_mfma_f32_16x16x32_bf16 a[96:99], a[180:183], v[76:79], a[96:99]
 s_waitcnt lgkmcnt(5)
 ds_read_b128 a[176:179], v6 offset:24576
 ds_read_b128 a[180:183], v6 offset:25600
 v_mfma_f32_16x16x32_bf16 a[100:103], a[184:187], v[72:75], a[100:103]
 s_waitcnt lgkmcnt(6)
 v_mfma_f32_16x16x32_bf16 a[100:103], a[188:191], v[76:79], a[100:103]
 s_waitcnt lgkmcnt(4)
 ds_read_b128 a[184:187], v6 offset:26624
 ds_read_b128 a[188:191], v6 offset:27648
 v_mfma_f32_16x16x32_bf16 a[104:107], a[192:195], v[72:75], a[104:107]
 buffer_load_dwordx4 v1, s[40:43], s68 offen offset:1024 sc1 lds
 v_mfma_f32_16x16x32_bf16 a[104:107], a[196:199], v[76:79], a[104:107]
 s_waitcnt lgkmcnt(4)
 ds_read_b128 a[192:195], v6 offset:28672
 ds_read_b128 a[196:199], v6 offset:29696
 v_mfma_f32_16x16x32_bf16 a[108:111], a[200:203], v[72:75], a[108:111]
 v_mfma_f32_16x16x32_bf16 a[108:111], a[204:207], v[76:79], a[108:111]
 s_waitcnt lgkmcnt(4)
 ds_read_b128 a[200:203], v6 offset:30720
 ds_read_b128 a[204:207], v6 offset:31744
 v_mfma_f32_16x16x32_bf16 a[112:115], a[176:179], v[72:75], a[112:115]
 buffer_load_dwordx4 v1, s[40:43], s68 offen offset:2048 sc1 lds
 v_mfma_f32_16x16x32_bf16 a[112:115], a[180:183], v[76:79], a[112:115]
 s_waitcnt lgkmcnt(4)
 v_mfma_f32_16x16x32_bf16 a[116:119], a[184:187], v[72:75], a[116:119]
 v_mfma_f32_16x16x32_bf16 a[116:119], a[188:191], v[76:79], a[116:119]
 s_waitcnt lgkmcnt(2)
 v_mfma_f32_16x16x32_bf16 a[120:123], a[192:195], v[72:75], a[120:123]
 buffer_load_dwordx4 v1, s[40:43], s68 offen offset:3072 sc1 lds
 v_mfma_f32_16x16x32_bf16 a[120:123], a[196:199], v[76:79], a[120:123]
 s_waitcnt lgkmcnt(0)
 v_mfma_f32_16x16x32_bf16 a[124:127], a[200:203], v[72:75], a[124:127]
 v_mfma_f32_16x16x32_bf16 a[124:127], a[204:207], v[76:79], a[124:127]
 v_accvgpr_read_b32 v216, a136
 v_accvgpr_read_b32 v218, a140
 v_add_f32 v219, v216, v218
 v_rcp_f32 v216, v216
 v_cmp_ngt_f32 vcc, 0x5f800000, v219
 v_rcp_f32 v218, v218
 s_or_b64 s[88:89], s[88:89], vcc
 s_cmp_lg_u64 s[88:89], 0
 s_cbranch_scc1 L_setbad
L_setbad_back:
 s_waitcnt lgkmcnt(0)
 s_barrier
 ds_read_b128 v[200:203], v222
 s_mul_i32 s86, s61, 17408
 s_add_u32 s85, s86, s79
 v_accvgpr_read_b32 v220, a64
 v_accvgpr_read_b32 v221, a65
 v_accvgpr_read_b32 v222, a66
 v_accvgpr_read_b32 v223, a67
 v_accvgpr_read_b32 v224, a68
 v_accvgpr_read_b32 v225, a69
 v_accvgpr_read_b32 v226, a70
 v_accvgpr_read_b32 v227, a71
 v_pk_mul_f32 v[220:221], v[220:221], v[216:217] op_sel_hi:[1,0]
 v_pk_mul_f32 v[222:223], v[222:223], v[216:217] op_sel_hi:[1,0]
 v_pk_mul_f32 v[224:225], v[224:225], v[216:217] op_sel_hi:[1,0]
 v_pk_mul_f32 v[226:227], v[226:227], v[216:217] op_sel_hi:[1,0]
 v_cvt_pk_bf16_f32 v228, v220, v221
 v_cvt_pk_bf16_f32 v229, v222, v223
 v_cvt_pk_bf16_f32 v230, v224, v225
 v_cvt_pk_bf16_f32 v231, v226, v227
 buffer_store_dwordx4 v[228:231], v1, s[40:43], s85 offen sc1
 s_waitcnt lgkmcnt(0)
 v_or3_b32 v200, v200, v201, v202
 v_or_b32 v200, v200, v203
 v_cmp_ne_u32 vcc, 0, v200
 s_nop 1
 s_cbranch_vccnz L_fallback
 s_add_u32 s85, s85, 4096
 v_accvgpr_read_b32 v220, a72
 v_accvgpr_read_b32 v221, a73
 v_accvgpr_read_b32 v222, a74
 v_accvgpr_read_b32 v223, a75
 v_accvgpr_read_b32 v224, a76
 v_accvgpr_read_b32 v225, a77
 v_accvgpr_read_b32 v226, a78
 v_accvgpr_read_b32 v227, a79
 v_pk_mul_f32 v[220:221], v[220:221], v[216:217] op_sel_hi:[1,0]
 v_pk_mul_f32 v[222:223], v[222:223], v[216:217] op_sel_hi:[1,0]
 v_pk_mul_f32 v[224:225], v[224:225], v[216:217] op_sel_hi:[1,0]
 v_pk_mul_f32 v[226:227], v[226:227], v[216:217] op_sel_hi:[1,0]
 v_cvt_pk_bf16_f32 v232, v220, v221
 v_cvt_pk_bf16_f32 v233, v222, v223
 v_cvt_pk_bf16_f32 v234, v224, v225
 v_cvt_pk_bf16_f32 v235, v226, v227
 buffer_store_dwordx4 v[232:235], v1, s[40:43], s85 offen sc1
 s_add_u32 m0, s69, 114688
 s_add_u32 s65, s63, 131072
 buffer_load_dwordx4 v12, s[32:35], s65 offen offset:0 lds
 s_add_u32 s85, s85, 4096
 v_accvgpr_read_b32 v220, a80
 v_accvgpr_read_b32 v221, a81
 v_accvgpr_read_b32 v222, a82
 v_accvgpr_read_b32 v223, a83
 v_accvgpr_read_b32 v224, a84
 v_accvgpr_read_b32 v225, a85
 v_accvgpr_read_b32 v226, a86
 v_accvgpr_read_b32 v227, a87
 v_pk_mul_f32 v[220:221], v[220:221], v[216:217] op_sel_hi:[1,0]
 v_pk_mul_f32 v[222:223], v[222:223], v[216:217] op_sel_hi:[1,0]
 v_pk_mul_f32 v[224:225], v[224:225], v[216:217] op_sel_hi:[1,0]
 v_pk_mul_f32 v[226:227], v[226:227], v[216:217] op_sel_hi:[1,0]
 v_cvt_pk_bf16_f32 v236, v220, v221
 v_cvt_pk_bf16_f32 v237, v222, v223
 v_cvt_pk_bf16_f32 v238, v224, v225
 v_cvt_pk_bf16_f32 v239, v226, v227
 buffer_store_dwordx4 v[236:239], v1, s[40:43], s85 offen sc1
 buffer_load_dwordx4 v13, s[32:35], s65 offen offset:1024 lds
 s_add_u32 s85, s85, 4096
 v_accvgpr_read_b32 v220, a88
 v_accvgpr_read_b32 v221, a89
 v_accvgpr_read_b32 v222, a90
 v_accvgpr_read_b32 v223, a91
 v_accvgpr_read_b32 v224, a92
 v_accvgpr_read_b32 v225, a93
 v_accvgpr_read_b32 v226, a94
 v_accvgpr_read_b32 v227, a95
 v_pk_mul_f32 v[220:221], v[220:221], v[216:217] op_sel_hi:[1,0]
 v_pk_mul_f32 v[222:223], v[222:223], v[216:217] op_sel_hi:[1,0]
 v_pk_mul_f32 v[224:225], v[224:225], v[216:217] op_sel_hi:[1,0]
 v_pk_mul_f32 v[226:227], v[226:227], v[216:217] op_sel_hi:[1,0]
 v_cvt_pk_bf16_f32 v228, v220, v221
 v_cvt_pk_bf16_f32 v229, v222, v223
 v_cvt_pk_bf16_f32 v230, v224, v225
 v_cvt_pk_bf16_f32 v231, v226, v227
 buffer_store_dwordx4 v[228:231], v1, s[40:43], s85 offen sc1
 buffer_load_dwordx4 v14, s[32:35], s65 offen offset:2048 lds
 s_add_u32 s85, s86, s80
 v_accvgpr_read_b32 v220, a96
 v_accvgpr_read_b32 v221, a97
 v_accvgpr_read_b32 v222, a98
 v_accvgpr_read_b32 v223, a99
 v_accvgpr_read_b32 v224, a100
 v_accvgpr_read_b32 v225, a101
 v_accvgpr_read_b32 v226, a102
 v_accvgpr_read_b32 v227, a103
 v_pk_mul_f32 v[220:221], v[220:221], v[218:219] op_sel_hi:[1,0]
 v_pk_mul_f32 v[222:223], v[222:223], v[218:219] op_sel_hi:[1,0]
 v_pk_mul_f32 v[224:225], v[224:225], v[218:219] op_sel_hi:[1,0]
 v_pk_mul_f32 v[226:227], v[226:227], v[218:219] op_sel_hi:[1,0]
 v_cvt_pk_bf16_f32 v232, v220, v221
 v_cvt_pk_bf16_f32 v233, v222, v223
 v_cvt_pk_bf16_f32 v234, v224, v225
 v_cvt_pk_bf16_f32 v235, v226, v227
 buffer_store_dwordx4 v[232:235], v1, s[40:43], s85 offen sc1
 buffer_load_dwordx4 v15, s[32:35], s65 offen offset:3072 lds
 s_add_u32 s85, s85, 4096
 v_accvgpr_read_b32 v220, a104
 v_accvgpr_read_b32 v221, a105
 v_accvgpr_read_b32 v222, a106
 v_accvgpr_read_b32 v223, a107
 v_accvgpr_read_b32 v224, a108
 v_accvgpr_read_b32 v225, a109
 v_accvgpr_read_b32 v226, a110
 v_accvgpr_read_b32 v227, a111
 v_pk_mul_f32 v[220:221], v[220:221], v[218:219] op_sel_hi:[1,0]
 v_pk_mul_f32 v[222:223], v[222:223], v[218:219] op_sel_hi:[1,0]
 v_pk_mul_f32 v[224:225], v[224:225], v[218:219] op_sel_hi:[1,0]
 v_pk_mul_f32 v[226:227], v[226:227], v[218:219] op_sel_hi:[1,0]
 v_cvt_pk_bf16_f32 v236, v220, v221
 v_cvt_pk_bf16_f32 v237, v222, v223
 v_cvt_pk_bf16_f32 v238, v224, v225
 v_cvt_pk_bf16_f32 v239, v226, v227
 buffer_store_dwordx4 v[236:239], v1, s[40:43], s85 offen sc1
 s_add_u32 m0, s69, 98304
 s_add_u32 s66, s75, 41467904
 buffer_load_dwordx4 v1, s[40:43], s66 offen offset:0 sc1 lds
 s_add_u32 s85, s85, 4096
 v_accvgpr_read_b32 v220, a112
 v_accvgpr_read_b32 v221, a113
 v_accvgpr_read_b32 v222, a114
 v_accvgpr_read_b32 v223, a115
 v_accvgpr_read_b32 v224, a116
 v_accvgpr_read_b32 v225, a117
 v_accvgpr_read_b32 v226, a118
 v_accvgpr_read_b32 v227, a119
 v_pk_mul_f32 v[220:221], v[220:221], v[218:219] op_sel_hi:[1,0]
 v_pk_mul_f32 v[222:223], v[222:223], v[218:219] op_sel_hi:[1,0]
 v_pk_mul_f32 v[224:225], v[224:225], v[218:219] op_sel_hi:[1,0]
 v_pk_mul_f32 v[226:227], v[226:227], v[218:219] op_sel_hi:[1,0]
 v_cvt_pk_bf16_f32 v228, v220, v221
 v_cvt_pk_bf16_f32 v229, v222, v223
 v_cvt_pk_bf16_f32 v230, v224, v225
 v_cvt_pk_bf16_f32 v231, v226, v227
 buffer_store_dwordx4 v[228:231], v1, s[40:43], s85 offen sc1
 buffer_load_dwordx4 v1, s[40:43], s66 offen offset:1024 sc1 lds
 s_add_u32 s85, s85, 4096
 v_accvgpr_read_b32 v220, a120
 v_accvgpr_read_b32 v221, a121
 v_accvgpr_read_b32 v222, a122
 v_accvgpr_read_b32 v223, a123
 v_accvgpr_read_b32 v224, a124
 v_accvgpr_read_b32 v225, a125
 v_accvgpr_read_b32 v226, a126
 v_accvgpr_read_b32 v227, a127
 v_pk_mul_f32 v[220:221], v[220:221], v[218:219] op_sel_hi:[1,0]
 v_pk_mul_f32 v[222:223], v[222:223], v[218:219] op_sel_hi:[1,0]
 v_pk_mul_f32 v[224:225], v[224:225], v[218:219] op_sel_hi:[1,0]
 v_pk_mul_f32 v[226:227], v[226:227], v[218:219] op_sel_hi:[1,0]
 v_cvt_pk_bf16_f32 v232, v220, v221
 v_cvt_pk_bf16_f32 v233, v222, v223
 v_cvt_pk_bf16_f32 v234, v224, v225
 v_cvt_pk_bf16_f32 v235, v226, v227
 buffer_store_dwordx4 v[232:235], v1, s[40:43], s85 offen sc1
 buffer_load_dwordx4 v1, s[40:43], s66 offen offset:2048 sc1 lds
 v_lshl_add_u32 v196, s2, 10, v1
 v_lshrrev_b32 v197, 1, s60
 v_lshlrev_b32 v197, 12, v197
 v_add_u32 v240, 0, v196
 v_and_b32 v240, 0xfff, v240
 v_add_u32 v240, v240, v197
 v_add_u32 v244, 0x10000, v240
 v_add_u32 v236, 0x20000, v240
 v_add_u32 v241, 1024, v196
 v_and_b32 v241, 0xfff, v241
 v_add_u32 v241, v241, v197
 v_add_u32 v245, 0x10000, v241
 v_add_u32 v237, 0x20000, v241
 v_add_u32 v242, 2048, v196
 v_and_b32 v242, 0xfff, v242
 v_add_u32 v242, v242, v197
 v_add_u32 v246, 0x10000, v242
 v_add_u32 v238, 0x20000, v242
 v_add_u32 v243, 3072, v196
 v_and_b32 v243, 0xfff, v243
 v_add_u32 v243, v243, v197
 v_add_u32 v247, 0x10000, v243
 v_add_u32 v239, 0x20000, v243
 v_add_u32 v4, 65536, v8
 v_add_u32 v232, 131072, v8
 v_add_u32 v5, 65536, v9
 v_add_u32 v233, 131072, v9
L_st0_5:
 s_cbranch_execz L_warmed0
 v_add_u32 v6, 65536, v10
 v_add_u32 v234, 131072, v10
 v_add_u32 v7, 65536, v11
 v_add_u32 v235, 131072, v11
 v_bfe_u32 v254, v1, 2, 5
 v_bfe_u32 v255, v1, 4, 4
 v_lshlrev_b32 v255, 10, v255
 v_lshrrev_b32 v252, 8, v1
 v_lshl_add_u32 v255, v252, 3, v255
 s_waitcnt vmcnt(23)
 s_barrier
 ds_read_b128 v[24:27], v237 offset:0
 ds_read_b128 v[28:31], v237 offset:8192
 ds_read_b64_tr_b16 v[80:81], v232 offset:0
 buffer_load_dwordx4 v1, s[40:43], s66 offen offset:3072 sc1 lds
 ds_read_b64_tr_b16 v[82:83], v232 offset:2048
 ds_read_b64_tr_b16 v[84:85], v232 offset:8192
 ds_read_b64_tr_b16 v[86:87], v232 offset:10240
 s_add_u32 m0, s69, 16384
 s_add_u32 s67, s63, 196608
 buffer_load_dwordx4 v12, s[32:35], s67 offen offset:0 lds
 ds_read_b64_tr_b16 v[88:89], v233 offset:0
 ds_read_b64_tr_b16 v[90:91], v233 offset:2048
 ds_read_b64_tr_b16 v[92:93], v233 offset:8192
 buffer_load_dwordx4 v13, s[32:35], s67 offen offset:1024 lds
 ds_read_b64_tr_b16 v[94:95], v233 offset:10240
 ds_read_b64_tr_b16 v[96:97], v234 offset:0
 ds_read_b64_tr_b16 v[98:99], v234 offset:2048
 buffer_load_dwordx4 v14, s[32:35], s67 offen offset:2048 lds
 ds_read_b64_tr_b16 v[100:101], v234 offset:8192
 ds_read_b64_tr_b16 v[102:103], v234 offset:10240
 ds_read_b64_tr_b16 v[104:105], v235 offset:0
 buffer_load_dwordx4 v15, s[32:35], s67 offen offset:3072 lds
 ds_read_b64_tr_b16 v[106:107], v235 offset:2048
 ds_read_b64_tr_b16 v[108:109], v235 offset:8192
 ds_read_b64_tr_b16 v[110:111], v235 offset:10240
 ds_read_b128 v[32:35], v238 offset:0
 ds_read_b128 v[36:39], v238 offset:8192
 ds_read_b128 v[40:43], v239 offset:0
 ds_read_b128 v[44:47], v239 offset:8192
 ds_read_b128 v[16:19], v236 offset:0
 ds_read_b128 v[20:23], v236 offset:8192
 s_mov_b64 exec, 0
 s_cmp_eq_u32 s60, 0
 s_cbranch_scc1 L_w1_0
 s_cmp_eq_u32 s60, 1
 s_cbranch_scc1 L_w1_1
 s_cmp_eq_u32 s60, 2
 s_cbranch_scc1 L_w1_2
 s_branch L_w1_3
L_warmed1:
 s_mov_b64 exec, -1
 s_waitcnt vmcnt(6) lgkmcnt(0)
 s_barrier
 v_mfma_f32_16x16x32_bf16 v[160:163], v[80:83], v[24:27], 0
 ds_read_b128 v[56:59], v245 offset:0
 v_mfma_f32_16x16x32_bf16 v[160:163], v[84:87], v[28:31], v[160:163]
 ds_read_b128 v[60:63], v245 offset:8192
 v_mfma_f32_16x16x32_bf16 v[164:167], v[88:91], v[24:27], 0
 buffer_store_dword v253, v0, s[40:43], s83 offen sc1
 s_add_u32 m0, s69, 0
 v_mfma_f32_16x16x32_bf16 v[164:167], v[92:95], v[28:31], v[164:167]
 s_add_u32 s68, s75, 41476096
 ds_read_b64_tr_b16 v[112:113], v4 offset:0
 v_mfma_f32_16x16x32_bf16 v[168:171], v[96:99], v[24:27], 0
 ds_read_b64_tr_b16 v[114:115], v4 offset:2048
 v_mfma_f32_16x16x32_bf16 v[168:171], v[100:103], v[28:31], v[168:171]
 ds_read_b64_tr_b16 v[116:117], v4 offset:8192
 v_mfma_f32_16x16x32_bf16 v[172:175], v[104:107], v[24:27], 0
 buffer_load_dwordx4 v1, s[40:43], s68 offen offset:0 sc1 lds
 v_mfma_f32_16x16x32_bf16 v[172:175], v[108:111], v[28:31], v[172:175]
 ds_read_b64_tr_b16 v[118:119], v4 offset:10240
 v_mfma_f32_16x16x32_bf16 v[176:179], v[80:83], v[32:35], 0
 ds_read_b64_tr_b16 v[120:121], v5 offset:0
 v_mfma_f32_16x16x32_bf16 v[176:179], v[84:87], v[36:39], v[176:179]
 ds_read_b64_tr_b16 v[122:123], v5 offset:2048
 v_mfma_f32_16x16x32_bf16 v[180:183], v[88:91], v[32:35], 0
 buffer_load_dwordx4 v1, s[40:43], s68 offen offset:1024 sc1 lds
 v_mfma_f32_16x16x32_bf16 v[180:183], v[92:95], v[36:39], v[180:183]
 ds_read_b64_tr_b16 v[124:125], v5 offset:8192
 v_mfma_f32_16x16x32_bf16 v[184:187], v[96:99], v[32:35], 0
 ds_read_b64_tr_b16 v[126:127], v5 offset:10240
 v_mfma_f32_16x16x32_bf16 v[184:187], v[100:103], v[36:39], v[184:187]
 ds_read_b64_tr_b16 v[128:129], v6 offset:0
 v_mfma_f32_16x16x32_bf16 v[188:191], v[104:107], v[32:35], 0
 buffer_load_dwordx4 v1, s[40:43], s68 offen offset:2048 sc1 lds
 v_mfma_f32_16x16x32_bf16 v[188:191], v[108:111], v[36:39], v[188:191]
 ds_read_b64_tr_b16 v[130:131], v6 offset:2048
 v_mfma_f32_16x16x32_bf16 v[192:195], v[80:83], v[40:43], 0
 ds_read_b64_tr_b16 v[132:133], v6 offset:8192
 v_mfma_f32_16x16x32_bf16 v[192:195], v[84:87], v[44:47], v[192:195]
 ds_read_b64_tr_b16 v[134:135], v6 offset:10240
 v_mfma_f32_16x16x32_bf16 v[196:199], v[88:91], v[40:43], 0
 buffer_load_dwordx4 v1, s[40:43], s68 offen offset:3072 sc1 lds
 v_mfma_f32_16x16x32_bf16 v[196:199], v[92:95], v[44:47], v[196:199]
 s_add_u32 m0, s69, 49152
 ds_read_b64_tr_b16 v[136:137], v7 offset:0
 s_add_u32 s65, s63, 262144
 v_mfma_f32_16x16x32_bf16 v[200:203], v[96:99], v[40:43], 0
 ds_read_b64_tr_b16 v[138:139], v7 offset:2048
 v_mfma_f32_16x16x32_bf16 v[200:203], v[100:103], v[44:47], v[200:203]
 ds_read_b64_tr_b16 v[140:141], v7 offset:8192
 v_mfma_f32_16x16x32_bf16 v[204:207], v[104:107], v[40:43], 0
 buffer_load_dwordx4 v12, s[32:35], s65 offen offset:0 lds
 v_mfma_f32_16x16x32_bf16 v[204:207], v[108:111], v[44:47], v[204:207]
 ds_read_b64_tr_b16 v[142:143], v7 offset:10240
 v_mfma_f32_16x16x32_bf16 v[144:147], v[80:83], v[16:19], 0
 ds_read_b128 v[64:67], v246 offset:0
 v_mfma_f32_16x16x32_bf16 v[144:147], v[84:87], v[20:23], v[144:147]
 ds_read_b128 v[68:71], v246 offset:8192
 v_mfma_f32_16x16x32_bf16 v[148:151], v[88:91], v[16:19], 0
 buffer_load_dwordx4 v13, s[32:35], s65 offen offset:1024 lds
 v_mfma_f32_16x16x32_bf16 v[148:151], v[92:95], v[20:23], v[148:151]
 ds_read_b128 v[72:75], v247 offset:0
 v_mfma_f32_16x16x32_bf16 v[152:155], v[96:99], v[16:19], 0
 ds_read_b128 v[76:79], v247 offset:8192
 v_mfma_f32_16x16x32_bf16 v[152:155], v[100:103], v[20:23], v[152:155]
 s_waitcnt vmcnt(11) lgkmcnt(3)
 ds_read_b128 v[48:51], v244 offset:0
 v_mfma_f32_16x16x32_bf16 v[156:159], v[104:107], v[16:19], 0
 buffer_load_dwordx4 v14, s[32:35], s65 offen offset:2048 lds
 buffer_load_dwordx4 v15, s[32:35], s65 offen offset:3072 lds
 v_mfma_f32_16x16x32_bf16 v[156:159], v[108:111], v[20:23], v[156:159]
 ds_read_b128 v[52:55], v244 offset:8192
 s_barrier
 v_mfma_f32_16x16x32_bf16 v[160:163], v[112:115], v[56:59], v[160:163]
 s_add_u32 m0, s69, 32768
 ds_read_b128 v[24:27], v245 offset:32768
 s_add_u32 s66, s75, 41484288
 v_mfma_f32_16x16x32_bf16 v[160:163], v[116:119], v[60:63], v[160:163]
 ds_read_b128 v[28:31], v245 offset:40960
 v_mfma_f32_16x16x32_bf16 v[164:167], v[120:123], v[56:59], v[164:167]
 buffer_load_dwordx4 v1, s[40:43], s66 offen offset:0 sc1 lds
 v_mfma_f32_16x16x32_bf16 v[164:167], v[124:127], v[60:63], v[164:167]
 ds_read_b64_tr_b16 v[80:81], v4 offset:32768
 v_mfma_f32_16x16x32_bf16 v[168:171], v[128:131], v[56:59], v[168:171]
 ds_read_b64_tr_b16 v[82:83], v4 offset:34816
 v_mfma_f32_16x16x32_bf16 v[168:171], v[132:135], v[60:63], v[168:171]
 ds_read_b64_tr_b16 v[84:85], v4 offset:40960
 v_mfma_f32_16x16x32_bf16 v[172:175], v[136:139], v[56:59], v[172:175]
 buffer_load_dwordx4 v1, s[40:43], s66 offen offset:1024 sc1 lds
 v_mfma_f32_16x16x32_bf16 v[172:175], v[140:143], v[60:63], v[172:175]
 ds_read_b64_tr_b16 v[86:87], v4 offset:43008
 v_mfma_f32_16x16x32_bf16 v[176:179], v[112:115], v[64:67], v[176:179]
 s_waitcnt lgkmcnt(6)
 ds_read_b64_tr_b16 v[88:89], v5 offset:32768
 v_mfma_f32_16x16x32_bf16 v[176:179], v[116:119], v[68:71], v[176:179]
 ds_read_b64_tr_b16 v[90:91], v5 offset:34816
 v_mfma_f32_16x16x32_bf16 v[180:183], v[120:123], v[64:67], v[180:183]
 buffer_load_dwordx4 v1, s[40:43], s66 offen offset:2048 sc1 lds
 v_mfma_f32_16x16x32_bf16 v[180:183], v[124:127], v[68:71], v[180:183]
 ds_read_b64_tr_b16 v[92:93], v5 offset:40960
 v_mfma_f32_16x16x32_bf16 v[184:187], v[128:131], v[64:67], v[184:187]
 ds_read_b64_tr_b16 v[94:95], v5 offset:43008
 v_mfma_f32_16x16x32_bf16 v[184:187], v[132:135], v[68:71], v[184:187]
 ds_read_b64_tr_b16 v[96:97], v6 offset:32768
 v_mfma_f32_16x16x32_bf16 v[188:191], v[136:139], v[64:67], v[188:191]
 buffer_load_dwordx4 v1, s[40:43], s66 offen offset:3072 sc1 lds
 v_mfma_f32_16x16x32_bf16 v[188:191], v[140:143], v[68:71], v[188:191]
 s_add_u32 m0, s69, 147456
 ds_read_b64_tr_b16 v[98:99], v6 offset:34816
 s_add_u32 s67, s63, 327680
 v_mfma_f32_16x16x32_bf16 v[192:195], v[112:115], v[72:75], v[192:195]
 ds_read_b64_tr_b16 v[100:101], v6 offset:40960
 v_mfma_f32_16x16x32_bf16 v[192:195], v[116:119], v[76:79], v[192:195]
 ds_read_b64_tr_b16 v[102:103], v6 offset:43008
 v_mfma_f32_16x16x32_bf16 v[196:199], v[120:123], v[72:75], v[196:199]
 buffer_load_dwordx4 v12, s[32:35], s67 offen offset:0 lds
 v_mfma_f32_16x16x32_bf16 v[196:199], v[124:127], v[76:79], v[196:199]
 ds_read_b64_tr_b16 v[104:105], v7 offset:32768
 v_mfma_f32_16x16x32_bf16 v[200:203], v[128:131], v[72:75], v[200:203]
 ds_read_b64_tr_b16 v[106:107], v7 offset:34816
 v_mfma_f32_16x16x32_bf16 v[200:203], v[132:135], v[76:79], v[200:203]
 ds_read_b64_tr_b16 v[108:109], v7 offset:40960
 v_mfma_f32_16x16x32_bf16 v[204:207], v[136:139], v[72:75], v[204:207]
 buffer_load_dwordx4 v13, s[32:35], s67 offen offset:1024 lds
 v_mfma_f32_16x16x32_bf16 v[204:207], v[140:143], v[76:79], v[204:207]
 ds_read_b64_tr_b16 v[110:111], v7 offset:43008
 v_mfma_f32_16x16x32_bf16 v[144:147], v[112:115], v[48:51], v[144:147]
 ds_read_b128 v[32:35], v246 offset:32768
 v_mfma_f32_16x16x32_bf16 v[144:147], v[116:119], v[52:55], v[144:147]
 ds_read_b128 v[36:39], v246 offset:40960
 v_mfma_f32_16x16x32_bf16 v[148:151], v[120:123], v[48:51], v[148:151]
 buffer_load_dwordx4 v14, s[32:35], s67 offen offset:2048 lds
 v_mfma_f32_16x16x32_bf16 v[148:151], v[124:127], v[52:55], v[148:151]
 ds_read_b128 v[40:43], v247 offset:32768
 v_mfma_f32_16x16x32_bf16 v[152:155], v[128:131], v[48:51], v[152:155]
 ds_read_b128 v[44:47], v247 offset:40960
 v_mfma_f32_16x16x32_bf16 v[152:155], v[132:135], v[52:55], v[152:155]
 s_waitcnt vmcnt(11) lgkmcnt(3)
 ds_read_b128 v[16:19], v244 offset:32768
 v_mfma_f32_16x16x32_bf16 v[156:159], v[136:139], v[48:51], v[156:159]
 buffer_load_dwordx4 v15, s[32:35], s67 offen offset:3072 lds
 v_mfma_f32_16x16x32_bf16 v[156:159], v[140:143], v[52:55], v[156:159]
 ds_read_b128 v[20:23], v244 offset:40960
 s_barrier
 v_mfma_f32_16x16x32_bf16 v[160:163], v[80:83], v[24:27], v[160:163]
 s_add_u32 m0, s69, 131072
 ds_read_b128 v[56:59], v241 offset:0
 s_add_u32 s68, s75, 41492480
 v_mfma_f32_16x16x32_bf16 v[160:163], v[84:87], v[28:31], v[160:163]
 ds_read_b128 v[60:63], v241 offset:8192
 v_mfma_f32_16x16x32_bf16 v[164:167], v[88:91], v[24:27], v[164:167]
 buffer_load_dwordx4 v1, s[40:43], s68 offen offset:0 sc1 lds
 v_mfma_f32_16x16x32_bf16 v[164:167], v[92:95], v[28:31], v[164:167]
 ds_read_b64_tr_b16 v[112:113], v8 offset:0
 v_mfma_f32_16x16x32_bf16 v[168:171], v[96:99], v[24:27], v[168:171]
 ds_read_b64_tr_b16 v[114:115], v8 offset:2048
 v_mfma_f32_16x16x32_bf16 v[168:171], v[100:103], v[28:31], v[168:171]
 ds_read_b64_tr_b16 v[116:117], v8 offset:8192
 v_mfma_f32_16x16x32_bf16 v[172:175], v[104:107], v[24:27], v[172:175]
 buffer_load_dwordx4 v1, s[40:43], s68 offen offset:1024 sc1 lds
 v_mfma_f32_16x16x32_bf16 v[172:175], v[108:111], v[28:31], v[172:175]
 ds_read_b64_tr_b16 v[118:119], v8 offset:10240
 v_mfma_f32_16x16x32_bf16 v[176:179], v[80:83], v[32:35], v[176:179]
 s_waitcnt lgkmcnt(6)
 ds_read_b64_tr_b16 v[120:121], v9 offset:0
 v_mfma_f32_16x16x32_bf16 v[176:179], v[84:87], v[36:39], v[176:179]
 ds_read_b64_tr_b16 v[122:123], v9 offset:2048
 v_mfma_f32_16x16x32_bf16 v[180:183], v[88:91], v[32:35], v[180:183]
 buffer_load_dwordx4 v1, s[40:43], s68 offen offset:2048 sc1 lds
 v_mfma_f32_16x16x32_bf16 v[180:183], v[92:95], v[36:39], v[180:183]
 ds_read_b64_tr_b16 v[124:125], v9 offset:8192
 v_mfma_f32_16x16x32_bf16 v[184:187], v[96:99], v[32:35], v[184:187]
 ds_read_b64_tr_b16 v[126:127], v9 offset:10240
 v_mfma_f32_16x16x32_bf16 v[184:187], v[100:103], v[36:39], v[184:187]
 ds_read_b64_tr_b16 v[128:129], v10 offset:0
 v_mfma_f32_16x16x32_bf16 v[188:191], v[104:107], v[32:35], v[188:191]
 buffer_load_dwordx4 v1, s[40:43], s68 offen offset:3072 sc1 lds
 v_mfma_f32_16x16x32_bf16 v[188:191], v[108:111], v[36:39], v[188:191]
 s_add_u32 m0, s69, 81920
 ds_read_b64_tr_b16 v[130:131], v10 offset:2048
 s_add_u32 s65, s63, 393216
 v_mfma_f32_16x16x32_bf16 v[192:195], v[80:83], v[40:43], v[192:195]
 ds_read_b64_tr_b16 v[132:133], v10 offset:8192
 v_mfma_f32_16x16x32_bf16 v[192:195], v[84:87], v[44:47], v[192:195]
 ds_read_b64_tr_b16 v[134:135], v10 offset:10240
 v_mfma_f32_16x16x32_bf16 v[196:199], v[88:91], v[40:43], v[196:199]
 buffer_load_dwordx4 v12, s[32:35], s65 offen offset:0 lds
 v_mfma_f32_16x16x32_bf16 v[196:199], v[92:95], v[44:47], v[196:199]
 ds_read_b64_tr_b16 v[136:137], v11 offset:0
 v_mfma_f32_16x16x32_bf16 v[200:203], v[96:99], v[40:43], v[200:203]
 ds_read_b64_tr_b16 v[138:139], v11 offset:2048
 v_mfma_f32_16x16x32_bf16 v[200:203], v[100:103], v[44:47], v[200:203]
 ds_read_b64_tr_b16 v[140:141], v11 offset:8192
 v_mfma_f32_16x16x32_bf16 v[204:207], v[104:107], v[40:43], v[204:207]
 buffer_load_dwordx4 v13, s[32:35], s65 offen offset:1024 lds
 v_mfma_f32_16x16x32_bf16 v[204:207], v[108:111], v[44:47], v[204:207]
 ds_read_b64_tr_b16 v[142:143], v11 offset:10240
 v_mfma_f32_16x16x32_bf16 v[144:147], v[80:83], v[16:19], v[144:147]
 ds_read_b128 v[64:67], v242 offset:0
 v_mfma_f32_16x16x32_bf16 v[144:147], v[84:87], v[20:23], v[144:147]
 ds_read_b128 v[68:71], v242 offset:8192
 v_mfma_f32_16x16x32_bf16 v[148:151], v[88:91], v[16:19], v[148:151]
 buffer_load_dwordx4 v14, s[32:35], s65 offen offset:2048 lds
 v_mfma_f32_16x16x32_bf16 v[148:151], v[92:95], v[20:23], v[148:151]
 ds_read_b128 v[72:75], v243 offset:0
 v_mfma_f32_16x16x32_bf16 v[152:155], v[96:99], v[16:19], v[152:155]
 ds_read_b128 v[76:79], v243 offset:8192
 v_mfma_f32_16x16x32_bf16 v[152:155], v[100:103], v[20:23], v[152:155]
 s_waitcnt vmcnt(11) lgkmcnt(3)
 ds_read_b128 v[48:51], v240 offset:0
 v_mfma_f32_16x16x32_bf16 v[156:159], v[104:107], v[16:19], v[156:159]
 buffer_load_dwordx4 v15, s[32:35], s65 offen offset:3072 lds
 v_mfma_f32_16x16x32_bf16 v[156:159], v[108:111], v[20:23], v[156:159]
 ds_read_b128 v[52:55], v240 offset:8192
 s_barrier
 v_mfma_f32_16x16x32_bf16 v[160:163], v[112:115], v[56:59], v[160:163]
 ds_read_b128 v[24:27], v241 offset:32768
 v_mfma_f32_16x16x32_bf16 v[160:163], v[116:119], v[60:63], v[160:163]
 ds_read_b128 v[28:31], v241 offset:40960
 v_mfma_f32_16x16x32_bf16 v[164:167], v[120:123], v[56:59], v[164:167]
 global_load_dword v251, v254, s[70:71] sc1
 v_mfma_f32_16x16x32_bf16 v[164:167], v[124:127], v[60:63], v[164:167]
 s_add_u32 m0, s69, 65536
 ds_read_b64_tr_b16 v[80:81], v8 offset:32768
 s_add_u32 s66, s75, 41500672
 v_mfma_f32_16x16x32_bf16 v[168:171], v[128:131], v[56:59], v[168:171]
 ds_read_b64_tr_b16 v[82:83], v8 offset:34816
 v_mfma_f32_16x16x32_bf16 v[168:171], v[132:135], v[60:63], v[168:171]
 ds_read_b64_tr_b16 v[84:85], v8 offset:40960
 v_mfma_f32_16x16x32_bf16 v[172:175], v[136:139], v[56:59], v[172:175]
 buffer_load_dwordx4 v1, s[40:43], s66 offen offset:0 sc1 lds
 v_mfma_f32_16x16x32_bf16 v[172:175], v[140:143], v[60:63], v[172:175]
 ds_read_b64_tr_b16 v[86:87], v8 offset:43008
 v_mfma_f32_16x16x32_bf16 v[176:179], v[112:115], v[64:67], v[176:179]
 s_waitcnt lgkmcnt(6)
 ds_read_b64_tr_b16 v[88:89], v9 offset:32768
 v_mfma_f32_16x16x32_bf16 v[176:179], v[116:119], v[68:71], v[176:179]
 ds_read_b64_tr_b16 v[90:91], v9 offset:34816
 v_mfma_f32_16x16x32_bf16 v[180:183], v[120:123], v[64:67], v[180:183]
 buffer_load_dwordx4 v1, s[40:43], s66 offen offset:1024 sc1 lds
 v_mfma_f32_16x16x32_bf16 v[180:183], v[124:127], v[68:71], v[180:183]
 ds_read_b64_tr_b16 v[92:93], v9 offset:40960
 v_mfma_f32_16x16x32_bf16 v[184:187], v[128:131], v[64:67], v[184:187]
 ds_read_b64_tr_b16 v[94:95], v9 offset:43008
 v_mfma_f32_16x16x32_bf16 v[184:187], v[132:135], v[68:71], v[184:187]
 ds_read_b64_tr_b16 v[96:97], v10 offset:32768
 v_mfma_f32_16x16x32_bf16 v[188:191], v[136:139], v[64:67], v[188:191]
 buffer_load_dwordx4 v1, s[40:43], s66 offen offset:2048 sc1 lds
 v_mfma_f32_16x16x32_bf16 v[188:191], v[140:143], v[68:71], v[188:191]
 ds_read_b64_tr_b16 v[98:99], v10 offset:34816
 v_mfma_f32_16x16x32_bf16 v[192:195], v[112:115], v[72:75], v[192:195]
 ds_read_b64_tr_b16 v[100:101], v10 offset:40960
 v_mfma_f32_16x16x32_bf16 v[192:195], v[116:119], v[76:79], v[192:195]
 ds_read_b64_tr_b16 v[102:103], v10 offset:43008
 v_mfma_f32_16x16x32_bf16 v[196:199], v[120:123], v[72:75], v[196:199]
 buffer_load_dwordx4 v1, s[40:43], s66 offen offset:3072 sc1 lds
 v_mfma_f32_16x16x32_bf16 v[196:199], v[124:127], v[76:79], v[196:199]
 s_mov_b32 s32, s14
 ds_read_b64_tr_b16 v[104:105], v11 offset:32768
 s_mov_b32 s33, s15
 v_mfma_f32_16x16x32_bf16 v[200:203], v[128:131], v[72:75], v[200:203]
 s_mov_b32 s34, 4194304
 ds_read_b64_tr_b16 v[106:107], v11 offset:34816
 s_add_u32 m0, s69, 114688
 v_mfma_f32_16x16x32_bf16 v[200:203], v[132:135], v[76:79], v[200:203]
 s_add_u32 s12, s11, 0
 ds_read_b64_tr_b16 v[108:109], v11 offset:40960
 s_and_b32 s12, s12, 15
 v_mfma_f32_16x16x32_bf16 v[204:207], v[136:139], v[72:75], v[204:207]
 s_xor_b32 s12, s12, s10
 s_lshl_b32 s67, s12, 16
 s_add_u32 s67, s67, s64
 v_mfma_f32_16x16x32_bf16 v[204:207], v[140:143], v[76:79], v[204:207]
 s_mul_i32 s21, s12, 8704
 ds_read_b64_tr_b16 v[110:111], v11 offset:43008
 v_mfma_f32_16x16x32_bf16 v[144:147], v[112:115], v[48:51], v[144:147]
 ds_read_b128 v[32:35], v242 offset:32768
 v_mfma_f32_16x16x32_bf16 v[144:147], v[116:119], v[52:55], v[144:147]
 ds_read_b128 v[36:39], v242 offset:40960
 v_mfma_f32_16x16x32_bf16 v[148:151], v[120:123], v[48:51], v[148:151]
 buffer_load_dwordx4 v12, s[32:35], s67 offen offset:0 lds
 v_mfma_f32_16x16x32_bf16 v[148:151], v[124:127], v[52:55], v[148:151]
 ds_read_b128 v[40:43], v243 offset:32768
 v_mfma_f32_16x16x32_bf16 v[152:155], v[128:131], v[48:51], v[152:155]
 ds_read_b128 v[44:47], v243 offset:40960
 v_mfma_f32_16x16x32_bf16 v[152:155], v[132:135], v[52:55], v[152:155]
 s_waitcnt vmcnt(10) lgkmcnt(3)
 ds_read_b128 v[16:19], v240 offset:32768
 v_mfma_f32_16x16x32_bf16 v[156:159], v[136:139], v[48:51], v[156:159]
 buffer_load_dwordx4 v13, s[32:35], s67 offen offset:1024 lds
 buffer_load_dwordx4 v14, s[32:35], s67 offen offset:2048 lds
 buffer_load_dwordx4 v15, s[32:35], s67 offen offset:3072 lds
 v_mfma_f32_16x16x32_bf16 v[156:159], v[140:143], v[52:55], v[156:159]
 ds_read_b128 v[20:23], v240 offset:40960
 s_barrier
 v_mfma_f32_16x16x32_bf16 v[160:163], v[80:83], v[24:27], v[160:163]
 s_add_u32 m0, s69, 16384
 ds_read_b128 v[56:59], v237 offset:0
 s_add_u32 s12, s11, 1
 v_mfma_f32_16x16x32_bf16 v[160:163], v[84:87], v[28:31], v[160:163]
 s_and_b32 s12, s12, 15
 ds_read_b128 v[60:63], v237 offset:8192
 s_xor_b32 s12, s12, s10
 v_mfma_f32_16x16x32_bf16 v[164:167], v[88:91], v[24:27], v[164:167]
 s_lshl_b32 s68, s12, 16
 s_add_u32 s68, s68, s64
 s_mul_i32 s18, s12, 8704
 v_mfma_f32_16x16x32_bf16 v[164:167], v[92:95], v[28:31], v[164:167]
 ds_read_b64_tr_b16 v[112:113], v232 offset:0
 v_mfma_f32_16x16x32_bf16 v[168:171], v[96:99], v[24:27], v[168:171]
 ds_read_b64_tr_b16 v[114:115], v232 offset:2048
 v_mfma_f32_16x16x32_bf16 v[168:171], v[100:103], v[28:31], v[168:171]
 ds_read_b64_tr_b16 v[116:117], v232 offset:8192
 v_mfma_f32_16x16x32_bf16 v[172:175], v[104:107], v[24:27], v[172:175]
 buffer_load_dwordx4 v12, s[32:35], s68 offen offset:0 lds
 v_mfma_f32_16x16x32_bf16 v[172:175], v[108:111], v[28:31], v[172:175]
 ds_read_b64_tr_b16 v[118:119], v232 offset:10240
 v_mfma_f32_16x16x32_bf16 v[176:179], v[80:83], v[32:35], v[176:179]
 s_waitcnt lgkmcnt(6)
 ds_read_b64_tr_b16 v[120:121], v233 offset:0
 v_mfma_f32_16x16x32_bf16 v[176:179], v[84:87], v[36:39], v[176:179]
 ds_read_b64_tr_b16 v[122:123], v233 offset:2048
 v_mfma_f32_16x16x32_bf16 v[180:183], v[88:91], v[32:35], v[180:183]
 buffer_load_dwordx4 v13, s[32:35], s68 offen offset:1024 lds
 v_mfma_f32_16x16x32_bf16 v[180:183], v[92:95], v[36:39], v[180:183]
 ds_read_b64_tr_b16 v[124:125], v233 offset:8192
 v_mfma_f32_16x16x32_bf16 v[184:187], v[96:99], v[32:35], v[184:187]
 ds_read_b64_tr_b16 v[126:127], v233 offset:10240
 v_mfma_f32_16x16x32_bf16 v[184:187], v[100:103], v[36:39], v[184:187]
 ds_read_b64_tr_b16 v[128:129], v234 offset:0
 v_mfma_f32_16x16x32_bf16 v[188:191], v[104:107], v[32:35], v[188:191]
 buffer_load_dwordx4 v14, s[32:35], s68 offen offset:2048 lds
 v_mfma_f32_16x16x32_bf16 v[188:191], v[108:111], v[36:39], v[188:191]
 ds_read_b64_tr_b16 v[130:131], v234 offset:2048
 v_mfma_f32_16x16x32_bf16 v[192:195], v[80:83], v[40:43], v[192:195]
 ds_read_b64_tr_b16 v[132:133], v234 offset:8192
 v_mfma_f32_16x16x32_bf16 v[192:195], v[84:87], v[44:47], v[192:195]
 ds_read_b64_tr_b16 v[134:135], v234 offset:10240
 v_mfma_f32_16x16x32_bf16 v[196:199], v[88:91], v[40:43], v[196:199]
 buffer_load_dwordx4 v15, s[32:35], s68 offen offset:3072 lds
 v_mfma_f32_16x16x32_bf16 v[196:199], v[92:95], v[44:47], v[196:199]
 s_waitcnt vmcnt(12)
 ds_read_b64_tr_b16 v[136:137], v235 offset:0
 v_cmp_eq_u32 vcc, 0, v251
 v_mfma_f32_16x16x32_bf16 v[200:203], v[96:99], v[40:43], v[200:203]
 ds_read_b64_tr_b16 v[138:139], v235 offset:2048
 s_cbranch_vccnz L_spin_c
L_back_c:
 v_mfma_f32_16x16x32_bf16 v[200:203], v[100:103], v[44:47], v[200:203]
 s_add_u32 m0, s69, 98304
 ds_read_b64_tr_b16 v[140:141], v235 offset:8192
 s_andn2_b32 s65, s21, 512
 v_mfma_f32_16x16x32_bf16 v[204:207], v[104:107], v[40:43], v[204:207]
 s_add_u32 s65, s65, s76
 s_add_u32 s65, s65, 40894464
 v_mfma_f32_16x16x32_bf16 v[204:207], v[108:111], v[44:47], v[204:207]
 ds_read_b64_tr_b16 v[142:143], v235 offset:10240
 v_mfma_f32_16x16x32_bf16 v[144:147], v[80:83], v[16:19], v[144:147]
 ds_read_b128 v[64:67], v238 offset:0
 v_mfma_f32_16x16x32_bf16 v[144:147], v[84:87], v[20:23], v[144:147]
 ds_read_b128 v[68:71], v238 offset:8192
 v_mfma_f32_16x16x32_bf16 v[148:151], v[88:91], v[16:19], v[148:151]
 buffer_load_dwordx4 v1, s[40:43], s65 offen offset:0 sc1 lds
 v_mfma_f32_16x16x32_bf16 v[148:151], v[92:95], v[20:23], v[148:151]
 ds_read_b128 v[72:75], v239 offset:0
 v_mfma_f32_16x16x32_bf16 v[152:155], v[96:99], v[16:19], v[152:155]
 ds_read_b128 v[76:79], v239 offset:8192
 v_mfma_f32_16x16x32_bf16 v[152:155], v[100:103], v[20:23], v[152:155]
 s_waitcnt vmcnt(9) lgkmcnt(3)
 ds_read_b128 v[48:51], v236 offset:0
 v_mfma_f32_16x16x32_bf16 v[156:159], v[104:107], v[16:19], v[156:159]
 buffer_load_dwordx4 v1, s[40:43], s65 offen offset:1024 sc1 lds
 buffer_load_dwordx4 v1, s[40:43], s65 offen offset:2048 sc1 lds
 buffer_load_dwordx4 v1, s[40:43], s65 offen offset:3072 sc1 lds
 v_mfma_f32_16x16x32_bf16 v[156:159], v[108:111], v[20:23], v[156:159]
 ds_read_b128 v[52:55], v236 offset:8192
 s_barrier
 v_mfma_f32_16x16x32_bf16 v[160:163], v[112:115], v[56:59], v[160:163]
 s_add_u32 m0, s69, 0
 ds_read_b128 v[24:27], v245 offset:0
 s_andn2_b32 s66, s18, 512
 v_mfma_f32_16x16x32_bf16 v[160:163], v[116:119], v[60:63], v[160:163]
 s_add_u32 s66, s66, s76
 ds_read_b128 v[28:31], v245 offset:8192
 s_add_u32 s66, s66, 40894464
 v_mfma_f32_16x16x32_bf16 v[164:167], v[120:123], v[56:59], v[164:167]
 buffer_load_dwordx4 v1, s[40:43], s66 offen offset:0 sc1 lds
 v_mfma_f32_16x16x32_bf16 v[164:167], v[124:127], v[60:63], v[164:167]
 ds_read_b64_tr_b16 v[80:81], v4 offset:0
 v_mfma_f32_16x16x32_bf16 v[168:171], v[128:131], v[56:59], v[168:171]
 ds_read_b64_tr_b16 v[82:83], v4 offset:2048
 v_mfma_f32_16x16x32_bf16 v[168:171], v[132:135], v[60:63], v[168:171]
 ds_read_b64_tr_b16 v[84:85], v4 offset:8192
 v_mfma_f32_16x16x32_bf16 v[172:175], v[136:139], v[56:59], v[172:175]
 buffer_load_dwordx4 v1, s[40:43], s66 offen offset:1024 sc1 lds
 v_mfma_f32_16x16x32_bf16 v[172:175], v[140:143], v[60:63], v[172:175]
 ds_read_b64_tr_b16 v[86:87], v4 offset:10240
 v_mfma_f32_16x16x32_bf16 v[176:179], v[112:115], v[64:67], v[176:179]
 s_waitcnt lgkmcnt(6)
 ds_read_b64_tr_b16 v[88:89], v5 offset:0
 v_mfma_f32_16x16x32_bf16 v[176:179], v[116:119], v[68:71], v[176:179]
 ds_read_b64_tr_b16 v[90:91], v5 offset:2048
 v_mfma_f32_16x16x32_bf16 v[180:183], v[120:123], v[64:67], v[180:183]
 buffer_load_dwordx4 v1, s[40:43], s66 offen offset:2048 sc1 lds
 v_mfma_f32_16x16x32_bf16 v[180:183], v[124:127], v[68:71], v[180:183]
 ds_read_b64_tr_b16 v[92:93], v5 offset:8192
 v_mfma_f32_16x16x32_bf16 v[184:187], v[128:131], v[64:67], v[184:187]
 ds_read_b64_tr_b16 v[94:95], v5 offset:10240
 v_mfma_f32_16x16x32_bf16 v[184:187], v[132:135], v[68:71], v[184:187]
 ds_read_b64_tr_b16 v[96:97], v6 offset:0
 v_mfma_f32_16x16x32_bf16 v[188:191], v[136:139], v[64:67], v[188:191]
 buffer_load_dwordx4 v1, s[40:43], s66 offen offset:3072 sc1 lds
 v_mfma_f32_16x16x32_bf16 v[188:191], v[140:143], v[68:71], v[188:191]
 s_add_u32 m0, s69, 49152
 ds_read_b64_tr_b16 v[98:99], v6 offset:2048
 s_add_u32 s12, s11, 2
 v_mfma_f32_16x16x32_bf16 v[192:195], v[112:115], v[72:75], v[192:195]
 s_and_b32 s12, s12, 15
 ds_read_b64_tr_b16 v[100:101], v6 offset:8192
 s_xor_b32 s12, s12, s10
 v_mfma_f32_16x16x32_bf16 v[192:195], v[116:119], v[76:79], v[192:195]
 s_lshl_b32 s67, s12, 16
 ds_read_b64_tr_b16 v[102:103], v6 offset:10240
 s_add_u32 s67, s67, s64
 v_mfma_f32_16x16x32_bf16 v[196:199], v[120:123], v[72:75], v[196:199]
 s_mul_i32 s19, s12, 8704
 v_mfma_f32_16x16x32_bf16 v[196:199], v[124:127], v[76:79], v[196:199]
 ds_read_b64_tr_b16 v[104:105], v7 offset:0
 v_mfma_f32_16x16x32_bf16 v[200:203], v[128:131], v[72:75], v[200:203]
 ds_read_b64_tr_b16 v[106:107], v7 offset:2048
 v_mfma_f32_16x16x32_bf16 v[200:203], v[132:135], v[76:79], v[200:203]
 ds_read_b64_tr_b16 v[108:109], v7 offset:8192
 v_mfma_f32_16x16x32_bf16 v[204:207], v[136:139], v[72:75], v[204:207]
 buffer_load_dwordx4 v12, s[32:35], s67 offen offset:0 lds
 v_mfma_f32_16x16x32_bf16 v[204:207], v[140:143], v[76:79], v[204:207]
 ds_read_b64_tr_b16 v[110:111], v7 offset:10240
 v_mfma_f32_16x16x32_bf16 v[144:147], v[112:115], v[48:51], v[144:147]
 ds_read_b128 v[32:35], v246 offset:0
 v_mfma_f32_16x16x32_bf16 v[144:147], v[116:119], v[52:55], v[144:147]
 ds_read_b128 v[36:39], v246 offset:8192
 v_mfma_f32_16x16x32_bf16 v[148:151], v[120:123], v[48:51], v[148:151]
 buffer_load_dwordx4 v13, s[32:35], s67 offen offset:1024 lds
 v_mfma_f32_16x16x32_bf16 v[148:151], v[124:127], v[52:55], v[148:151]
 ds_read_b128 v[40:43], v247 offset:0
 v_mfma_f32_16x16x32_bf16 v[152:155], v[128:131], v[48:51], v[152:155]
 ds_read_b128 v[44:47], v247 offset:8192
 v_mfma_f32_16x16x32_bf16 v[152:155], v[132:135], v[52:55], v[152:155]
 s_waitcnt vmcnt(6) lgkmcnt(3)
 ds_read_b128 v[16:19], v244 offset:0
 v_mfma_f32_16x16x32_bf16 v[156:159], v[136:139], v[48:51], v[156:159]
 buffer_load_dwordx4 v14, s[32:35], s67 offen offset:2048 lds
 buffer_load_dwordx4 v15, s[32:35], s67 offen offset:3072 lds
 v_mfma_f32_16x16x32_bf16 v[156:159], v[140:143], v[52:55], v[156:159]
 ds_read_b128 v[20:23], v244 offset:8192
 s_barrier
 v_mfma_f32_16x16x32_bf16 v[160:163], v[80:83], v[24:27], v[160:163]
 s_add_u32 m0, s69, 32768
 ds_read_b128 v[56:59], v245 offset:32768
 s_andn2_b32 s68, s19, 512
 v_mfma_f32_16x16x32_bf16 v[160:163], v[84:87], v[28:31], v[160:163]
 s_add_u32 s68, s68, s76
 ds_read_b128 v[60:63], v245 offset:40960
 s_add_u32 s68, s68, 40894464
 v_mfma_f32_16x16x32_bf16 v[164:167], v[88:91], v[24:27], v[164:167]
 buffer_load_dwordx4 v1, s[40:43], s68 offen offset:0 sc1 lds
 v_mfma_f32_16x16x32_bf16 v[164:167], v[92:95], v[28:31], v[164:167]
 ds_read_b64_tr_b16 v[112:113], v4 offset:32768
 v_mfma_f32_16x16x32_bf16 v[168:171], v[96:99], v[24:27], v[168:171]
 ds_read_b64_tr_b16 v[114:115], v4 offset:34816
 v_mfma_f32_16x16x32_bf16 v[168:171], v[100:103], v[28:31], v[168:171]
 ds_read_b64_tr_b16 v[116:117], v4 offset:40960
 v_mfma_f32_16x16x32_bf16 v[172:175], v[104:107], v[24:27], v[172:175]
 buffer_load_dwordx4 v1, s[40:43], s68 offen offset:1024 sc1 lds
 v_mfma_f32_16x16x32_bf16 v[172:175], v[108:111], v[28:31], v[172:175]
 ds_read_b64_tr_b16 v[118:119], v4 offset:43008
 v_mfma_f32_16x16x32_bf16 v[176:179], v[80:83], v[32:35], v[176:179]
 s_waitcnt lgkmcnt(6)
 ds_read_b64_tr_b16 v[120:121], v5 offset:32768
 v_mfma_f32_16x16x32_bf16 v[176:179], v[84:87], v[36:39], v[176:179]
 ds_read_b64_tr_b16 v[122:123], v5 offset:34816
 v_mfma_f32_16x16x32_bf16 v[180:183], v[88:91], v[32:35], v[180:183]
 buffer_load_dwordx4 v1, s[40:43], s68 offen offset:2048 sc1 lds
 v_mfma_f32_16x16x32_bf16 v[180:183], v[92:95], v[36:39], v[180:183]
 ds_read_b64_tr_b16 v[124:125], v5 offset:40960
 v_mfma_f32_16x16x32_bf16 v[184:187], v[96:99], v[32:35], v[184:187]
 ds_read_b64_tr_b16 v[126:127], v5 offset:43008
 v_mfma_f32_16x16x32_bf16 v[184:187], v[100:103], v[36:39], v[184:187]
 ds_read_b64_tr_b16 v[128:129], v6 offset:32768
 v_mfma_f32_16x16x32_bf16 v[188:191], v[104:107], v[32:35], v[188:191]
 buffer_load_dwordx4 v1, s[40:43], s68 offen offset:3072 sc1 lds
 v_mfma_f32_16x16x32_bf16 v[188:191], v[108:111], v[36:39], v[188:191]
 s_add_u32 m0, s69, 147456
 ds_read_b64_tr_b16 v[130:131], v6 offset:34816
 s_add_u32 s12, s11, 3
 v_mfma_f32_16x16x32_bf16 v[192:195], v[80:83], v[40:43], v[192:195]
 s_and_b32 s12, s12, 15
L_w1_0:
L_st1_0:
 s_cbranch_execz L_warmed1
 ds_read_b64_tr_b16 v[132:133], v6 offset:40960
 s_xor_b32 s12, s12, s10
 v_mfma_f32_16x16x32_bf16 v[192:195], v[84:87], v[44:47], v[192:195]
 s_lshl_b32 s65, s12, 16
 ds_read_b64_tr_b16 v[134:135], v6 offset:43008
 s_add_u32 s65, s65, s64
 v_mfma_f32_16x16x32_bf16 v[196:199], v[88:91], v[40:43], v[196:199]
 s_mul_i32 s20, s12, 8704
 v_mfma_f32_16x16x32_bf16 v[196:199], v[92:95], v[44:47], v[196:199]
 ds_read_b64_tr_b16 v[136:137], v7 offset:32768
 v_mfma_f32_16x16x32_bf16 v[200:203], v[96:99], v[40:43], v[200:203]
 ds_read_b64_tr_b16 v[138:139], v7 offset:34816
 v_mfma_f32_16x16x32_bf16 v[200:203], v[100:103], v[44:47], v[200:203]
 ds_read_b64_tr_b16 v[140:141], v7 offset:40960
 v_mfma_f32_16x16x32_bf16 v[204:207], v[104:107], v[40:43], v[204:207]
 buffer_load_dwordx4 v12, s[32:35], s65 offen offset:0 lds
 v_mfma_f32_16x16x32_bf16 v[204:207], v[108:111], v[44:47], v[204:207]
 ds_read_b64_tr_b16 v[142:143], v7 offset:43008
 v_mfma_f32_16x16x32_bf16 v[144:147], v[80:83], v[16:19], v[144:147]
 ds_read_b128 v[64:67], v246 offset:32768
 v_mfma_f32_16x16x32_bf16 v[144:147], v[84:87], v[20:23], v[144:147]
 ds_read_b128 v[68:71], v246 offset:40960
 v_mfma_f32_16x16x32_bf16 v[148:151], v[88:91], v[16:19], v[148:151]
 buffer_load_dwordx4 v13, s[32:35], s65 offen offset:1024 lds
 v_mfma_f32_16x16x32_bf16 v[148:151], v[92:95], v[20:23], v[148:151]
 ds_read_b128 v[72:75], v247 offset:32768
 v_mfma_f32_16x16x32_bf16 v[152:155], v[96:99], v[16:19], v[152:155]
 ds_read_b128 v[76:79], v247 offset:40960
 v_mfma_f32_16x16x32_bf16 v[152:155], v[100:103], v[20:23], v[152:155]
 s_waitcnt vmcnt(10) lgkmcnt(3)
 ds_read_b128 v[48:51], v244 offset:32768
 v_mfma_f32_16x16x32_bf16 v[156:159], v[104:107], v[16:19], v[156:159]
 buffer_load_dwordx4 v14, s[32:35], s65 offen offset:2048 lds
 buffer_load_dwordx4 v15, s[32:35], s65 offen offset:3072 lds
 v_mfma_f32_16x16x32_bf16 v[156:159], v[108:111], v[20:23], v[156:159]
 ds_read_b128 v[52:55], v244 offset:40960
 s_barrier
 v_mfma_f32_16x16x32_bf16 v[160:163], v[112:115], v[56:59], v[160:163]
 s_add_u32 m0, s69, 131072
 ds_read_b128 v[24:27], v241 offset:0
 s_andn2_b32 s66, s20, 512
 v_mfma_f32_16x16x32_bf16 v[160:163], v[116:119], v[60:63], v[160:163]
 s_add_u32 s66, s66, s76
 ds_read_b128 v[28:31], v241 offset:8192
 s_add_u32 s66, s66, 40894464
 v_mfma_f32_16x16x32_bf16 v[164:167], v[120:123], v[56:59], v[164:167]
 buffer_load_dwordx4 v1, s[40:43], s66 offen offset:0 sc1 lds
 v_mfma_f32_16x16x32_bf16 v[164:167], v[124:127], v[60:63], v[164:167]
 ds_read_b64_tr_b16 v[80:81], v8 offset:0
 v_mfma_f32_16x16x32_bf16 v[168:171], v[128:131], v[56:59], v[168:171]
 ds_read_b64_tr_b16 v[82:83], v8 offset:2048
 v_mfma_f32_16x16x32_bf16 v[168:171], v[132:135], v[60:63], v[168:171]
 ds_read_b64_tr_b16 v[84:85], v8 offset:8192
 v_mfma_f32_16x16x32_bf16 v[172:175], v[136:139], v[56:59], v[172:175]
 buffer_load_dwordx4 v1, s[40:43], s66 offen offset:1024 sc1 lds
 v_mfma_f32_16x16x32_bf16 v[172:175], v[140:143], v[60:63], v[172:175]
 ds_read_b64_tr_b16 v[86:87], v8 offset:10240
 v_mfma_f32_16x16x32_bf16 v[176:179], v[112:115], v[64:67], v[176:179]
 s_waitcnt lgkmcnt(6)
 ds_read_b64_tr_b16 v[88:89], v9 offset:0
 v_mfma_f32_16x16x32_bf16 v[176:179], v[116:119], v[68:71], v[176:179]
 ds_read_b64_tr_b16 v[90:91], v9 offset:2048
 v_mfma_f32_16x16x32_bf16 v[180:183], v[120:123], v[64:67], v[180:183]
 buffer_load_dwordx4 v1, s[40:43], s66 offen offset:2048 sc1 lds
 v_mfma_f32_16x16x32_bf16 v[180:183], v[124:127], v[68:71], v[180:183]
 ds_read_b64_tr_b16 v[92:93], v9 offset:8192
 v_mfma_f32_16x16x32_bf16 v[184:187], v[128:131], v[64:67], v[184:187]
 ds_read_b64_tr_b16 v[94:95], v9 offset:10240
 v_mfma_f32_16x16x32_bf16 v[184:187], v[132:135], v[68:71], v[184:187]
 ds_read_b64_tr_b16 v[96:97], v10 offset:0
 v_mfma_f32_16x16x32_bf16 v[188:191], v[136:139], v[64:67], v[188:191]
 buffer_load_dwordx4 v1, s[40:43], s66 offen offset:3072 sc1 lds
 v_mfma_f32_16x16x32_bf16 v[188:191], v[140:143], v[68:71], v[188:191]
 s_add_u32 m0, s69, 81920
 ds_read_b64_tr_b16 v[98:99], v10 offset:2048
 s_add_u32 s12, s11, 4
 v_mfma_f32_16x16x32_bf16 v[192:195], v[112:115], v[72:75], v[192:195]
 s_and_b32 s12, s12, 15
 ds_read_b64_tr_b16 v[100:101], v10 offset:8192
 s_xor_b32 s12, s12, s10
 v_mfma_f32_16x16x32_bf16 v[192:195], v[116:119], v[76:79], v[192:195]
 s_lshl_b32 s67, s12, 16
 ds_read_b64_tr_b16 v[102:103], v10 offset:10240
 s_add_u32 s67, s67, s64
 v_mfma_f32_16x16x32_bf16 v[196:199], v[120:123], v[72:75], v[196:199]
 s_mul_i32 s21, s12, 8704
 v_mfma_f32_16x16x32_bf16 v[196:199], v[124:127], v[76:79], v[196:199]
 ds_read_b64_tr_b16 v[104:105], v11 offset:0
 v_mfma_f32_16x16x32_bf16 v[200:203], v[128:131], v[72:75], v[200:203]
 ds_read_b64_tr_b16 v[106:107], v11 offset:2048
 v_mfma_f32_16x16x32_bf16 v[200:203], v[132:135], v[76:79], v[200:203]
 ds_read_b64_tr_b16 v[108:109], v11 offset:8192
 v_mfma_f32_16x16x32_bf16 v[204:207], v[136:139], v[72:75], v[204:207]
 buffer_load_dwordx4 v12, s[32:35], s67 offen offset:0 lds
 v_mfma_f32_16x16x32_bf16 v[204:207], v[140:143], v[76:79], v[204:207]
 ds_read_b64_tr_b16 v[110:111], v11 offset:10240
 v_mfma_f32_16x16x32_bf16 v[144:147], v[112:115], v[48:51], v[144:147]
 ds_read_b128 v[32:35], v242 offset:0
 v_mfma_f32_16x16x32_bf16 v[144:147], v[116:119], v[52:55], v[144:147]
 ds_read_b128 v[36:39], v242 offset:8192
 v_mfma_f32_16x16x32_bf16 v[148:151], v[120:123], v[48:51], v[148:151]
 buffer_load_dwordx4 v13, s[32:35], s67 offen offset:1024 lds
 v_mfma_f32_16x16x32_bf16 v[148:151], v[124:127], v[52:55], v[148:151]
 ds_read_b128 v[40:43], v243 offset:0
 v_mfma_f32_16x16x32_bf16 v[152:155], v[128:131], v[48:51], v[152:155]
 ds_read_b128 v[44:47], v243 offset:8192
 v_mfma_f32_16x16x32_bf16 v[152:155], v[132:135], v[52:55], v[152:155]
 s_waitcnt vmcnt(10) lgkmcnt(3)
 ds_read_b128 v[16:19], v240 offset:0
 v_mfma_f32_16x16x32_bf16 v[156:159], v[136:139], v[48:51], v[156:159]
 buffer_load_dwordx4 v14, s[32:35], s67 offen offset:2048 lds
 buffer_load_dwordx4 v15, s[32:35], s67 offen offset:3072 lds
 v_mfma_f32_16x16x32_bf16 v[156:159], v[140:143], v[52:55], v[156:159]
 ds_read_b128 v[20:23], v240 offset:8192
 s_barrier
 v_mfma_f32_16x16x32_bf16 v[160:163], v[80:83], v[24:27], v[160:163]
 s_add_u32 m0, s69, 65536
 ds_read_b128 v[56:59], v241 offset:32768
 s_andn2_b32 s68, s21, 512
 v_mfma_f32_16x16x32_bf16 v[160:163], v[84:87], v[28:31], v[160:163]
 s_add_u32 s68, s68, s76
 ds_read_b128 v[60:63], v241 offset:40960
 s_add_u32 s68, s68, 40894464
 v_mfma_f32_16x16x32_bf16 v[164:167], v[88:91], v[24:27], v[164:167]
 buffer_load_dwordx4 v1, s[40:43], s68 offen offset:0 sc1 lds
 v_mfma_f32_16x16x32_bf16 v[164:167], v[92:95], v[28:31], v[164:167]
 ds_read_b64_tr_b16 v[112:113], v8 offset:32768
 v_mfma_f32_16x16x32_bf16 v[168:171], v[96:99], v[24:27], v[168:171]
 ds_read_b64_tr_b16 v[114:115], v8 offset:34816
 v_mfma_f32_16x16x32_bf16 v[168:171], v[100:103], v[28:31], v[168:171]
 ds_read_b64_tr_b16 v[116:117], v8 offset:40960
 v_mfma_f32_16x16x32_bf16 v[172:175], v[104:107], v[24:27], v[172:175]
 buffer_load_dwordx4 v1, s[40:43], s68 offen offset:1024 sc1 lds
 v_mfma_f32_16x16x32_bf16 v[172:175], v[108:111], v[28:31], v[172:175]
 ds_read_b64_tr_b16 v[118:119], v8 offset:43008
 v_mfma_f32_16x16x32_bf16 v[176:179], v[80:83], v[32:35], v[176:179]
 s_waitcnt lgkmcnt(6)
 ds_read_b64_tr_b16 v[120:121], v9 offset:32768
 v_mfma_f32_16x16x32_bf16 v[176:179], v[84:87], v[36:39], v[176:179]
 ds_read_b64_tr_b16 v[122:123], v9 offset:34816
 v_mfma_f32_16x16x32_bf16 v[180:183], v[88:91], v[32:35], v[180:183]
 buffer_load_dwordx4 v1, s[40:43], s68 offen offset:2048 sc1 lds
 v_mfma_f32_16x16x32_bf16 v[180:183], v[92:95], v[36:39], v[180:183]
 ds_read_b64_tr_b16 v[124:125], v9 offset:40960
 v_mfma_f32_16x16x32_bf16 v[184:187], v[96:99], v[32:35], v[184:187]
 ds_read_b64_tr_b16 v[126:127], v9 offset:43008
 v_mfma_f32_16x16x32_bf16 v[184:187], v[100:103], v[36:39], v[184:187]
 ds_read_b64_tr_b16 v[128:129], v10 offset:32768
 v_mfma_f32_16x16x32_bf16 v[188:191], v[104:107], v[32:35], v[188:191]
 buffer_load_dwordx4 v1, s[40:43], s68 offen offset:3072 sc1 lds
 v_mfma_f32_16x16x32_bf16 v[188:191], v[108:111], v[36:39], v[188:191]
 s_add_u32 m0, s69, 114688
 ds_read_b64_tr_b16 v[130:131], v10 offset:34816
 s_add_u32 s12, s11, 5
 v_mfma_f32_16x16x32_bf16 v[192:195], v[80:83], v[40:43], v[192:195]
 s_and_b32 s12, s12, 15
 ds_read_b64_tr_b16 v[132:133], v10 offset:40960
 s_xor_b32 s12, s12, s10
 v_mfma_f32_16x16x32_bf16 v[192:195], v[84:87], v[44:47], v[192:195]
 s_lshl_b32 s65, s12, 16
 ds_read_b64_tr_b16 v[134:135], v10 offset:43008
 s_add_u32 s65, s65, s64
 v_mfma_f32_16x16x32_bf16 v[196:199], v[88:91], v[40:43], v[196:199]
 s_mul_i32 s18, s12, 8704
 v_mfma_f32_16x16x32_bf16 v[196:199], v[92:95], v[44:47], v[196:199]
 ds_read_b64_tr_b16 v[136:137], v11 offset:32768
 v_mfma_f32_16x16x32_bf16 v[200:203], v[96:99], v[40:43], v[200:203]
 ds_read_b64_tr_b16 v[138:139], v11 offset:34816
 v_mfma_f32_16x16x32_bf16 v[200:203], v[100:103], v[44:47], v[200:203]
 ds_read_b64_tr_b16 v[140:141], v11 offset:40960
 v_mfma_f32_16x16x32_bf16 v[204:207], v[104:107], v[40:43], v[204:207]
 buffer_load_dwordx4 v12, s[32:35], s65 offen offset:0 lds
 v_mfma_f32_16x16x32_bf16 v[204:207], v[108:111], v[44:47], v[204:207]
 ds_read_b64_tr_b16 v[142:143], v11 offset:43008
 v_mfma_f32_16x16x32_bf16 v[144:147], v[80:83], v[16:19], v[144:147]
 ds_read_b128 v[64:67], v242 offset:32768
 v_mfma_f32_16x16x32_bf16 v[144:147], v[84:87], v[20:23], v[144:147]
 ds_read_b128 v[68:71], v242 offset:40960
 v_mfma_f32_16x16x32_bf16 v[148:151], v[88:91], v[16:19], v[148:151]
 buffer_load_dwordx4 v13, s[32:35], s65 offen offset:1024 lds
 v_mfma_f32_16x16x32_bf16 v[148:151], v[92:95], v[20:23], v[148:151]
 ds_read_b128 v[72:75], v243 offset:32768
 v_mfma_f32_16x16x32_bf16 v[152:155], v[96:99], v[16:19], v[152:155]
 ds_read_b128 v[76:79], v243 offset:40960
 v_mfma_f32_16x16x32_bf16 v[152:155], v[100:103], v[20:23], v[152:155]
 s_waitcnt vmcnt(10) lgkmcnt(3)
 ds_read_b128 v[48:51], v240 offset:32768
 v_mfma_f32_16x16x32_bf16 v[156:159], v[104:107], v[16:19], v[156:159]
 buffer_load_dwordx4 v14, s[32:35], s65 offen offset:2048 lds
 buffer_load_dwordx4 v15, s[32:35], s65 offen offset:3072 lds
 v_mfma_f32_16x16x32_bf16 v[156:159], v[108:111], v[20:23], v[156:159]
 ds_read_b128 v[52:55], v240 offset:40960
 s_barrier
 v_mfma_f32_16x16x32_bf16 v[160:163], v[112:115], v[56:59], v[160:163]
 s_add_u32 m0, s69, 98304
 ds_read_b128 v[24:27], v237 offset:0
 s_andn2_b32 s66, s18, 512
 v_mfma_f32_16x16x32_bf16 v[160:163], v[116:119], v[60:63], v[160:163]
 s_add_u32 s66, s66, s76
 ds_read_b128 v[28:31], v237 offset:8192
 s_add_u32 s66, s66, 40894464
 v_mfma_f32_16x16x32_bf16 v[164:167], v[120:123], v[56:59], v[164:167]
 buffer_load_dwordx4 v1, s[40:43], s66 offen offset:0 sc1 lds
 v_mfma_f32_16x16x32_bf16 v[164:167], v[124:127], v[60:63], v[164:167]
 ds_read_b64_tr_b16 v[80:81], v232 offset:0
 v_mfma_f32_16x16x32_bf16 v[168:171], v[128:131], v[56:59], v[168:171]
 ds_read_b64_tr_b16 v[82:83], v232 offset:2048
 v_mfma_f32_16x16x32_bf16 v[168:171], v[132:135], v[60:63], v[168:171]
 ds_read_b64_tr_b16 v[84:85], v232 offset:8192
 v_mfma_f32_16x16x32_bf16 v[172:175], v[136:139], v[56:59], v[172:175]
 buffer_load_dwordx4 v1, s[40:43], s66 offen offset:1024 sc1 lds
 v_mfma_f32_16x16x32_bf16 v[172:175], v[140:143], v[60:63], v[172:175]
 ds_read_b64_tr_b16 v[86:87], v232 offset:10240
 v_mfma_f32_16x16x32_bf16 v[176:179], v[112:115], v[64:67], v[176:179]
 s_waitcnt lgkmcnt(6)
 ds_read_b64_tr_b16 v[88:89], v233 offset:0
 v_mfma_f32_16x16x32_bf16 v[176:179], v[116:119], v[68:71], v[176:179]
 ds_read_b64_tr_b16 v[90:91], v233 offset:2048
 v_mfma_f32_16x16x32_bf16 v[180:183], v[120:123], v[64:67], v[180:183]
 buffer_load_dwordx4 v1, s[40:43], s66 offen offset:2048 sc1 lds
 v_mfma_f32_16x16x32_bf16 v[180:183], v[124:127], v[68:71], v[180:183]
 ds_read_b64_tr_b16 v[92:93], v233 offset:8192
 v_mfma_f32_16x16x32_bf16 v[184:187], v[128:131], v[64:67], v[184:187]
 ds_read_b64_tr_b16 v[94:95], v233 offset:10240
 v_mfma_f32_16x16x32_bf16 v[184:187], v[132:135], v[68:71], v[184:187]
 ds_read_b64_tr_b16 v[96:97], v234 offset:0
 v_mfma_f32_16x16x32_bf16 v[188:191], v[136:139], v[64:67], v[188:191]
 buffer_load_dwordx4 v1, s[40:43], s66 offen offset:3072 sc1 lds
 v_mfma_f32_16x16x32_bf16 v[188:191], v[140:143], v[68:71], v[188:191]
 s_add_u32 m0, s69, 16384
 ds_read_b64_tr_b16 v[98:99], v234 offset:2048
 s_add_u32 s12, s11, 6
 v_mfma_f32_16x16x32_bf16 v[192:195], v[112:115], v[72:75], v[192:195]
 s_and_b32 s12, s12, 15
 ds_read_b64_tr_b16 v[100:101], v234 offset:8192
 s_xor_b32 s12, s12, s10
 v_mfma_f32_16x16x32_bf16 v[192:195], v[116:119], v[76:79], v[192:195]
 s_lshl_b32 s67, s12, 16
 ds_read_b64_tr_b16 v[102:103], v234 offset:10240
 s_add_u32 s67, s67, s64
 v_mfma_f32_16x16x32_bf16 v[196:199], v[120:123], v[72:75], v[196:199]
 s_mul_i32 s19, s12, 8704
 v_mfma_f32_16x16x32_bf16 v[196:199], v[124:127], v[76:79], v[196:199]
 ds_read_b64_tr_b16 v[104:105], v235 offset:0
 v_mfma_f32_16x16x32_bf16 v[200:203], v[128:131], v[72:75], v[200:203]
 ds_read_b64_tr_b16 v[106:107], v235 offset:2048
 v_mfma_f32_16x16x32_bf16 v[200:203], v[132:135], v[76:79], v[200:203]
 ds_read_b64_tr_b16 v[108:109], v235 offset:8192
 v_mfma_f32_16x16x32_bf16 v[204:207], v[136:139], v[72:75], v[204:207]
 buffer_load_dwordx4 v12, s[32:35], s67 offen offset:0 lds
 v_mfma_f32_16x16x32_bf16 v[204:207], v[140:143], v[76:79], v[204:207]
 ds_read_b64_tr_b16 v[110:111], v235 offset:10240
 v_mfma_f32_16x16x32_bf16 v[144:147], v[112:115], v[48:51], v[144:147]
 ds_read_b128 v[32:35], v238 offset:0
 v_mfma_f32_16x16x32_bf16 v[144:147], v[116:119], v[52:55], v[144:147]
 ds_read_b128 v[36:39], v238 offset:8192
 v_mfma_f32_16x16x32_bf16 v[148:151], v[120:123], v[48:51], v[148:151]
 buffer_load_dwordx4 v13, s[32:35], s67 offen offset:1024 lds
 v_mfma_f32_16x16x32_bf16 v[148:151], v[124:127], v[52:55], v[148:151]
 ds_read_b128 v[40:43], v239 offset:0
 v_mfma_f32_16x16x32_bf16 v[152:155], v[128:131], v[48:51], v[152:155]
 ds_read_b128 v[44:47], v239 offset:8192
 v_mfma_f32_16x16x32_bf16 v[152:155], v[132:135], v[52:55], v[152:155]
 s_waitcnt vmcnt(10) lgkmcnt(6)
 ds_read_b128 v[16:19], v236 offset:0
 v_mfma_f32_16x16x32_bf16 v[156:159], v[136:139], v[48:51], v[156:159]
 buffer_load_dwordx4 v14, s[32:35], s67 offen offset:2048 lds
 buffer_load_dwordx4 v15, s[32:35], s67 offen offset:3072 lds
 v_mfma_f32_16x16x32_bf16 v[156:159], v[140:143], v[52:55], v[156:159]
 ds_read_b128 v[20:23], v236 offset:8192
 s_barrier
 v_mfma_f32_16x16x32_bf16 v[160:163], v[80:83], v[24:27], v[160:163]
 s_add_u32 m0, s69, 0
 ds_read_b128 v[56:59], v245 offset:0
 s_andn2_b32 s68, s19, 512
 v_mfma_f32_16x16x32_bf16 v[160:163], v[84:87], v[28:31], v[160:163]
 s_add_u32 s68, s68, s76
 ds_read_b128 v[60:63], v245 offset:8192
 s_add_u32 s68, s68, 40894464
 v_mfma_f32_16x16x32_bf16 v[164:167], v[88:91], v[24:27], v[164:167]
 buffer_load_dwordx4 v1, s[40:43], s68 offen offset:0 sc1 lds
 v_mfma_f32_16x16x32_bf16 v[164:167], v[92:95], v[28:31], v[164:167]
 ds_read_b64_tr_b16 v[112:113], v4 offset:0
 v_mfma_f32_16x16x32_bf16 v[168:171], v[96:99], v[24:27], v[168:171]
 ds_read_b64_tr_b16 v[114:115], v4 offset:2048
 v_mfma_f32_16x16x32_bf16 v[168:171], v[100:103], v[28:31], v[168:171]
 ds_read_b64_tr_b16 v[116:117], v4 offset:8192
 v_mfma_f32_16x16x32_bf16 v[172:175], v[104:107], v[24:27], v[172:175]
 s_waitcnt lgkmcnt(5)
 buffer_load_dwordx4 v1, s[40:43], s68 offen offset:1024 sc1 lds
 v_mfma_f32_16x16x32_bf16 v[172:175], v[108:111], v[28:31], v[172:175]
 s_add_u32 s85, s2, 0
 ds_read_b64_tr_b16 v[118:119], v4 offset:10240
 s_and_b32 s85, s85, 3
 v_mfma_f32_16x16x32_bf16 v[176:179], v[80:83], v[32:35], v[176:179]
 s_andn2_b32 s86, s2, 3
 ds_read_b64_tr_b16 v[120:121], v5 offset:0
 s_add_u32 s85, s85, s86
 v_mfma_f32_16x16x32_bf16 v[176:179], v[84:87], v[36:39], v[176:179]
 s_lshl_b32 s85, s85, 2
 ds_read_b64_tr_b16 v[122:123], v5 offset:2048
 s_add_u32 s85, s85, s60
 v_mfma_f32_16x16x32_bf16 v[180:183], v[88:91], v[32:35], v[180:183]
 buffer_load_dwordx4 v1, s[40:43], s68 offen offset:2048 sc1 lds
 v_mfma_f32_16x16x32_bf16 v[180:183], v[92:95], v[36:39], v[180:183]
 s_mul_i32 s85, s85, 7168
 ds_read_b64_tr_b16 v[124:125], v5 offset:8192
 s_add_u32 s77, s85, 70254592
 v_mfma_f32_16x16x32_bf16 v[184:187], v[96:99], v[32:35], v[184:187]
 ds_read_b64_tr_b16 v[126:127], v5 offset:10240
 v_mfma_f32_16x16x32_bf16 v[184:187], v[100:103], v[36:39], v[184:187]
 ds_read_b64_tr_b16 v[128:129], v6 offset:0
 v_mfma_f32_16x16x32_bf16 v[188:191], v[104:107], v[32:35], v[188:191]
 buffer_load_dwordx4 v1, s[40:43], s68 offen offset:3072 sc1 lds
 v_mfma_f32_16x16x32_bf16 v[188:191], v[108:111], v[36:39], v[188:191]
 s_add_u32 m0, s69, 49152
 ds_read_b64_tr_b16 v[130:131], v6 offset:2048
 s_add_u32 s12, s11, 7
 v_mfma_f32_16x16x32_bf16 v[192:195], v[80:83], v[40:43], v[192:195]
 s_and_b32 s12, s12, 15
 ds_read_b64_tr_b16 v[132:133], v6 offset:8192
 s_xor_b32 s12, s12, s10
 v_mfma_f32_16x16x32_bf16 v[192:195], v[84:87], v[44:47], v[192:195]
 s_lshl_b32 s65, s12, 16
 ds_read_b64_tr_b16 v[134:135], v6 offset:10240
 s_add_u32 s65, s65, s64
 v_mfma_f32_16x16x32_bf16 v[196:199], v[88:91], v[40:43], v[196:199]
 s_mul_i32 s20, s12, 8704
 v_mfma_f32_16x16x32_bf16 v[196:199], v[92:95], v[44:47], v[196:199]
 ds_read_b64_tr_b16 v[136:137], v7 offset:0
 v_mfma_f32_16x16x32_bf16 v[200:203], v[96:99], v[40:43], v[200:203]
 ds_read_b64_tr_b16 v[138:139], v7 offset:2048
 v_mfma_f32_16x16x32_bf16 v[200:203], v[100:103], v[44:47], v[200:203]
 ds_read_b64_tr_b16 v[140:141], v7 offset:8192
 v_mfma_f32_16x16x32_bf16 v[204:207], v[104:107], v[40:43], v[204:207]
 buffer_load_dwordx4 v12, s[32:35], s65 offen offset:0 lds
 v_mfma_f32_16x16x32_bf16 v[204:207], v[108:111], v[44:47], v[204:207]
 ds_read_b64_tr_b16 v[142:143], v7 offset:10240
 v_mfma_f32_16x16x32_bf16 v[144:147], v[80:83], v[16:19], v[144:147]
 ds_read_b128 v[64:67], v246 offset:0
 v_mfma_f32_16x16x32_bf16 v[144:147], v[84:87], v[20:23], v[144:147]
 ds_read_b128 v[68:71], v246 offset:8192
 v_mfma_f32_16x16x32_bf16 v[148:151], v[88:91], v[16:19], v[148:151]
 buffer_load_dwordx4 v13, s[32:35], s65 offen offset:1024 lds
 v_mfma_f32_16x16x32_bf16 v[148:151], v[92:95], v[20:23], v[148:151]
 ds_read_b128 v[72:75], v247 offset:0
 v_mfma_f32_16x16x32_bf16 v[152:155], v[96:99], v[16:19], v[152:155]
 ds_read_b128 v[76:79], v247 offset:8192
 v_mfma_f32_16x16x32_bf16 v[152:155], v[100:103], v[20:23], v[152:155]
 s_waitcnt vmcnt(10) lgkmcnt(6)
 ds_read_b128 v[48:51], v244 offset:0
 v_mfma_f32_16x16x32_bf16 v[156:159], v[104:107], v[16:19], v[156:159]
 buffer_load_dwordx4 v14, s[32:35], s65 offen offset:2048 lds
 buffer_load_dwordx4 v15, s[32:35], s65 offen offset:3072 lds
 v_mfma_f32_16x16x32_bf16 v[156:159], v[108:111], v[20:23], v[156:159]
 ds_read_b128 v[52:55], v244 offset:8192
 s_barrier
 v_mfma_f32_16x16x32_bf16 v[160:163], v[112:115], v[56:59], v[160:163]
 s_add_u32 m0, s69, 32768
 ds_read_b128 v[24:27], v245 offset:32768
 s_andn2_b32 s66, s20, 512
 v_mfma_f32_16x16x32_bf16 v[160:163], v[116:119], v[60:63], v[160:163]
 s_add_u32 s66, s66, s76
 ds_read_b128 v[28:31], v245 offset:40960
 s_add_u32 s66, s66, 40894464
 v_mfma_f32_16x16x32_bf16 v[164:167], v[120:123], v[56:59], v[164:167]
 buffer_load_dwordx4 v1, s[40:43], s66 offen offset:0 sc1 lds
 v_mfma_f32_16x16x32_bf16 v[164:167], v[124:127], v[60:63], v[164:167]
 ds_read_b64_tr_b16 v[80:81], v4 offset:32768
 v_mfma_f32_16x16x32_bf16 v[168:171], v[128:131], v[56:59], v[168:171]
 ds_read_b64_tr_b16 v[82:83], v4 offset:34816
 v_mfma_f32_16x16x32_bf16 v[168:171], v[132:135], v[60:63], v[168:171]
 ds_read_b64_tr_b16 v[84:85], v4 offset:40960
 v_mfma_f32_16x16x32_bf16 v[172:175], v[136:139], v[56:59], v[172:175]
 s_waitcnt lgkmcnt(5)
 buffer_load_dwordx4 v1, s[40:43], s66 offen offset:1024 sc1 lds
 v_mfma_f32_16x16x32_bf16 v[172:175], v[140:143], v[60:63], v[172:175]
 s_add_u32 s85, s2, 1
 ds_read_b64_tr_b16 v[86:87], v4 offset:43008
 s_and_b32 s85, s85, 3
 v_mfma_f32_16x16x32_bf16 v[176:179], v[112:115], v[64:67], v[176:179]
 s_andn2_b32 s86, s2, 3
 ds_read_b64_tr_b16 v[88:89], v5 offset:32768
 s_add_u32 s85, s85, s86
 v_mfma_f32_16x16x32_bf16 v[176:179], v[116:119], v[68:71], v[176:179]
 s_lshl_b32 s85, s85, 2
 ds_read_b64_tr_b16 v[90:91], v5 offset:34816
 s_add_u32 s85, s85, s60
 v_mfma_f32_16x16x32_bf16 v[180:183], v[120:123], v[64:67], v[180:183]
 buffer_load_dwordx4 v1, s[40:43], s66 offen offset:2048 sc1 lds
 v_mfma_f32_16x16x32_bf16 v[180:183], v[124:127], v[68:71], v[180:183]
 s_mul_i32 s85, s85, 7168
 ds_read_b64_tr_b16 v[92:93], v5 offset:40960
 s_add_u32 s78, s85, 70254592
 v_mfma_f32_16x16x32_bf16 v[184:187], v[128:131], v[64:67], v[184:187]
 ds_read_b64_tr_b16 v[94:95], v5 offset:43008
 v_mfma_f32_16x16x32_bf16 v[184:187], v[132:135], v[68:71], v[184:187]
 ds_read_b64_tr_b16 v[96:97], v6 offset:32768
 v_mfma_f32_16x16x32_bf16 v[188:191], v[136:139], v[64:67], v[188:191]
 buffer_load_dwordx4 v1, s[40:43], s66 offen offset:3072 sc1 lds
 v_mfma_f32_16x16x32_bf16 v[188:191], v[140:143], v[68:71], v[188:191]
 s_add_u32 m0, s69, 147456
 ds_read_b64_tr_b16 v[98:99], v6 offset:34816
 s_add_u32 s12, s11, 8
 v_mfma_f32_16x16x32_bf16 v[192:195], v[112:115], v[72:75], v[192:195]
 s_and_b32 s12, s12, 15
 ds_read_b64_tr_b16 v[100:101], v6 offset:40960
 s_xor_b32 s12, s12, s10
 v_mfma_f32_16x16x32_bf16 v[192:195], v[116:119], v[76:79], v[192:195]
 s_lshl_b32 s67, s12, 16
 ds_read_b64_tr_b16 v[102:103], v6 offset:43008
 s_add_u32 s67, s67, s64
 v_mfma_f32_16x16x32_bf16 v[196:199], v[120:123], v[72:75], v[196:199]
 s_mul_i32 s21, s12, 8704
 v_mfma_f32_16x16x32_bf16 v[196:199], v[124:127], v[76:79], v[196:199]
 ds_read_b64_tr_b16 v[104:105], v7 offset:32768
 v_mfma_f32_16x16x32_bf16 v[200:203], v[128:131], v[72:75], v[200:203]
 ds_read_b64_tr_b16 v[106:107], v7 offset:34816
 v_mfma_f32_16x16x32_bf16 v[200:203], v[132:135], v[76:79], v[200:203]
 ds_read_b64_tr_b16 v[108:109], v7 offset:40960
 v_mfma_f32_16x16x32_bf16 v[204:207], v[136:139], v[72:75], v[204:207]
 buffer_load_dwordx4 v12, s[32:35], s67 offen offset:0 lds
 v_mfma_f32_16x16x32_bf16 v[204:207], v[140:143], v[76:79], v[204:207]
 ds_read_b64_tr_b16 v[110:111], v7 offset:43008
 v_mfma_f32_16x16x32_bf16 v[144:147], v[112:115], v[48:51], v[144:147]
 ds_read_b128 v[32:35], v246 offset:32768
 v_mfma_f32_16x16x32_bf16 v[144:147], v[116:119], v[52:55], v[144:147]
 ds_read_b128 v[36:39], v246 offset:40960
 v_mfma_f32_16x16x32_bf16 v[148:151], v[120:123], v[48:51], v[148:151]
 buffer_load_dwordx4 v13, s[32:35], s67 offen offset:1024 lds
 v_mfma_f32_16x16x32_bf16 v[148:151], v[124:127], v[52:55], v[148:151]
 ds_read_b128 v[40:43], v247 offset:32768
 v_mfma_f32_16x16x32_bf16 v[152:155], v[128:131], v[48:51], v[152:155]
 ds_read_b128 v[44:47], v247 offset:40960
 v_mfma_f32_16x16x32_bf16 v[152:155], v[132:135], v[52:55], v[152:155]
 s_waitcnt vmcnt(10) lgkmcnt(6)
 ds_read_b128 v[16:19], v244 offset:32768
 v_mfma_f32_16x16x32_bf16 v[156:159], v[136:139], v[48:51], v[156:159]
 buffer_load_dwordx4 v14, s[32:35], s67 offen offset:2048 lds
 buffer_load_dwordx4 v15, s[32:35], s67 offen offset:3072 lds
 v_mfma_f32_16x16x32_bf16 v[156:159], v[140:143], v[52:55], v[156:159]
 ds_read_b128 v[20:23], v244 offset:40960
 s_barrier
 v_mfma_f32_16x16x32_bf16 v[160:163], v[80:83], v[24:27], v[160:163]
 s_add_u32 m0, s69, 131072
 ds_read_b128 v[56:59], v241 offset:0
 s_andn2_b32 s68, s21, 512
 v_mfma_f32_16x16x32_bf16 v[160:163], v[84:87], v[28:31], v[160:163]
 s_add_u32 s68, s68, s76
 ds_read_b128 v[60:63], v241 offset:8192
 s_add_u32 s68, s68, 40894464
 v_mfma_f32_16x16x32_bf16 v[164:167], v[88:91], v[24:27], v[164:167]
 buffer_load_dwordx4 v1, s[40:43], s68 offen offset:0 sc1 lds
 v_mfma_f32_16x16x32_bf16 v[164:167], v[92:95], v[28:31], v[164:167]
 ds_read_b64_tr_b16 v[112:113], v8 offset:0
 v_mfma_f32_16x16x32_bf16 v[168:171], v[96:99], v[24:27], v[168:171]
 ds_read_b64_tr_b16 v[114:115], v8 offset:2048
 v_mfma_f32_16x16x32_bf16 v[168:171], v[100:103], v[28:31], v[168:171]
 ds_read_b64_tr_b16 v[116:117], v8 offset:8192
 v_mfma_f32_16x16x32_bf16 v[172:175], v[104:107], v[24:27], v[172:175]
 s_waitcnt lgkmcnt(5)
 buffer_load_dwordx4 v1, s[40:43], s68 offen offset:1024 sc1 lds
 v_mfma_f32_16x16x32_bf16 v[172:175], v[108:111], v[28:31], v[172:175]
 s_add_u32 s85, s2, 2
 ds_read_b64_tr_b16 v[118:119], v8 offset:10240
 s_and_b32 s85, s85, 3
 v_mfma_f32_16x16x32_bf16 v[176:179], v[80:83], v[32:35], v[176:179]
 s_andn2_b32 s86, s2, 3
 ds_read_b64_tr_b16 v[120:121], v9 offset:0
 s_add_u32 s85, s85, s86
 v_mfma_f32_16x16x32_bf16 v[176:179], v[84:87], v[36:39], v[176:179]
 s_lshl_b32 s85, s85, 2
 ds_read_b64_tr_b16 v[122:123], v9 offset:2048
 s_add_u32 s85, s85, s60
 v_mfma_f32_16x16x32_bf16 v[180:183], v[88:91], v[32:35], v[180:183]
 buffer_load_dwordx4 v1, s[40:43], s68 offen offset:2048 sc1 lds
 v_mfma_f32_16x16x32_bf16 v[180:183], v[92:95], v[36:39], v[180:183]
 s_mul_i32 s85, s85, 7168
 ds_read_b64_tr_b16 v[124:125], v9 offset:8192
 s_add_u32 s79, s85, 70256640
 v_mfma_f32_16x16x32_bf16 v[184:187], v[96:99], v[32:35], v[184:187]
 ds_read_b64_tr_b16 v[126:127], v9 offset:10240
 v_mfma_f32_16x16x32_bf16 v[184:187], v[100:103], v[36:39], v[184:187]
 ds_read_b64_tr_b16 v[128:129], v10 offset:0
 v_mfma_f32_16x16x32_bf16 v[188:191], v[104:107], v[32:35], v[188:191]
 buffer_load_dwordx4 v1, s[40:43], s68 offen offset:3072 sc1 lds
 v_mfma_f32_16x16x32_bf16 v[188:191], v[108:111], v[36:39], v[188:191]
 s_add_u32 m0, s69, 81920
 ds_read_b64_tr_b16 v[130:131], v10 offset:2048
 s_add_u32 s12, s11, 9
 v_mfma_f32_16x16x32_bf16 v[192:195], v[80:83], v[40:43], v[192:195]
 s_and_b32 s12, s12, 15
 ds_read_b64_tr_b16 v[132:133], v10 offset:8192
 s_xor_b32 s12, s12, s10
 v_mfma_f32_16x16x32_bf16 v[192:195], v[84:87], v[44:47], v[192:195]
 s_lshl_b32 s65, s12, 16
 ds_read_b64_tr_b16 v[134:135], v10 offset:10240
 s_add_u32 s65, s65, s64
 v_mfma_f32_16x16x32_bf16 v[196:199], v[88:91], v[40:43], v[196:199]
 s_mul_i32 s18, s12, 8704
 v_mfma_f32_16x16x32_bf16 v[196:199], v[92:95], v[44:47], v[196:199]
 ds_read_b64_tr_b16 v[136:137], v11 offset:0
 v_mfma_f32_16x16x32_bf16 v[200:203], v[96:99], v[40:43], v[200:203]
 ds_read_b64_tr_b16 v[138:139], v11 offset:2048
 v_mfma_f32_16x16x32_bf16 v[200:203], v[100:103], v[44:47], v[200:203]
 ds_read_b64_tr_b16 v[140:141], v11 offset:8192
 v_mfma_f32_16x16x32_bf16 v[204:207], v[104:107], v[40:43], v[204:207]
 buffer_load_dwordx4 v12, s[32:35], s65 offen offset:0 lds
 v_mfma_f32_16x16x32_bf16 v[204:207], v[108:111], v[44:47], v[204:207]
 ds_read_b64_tr_b16 v[142:143], v11 offset:10240
 v_mfma_f32_16x16x32_bf16 v[144:147], v[80:83], v[16:19], v[144:147]
 ds_read_b128 v[64:67], v242 offset:0
 v_mfma_f32_16x16x32_bf16 v[144:147], v[84:87], v[20:23], v[144:147]
 ds_read_b128 v[68:71], v242 offset:8192
 v_mfma_f32_16x16x32_bf16 v[148:151], v[88:91], v[16:19], v[148:151]
 buffer_load_dwordx4 v13, s[32:35], s65 offen offset:1024 lds
 v_mfma_f32_16x16x32_bf16 v[148:151], v[92:95], v[20:23], v[148:151]
 ds_read_b128 v[72:75], v243 offset:0
 v_mfma_f32_16x16x32_bf16 v[152:155], v[96:99], v[16:19], v[152:155]
 ds_read_b128 v[76:79], v243 offset:8192
 v_mfma_f32_16x16x32_bf16 v[152:155], v[100:103], v[20:23], v[152:155]
 s_waitcnt vmcnt(10) lgkmcnt(6)
 ds_read_b128 v[48:51], v240 offset:0
 v_mfma_f32_16x16x32_bf16 v[156:159], v[104:107], v[16:19], v[156:159]
 buffer_load_dwordx4 v14, s[32:35], s65 offen offset:2048 lds
 buffer_load_dwordx4 v15, s[32:35], s65 offen offset:3072 lds
 v_mfma_f32_16x16x32_bf16 v[156:159], v[108:111], v[20:23], v[156:159]
 ds_read_b128 v[52:55], v240 offset:8192
 s_barrier
 v_mfma_f32_16x16x32_bf16 v[160:163], v[112:115], v[56:59], v[160:163]
 s_add_u32 m0, s69, 65536
 ds_read_b128 v[24:27], v241 offset:32768
 s_andn2_b32 s66, s18, 512
 v_mfma_f32_16x16x32_bf16 v[160:163], v[116:119], v[60:63], v[160:163]
 s_add_u32 s66, s66, s76
 ds_read_b128 v[28:31], v241 offset:40960
 s_add_u32 s66, s66, 40894464
 v_mfma_f32_16x16x32_bf16 v[164:167], v[120:123], v[56:59], v[164:167]
 buffer_load_dwordx4 v1, s[40:43], s66 offen offset:0 sc1 lds
 v_mfma_f32_16x16x32_bf16 v[164:167], v[124:127], v[60:63], v[164:167]
 ds_read_b64_tr_b16 v[80:81], v8 offset:32768
 v_mfma_f32_16x16x32_bf16 v[168:171], v[128:131], v[56:59], v[168:171]
 ds_read_b64_tr_b16 v[82:83], v8 offset:34816
 v_mfma_f32_16x16x32_bf16 v[168:171], v[132:135], v[60:63], v[168:171]
 ds_read_b64_tr_b16 v[84:85], v8 offset:40960
 v_mfma_f32_16x16x32_bf16 v[172:175], v[136:139], v[56:59], v[172:175]
 s_waitcnt lgkmcnt(5)
 buffer_load_dwordx4 v1, s[40:43], s66 offen offset:1024 sc1 lds
 v_mfma_f32_16x16x32_bf16 v[172:175], v[140:143], v[60:63], v[172:175]
 s_add_u32 s85, s2, 3
 ds_read_b64_tr_b16 v[86:87], v8 offset:43008
 s_and_b32 s85, s85, 3
 v_mfma_f32_16x16x32_bf16 v[176:179], v[112:115], v[64:67], v[176:179]
L_w1_1:
L_st1_1:
 s_cbranch_execz L_warmed1
 s_andn2_b32 s86, s2, 3
 ds_read_b64_tr_b16 v[88:89], v9 offset:32768
 s_add_u32 s85, s85, s86
 v_mfma_f32_16x16x32_bf16 v[176:179], v[116:119], v[68:71], v[176:179]
 s_lshl_b32 s85, s85, 2
 ds_read_b64_tr_b16 v[90:91], v9 offset:34816
 s_add_u32 s85, s85, s60
 v_mfma_f32_16x16x32_bf16 v[180:183], v[120:123], v[64:67], v[180:183]
 buffer_load_dwordx4 v1, s[40:43], s66 offen offset:2048 sc1 lds
 v_mfma_f32_16x16x32_bf16 v[180:183], v[124:127], v[68:71], v[180:183]
 s_mul_i32 s85, s85, 7168
 ds_read_b64_tr_b16 v[92:93], v9 offset:40960
 s_add_u32 s80, s85, 70258688
 v_mfma_f32_16x16x32_bf16 v[184:187], v[128:131], v[64:67], v[184:187]
 ds_read_b64_tr_b16 v[94:95], v9 offset:43008
 v_mfma_f32_16x16x32_bf16 v[184:187], v[132:135], v[68:71], v[184:187]
 ds_read_b64_tr_b16 v[96:97], v10 offset:32768
 v_mfma_f32_16x16x32_bf16 v[188:191], v[136:139], v[64:67], v[188:191]
 buffer_load_dwordx4 v1, s[40:43], s66 offen offset:3072 sc1 lds
 v_mfma_f32_16x16x32_bf16 v[188:191], v[140:143], v[68:71], v[188:191]
 s_add_u32 m0, s69, 114688
 ds_read_b64_tr_b16 v[98:99], v10 offset:34816
 s_add_u32 s12, s11, 10
 v_mfma_f32_16x16x32_bf16 v[192:195], v[112:115], v[72:75], v[192:195]
 s_and_b32 s12, s12, 15
 ds_read_b64_tr_b16 v[100:101], v10 offset:40960
 s_xor_b32 s12, s12, s10
 v_mfma_f32_16x16x32_bf16 v[192:195], v[116:119], v[76:79], v[192:195]
 s_lshl_b32 s67, s12, 16
 ds_read_b64_tr_b16 v[102:103], v10 offset:43008
 s_add_u32 s67, s67, s64
 v_mfma_f32_16x16x32_bf16 v[196:199], v[120:123], v[72:75], v[196:199]
 s_mul_i32 s19, s12, 8704
 v_mfma_f32_16x16x32_bf16 v[196:199], v[124:127], v[76:79], v[196:199]
 ds_read_b64_tr_b16 v[104:105], v11 offset:32768
 v_mfma_f32_16x16x32_bf16 v[200:203], v[128:131], v[72:75], v[200:203]
 ds_read_b64_tr_b16 v[106:107], v11 offset:34816
 v_mfma_f32_16x16x32_bf16 v[200:203], v[132:135], v[76:79], v[200:203]
 ds_read_b64_tr_b16 v[108:109], v11 offset:40960
 v_mfma_f32_16x16x32_bf16 v[204:207], v[136:139], v[72:75], v[204:207]
 buffer_load_dwordx4 v12, s[32:35], s67 offen offset:0 lds
 v_mfma_f32_16x16x32_bf16 v[204:207], v[140:143], v[76:79], v[204:207]
 ds_read_b64_tr_b16 v[110:111], v11 offset:43008
 v_mfma_f32_16x16x32_bf16 v[144:147], v[112:115], v[48:51], v[144:147]
 ds_read_b128 v[32:35], v242 offset:32768
 v_mfma_f32_16x16x32_bf16 v[144:147], v[116:119], v[52:55], v[144:147]
 ds_read_b128 v[36:39], v242 offset:40960
 v_mfma_f32_16x16x32_bf16 v[148:151], v[120:123], v[48:51], v[148:151]
 buffer_load_dwordx4 v13, s[32:35], s67 offen offset:1024 lds
 v_mfma_f32_16x16x32_bf16 v[148:151], v[124:127], v[52:55], v[148:151]
 ds_read_b128 v[40:43], v243 offset:32768
 v_mfma_f32_16x16x32_bf16 v[152:155], v[128:131], v[48:51], v[152:155]
 ds_read_b128 v[44:47], v243 offset:40960
 v_mfma_f32_16x16x32_bf16 v[152:155], v[132:135], v[52:55], v[152:155]
 s_waitcnt vmcnt(10) lgkmcnt(3)
 ds_read_b128 v[16:19], v240 offset:32768
 v_mfma_f32_16x16x32_bf16 v[156:159], v[136:139], v[48:51], v[156:159]
 buffer_load_dwordx4 v14, s[32:35], s67 offen offset:2048 lds
 buffer_load_dwordx4 v15, s[32:35], s67 offen offset:3072 lds
 v_mfma_f32_16x16x32_bf16 v[156:159], v[140:143], v[52:55], v[156:159]
 ds_read_b128 v[20:23], v240 offset:40960
 s_barrier
 v_mfma_f32_16x16x32_bf16 v[160:163], v[80:83], v[24:27], v[160:163]
 s_add_u32 m0, s69, 98304
 ds_read_b128 v[56:59], v237 offset:0
 s_andn2_b32 s68, s19, 512
 v_mfma_f32_16x16x32_bf16 v[160:163], v[84:87], v[28:31], v[160:163]
 s_add_u32 s68, s68, s76
 ds_read_b128 v[60:63], v237 offset:8192
 s_add_u32 s68, s68, 40894464
 v_mfma_f32_16x16x32_bf16 v[164:167], v[88:91], v[24:27], v[164:167]
 buffer_load_dwordx4 v1, s[40:43], s68 offen offset:0 sc1 lds
 v_mfma_f32_16x16x32_bf16 v[164:167], v[92:95], v[28:31], v[164:167]
 ds_read_b64_tr_b16 v[112:113], v232 offset:0
 v_mfma_f32_16x16x32_bf16 v[168:171], v[96:99], v[24:27], v[168:171]
 ds_read_b64_tr_b16 v[114:115], v232 offset:2048
 v_mfma_f32_16x16x32_bf16 v[168:171], v[100:103], v[28:31], v[168:171]
 ds_read_b64_tr_b16 v[116:117], v232 offset:8192
 v_mfma_f32_16x16x32_bf16 v[172:175], v[104:107], v[24:27], v[172:175]
 buffer_load_dwordx4 v1, s[40:43], s68 offen offset:1024 sc1 lds
 v_mfma_f32_16x16x32_bf16 v[172:175], v[108:111], v[28:31], v[172:175]
 s_add_u32 s85, s77, 4096
 ds_read_b64_tr_b16 v[118:119], v232 offset:10240
 s_mov_b32 s94, 0
 v_mfma_f32_16x16x32_bf16 v[176:179], v[80:83], v[32:35], v[176:179]
 s_waitcnt lgkmcnt(6)
 ds_read_b64_tr_b16 v[120:121], v233 offset:0
 v_mfma_f32_16x16x32_bf16 v[176:179], v[84:87], v[36:39], v[176:179]
 ds_read_b64_tr_b16 v[122:123], v233 offset:2048
 v_mfma_f32_16x16x32_bf16 v[180:183], v[88:91], v[32:35], v[180:183]
 buffer_load_dwordx4 v1, s[40:43], s68 offen offset:2048 sc1 lds
 v_mfma_f32_16x16x32_bf16 v[180:183], v[92:95], v[36:39], v[180:183]
 ds_read_b64_tr_b16 v[124:125], v233 offset:8192
 v_mfma_f32_16x16x32_bf16 v[184:187], v[96:99], v[32:35], v[184:187]
 ds_read_b64_tr_b16 v[126:127], v233 offset:10240
 v_mfma_f32_16x16x32_bf16 v[184:187], v[100:103], v[36:39], v[184:187]
 ds_read_b64_tr_b16 v[128:129], v234 offset:0
 v_mfma_f32_16x16x32_bf16 v[188:191], v[104:107], v[32:35], v[188:191]
 buffer_load_dwordx4 v1, s[40:43], s68 offen offset:3072 sc1 lds
 v_mfma_f32_16x16x32_bf16 v[188:191], v[108:111], v[36:39], v[188:191]
 s_add_u32 m0, s69, 16384
 ds_read_b64_tr_b16 v[130:131], v234 offset:2048
 s_add_u32 s12, s11, 11
 v_mfma_f32_16x16x32_bf16 v[192:195], v[80:83], v[40:43], v[192:195]
 s_and_b32 s12, s12, 15
 ds_read_b64_tr_b16 v[132:133], v234 offset:8192
 s_xor_b32 s12, s12, s10
 v_mfma_f32_16x16x32_bf16 v[192:195], v[84:87], v[44:47], v[192:195]
 s_lshl_b32 s65, s12, 16
 ds_read_b64_tr_b16 v[134:135], v234 offset:10240
 s_add_u32 s65, s65, s64
 v_mfma_f32_16x16x32_bf16 v[196:199], v[88:91], v[40:43], v[196:199]
 s_mul_i32 s20, s12, 8704
 v_mfma_f32_16x16x32_bf16 v[196:199], v[92:95], v[44:47], v[196:199]
 ds_read_b64_tr_b16 v[136:137], v235 offset:0
 v_mfma_f32_16x16x32_bf16 v[200:203], v[96:99], v[40:43], v[200:203]
 ds_read_b64_tr_b16 v[138:139], v235 offset:2048
 v_mfma_f32_16x16x32_bf16 v[200:203], v[100:103], v[44:47], v[200:203]
 ds_read_b64_tr_b16 v[140:141], v235 offset:8192
 v_mfma_f32_16x16x32_bf16 v[204:207], v[104:107], v[40:43], v[204:207]
 buffer_load_dwordx4 v12, s[32:35], s65 offen offset:0 lds
 v_mfma_f32_16x16x32_bf16 v[204:207], v[108:111], v[44:47], v[204:207]
 ds_read_b64_tr_b16 v[142:143], v235 offset:10240
 v_mfma_f32_16x16x32_bf16 v[144:147], v[80:83], v[16:19], v[144:147]
 ds_read_b128 v[64:67], v238 offset:0
 v_mfma_f32_16x16x32_bf16 v[144:147], v[84:87], v[20:23], v[144:147]
 ds_read_b128 v[68:71], v238 offset:8192
 v_mfma_f32_16x16x32_bf16 v[148:151], v[88:91], v[16:19], v[148:151]
 buffer_load_dwordx4 v13, s[32:35], s65 offen offset:1024 lds
 v_mfma_f32_16x16x32_bf16 v[148:151], v[92:95], v[20:23], v[148:151]
 ds_read_b128 v[72:75], v239 offset:0
 v_mfma_f32_16x16x32_bf16 v[152:155], v[96:99], v[16:19], v[152:155]
 ds_read_b128 v[76:79], v239 offset:8192
 v_mfma_f32_16x16x32_bf16 v[152:155], v[100:103], v[20:23], v[152:155]
 s_waitcnt vmcnt(10) lgkmcnt(3)
 ds_read_b128 v[48:51], v236 offset:0
 v_mfma_f32_16x16x32_bf16 v[156:159], v[104:107], v[16:19], v[156:159]
 buffer_load_dwordx4 v14, s[32:35], s65 offen offset:2048 lds
 buffer_load_dwordx4 v15, s[32:35], s65 offen offset:3072 lds
 v_mfma_f32_16x16x32_bf16 v[156:159], v[108:111], v[20:23], v[156:159]
 ds_read_b128 v[52:55], v236 offset:8192
 s_barrier
 v_mfma_f32_16x16x32_bf16 v[160:163], v[112:115], v[56:59], v[160:163]
 s_add_u32 m0, s69, 0
 ds_read_b128 v[24:27], v245 offset:0
 s_andn2_b32 s66, s20, 512
 v_mfma_f32_16x16x32_bf16 v[160:163], v[116:119], v[60:63], v[160:163]
 s_add_u32 s66, s66, s76
 ds_read_b128 v[28:31], v245 offset:8192
 s_add_u32 s66, s66, 40894464
 v_mfma_f32_16x16x32_bf16 v[164:167], v[120:123], v[56:59], v[164:167]
 buffer_load_dwordx4 v1, s[40:43], s66 offen offset:0 sc1 lds
 v_mfma_f32_16x16x32_bf16 v[164:167], v[124:127], v[60:63], v[164:167]
 ds_read_b64_tr_b16 v[80:81], v4 offset:0
 v_mfma_f32_16x16x32_bf16 v[168:171], v[128:131], v[56:59], v[168:171]
 ds_read_b64_tr_b16 v[82:83], v4 offset:2048
 v_mfma_f32_16x16x32_bf16 v[168:171], v[132:135], v[60:63], v[168:171]
 ds_read_b64_tr_b16 v[84:85], v4 offset:8192
 v_mfma_f32_16x16x32_bf16 v[172:175], v[136:139], v[56:59], v[172:175]
 buffer_load_dwordx4 v1, s[40:43], s66 offen offset:1024 sc1 lds
 v_mfma_f32_16x16x32_bf16 v[172:175], v[140:143], v[60:63], v[172:175]
 ds_read_b64_tr_b16 v[86:87], v4 offset:10240
 v_mfma_f32_16x16x32_bf16 v[176:179], v[112:115], v[64:67], v[176:179]
 s_waitcnt lgkmcnt(6)
 ds_read_b64_tr_b16 v[88:89], v5 offset:0
 v_mfma_f32_16x16x32_bf16 v[176:179], v[116:119], v[68:71], v[176:179]
 ds_read_b64_tr_b16 v[90:91], v5 offset:2048
 v_mfma_f32_16x16x32_bf16 v[180:183], v[120:123], v[64:67], v[180:183]
 buffer_load_dwordx4 v1, s[40:43], s66 offen offset:2048 sc1 lds
 v_mfma_f32_16x16x32_bf16 v[180:183], v[124:127], v[68:71], v[180:183]
 ds_read_b64_tr_b16 v[92:93], v5 offset:8192
 v_mfma_f32_16x16x32_bf16 v[184:187], v[128:131], v[64:67], v[184:187]
 ds_read_b64_tr_b16 v[94:95], v5 offset:10240
 v_mfma_f32_16x16x32_bf16 v[184:187], v[132:135], v[68:71], v[184:187]
 ds_read_b64_tr_b16 v[96:97], v6 offset:0
 v_mfma_f32_16x16x32_bf16 v[188:191], v[136:139], v[64:67], v[188:191]
 buffer_load_dwordx4 v1, s[40:43], s66 offen offset:3072 sc1 lds
 v_mfma_f32_16x16x32_bf16 v[188:191], v[140:143], v[68:71], v[188:191]
 s_add_u32 m0, s69, 49152
 ds_read_b64_tr_b16 v[98:99], v6 offset:2048
 s_add_u32 s12, s11, 12
 v_mfma_f32_16x16x32_bf16 v[192:195], v[112:115], v[72:75], v[192:195]
 s_and_b32 s12, s12, 15
 ds_read_b64_tr_b16 v[100:101], v6 offset:8192
 s_xor_b32 s12, s12, s10
 v_mfma_f32_16x16x32_bf16 v[192:195], v[116:119], v[76:79], v[192:195]
 s_lshl_b32 s67, s12, 16
 ds_read_b64_tr_b16 v[102:103], v6 offset:10240
 s_add_u32 s67, s67, s64
 v_mfma_f32_16x16x32_bf16 v[196:199], v[120:123], v[72:75], v[196:199]
 s_mul_i32 s21, s12, 8704
 v_mfma_f32_16x16x32_bf16 v[196:199], v[124:127], v[76:79], v[196:199]
 ds_read_b64_tr_b16 v[104:105], v7 offset:0
 v_mfma_f32_16x16x32_bf16 v[200:203], v[128:131], v[72:75], v[200:203]
 ds_read_b64_tr_b16 v[106:107], v7 offset:2048
 v_mfma_f32_16x16x32_bf16 v[200:203], v[132:135], v[76:79], v[200:203]
 ds_read_b64_tr_b16 v[108:109], v7 offset:8192
 v_mfma_f32_16x16x32_bf16 v[204:207], v[136:139], v[72:75], v[204:207]
 buffer_load_dwordx4 v12, s[32:35], s67 offen offset:0 lds
 v_mfma_f32_16x16x32_bf16 v[204:207], v[140:143], v[76:79], v[204:207]
 ds_read_b64_tr_b16 v[110:111], v7 offset:10240
 v_mfma_f32_16x16x32_bf16 v[144:147], v[112:115], v[48:51], v[144:147]
 ds_read_b128 v[32:35], v246 offset:0
 v_mfma_f32_16x16x32_bf16 v[144:147], v[116:119], v[52:55], v[144:147]
 ds_read_b128 v[36:39], v246 offset:8192
 v_mfma_f32_16x16x32_bf16 v[148:151], v[120:123], v[48:51], v[148:151]
 buffer_load_dwordx4 v13, s[32:35], s67 offen offset:1024 lds
 v_mfma_f32_16x16x32_bf16 v[148:151], v[124:127], v[52:55], v[148:151]
 ds_read_b128 v[40:43], v247 offset:0
 v_mfma_f32_16x16x32_bf16 v[152:155], v[128:131], v[48:51], v[152:155]
 ds_read_b128 v[44:47], v247 offset:8192
 v_mfma_f32_16x16x32_bf16 v[152:155], v[132:135], v[52:55], v[152:155]
 s_waitcnt vmcnt(10) lgkmcnt(3)
 ds_read_b128 v[16:19], v244 offset:0
 v_mfma_f32_16x16x32_bf16 v[156:159], v[136:139], v[48:51], v[156:159]
 buffer_load_dwordx4 v14, s[32:35], s67 offen offset:2048 lds
 buffer_load_dwordx4 v15, s[32:35], s67 offen offset:3072 lds
 v_mfma_f32_16x16x32_bf16 v[156:159], v[140:143], v[52:55], v[156:159]
 ds_read_b128 v[20:23], v244 offset:8192
 s_barrier
 v_mfma_f32_16x16x32_bf16 v[160:163], v[80:83], v[24:27], v[160:163]
 s_add_u32 m0, s69, 32768
 ds_read_b128 v[56:59], v245 offset:32768
 s_andn2_b32 s68, s21, 512
 v_mfma_f32_16x16x32_bf16 v[160:163], v[84:87], v[28:31], v[160:163]
 s_add_u32 s68, s68, s76
 ds_read_b128 v[60:63], v245 offset:40960
 s_add_u32 s68, s68, 40894464
 v_mfma_f32_16x16x32_bf16 v[164:167], v[88:91], v[24:27], v[164:167]
 buffer_load_dwordx4 v1, s[40:43], s68 offen offset:0 sc1 lds
 v_mfma_f32_16x16x32_bf16 v[164:167], v[92:95], v[28:31], v[164:167]
 ds_read_b64_tr_b16 v[112:113], v4 offset:32768
 v_mfma_f32_16x16x32_bf16 v[168:171], v[96:99], v[24:27], v[168:171]
 ds_read_b64_tr_b16 v[114:115], v4 offset:34816
 v_mfma_f32_16x16x32_bf16 v[168:171], v[100:103], v[28:31], v[168:171]
 ds_read_b64_tr_b16 v[116:117], v4 offset:40960
 v_mfma_f32_16x16x32_bf16 v[172:175], v[104:107], v[24:27], v[172:175]
 buffer_load_dwordx4 v1, s[40:43], s68 offen offset:1024 sc1 lds
 v_mfma_f32_16x16x32_bf16 v[172:175], v[108:111], v[28:31], v[172:175]
 ds_read_b64_tr_b16 v[118:119], v4 offset:43008
 v_mfma_f32_16x16x32_bf16 v[176:179], v[80:83], v[32:35], v[176:179]
 s_waitcnt lgkmcnt(6)
 ds_read_b64_tr_b16 v[120:121], v5 offset:32768
 v_mfma_f32_16x16x32_bf16 v[176:179], v[84:87], v[36:39], v[176:179]
 ds_read_b64_tr_b16 v[122:123], v5 offset:34816
 v_mfma_f32_16x16x32_bf16 v[180:183], v[88:91], v[32:35], v[180:183]
 buffer_load_dwordx4 v1, s[40:43], s68 offen offset:2048 sc1 lds
 v_mfma_f32_16x16x32_bf16 v[180:183], v[92:95], v[36:39], v[180:183]
 ds_read_b64_tr_b16 v[124:125], v5 offset:40960
 v_mfma_f32_16x16x32_bf16 v[184:187], v[96:99], v[32:35], v[184:187]
 ds_read_b64_tr_b16 v[126:127], v5 offset:43008
 v_mfma_f32_16x16x32_bf16 v[184:187], v[100:103], v[36:39], v[184:187]
 ds_read_b64_tr_b16 v[128:129], v6 offset:32768
 v_mfma_f32_16x16x32_bf16 v[188:191], v[104:107], v[32:35], v[188:191]
 buffer_load_dwordx4 v1, s[40:43], s68 offen offset:3072 sc1 lds
 v_mfma_f32_16x16x32_bf16 v[188:191], v[108:111], v[36:39], v[188:191]
 s_add_u32 m0, s69, 147456
 ds_read_b64_tr_b16 v[130:131], v6 offset:34816
 s_add_u32 s12, s11, 13
 v_mfma_f32_16x16x32_bf16 v[192:195], v[80:83], v[40:43], v[192:195]
 s_and_b32 s12, s12, 15
 ds_read_b64_tr_b16 v[132:133], v6 offset:40960
 s_xor_b32 s12, s12, s10
 v_mfma_f32_16x16x32_bf16 v[192:195], v[84:87], v[44:47], v[192:195]
 s_lshl_b32 s65, s12, 16
 ds_read_b64_tr_b16 v[134:135], v6 offset:43008
 s_add_u32 s65, s65, s64
 v_mfma_f32_16x16x32_bf16 v[196:199], v[88:91], v[40:43], v[196:199]
 s_mul_i32 s18, s12, 8704
 v_mfma_f32_16x16x32_bf16 v[196:199], v[92:95], v[44:47], v[196:199]
 ds_read_b64_tr_b16 v[136:137], v7 offset:32768
 v_mfma_f32_16x16x32_bf16 v[200:203], v[96:99], v[40:43], v[200:203]
 ds_read_b64_tr_b16 v[138:139], v7 offset:34816
 v_mfma_f32_16x16x32_bf16 v[200:203], v[100:103], v[44:47], v[200:203]
 ds_read_b64_tr_b16 v[140:141], v7 offset:40960
 v_mfma_f32_16x16x32_bf16 v[204:207], v[104:107], v[40:43], v[204:207]
 buffer_load_dwordx4 v12, s[32:35], s65 offen offset:0 lds
 v_mfma_f32_16x16x32_bf16 v[204:207], v[108:111], v[44:47], v[204:207]
 ds_read_b64_tr_b16 v[142:143], v7 offset:43008
 v_mfma_f32_16x16x32_bf16 v[144:147], v[80:83], v[16:19], v[144:147]
 ds_read_b128 v[64:67], v246 offset:32768
 v_mfma_f32_16x16x32_bf16 v[144:147], v[84:87], v[20:23], v[144:147]
 ds_read_b128 v[68:71], v246 offset:40960
 v_mfma_f32_16x16x32_bf16 v[148:151], v[88:91], v[16:19], v[148:151]
 buffer_load_dwordx4 v13, s[32:35], s65 offen offset:1024 lds
 v_mfma_f32_16x16x32_bf16 v[148:151], v[92:95], v[20:23], v[148:151]
 ds_read_b128 v[72:75], v247 offset:32768
 v_mfma_f32_16x16x32_bf16 v[152:155], v[96:99], v[16:19], v[152:155]
 ds_read_b128 v[76:79], v247 offset:40960
 v_mfma_f32_16x16x32_bf16 v[152:155], v[100:103], v[20:23], v[152:155]
 s_waitcnt vmcnt(10) lgkmcnt(3)
 ds_read_b128 v[48:51], v244 offset:32768
 v_mfma_f32_16x16x32_bf16 v[156:159], v[104:107], v[16:19], v[156:159]
 buffer_load_dwordx4 v14, s[32:35], s65 offen offset:2048 lds
 buffer_load_dwordx4 v15, s[32:35], s65 offen offset:3072 lds
 v_mfma_f32_16x16x32_bf16 v[156:159], v[108:111], v[20:23], v[156:159]
 ds_read_b128 v[52:55], v244 offset:40960
 s_barrier
 v_mfma_f32_16x16x32_bf16 v[160:163], v[112:115], v[56:59], v[160:163]
 s_add_u32 m0, s69, 131072
 ds_read_b128 v[24:27], v241 offset:0
 s_andn2_b32 s66, s18, 512
 v_mfma_f32_16x16x32_bf16 v[160:163], v[116:119], v[60:63], v[160:163]
 s_add_u32 s66, s66, s76
 ds_read_b128 v[28:31], v241 offset:8192
 s_add_u32 s66, s66, 40894464
 v_mfma_f32_16x16x32_bf16 v[164:167], v[120:123], v[56:59], v[164:167]
 buffer_load_dwordx4 v1, s[40:43], s66 offen offset:0 sc1 lds
 v_mfma_f32_16x16x32_bf16 v[164:167], v[124:127], v[60:63], v[164:167]
 ds_read_b64_tr_b16 v[80:81], v8 offset:0
 v_mfma_f32_16x16x32_bf16 v[168:171], v[128:131], v[56:59], v[168:171]
 ds_read_b64_tr_b16 v[82:83], v8 offset:2048
 v_mfma_f32_16x16x32_bf16 v[168:171], v[132:135], v[60:63], v[168:171]
 ds_read_b64_tr_b16 v[84:85], v8 offset:8192
 v_mfma_f32_16x16x32_bf16 v[172:175], v[136:139], v[56:59], v[172:175]
 buffer_load_dwordx4 v1, s[40:43], s66 offen offset:1024 sc1 lds
 v_mfma_f32_16x16x32_bf16 v[172:175], v[140:143], v[60:63], v[172:175]
 ds_read_b64_tr_b16 v[86:87], v8 offset:10240
 v_mfma_f32_16x16x32_bf16 v[176:179], v[112:115], v[64:67], v[176:179]
 s_waitcnt lgkmcnt(6)
 ds_read_b64_tr_b16 v[88:89], v9 offset:0
 v_mfma_f32_16x16x32_bf16 v[176:179], v[116:119], v[68:71], v[176:179]
 ds_read_b64_tr_b16 v[90:91], v9 offset:2048
 v_mfma_f32_16x16x32_bf16 v[180:183], v[120:123], v[64:67], v[180:183]
 buffer_load_dwordx4 v1, s[40:43], s66 offen offset:2048 sc1 lds
 v_mfma_f32_16x16x32_bf16 v[180:183], v[124:127], v[68:71], v[180:183]
 ds_read_b64_tr_b16 v[92:93], v9 offset:8192
 v_mfma_f32_16x16x32_bf16 v[184:187], v[128:131], v[64:67], v[184:187]
 ds_read_b64_tr_b16 v[94:95], v9 offset:10240
 v_mfma_f32_16x16x32_bf16 v[184:187], v[132:135], v[68:71], v[184:187]
 ds_read_b64_tr_b16 v[96:97], v10 offset:0
 v_mfma_f32_16x16x32_bf16 v[188:191], v[136:139], v[64:67], v[188:191]
 buffer_load_dwordx4 v1, s[40:43], s66 offen offset:3072 sc1 lds
 v_mfma_f32_16x16x32_bf16 v[188:191], v[140:143], v[68:71], v[188:191]
 s_add_u32 m0, s69, 81920
 ds_read_b64_tr_b16 v[98:99], v10 offset:2048
 s_add_u32 s12, s11, 14
 v_mfma_f32_16x16x32_bf16 v[192:195], v[112:115], v[72:75], v[192:195]
 s_and_b32 s12, s12, 15
 ds_read_b64_tr_b16 v[100:101], v10 offset:8192
 s_xor_b32 s12, s12, s10
 v_mfma_f32_16x16x32_bf16 v[192:195], v[116:119], v[76:79], v[192:195]
 s_lshl_b32 s67, s12, 16
 ds_read_b64_tr_b16 v[102:103], v10 offset:10240
 s_add_u32 s67, s67, s64
 v_mfma_f32_16x16x32_bf16 v[196:199], v[120:123], v[72:75], v[196:199]
 s_mul_i32 s19, s12, 8704
 v_mfma_f32_16x16x32_bf16 v[196:199], v[124:127], v[76:79], v[196:199]
 ds_read_b64_tr_b16 v[104:105], v11 offset:0
 v_mfma_f32_16x16x32_bf16 v[200:203], v[128:131], v[72:75], v[200:203]
 ds_read_b64_tr_b16 v[106:107], v11 offset:2048
 v_mfma_f32_16x16x32_bf16 v[200:203], v[132:135], v[76:79], v[200:203]
 ds_read_b64_tr_b16 v[108:109], v11 offset:8192
 v_mfma_f32_16x16x32_bf16 v[204:207], v[136:139], v[72:75], v[204:207]
 buffer_load_dwordx4 v12, s[32:35], s67 offen offset:0 lds
 v_mfma_f32_16x16x32_bf16 v[204:207], v[140:143], v[76:79], v[204:207]
 ds_read_b64_tr_b16 v[110:111], v11 offset:10240
 v_mfma_f32_16x16x32_bf16 v[144:147], v[112:115], v[48:51], v[144:147]
 ds_read_b128 v[32:35], v242 offset:0
 v_mfma_f32_16x16x32_bf16 v[144:147], v[116:119], v[52:55], v[144:147]
 ds_read_b128 v[36:39], v242 offset:8192
 v_mfma_f32_16x16x32_bf16 v[148:151], v[120:123], v[48:51], v[148:151]
 buffer_load_dwordx4 v13, s[32:35], s67 offen offset:1024 lds
 v_mfma_f32_16x16x32_bf16 v[148:151], v[124:127], v[52:55], v[148:151]
 ds_read_b128 v[40:43], v243 offset:0
 v_mfma_f32_16x16x32_bf16 v[152:155], v[128:131], v[48:51], v[152:155]
 ds_read_b128 v[44:47], v243 offset:8192
 v_mfma_f32_16x16x32_bf16 v[152:155], v[132:135], v[52:55], v[152:155]
 s_waitcnt vmcnt(10) lgkmcnt(3)
 ds_read_b128 v[16:19], v240 offset:0
 v_mfma_f32_16x16x32_bf16 v[156:159], v[136:139], v[48:51], v[156:159]
 buffer_load_dwordx4 v14, s[32:35], s67 offen offset:2048 lds
 buffer_load_dwordx4 v15, s[32:35], s67 offen offset:3072 lds
 v_mfma_f32_16x16x32_bf16 v[156:159], v[140:143], v[52:55], v[156:159]
 ds_read_b128 v[20:23], v240 offset:8192
 s_barrier
 v_mfma_f32_16x16x32_bf16 v[160:163], v[80:83], v[24:27], v[160:163]
 s_add_u32 m0, s69, 65536
 ds_read_b128 v[56:59], v241 offset:32768
 s_andn2_b32 s68, s19, 512
 v_mfma_f32_16x16x32_bf16 v[160:163], v[84:87], v[28:31], v[160:163]
 s_add_u32 s68, s68, s76
 ds_read_b128 v[60:63], v241 offset:40960
 s_add_u32 s68, s68, 40894464
 v_mfma_f32_16x16x32_bf16 v[164:167], v[88:91], v[24:27], v[164:167]
 buffer_load_dwordx4 v1, s[40:43], s68 offen offset:0 sc1 lds
 v_mfma_f32_16x16x32_bf16 v[164:167], v[92:95], v[28:31], v[164:167]
 ds_read_b64_tr_b16 v[112:113], v8 offset:32768
 v_mfma_f32_16x16x32_bf16 v[168:171], v[96:99], v[24:27], v[168:171]
 ds_read_b64_tr_b16 v[114:115], v8 offset:34816
 v_mfma_f32_16x16x32_bf16 v[168:171], v[100:103], v[28:31], v[168:171]
 ds_read_b64_tr_b16 v[116:117], v8 offset:40960
 v_mfma_f32_16x16x32_bf16 v[172:175], v[104:107], v[24:27], v[172:175]
 buffer_load_dwordx4 v1, s[40:43], s68 offen offset:1024 sc1 lds
 v_mfma_f32_16x16x32_bf16 v[172:175], v[108:111], v[28:31], v[172:175]
 ds_read_b64_tr_b16 v[118:119], v8 offset:43008
 v_mfma_f32_16x16x32_bf16 v[176:179], v[80:83], v[32:35], v[176:179]
 s_waitcnt lgkmcnt(6)
 ds_read_b64_tr_b16 v[120:121], v9 offset:32768
 v_mfma_f32_16x16x32_bf16 v[176:179], v[84:87], v[36:39], v[176:179]
 ds_read_b64_tr_b16 v[122:123], v9 offset:34816
 v_mfma_f32_16x16x32_bf16 v[180:183], v[88:91], v[32:35], v[180:183]
 buffer_load_dwordx4 v1, s[40:43], s68 offen offset:2048 sc1 lds
 v_mfma_f32_16x16x32_bf16 v[180:183], v[92:95], v[36:39], v[180:183]
 ds_read_b64_tr_b16 v[124:125], v9 offset:40960
 v_mfma_f32_16x16x32_bf16 v[184:187], v[96:99], v[32:35], v[184:187]
 ds_read_b64_tr_b16 v[126:127], v9 offset:43008
 v_mfma_f32_16x16x32_bf16 v[184:187], v[100:103], v[36:39], v[184:187]
 ds_read_b64_tr_b16 v[128:129], v10 offset:32768
 v_mfma_f32_16x16x32_bf16 v[188:191], v[104:107], v[32:35], v[188:191]
 buffer_load_dwordx4 v1, s[40:43], s68 offen offset:3072 sc1 lds
 v_mfma_f32_16x16x32_bf16 v[188:191], v[108:111], v[36:39], v[188:191]
 s_add_u32 m0, s69, 114688
 ds_read_b64_tr_b16 v[130:131], v10 offset:34816
 s_add_u32 s12, s11, 15
 v_mfma_f32_16x16x32_bf16 v[192:195], v[80:83], v[40:43], v[192:195]
 s_and_b32 s12, s12, 15
 ds_read_b64_tr_b16 v[132:133], v10 offset:40960
 s_xor_b32 s12, s12, s10
 v_mfma_f32_16x16x32_bf16 v[192:195], v[84:87], v[44:47], v[192:195]
 s_lshl_b32 s65, s12, 16
 ds_read_b64_tr_b16 v[134:135], v10 offset:43008
 s_add_u32 s65, s65, s64
 v_mfma_f32_16x16x32_bf16 v[196:199], v[88:91], v[40:43], v[196:199]
 s_mul_i32 s20, s12, 8704
 v_mfma_f32_16x16x32_bf16 v[196:199], v[92:95], v[44:47], v[196:199]
 ds_read_b64_tr_b16 v[136:137], v11 offset:32768
 v_mfma_f32_16x16x32_bf16 v[200:203], v[96:99], v[40:43], v[200:203]
 ds_read_b64_tr_b16 v[138:139], v11 offset:34816
 v_mfma_f32_16x16x32_bf16 v[200:203], v[100:103], v[44:47], v[200:203]
 ds_read_b64_tr_b16 v[140:141], v11 offset:40960
 v_mfma_f32_16x16x32_bf16 v[204:207], v[104:107], v[40:43], v[204:207]
 buffer_load_dwordx4 v12, s[32:35], s65 offen offset:0 lds
 v_mfma_f32_16x16x32_bf16 v[204:207], v[108:111], v[44:47], v[204:207]
 ds_read_b64_tr_b16 v[142:143], v11 offset:43008
 v_mfma_f32_16x16x32_bf16 v[144:147], v[80:83], v[16:19], v[144:147]
 ds_read_b128 v[64:67], v242 offset:32768
 v_mfma_f32_16x16x32_bf16 v[144:147], v[84:87], v[20:23], v[144:147]
 ds_read_b128 v[68:71], v242 offset:40960
 v_mfma_f32_16x16x32_bf16 v[148:151], v[88:91], v[16:19], v[148:151]
 buffer_load_dwordx4 v13, s[32:35], s65 offen offset:1024 lds
 v_mfma_f32_16x16x32_bf16 v[148:151], v[92:95], v[20:23], v[148:151]
 ds_read_b128 v[72:75], v243 offset:32768
 v_mfma_f32_16x16x32_bf16 v[152:155], v[96:99], v[16:19], v[152:155]
 ds_read_b128 v[76:79], v243 offset:40960
 v_mfma_f32_16x16x32_bf16 v[152:155], v[100:103], v[20:23], v[152:155]
 s_waitcnt vmcnt(10) lgkmcnt(3)
 ds_read_b128 v[48:51], v240 offset:32768
 v_mfma_f32_16x16x32_bf16 v[156:159], v[104:107], v[16:19], v[156:159]
 buffer_load_dwordx4 v14, s[32:35], s65 offen offset:2048 lds
 buffer_load_dwordx4 v15, s[32:35], s65 offen offset:3072 lds
 v_mfma_f32_16x16x32_bf16 v[156:159], v[108:111], v[20:23], v[156:159]
 ds_read_b128 v[52:55], v240 offset:40960
 s_barrier
 v_mfma_f32_16x16x32_bf16 v[160:163], v[112:115], v[56:59], v[160:163]
 s_add_u32 m0, s69, 98304
 ds_read_b128 v[24:27], v237 offset:0
 s_andn2_b32 s66, s20, 512
 v_mfma_f32_16x16x32_bf16 v[160:163], v[116:119], v[60:63], v[160:163]
 s_add_u32 s66, s66, s76
 ds_read_b128 v[28:31], v237 offset:8192
 s_add_u32 s66, s66, 40894464
 v_mfma_f32_16x16x32_bf16 v[164:167], v[120:123], v[56:59], v[164:167]
 buffer_load_dwordx4 v1, s[40:43], s66 offen offset:0 sc1 lds
 v_mfma_f32_16x16x32_bf16 v[164:167], v[124:127], v[60:63], v[164:167]
 ds_read_b64_tr_b16 a[0:1], v232 offset:0
 v_mfma_f32_16x16x32_bf16 v[168:171], v[128:131], v[56:59], v[168:171]
 ds_read_b64_tr_b16 a[2:3], v232 offset:2048
 v_mfma_f32_16x16x32_bf16 v[168:171], v[132:135], v[60:63], v[168:171]
 ds_read_b64_tr_b16 a[4:5], v232 offset:8192
 v_mfma_f32_16x16x32_bf16 v[172:175], v[136:139], v[56:59], v[172:175]
 buffer_load_dwordx4 v1, s[40:43], s66 offen offset:1024 sc1 lds
 v_mfma_f32_16x16x32_bf16 v[172:175], v[140:143], v[60:63], v[172:175]
 ds_read_b64_tr_b16 a[6:7], v232 offset:10240
 v_mfma_f32_16x16x32_bf16 v[176:179], v[112:115], v[64:67], v[176:179]
 s_waitcnt lgkmcnt(6)
 ds_read_b64_tr_b16 a[8:9], v233 offset:0
 v_mfma_f32_16x16x32_bf16 v[176:179], v[116:119], v[68:71], v[176:179]
 ds_read_b64_tr_b16 a[10:11], v233 offset:2048
 v_mfma_f32_16x16x32_bf16 v[180:183], v[120:123], v[64:67], v[180:183]
 buffer_load_dwordx4 v1, s[40:43], s66 offen offset:2048 sc1 lds
 v_mfma_f32_16x16x32_bf16 v[180:183], v[124:127], v[68:71], v[180:183]
 ds_read_b64_tr_b16 a[12:13], v233 offset:8192
 v_mfma_f32_16x16x32_bf16 v[184:187], v[128:131], v[64:67], v[184:187]
 ds_read_b64_tr_b16 a[14:15], v233 offset:10240
 v_mfma_f32_16x16x32_bf16 v[184:187], v[132:135], v[68:71], v[184:187]
 ds_read_b64_tr_b16 a[16:17], v234 offset:0
 v_mfma_f32_16x16x32_bf16 v[188:191], v[136:139], v[64:67], v[188:191]
 buffer_load_dwordx4 v1, s[40:43], s66 offen offset:3072 sc1 lds
 v_mfma_f32_16x16x32_bf16 v[188:191], v[140:143], v[68:71], v[188:191]
 s_mov_b32 s52, s4
 ds_read_b64_tr_b16 a[18:19], v234 offset:2048
 s_mov_b32 s53, s5
 v_mfma_f32_16x16x32_bf16 v[192:195], v[112:115], v[72:75], v[192:195]
 s_mov_b32 s54, 2097152
 ds_read_b64_tr_b16 a[20:21], v234 offset:8192
 v_mfma_f32_16x16x32_bf16 v[192:195], v[116:119], v[76:79], v[192:195]
 ds_read_b64_tr_b16 a[22:23], v234 offset:10240
 v_mfma_f32_16x16x32_bf16 v[196:199], v[120:123], v[72:75], v[196:199]
 buffer_load_dwordx2 v[208:209], v255, s[52:55], s73 offen offset:0
 v_mfma_f32_16x16x32_bf16 v[196:199], v[124:127], v[76:79], v[196:199]
 ds_read_b64_tr_b16 a[24:25], v235 offset:0
 v_mfma_f32_16x16x32_bf16 v[200:203], v[128:131], v[72:75], v[200:203]
 ds_read_b64_tr_b16 a[26:27], v235 offset:2048
 v_mfma_f32_16x16x32_bf16 v[200:203], v[132:135], v[76:79], v[200:203]
 ds_read_b64_tr_b16 a[28:29], v235 offset:8192
 v_mfma_f32_16x16x32_bf16 v[204:207], v[136:139], v[72:75], v[204:207]
 buffer_load_dwordx2 v[210:211], v255, s[52:55], s73 offen offset:32
 v_mfma_f32_16x16x32_bf16 v[204:207], v[140:143], v[76:79], v[204:207]
 ds_read_b64_tr_b16 a[30:31], v235 offset:10240
 v_mfma_f32_16x16x32_bf16 v[144:147], v[112:115], v[48:51], v[144:147]
 ds_read_b128 v[32:35], v238 offset:0
 v_mfma_f32_16x16x32_bf16 v[144:147], v[116:119], v[52:55], v[144:147]
 ds_read_b128 v[36:39], v238 offset:8192
 v_mfma_f32_16x16x32_bf16 v[148:151], v[120:123], v[48:51], v[148:151]
 buffer_load_dwordx2 v[212:213], v255, s[52:55], s73 offen offset:64
 v_mfma_f32_16x16x32_bf16 v[148:151], v[124:127], v[52:55], v[148:151]
 ds_read_b128 v[40:43], v239 offset:0
 v_mfma_f32_16x16x32_bf16 v[152:155], v[128:131], v[48:51], v[152:155]
 ds_read_b128 v[44:47], v239 offset:8192
 v_mfma_f32_16x16x32_bf16 v[152:155], v[132:135], v[52:55], v[152:155]
 s_waitcnt vmcnt(11) lgkmcnt(3)
 ds_read_b128 a[160:163], v236 offset:0
 v_mfma_f32_16x16x32_bf16 v[156:159], v[136:139], v[48:51], v[156:159]
 buffer_load_dwordx2 v[214:215], v255, s[52:55], s73 offen offset:96
 v_mfma_f32_16x16x32_bf16 v[156:159], v[140:143], v[52:55], v[156:159]
 ds_read_b128 a[164:167], v236 offset:8192
 s_barrier
 v_mfma_f32_16x16x32_bf16 v[160:163], a[0:3], v[24:27], v[160:163]
 ds_read_b128 v[56:59], v245 offset:0
 v_mfma_f32_16x16x32_bf16 v[160:163], a[4:7], v[28:31], v[160:163]
 ds_read_b128 v[60:63], v245 offset:8192
 v_mfma_f32_16x16x32_bf16 v[164:167], a[8:11], v[24:27], v[164:167]
 ds_read_b64_tr_b16 a[32:33], v4 offset:0
 v_mfma_f32_16x16x32_bf16 v[164:167], a[12:15], v[28:31], v[164:167]
 ds_read_b64_tr_b16 a[34:35], v4 offset:2048
 v_mfma_f32_16x16x32_bf16 v[168:171], a[16:19], v[24:27], v[168:171]
 ds_read_b64_tr_b16 a[36:37], v4 offset:8192
 v_mfma_f32_16x16x32_bf16 v[168:171], a[20:23], v[28:31], v[168:171]
L_w1_3:
L_w1_2:
L_st1_2:
 s_cbranch_execz L_warmed1
 ds_read_b64_tr_b16 a[38:39], v4 offset:10240
 v_mfma_f32_16x16x32_bf16 v[172:175], a[24:27], v[24:27], v[172:175]
 ds_read_b64_tr_b16 a[40:41], v5 offset:0
 v_mfma_f32_16x16x32_bf16 v[172:175], a[28:31], v[28:31], v[172:175]
 ds_read_b64_tr_b16 a[42:43], v5 offset:2048
 v_mfma_f32_16x16x32_bf16 v[176:179], a[0:3], v[32:35], v[176:179]
 s_waitcnt lgkmcnt(10)
 ds_read_b64_tr_b16 a[44:45], v5 offset:8192
 v_mfma_f32_16x16x32_bf16 v[176:179], a[4:7], v[36:39], v[176:179]
 ds_read_b64_tr_b16 a[46:47], v5 offset:10240
 v_mfma_f32_16x16x32_bf16 v[180:183], a[8:11], v[32:35], v[180:183]
 ds_read_b64_tr_b16 a[48:49], v6 offset:0
 v_mfma_f32_16x16x32_bf16 v[180:183], a[12:15], v[36:39], v[180:183]
 ds_read_b64_tr_b16 a[50:51], v6 offset:2048
 v_mfma_f32_16x16x32_bf16 v[184:187], a[16:19], v[32:35], v[184:187]
 ds_read_b64_tr_b16 a[52:53], v6 offset:8192
 v_mfma_f32_16x16x32_bf16 v[184:187], a[20:23], v[36:39], v[184:187]
 ds_read_b64_tr_b16 a[54:55], v6 offset:10240
 v_mfma_f32_16x16x32_bf16 v[188:191], a[24:27], v[32:35], v[188:191]
 ds_read_b64_tr_b16 a[56:57], v7 offset:0
 v_mfma_f32_16x16x32_bf16 v[188:191], a[28:31], v[36:39], v[188:191]
 ds_read_b64_tr_b16 a[58:59], v7 offset:2048
 v_mfma_f32_16x16x32_bf16 v[192:195], a[0:3], v[40:43], v[192:195]
 ds_read_b64_tr_b16 a[60:61], v7 offset:8192
 v_mfma_f32_16x16x32_bf16 v[192:195], a[4:7], v[44:47], v[192:195]
 ds_read_b64_tr_b16 a[62:63], v7 offset:10240
 v_mfma_f32_16x16x32_bf16 v[196:199], a[8:11], v[40:43], v[196:199]
 ds_read_b128 v[64:67], v246 offset:0
 v_mfma_f32_16x16x32_bf16 v[196:199], a[12:15], v[44:47], v[196:199]
 ds_read_b128 v[68:71], v246 offset:8192
 v_mfma_f32_16x16x32_bf16 v[200:203], a[16:19], v[40:43], v[200:203]
 ds_read_b128 v[72:75], v247 offset:0
 v_mfma_f32_16x16x32_bf16 v[200:203], a[20:23], v[44:47], v[200:203]
 s_waitcnt vmcnt(4) lgkmcnt(5)
 ds_read_b128 v[76:79], v247 offset:8192
 v_mfma_f32_16x16x32_bf16 v[204:207], a[24:27], v[40:43], v[204:207]
 ds_read_b128 a[168:171], v244 offset:0
 v_mfma_f32_16x16x32_bf16 v[204:207], a[28:31], v[44:47], v[204:207]
 ds_read_b128 a[172:175], v244 offset:8192
 s_barrier
 v_mfma_f32_16x16x32_bf16 v[160:163], a[32:35], v[56:59], v[160:163]
 ds_read_b128 v[24:27], v245 offset:32768
 v_mfma_f32_16x16x32_bf16 v[160:163], a[36:39], v[60:63], v[160:163]
 ds_read_b128 v[28:31], v245 offset:40960
 v_mfma_f32_16x16x32_bf16 v[164:167], a[40:43], v[56:59], v[164:167]
 ds_read_b64_tr_b16 a[64:65], v4 offset:32768
 v_mfma_f32_16x16x32_bf16 v[164:167], a[44:47], v[60:63], v[164:167]
 ds_read_b64_tr_b16 a[66:67], v4 offset:34816
 v_mfma_f32_16x16x32_bf16 v[168:171], a[48:51], v[56:59], v[168:171]
 ds_read_b64_tr_b16 a[68:69], v4 offset:40960
 v_mfma_f32_16x16x32_bf16 v[168:171], a[52:55], v[60:63], v[168:171]
 ds_read_b64_tr_b16 a[70:71], v4 offset:43008
 v_mfma_f32_16x16x32_bf16 v[172:175], a[56:59], v[56:59], v[172:175]
 s_waitcnt lgkmcnt(8)
 ds_read_b64_tr_b16 a[72:73], v5 offset:32768
 v_mfma_f32_16x16x32_bf16 v[172:175], a[60:63], v[60:63], v[172:175]
 ds_read_b64_tr_b16 a[74:75], v5 offset:34816
 v_mfma_f32_16x16x32_bf16 v[176:179], a[32:35], v[64:67], v[176:179]
 ds_read_b64_tr_b16 a[76:77], v5 offset:40960
 v_mfma_f32_16x16x32_bf16 v[176:179], a[36:39], v[68:71], v[176:179]
 ds_read_b64_tr_b16 a[78:79], v5 offset:43008
 v_mfma_f32_16x16x32_bf16 v[180:183], a[40:43], v[64:67], v[180:183]
 ds_read_b64_tr_b16 a[80:81], v6 offset:32768
 v_mfma_f32_16x16x32_bf16 v[180:183], a[44:47], v[68:71], v[180:183]
 ds_read_b64_tr_b16 a[82:83], v6 offset:34816
 v_mfma_f32_16x16x32_bf16 v[184:187], a[48:51], v[64:67], v[184:187]
 ds_read_b64_tr_b16 a[84:85], v6 offset:40960
 v_mfma_f32_16x16x32_bf16 v[184:187], a[52:55], v[68:71], v[184:187]
 ds_read_b64_tr_b16 a[86:87], v6 offset:43008
 v_mfma_f32_16x16x32_bf16 v[188:191], a[56:59], v[64:67], v[188:191]
 ds_read_b64_tr_b16 a[88:89], v7 offset:32768
 v_mfma_f32_16x16x32_bf16 v[188:191], a[60:63], v[68:71], v[188:191]
 ds_read_b64_tr_b16 a[90:91], v7 offset:34816
 v_mfma_f32_16x16x32_bf16 v[192:195], a[32:35], v[72:75], v[192:195]
 ds_read_b64_tr_b16 a[92:93], v7 offset:40960
 v_mfma_f32_16x16x32_bf16 v[192:195], a[36:39], v[76:79], v[192:195]
 ds_read_b64_tr_b16 a[94:95], v7 offset:43008
 v_mfma_f32_16x16x32_bf16 v[196:199], a[40:43], v[72:75], v[196:199]
 ds_read_b128 v[32:35], v246 offset:32768
 v_mfma_f32_16x16x32_bf16 v[196:199], a[44:47], v[76:79], v[196:199]
 ds_read_b128 v[36:39], v246 offset:40960
 v_mfma_f32_16x16x32_bf16 v[200:203], a[48:51], v[72:75], v[200:203]
 ds_read_b128 v[40:43], v247 offset:32768
 v_mfma_f32_16x16x32_bf16 v[200:203], a[52:55], v[76:79], v[200:203]
 ds_read_b128 v[44:47], v247 offset:40960
 v_mfma_f32_16x16x32_bf16 v[204:207], a[56:59], v[72:75], v[204:207]
 ds_read_b128 a[176:179], v244 offset:32768
 v_mfma_f32_16x16x32_bf16 v[204:207], a[60:63], v[76:79], v[204:207]
 s_waitcnt lgkmcnt(4)
 ds_read_b128 a[180:183], v244 offset:40960
 v_mfma_f32_16x16x32_bf16 v[160:163], a[64:67], v[24:27], v[160:163]
 v_mfma_f32_16x16x32_bf16 v[160:163], a[68:71], v[28:31], v[160:163]
 v_mfma_f32_16x16x32_bf16 v[164:167], a[72:75], v[24:27], v[164:167]
 v_mfma_f32_16x16x32_bf16 v[164:167], a[76:79], v[28:31], v[164:167]
 v_mfma_f32_16x16x32_bf16 v[168:171], a[80:83], v[24:27], v[168:171]
 v_mfma_f32_16x16x32_bf16 v[168:171], a[84:87], v[28:31], v[168:171]
 v_mfma_f32_16x16x32_bf16 v[172:175], a[88:91], v[24:27], v[172:175]
 v_mfma_f32_16x16x32_bf16 v[172:175], a[92:95], v[28:31], v[172:175]
 v_mfma_f32_16x16x32_bf16 v[176:179], a[64:67], v[32:35], v[176:179]
 s_waitcnt lgkmcnt(0)
 v_mfma_f32_16x16x32_bf16 v[176:179], a[68:71], v[36:39], v[176:179]
 v_mfma_f32_16x16x32_bf16 v[180:183], a[72:75], v[32:35], v[180:183]
 v_cvt_pk_bf16_f32 v48, v160, v161
 v_cvt_pk_bf16_f32 v49, v162, v163
 v_mfma_f32_16x16x32_bf16 v[180:183], a[76:79], v[36:39], v[180:183]
 v_cvt_pk_bf16_f32 v50, v164, v165
 v_cvt_pk_bf16_f32 v51, v166, v167
 v_mfma_f32_16x16x32_bf16 v[184:187], a[80:83], v[32:35], v[184:187]
 v_cvt_pk_bf16_f32 v52, v168, v169
 v_cvt_pk_bf16_f32 v53, v170, v171
 v_mfma_f32_16x16x32_bf16 v[184:187], a[84:87], v[36:39], v[184:187]
 v_cvt_pk_bf16_f32 v54, v172, v173
 v_cvt_pk_bf16_f32 v55, v174, v175
 v_mfma_f32_16x16x32_bf16 v[188:191], a[88:91], v[32:35], v[188:191]
 buffer_store_dwordx4 v[48:51], v1, s[40:43], s78 offen offset:0 sc1
 v_mfma_f32_16x16x32_bf16 v[188:191], a[92:95], v[36:39], v[188:191]
 buffer_store_dwordx4 v[52:55], v1, s[40:43], s78 offen offset:1024 sc1
 v_mfma_f32_16x16x32_bf16 v[192:195], a[64:67], v[40:43], v[192:195]
 v_mfma_f32_16x16x32_bf16 v[192:195], a[68:71], v[44:47], v[192:195]
 v_mfma_f32_16x16x32_bf16 v[196:199], a[72:75], v[40:43], v[196:199]
 v_cvt_pk_bf16_f32 v56, v176, v177
 v_cvt_pk_bf16_f32 v57, v178, v179
 v_mfma_f32_16x16x32_bf16 v[196:199], a[76:79], v[44:47], v[196:199]
 v_cvt_pk_bf16_f32 v58, v180, v181
 v_cvt_pk_bf16_f32 v59, v182, v183
 v_mfma_f32_16x16x32_bf16 v[200:203], a[80:83], v[40:43], v[200:203]
 v_cvt_pk_bf16_f32 v60, v184, v185
 v_cvt_pk_bf16_f32 v61, v186, v187
 v_mfma_f32_16x16x32_bf16 v[200:203], a[84:87], v[44:47], v[200:203]
 v_cvt_pk_bf16_f32 v62, v188, v189
 v_cvt_pk_bf16_f32 v63, v190, v191
 v_mfma_f32_16x16x32_bf16 v[204:207], a[88:91], v[40:43], v[204:207]
 buffer_store_dwordx4 v[56:59], v1, s[40:43], s79 offen offset:0 sc1
 v_mfma_f32_16x16x32_bf16 v[204:207], a[92:95], v[44:47], v[204:207]
 buffer_store_dwordx4 v[60:63], v1, s[40:43], s79 offen offset:1024 sc1
 v_mfma_f32_16x16x32_bf16 v[144:147], a[0:3], a[160:163], v[144:147]
 v_mfma_f32_16x16x32_bf16 v[144:147], a[4:7], a[164:167], v[144:147]
 v_mfma_f32_16x16x32_bf16 v[144:147], a[32:35], a[168:171], v[144:147]
 v_cvt_pk_bf16_f32 v64, v192, v193
 v_cvt_pk_bf16_f32 v65, v194, v195
 v_mfma_f32_16x16x32_bf16 v[144:147], a[36:39], a[172:175], v[144:147]
 v_cvt_pk_bf16_f32 v66, v196, v197
 v_cvt_pk_bf16_f32 v67, v198, v199
 v_mfma_f32_16x16x32_bf16 v[144:147], a[64:67], a[176:179], v[144:147]
 v_cvt_pk_bf16_f32 v68, v200, v201
 v_cvt_pk_bf16_f32 v69, v202, v203
 v_mfma_f32_16x16x32_bf16 v[144:147], a[68:71], a[180:183], v[144:147]
 v_cvt_pk_bf16_f32 v70, v204, v205
 v_cvt_pk_bf16_f32 v71, v206, v207
 v_mfma_f32_16x16x32_bf16 v[148:151], a[8:11], a[160:163], v[148:151]
 buffer_store_dwordx4 v[64:67], v1, s[40:43], s80 offen offset:0 sc1
 v_mfma_f32_16x16x32_bf16 v[148:151], a[12:15], a[164:167], v[148:151]
 buffer_store_dwordx4 v[68:71], v1, s[40:43], s80 offen offset:1024 sc1
 v_mfma_f32_16x16x32_bf16 v[148:151], a[40:43], a[168:171], v[148:151]
 v_mfma_f32_16x16x32_bf16 v[148:151], a[44:47], a[172:175], v[148:151]
 v_mfma_f32_16x16x32_bf16 v[148:151], a[72:75], a[176:179], v[148:151]
 v_mfma_f32_16x16x32_bf16 v[148:151], a[76:79], a[180:183], v[148:151]
 v_mfma_f32_16x16x32_bf16 v[152:155], a[16:19], a[160:163], v[152:155]
 v_mfma_f32_16x16x32_bf16 v[152:155], a[20:23], a[164:167], v[152:155]
 v_mfma_f32_16x16x32_bf16 v[152:155], a[48:51], a[168:171], v[152:155]
 v_mfma_f32_16x16x32_bf16 v[152:155], a[52:55], a[172:175], v[152:155]
 v_mfma_f32_16x16x32_bf16 v[152:155], a[80:83], a[176:179], v[152:155]
 v_mfma_f32_16x16x32_bf16 v[152:155], a[84:87], a[180:183], v[152:155]
 v_mfma_f32_16x16x32_bf16 v[156:159], a[24:27], a[160:163], v[156:159]
 v_mfma_f32_16x16x32_bf16 v[156:159], a[28:31], a[164:167], v[156:159]
 buffer_load_dwordx4 v[80:83], v1, s[40:43], s77 offen offset:0 sc1
 v_mfma_f32_16x16x32_bf16 v[156:159], a[56:59], a[168:171], v[156:159]
 buffer_load_dwordx4 v[84:87], v1, s[40:43], s77 offen offset:1024 sc1
 v_mfma_f32_16x16x32_bf16 v[156:159], a[60:63], a[172:175], v[156:159]
 buffer_load_dwordx4 v[88:91], v1, s[40:43], s77 offen offset:2048 sc1
 v_mfma_f32_16x16x32_bf16 v[156:159], a[88:91], a[176:179], v[156:159]
 buffer_load_dwordx4 v[92:95], v1, s[40:43], s77 offen offset:3072 sc1
 v_mfma_f32_16x16x32_bf16 v[156:159], a[92:95], a[180:183], v[156:159]
 buffer_load_dwordx4 v[96:99], v1, s[40:43], s85 offen offset:0 sc1
 buffer_load_dwordx4 v[100:103], v1, s[40:43], s85 offen offset:1024 sc1
 s_waitcnt vmcnt(12)
 v_lshlrev_b32 v216, 16, v208
 v_and_b32 v217, 0xffff0000, v208
 v_lshlrev_b32 v218, 16, v209
 v_and_b32 v219, 0xffff0000, v209
 v_lshlrev_b32 v220, 16, v210
 v_and_b32 v221, 0xffff0000, v210
 v_lshlrev_b32 v222, 16, v211
 v_and_b32 v223, 0xffff0000, v211
 v_lshlrev_b32 v224, 16, v212
 v_and_b32 v225, 0xffff0000, v212
 v_lshlrev_b32 v226, 16, v213
 v_and_b32 v227, 0xffff0000, v213
 v_lshlrev_b32 v228, 16, v214
 v_and_b32 v229, 0xffff0000, v214
 v_lshlrev_b32 v230, 16, v215
 v_and_b32 v231, 0xffff0000, v215
 v_pk_add_f32 v[144:145], v[144:145], v[216:217]
 v_pk_add_f32 v[146:147], v[146:147], v[218:219]
 v_pk_add_f32 v[148:149], v[148:149], v[220:221]
 v_pk_add_f32 v[150:151], v[150:151], v[222:223]
 v_pk_add_f32 v[152:153], v[152:153], v[224:225]
 v_pk_add_f32 v[154:155], v[154:155], v[226:227]
 v_pk_add_f32 v[156:157], v[156:157], v[228:229]
 v_pk_add_f32 v[158:159], v[158:159], v[230:231]
L_xchk:
 s_waitcnt vmcnt(0)
 v_max_u32 v251, v80, v81
 v_max_u32 v252, v82, v83
 v_max3_u32 v251, v251, v84, v85
 v_max3_u32 v252, v252, v86, v87
 v_max3_u32 v251, v251, v88, v89
 v_max3_u32 v252, v252, v90, v91
 v_max3_u32 v251, v251, v92, v93
 v_max3_u32 v252, v252, v94, v95
 v_max3_u32 v251, v251, v96, v97
 v_max3_u32 v252, v252, v98, v99
 v_max3_u32 v251, v251, v100, v101
 v_max3_u32 v252, v252, v102, v103
 v_max_u32 v251, v251, v252
 v_cmp_eq_u32 vcc, -1, v251
 s_nop 1
 s_cbranch_vccnz L_xspin
L_xok:
 v_lshlrev_b32 v216, 16, v80
 v_and_b32 v217, 0xffff0000, v80
 v_lshlrev_b32 v218, 16, v81
 v_and_b32 v219, 0xffff0000, v81
 v_lshlrev_b32 v220, 16, v88
 v_and_b32 v221, 0xffff0000, v88
 v_lshlrev_b32 v222, 16, v89
 v_and_b32 v223, 0xffff0000, v89
 v_lshlrev_b32 v224, 16, v96
 v_and_b32 v225, 0xffff0000, v96
 v_lshlrev_b32 v226, 16, v97
 v_and_b32 v227, 0xffff0000, v97
 v_pk_add_f32 v[144:145], v[144:145], v[216:217]
 v_pk_add_f32 v[146:147], v[146:147], v[218:219]
 v_pk_add_f32 v[144:145], v[144:145], v[220:221]
 v_pk_add_f32 v[146:147], v[146:147], v[222:223]
 v_pk_add_f32 v[144:145], v[144:145], v[224:225]
 v_pk_add_f32 v[146:147], v[146:147], v[226:227]
 v_cvt_pk_bf16_f32 v208, v144, v145
 v_cvt_pk_bf16_f32 v209, v146, v147
 buffer_store_dwordx2 v[208:209], v255, s[44:47], s73 offen offset:0
 v_lshlrev_b32 v216, 16, v82
 v_and_b32 v217, 0xffff0000, v82
 v_lshlrev_b32 v218, 16, v83
 v_and_b32 v219, 0xffff0000, v83
 v_lshlrev_b32 v220, 16, v90
 v_and_b32 v221, 0xffff0000, v90
 v_lshlrev_b32 v222, 16, v91
 v_and_b32 v223, 0xffff0000, v91
 v_lshlrev_b32 v224, 16, v98
 v_and_b32 v225, 0xffff0000, v98
 v_lshlrev_b32 v226, 16, v99
 v_and_b32 v227, 0xffff0000, v99
 v_pk_add_f32 v[148:149], v[148:149], v[216:217]
 v_pk_add_f32 v[150:151], v[150:151], v[218:219]
 v_pk_add_f32 v[148:149], v[148:149], v[220:221]
 v_pk_add_f32 v[150:151], v[150:151], v[222:223]
 v_pk_add_f32 v[148:149], v[148:149], v[224:225]
 v_pk_add_f32 v[150:151], v[150:151], v[226:227]
 v_cvt_pk_bf16_f32 v210, v148, v149
 v_cvt_pk_bf16_f32 v211, v150, v151
 buffer_store_dwordx2 v[210:211], v255, s[44:47], s73 offen offset:32
 v_lshlrev_b32 v216, 16, v84
 v_and_b32 v217, 0xffff0000, v84
 v_lshlrev_b32 v218, 16, v85
 v_and_b32 v219, 0xffff0000, v85
 v_lshlrev_b32 v220, 16, v92
 v_and_b32 v221, 0xffff0000, v92
 v_lshlrev_b32 v222, 16, v93
 v_and_b32 v223, 0xffff0000, v93
 v_lshlrev_b32 v224, 16, v100
 v_and_b32 v225, 0xffff0000, v100
 v_lshlrev_b32 v226, 16, v101
 v_and_b32 v227, 0xffff0000, v101
 v_pk_add_f32 v[152:153], v[152:153], v[216:217]
 v_pk_add_f32 v[154:155], v[154:155], v[218:219]
 v_pk_add_f32 v[152:153], v[152:153], v[220:221]
 v_pk_add_f32 v[154:155], v[154:155], v[222:223]
 v_pk_add_f32 v[152:153], v[152:153], v[224:225]
 v_pk_add_f32 v[154:155], v[154:155], v[226:227]
 v_cvt_pk_bf16_f32 v212, v152, v153
 v_cvt_pk_bf16_f32 v213, v154, v155
 buffer_store_dwordx2 v[212:213], v255, s[44:47], s73 offen offset:64
 v_lshlrev_b32 v216, 16, v86
 v_and_b32 v217, 0xffff0000, v86
 v_lshlrev_b32 v218, 16, v87
 v_and_b32 v219, 0xffff0000, v87
 v_lshlrev_b32 v220, 16, v94
 v_and_b32 v221, 0xffff0000, v94
 v_lshlrev_b32 v222, 16, v95
 v_and_b32 v223, 0xffff0000, v95
 v_lshlrev_b32 v224, 16, v102
 v_and_b32 v225, 0xffff0000, v102
 v_lshlrev_b32 v226, 16, v103
 v_and_b32 v227, 0xffff0000, v103
 v_pk_add_f32 v[156:157], v[156:157], v[216:217]
 v_pk_add_f32 v[158:159], v[158:159], v[218:219]
 v_pk_add_f32 v[156:157], v[156:157], v[220:221]
 v_pk_add_f32 v[158:159], v[158:159], v[222:223]
 v_pk_add_f32 v[156:157], v[156:157], v[224:225]
 v_pk_add_f32 v[158:159], v[158:159], v[226:227]
 v_cvt_pk_bf16_f32 v214, v156, v157
 v_cvt_pk_bf16_f32 v215, v158, v159
 buffer_store_dwordx2 v[214:215], v255, s[44:47], s73 offen offset:96
L_end:
 s_endpgm
L_spin_clr:
 s_mov_b32 s87, 0
L_spin2_clr:
 s_sleep 4
 buffer_load_dword v251, v201, s[48:51], 0 offen sc1
 s_add_u32 s87, s87, 1
 s_cmp_gt_u32 s87, 200000
 s_waitcnt vmcnt(0)
 s_cbranch_scc1 L_back_clr
 v_cmp_eq_u32 vcc, 0, v251
 s_nop 1
 s_cbranch_vccnz L_spin2_clr
 s_branch L_back_clr
L_spin_xn:
 s_mov_b32 s87, 0
L_spin2_xn:
 s_sleep 4
 buffer_load_dword v251, v252, s[40:43], 0 offen sc1
 s_add_u32 s87, s87, 1
 s_cmp_gt_u32 s87, 200000
 s_waitcnt vmcnt(0)
 s_cbranch_scc1 L_back_xn
 v_cmp_eq_u32 vcc, 0, v251
 s_nop 1
 s_cbranch_vccnz L_spin2_xn
 s_branch L_back_xn
L_spin_k:
 s_mov_b32 s87, 0
L_spin2_k:
 s_sleep 4
 buffer_load_dword v251, v252, s[40:43], s3 offen sc1
 s_add_u32 s87, s87, 1
 s_cmp_gt_u32 s87, 200000
 s_waitcnt vmcnt(0)
 s_cbranch_scc1 L_back_k
 v_cmp_eq_u32 vcc, 0, v251
 s_nop 1
 s_cbranch_vccnz L_spin2_k
 s_branch L_back_k
L_spin_v:
 s_mov_b32 s87, 0
L_spin2_v:
 s_sleep 4
 buffer_load_dword v251, v252, s[40:43], s3 offen offset:32 sc1
 s_add_u32 s87, s87, 1
 s_cmp_gt_u32 s87, 200000
 s_waitcnt vmcnt(0)
 s_cbranch_scc1 L_back_v
 v_cmp_eq_u32 vcc, 0, v251
 s_nop 1
 s_cbranch_vccnz L_spin2_v
 s_branch L_back_v
.p2align 6
L_dloop:
 v_mfma_f32_16x16x32_bf16 v[148:151], a[144:147], v[88:91], v[180:183]
 s_sub_u32 s94, s94, 1
 ds_read_b128 a[184:187], v6 offset:2048
 s_lshl_b32 s85, s94, 7
 v_mfma_f32_16x16x32_bf16 v[148:151], a[148:151], v[120:123], v[148:151]
 s_add_u32 m0, s92, 65536
L_st0_6:
 s_cbranch_execz L_warmed0
 v_exp_f32 v144, v144
 v_mfma_f32_16x16x32_bf16 v[148:151], a[152:155], v[104:107], v[148:151]
 ds_read_b128 a[188:191], v6 offset:3072
 v_add_u32 v254, s85, v248
 v_mfma_f32_16x16x32_bf16 v[148:151], a[156:159], v[136:139], v[148:151]
 s_waitcnt lgkmcnt(4)
 v_exp_f32 v145, v145
 v_mfma_f32_16x16x32_bf16 a[96:99], a[176:179], v[40:43], a[96:99]
 ds_read_b128 a[168:171], v4 offset:22528
 v_cvt_pk_bf16_f32 v72, v144, v145
 v_mfma_f32_16x16x32_bf16 a[96:99], a[180:183], v[44:47], a[96:99]
 v_exp_f32 v146, v146
 v_mfma_f32_16x16x32_bf16 a[64:67], a[176:179], v[32:35], a[64:67]
 ds_read_b128 a[172:175], v4 offset:23552
 v_xor_b32 v7, 0x8000, v7
 v_mfma_f32_16x16x32_bf16 a[64:67], a[180:183], v[36:39], a[64:67]
 v_exp_f32 v147, v147
 v_mfma_f32_16x16x32_bf16 v[152:155], a[144:147], v[84:87], v[176:179]
 ds_read_b128 a[192:195], v6 offset:4096
 v_cvt_pk_bf16_f32 v73, v146, v147
 v_mfma_f32_16x16x32_bf16 v[152:155], a[148:151], v[116:119], v[152:155]
 buffer_load_dwordx4 v1, s[36:39], s90 offen offset:0 sc1 lds
 v_mfma_f32_16x16x32_bf16 v[152:155], a[152:155], v[100:103], v[152:155]
 ds_read_b128 a[196:199], v6 offset:5120
 v_mfma_f32_16x16x32_bf16 v[152:155], a[156:159], v[132:135], v[152:155]
 v_exp_f32 v148, v148
 v_mfma_f32_16x16x32_bf16 a[32:35], a[176:179], v[24:27], a[32:35]
 ds_read_b128 a[200:203], v6 offset:6144
 v_mfma_f32_16x16x32_bf16 a[32:35], a[180:183], v[28:31], a[32:35]
 v_exp_f32 v149, v149
 v_mfma_f32_16x16x32_bf16 a[0:3], a[176:179], v[16:19], a[0:3]
 ds_read_b128 a[204:207], v6 offset:7168
 v_cvt_pk_bf16_f32 v64, v148, v149
 v_mfma_f32_16x16x32_bf16 a[0:3], a[180:183], v[20:23], a[0:3]
 v_exp_f32 v150, v150
 v_mfma_f32_16x16x32_bf16 v[156:159], a[144:147], v[80:83], v[160:163]
 ds_read_b128 a[144:147], v4 offset:24576
 v_mfma_f32_16x16x32_bf16 v[156:159], a[148:151], v[112:115], v[156:159]
 v_exp_f32 v151, v151
 v_mfma_f32_16x16x32_bf16 v[156:159], a[152:155], v[96:99], v[156:159]
 ds_read_b128 a[148:151], v4 offset:25600
 v_cvt_pk_bf16_f32 v65, v150, v151
 v_mfma_f32_16x16x32_bf16 v[156:159], a[156:159], v[128:131], v[156:159]
 s_waitcnt lgkmcnt(2)
 v_exp_f32 v152, v152
 v_mfma_f32_16x16x32_bf16 a[100:103], a[184:187], v[40:43], a[100:103]
 ds_read_b128 a[152:155], v4 offset:26624
 v_cmp_le_i32 vcc, 0, v254
 v_mfma_f32_16x16x32_bf16 a[100:103], a[188:191], v[44:47], a[100:103]
 v_exp_f32 v153, v153
 v_mfma_f32_16x16x32_bf16 a[68:71], a[184:187], v[32:35], a[68:71]
 ds_read_b128 a[156:159], v4 offset:27648
 v_cvt_pk_bf16_f32 v56, v152, v153
 v_mfma_f32_16x16x32_bf16 a[68:71], a[188:191], v[36:39], a[68:71]
 v_exp_f32 v154, v154
 v_mfma_f32_16x16x32_bf16 v[144:147], a[160:163], v[92:95], v[184:187]
 ds_read_b128 a[176:179], v6 offset:8192
 v_cmp_le_i32 s[98:99], 1, v254
 v_mfma_f32_16x16x32_bf16 v[144:147], a[164:167], v[124:127], v[144:147]
 v_exp_f32 v155, v155
 v_mfma_f32_16x16x32_bf16 v[144:147], a[168:171], v[108:111], v[144:147]
 ds_read_b128 a[180:183], v6 offset:9216
 v_cvt_pk_bf16_f32 v57, v154, v155
 v_mfma_f32_16x16x32_bf16 v[144:147], a[172:175], v[140:143], v[144:147]
 buffer_load_dwordx4 v1, s[36:39], s90 offen offset:1024 sc1 lds
 v_mfma_f32_16x16x32_bf16 a[36:39], a[184:187], v[24:27], a[36:39]
 v_exp_f32 v156, v156
 v_mfma_f32_16x16x32_bf16 a[36:39], a[188:191], v[28:31], a[36:39]
 v_exp_f32 v157, v157
 v_mfma_f32_16x16x32_bf16 a[4:7], a[184:187], v[16:19], a[4:7]
 v_exp_f32 v158, v158
 v_mfma_f32_16x16x32_bf16 a[4:7], a[188:191], v[20:23], a[4:7]
 ds_read_b128 a[184:187], v6 offset:10240
 v_cvt_pk_bf16_f32 v48, v156, v157
 v_mfma_f32_16x16x32_bf16 a[104:107], a[192:195], v[40:43], a[104:107]
 v_exp_f32 v159, v159
 v_mfma_f32_16x16x32_bf16 a[104:107], a[196:199], v[44:47], a[104:107]
 ds_read_b128 a[188:191], v6 offset:11264
 v_cvt_pk_bf16_f32 v49, v158, v159
 v_mfma_f32_16x16x32_bf16 v[148:151], a[160:163], v[88:91], v[180:183]
 v_exp_f32 v144, v144
 v_mfma_f32_16x16x32_bf16 v[148:151], a[164:167], v[120:123], v[148:151]
 v_exp_f32 v145, v145
 v_mfma_f32_16x16x32_bf16 v[148:151], a[168:171], v[104:107], v[148:151]
 v_exp_f32 v146, v146
 v_mfma_f32_16x16x32_bf16 v[148:151], a[172:175], v[136:139], v[148:151]
 v_exp_f32 v147, v147
 v_mfma_f32_16x16x32_bf16 a[72:75], a[192:195], v[32:35], a[72:75]
 v_cvt_pk_bf16_f32 v74, v144, v145
 v_cvt_pk_bf16_f32 v75, v146, v147
 v_mfma_f32_16x16x32_bf16 a[72:75], a[196:199], v[36:39], a[72:75]
 v_cmp_le_i32 s[100:101], 2, v254
 v_cndmask_b32 v160, v250, v192, vcc
 v_mfma_f32_16x16x32_bf16 a[40:43], a[192:195], v[24:27], a[40:43]
 v_exp_f32 v148, v148
 v_mfma_f32_16x16x32_bf16 a[40:43], a[196:199], v[28:31], a[40:43]
 v_exp_f32 v149, v149
 v_mfma_f32_16x16x32_bf16 v[152:155], a[160:163], v[84:87], v[176:179]
 v_exp_f32 v150, v150
 v_mfma_f32_16x16x32_bf16 v[152:155], a[164:167], v[116:119], v[152:155]
 v_exp_f32 v151, v151
 v_mfma_f32_16x16x32_bf16 v[152:155], a[168:171], v[100:103], v[152:155]
 v_cvt_pk_bf16_f32 v66, v148, v149
 v_cvt_pk_bf16_f32 v67, v150, v151
 v_mfma_f32_16x16x32_bf16 v[152:155], a[172:175], v[132:135], v[152:155]
 v_cmp_le_i32 vcc, 3, v254
 v_cndmask_b32 v161, v250, v192, s[98:99]
 v_mfma_f32_16x16x32_bf16 a[8:11], a[192:195], v[16:19], a[8:11]
 v_cndmask_b32 v162, v250, v192, s[100:101]
 v_cndmask_b32 v163, v250, v192, vcc
 v_mfma_f32_16x16x32_bf16 a[8:11], a[196:199], v[20:23], a[8:11]
 buffer_load_dwordx4 v1, s[36:39], s90 offen offset:2048 sc1 lds
 v_mfma_f32_16x16x32_bf16 a[108:111], a[200:203], v[40:43], a[108:111]
 v_exp_f32 v152, v152
 v_mfma_f32_16x16x32_bf16 a[108:111], a[204:207], v[44:47], a[108:111]
 v_exp_f32 v153, v153
 v_mfma_f32_16x16x32_bf16 v[156:159], a[160:163], v[80:83], v[164:167]
 ds_read_b128 a[160:163], v4 offset:28672
 v_cvt_pk_bf16_f32 v58, v152, v153
 v_mfma_f32_16x16x32_bf16 v[156:159], a[164:167], v[112:115], v[156:159]
 v_exp_f32 v154, v154
 v_mfma_f32_16x16x32_bf16 v[156:159], a[168:171], v[96:99], v[156:159]
 ds_read_b128 a[164:167], v4 offset:29696
 v_cmp_le_i32 vcc, 16, v254
 v_mfma_f32_16x16x32_bf16 v[156:159], a[172:175], v[128:131], v[156:159]
 v_exp_f32 v155, v155
 v_mfma_f32_16x16x32_bf16 a[76:79], a[200:203], v[32:35], a[76:79]
 ds_read_b128 a[168:171], v4 offset:30720
 v_cvt_pk_bf16_f32 v59, v154, v155
 v_mfma_f32_16x16x32_bf16 a[76:79], a[204:207], v[36:39], a[76:79]
 ds_read_b128 a[172:175], v4 offset:31744
 v_cmp_le_i32 s[98:99], 17, v254
 v_mfma_f32_16x16x32_bf16 a[44:47], a[200:203], v[24:27], a[44:47]
 v_exp_f32 v156, v156
 v_mfma_f32_16x16x32_bf16 a[44:47], a[204:207], v[28:31], a[44:47]
 s_waitcnt lgkmcnt(2)
 ds_read_b128 a[192:195], v6 offset:12288
 v_cmp_le_i32 s[100:101], 18, v254
 v_mfma_f32_16x16x32_bf16 v[144:147], a[144:147], v[92:95], v[184:187]
 v_exp_f32 v157, v157
 v_mfma_f32_16x16x32_bf16 v[144:147], a[148:151], v[124:127], v[144:147]
 ds_read_b128 a[196:199], v6 offset:13312
 v_cvt_pk_bf16_f32 v50, v156, v157
 v_mfma_f32_16x16x32_bf16 v[144:147], a[152:155], v[108:111], v[144:147]
 v_exp_f32 v158, v158
 v_mfma_f32_16x16x32_bf16 v[144:147], a[156:159], v[140:143], v[144:147]
 v_exp_f32 v159, v159
 v_mfma_f32_16x16x32_bf16 a[12:15], a[200:203], v[16:19], a[12:15]
 v_cvt_pk_bf16_f32 v51, v158, v159
 v_cndmask_b32 v164, v250, v192, vcc
 v_mfma_f32_16x16x32_bf16 a[12:15], a[204:207], v[20:23], a[12:15]
 ds_read_b128 a[200:203], v6 offset:14336
 v_cmp_le_i32 vcc, 19, v254
 v_mfma_f32_16x16x32_bf16 a[112:115], a[176:179], v[40:43], a[112:115]
 v_exp_f32 v144, v144
 v_mfma_f32_16x16x32_bf16 a[112:115], a[180:183], v[44:47], a[112:115]
 ds_read_b128 a[204:207], v6 offset:15360
 v_cndmask_b32 v165, v250, v192, s[98:99]
 v_mfma_f32_16x16x32_bf16 a[80:83], a[176:179], v[32:35], a[80:83]
 v_exp_f32 v145, v145
 v_mfma_f32_16x16x32_bf16 a[80:83], a[180:183], v[36:39], a[80:83]
 v_exp_f32 v146, v146
 v_mfma_f32_16x16x32_bf16 v[148:151], a[144:147], v[88:91], v[180:183]
 v_exp_f32 v147, v147
 v_mfma_f32_16x16x32_bf16 v[148:151], a[148:151], v[120:123], v[148:151]
 v_cvt_pk_bf16_f32 v76, v144, v145
 v_cvt_pk_bf16_f32 v77, v146, v147
 v_mfma_f32_16x16x32_bf16 v[148:151], a[152:155], v[104:107], v[148:151]
 buffer_load_dwordx4 v1, s[36:39], s90 offen offset:3072 sc1 lds
 v_mfma_f32_16x16x32_bf16 v[148:151], a[156:159], v[136:139], v[148:151]
 s_add_u32 m0, s93, 16384
 s_add_u32 s90, s90, 17408
 v_cndmask_b32 v166, v250, v192, s[100:101]
 v_mfma_f32_16x16x32_bf16 a[48:51], a[176:179], v[24:27], a[48:51]
 v_cndmask_b32 v167, v250, v192, vcc
 v_mfma_f32_16x16x32_bf16 a[48:51], a[180:183], v[28:31], a[48:51]
 v_mfma_f32_16x16x32_bf16 a[16:19], a[176:179], v[16:19], a[16:19]
 v_exp_f32 v148, v148
 v_mfma_f32_16x16x32_bf16 a[16:19], a[180:183], v[20:23], a[16:19]
 v_exp_f32 v149, v149
 v_mfma_f32_16x16x32_bf16 v[152:155], a[144:147], v[84:87], v[176:179]
 v_exp_f32 v150, v150
 v_mfma_f32_16x16x32_bf16 v[152:155], a[148:151], v[116:119], v[152:155]
 v_exp_f32 v151, v151
 v_mfma_f32_16x16x32_bf16 v[152:155], a[152:155], v[100:103], v[152:155]
 v_cvt_pk_bf16_f32 v68, v148, v149
 v_cvt_pk_bf16_f32 v69, v150, v151
 v_mfma_f32_16x16x32_bf16 v[152:155], a[156:159], v[132:135], v[152:155]
 v_mfma_f32_16x16x32_bf16 a[116:119], a[184:187], v[40:43], a[116:119]
 v_mfma_f32_16x16x32_bf16 a[116:119], a[188:191], v[44:47], a[116:119]
 v_mfma_f32_16x16x32_bf16 a[84:87], a[184:187], v[32:35], a[84:87]
 v_exp_f32 v152, v152
 v_mfma_f32_16x16x32_bf16 a[84:87], a[188:191], v[36:39], a[84:87]
 v_exp_f32 v153, v153
 v_mfma_f32_16x16x32_bf16 v[156:159], a[144:147], v[80:83], v[168:171]
 v_exp_f32 v154, v154
 v_mfma_f32_16x16x32_bf16 v[156:159], a[148:151], v[112:115], v[156:159]
 v_exp_f32 v155, v155
 v_mfma_f32_16x16x32_bf16 v[156:159], a[152:155], v[96:99], v[156:159]
 v_cvt_pk_bf16_f32 v60, v152, v153
 v_cvt_pk_bf16_f32 v61, v154, v155
 v_mfma_f32_16x16x32_bf16 v[156:159], a[156:159], v[128:131], v[156:159]
 v_cmp_le_i32 vcc, 32, v254
 v_cmp_le_i32 s[98:99], 33, v254
 v_mfma_f32_16x16x32_bf16 a[52:55], a[184:187], v[24:27], a[52:55]
 v_cmp_le_i32 s[100:101], 34, v254
 v_cndmask_b32 v168, v250, v192, vcc
 v_mfma_f32_16x16x32_bf16 a[52:55], a[188:191], v[28:31], a[52:55]
 v_cmp_le_i32 vcc, 35, v254
 v_cndmask_b32 v169, v250, v192, s[98:99]
 v_mfma_f32_16x16x32_bf16 a[20:23], a[184:187], v[16:19], a[20:23]
 v_exp_f32 v156, v156
 v_mfma_f32_16x16x32_bf16 a[20:23], a[188:191], v[20:23], a[20:23]
 v_exp_f32 v157, v157
 v_mfma_f32_16x16x32_bf16 v[144:147], a[160:163], v[92:95], v[184:187]
 v_exp_f32 v158, v158
 v_mfma_f32_16x16x32_bf16 v[144:147], a[164:167], v[124:127], v[144:147]
 s_waitcnt lgkmcnt(5)
 v_exp_f32 v159, v159
 v_mfma_f32_16x16x32_bf16 v[144:147], a[168:171], v[108:111], v[144:147]
 s_waitcnt vmcnt(13) lgkmcnt(0)
 v_cvt_pk_bf16_f32 v52, v156, v157
 v_cvt_pk_bf16_f32 v53, v158, v159
 v_mfma_f32_16x16x32_bf16 v[144:147], a[172:175], v[140:143], v[144:147]
 s_barrier
 v_xor_b32 v4, 0x8000, v4
 v_mfma_f32_16x16x32_bf16 a[120:123], a[192:195], v[40:43], a[120:123]
 ds_read_b128 a[144:147], v5 offset:0
 v_cndmask_b32 v170, v250, v192, s[100:101]
 v_mfma_f32_16x16x32_bf16 a[120:123], a[196:199], v[44:47], a[120:123]
L_st0_7:
 s_cbranch_execz L_warmed0
 buffer_load_dwordx4 v1, s[56:59], s91 offen offset:0 sc1 lds
 v_mfma_f32_16x16x32_bf16 a[88:91], a[192:195], v[32:35], a[88:91]
 ds_read_b128 a[148:151], v5 offset:1024
 v_cndmask_b32 v171, v250, v192, vcc
 v_mfma_f32_16x16x32_bf16 a[88:91], a[196:199], v[36:39], a[88:91]
 v_exp_f32 v144, v144
 v_mfma_f32_16x16x32_bf16 a[56:59], a[192:195], v[24:27], a[56:59]
 ds_read_b128 a[152:155], v5 offset:2048
 v_mfma_f32_16x16x32_bf16 a[56:59], a[196:199], v[28:31], a[56:59]
 v_exp_f32 v145, v145
 v_mfma_f32_16x16x32_bf16 v[148:151], a[160:163], v[88:91], v[180:183]
 ds_read_b128 a[156:159], v5 offset:3072
 v_cvt_pk_bf16_f32 v78, v144, v145
 v_mfma_f32_16x16x32_bf16 v[148:151], a[164:167], v[120:123], v[148:151]
 v_exp_f32 v146, v146
 v_mfma_f32_16x16x32_bf16 v[148:151], a[168:171], v[104:107], v[148:151]
 ds_read_b128 a[176:179], v6 offset:16384
 v_mfma_f32_16x16x32_bf16 v[148:151], a[172:175], v[136:139], v[148:151]
 buffer_load_dwordx4 v1, s[56:59], s91 offen offset:1024 sc1 lds
 v_mfma_f32_16x16x32_bf16 a[24:27], a[192:195], v[16:19], a[24:27]
 ds_read_b128 a[180:183], v6 offset:17408
 v_mfma_f32_16x16x32_bf16 a[24:27], a[196:199], v[20:23], a[24:27]
 v_exp_f32 v147, v147
 v_mfma_f32_16x16x32_bf16 a[124:127], a[200:203], v[40:43], a[124:127]
 v_exp_f32 v148, v148
 v_mfma_f32_16x16x32_bf16 a[124:127], a[204:207], v[44:47], a[124:127]
 v_exp_f32 v149, v149
 v_mfma_f32_16x16x32_bf16 v[152:155], a[160:163], v[84:87], v[176:179]
 v_exp_f32 v150, v150
 v_mfma_f32_16x16x32_bf16 v[152:155], a[164:167], v[116:119], v[152:155]
 v_exp_f32 v151, v151
 v_mfma_f32_16x16x32_bf16 v[152:155], a[168:171], v[100:103], v[152:155]
 v_cvt_pk_bf16_f32 v79, v146, v147
 v_cvt_pk_bf16_f32 v70, v148, v149
 v_mfma_f32_16x16x32_bf16 v[152:155], a[172:175], v[132:135], v[152:155]
 v_cvt_pk_bf16_f32 v71, v150, v151
 v_mfma_f32_16x16x32_bf16 a[92:95], a[200:203], v[32:35], a[92:95]
 v_mfma_f32_16x16x32_bf16 a[92:95], a[204:207], v[36:39], a[92:95]
 buffer_load_dwordx4 v1, s[56:59], s91 offen offset:2048 sc1 lds
 v_mfma_f32_16x16x32_bf16 a[60:63], a[200:203], v[24:27], a[60:63]
 v_exp_f32 v152, v152
 v_mfma_f32_16x16x32_bf16 a[60:63], a[204:207], v[28:31], a[60:63]
 v_exp_f32 v153, v153
 v_mfma_f32_16x16x32_bf16 v[156:159], a[160:163], v[80:83], v[172:175]
 ds_read_b128 a[160:163], v5 offset:4096
 v_cvt_pk_bf16_f32 v62, v152, v153
 v_mfma_f32_16x16x32_bf16 v[156:159], a[164:167], v[112:115], v[156:159]
 v_exp_f32 v154, v154
 v_mfma_f32_16x16x32_bf16 v[156:159], a[168:171], v[96:99], v[156:159]
 ds_read_b128 a[164:167], v5 offset:5120
 v_cmp_le_i32 vcc, 48, v254
 v_mfma_f32_16x16x32_bf16 v[156:159], a[172:175], v[128:131], v[156:159]
 v_exp_f32 v155, v155
 v_mfma_f32_16x16x32_bf16 a[28:31], a[200:203], v[16:19], a[28:31]
 v_cvt_pk_bf16_f32 v63, v154, v155
 v_cmp_le_i32 s[98:99], 49, v254
 v_mfma_f32_16x16x32_bf16 a[28:31], a[204:207], v[20:23], a[28:31]
 v_cmp_le_i32 s[100:101], 50, v254
 v_cndmask_b32 v172, v250, v192, vcc
 v_mfma_f32_16x16x32_bf16 a[140:143], v[212:215], v[40:43], a[140:143]
 v_exp_f32 v156, v156
 v_mfma_f32_16x16x32_bf16 a[140:143], v[212:215], v[44:47], a[140:143]
 s_waitcnt lgkmcnt(4)
 v_exp_f32 v157, v157
 v_mfma_f32_16x16x32_bf16 v[144:147], a[144:147], v[92:95], v[188:191]
 v_exp_f32 v158, v158
 v_mfma_f32_16x16x32_bf16 v[144:147], a[148:151], v[124:127], v[144:147]
 v_exp_f32 v159, v159
 v_mfma_f32_16x16x32_bf16 v[144:147], a[152:155], v[108:111], v[144:147]
 buffer_load_dwordx4 v1, s[56:59], s91 offen offset:3072 sc1 lds
 v_mfma_f32_16x16x32_bf16 v[144:147], a[156:159], v[140:143], v[144:147]
 s_add_u32 s91, s91, 17408
 v_cvt_pk_bf16_f32 v54, v156, v157
 v_cvt_pk_bf16_f32 v55, v158, v159
 v_mfma_f32_16x16x32_bf16 a[136:139], v[212:215], v[32:35], a[136:139]
 v_cmp_le_i32 vcc, 51, v254
 v_cndmask_b32 v173, v250, v192, s[98:99]
 v_mfma_f32_16x16x32_bf16 a[136:139], v[212:215], v[36:39], a[136:139]
 v_cndmask_b32 v174, v250, v192, s[100:101]
 v_cndmask_b32 v175, v250, v192, vcc
 v_mfma_f32_16x16x32_bf16 a[132:135], v[212:215], v[24:27], a[132:135]
 v_mfma_f32_16x16x32_bf16 a[132:135], v[212:215], v[28:31], a[132:135]
 v_mfma_f32_16x16x32_bf16 a[128:131], v[212:215], v[16:19], a[128:131]
 v_mfma_f32_16x16x32_bf16 a[128:131], v[212:215], v[20:23], a[128:131]
 v_mfma_f32_16x16x32_bf16 v[148:151], a[144:147], v[88:91], v[180:183]
 s_add_u32 m0, s92, 81920
 ds_read_b128 a[184:187], v7 offset:18432
 s_lshl_b32 s85, s2, 2
 v_mfma_f32_16x16x32_bf16 v[148:151], a[148:151], v[120:123], v[148:151]
 s_waitcnt lgkmcnt(3)
 buffer_load_dwordx4 v1, s[36:39], s90 offen offset:0 sc1 lds
 v_mfma_f32_16x16x32_bf16 v[148:151], a[152:155], v[104:107], v[148:151]
 s_add_u32 s85, s85, s60
 ds_read_b128 a[188:191], v7 offset:19456
 s_lshl_b32 s86, s94, 9
 v_mfma_f32_16x16x32_bf16 v[148:151], a[156:159], v[136:139], v[148:151]
 s_add_u32 s85, s85, s86
 v_exp_f32 v144, v144
 v_mfma_f32_16x16x32_bf16 a[96:99], a[176:179], v[72:75], a[96:99]
 s_sub_u32 s85, s85, 1024
 ds_read_b128 a[168:171], v4 offset:6144
 s_lshl_b32 s85, s85, 12
 v_mfma_f32_16x16x32_bf16 a[96:99], a[180:183], v[76:79], a[96:99]
 s_xor_b32 s93, s93, 0x8000
 v_exp_f32 v145, v145
 v_mfma_f32_16x16x32_bf16 a[64:67], a[176:179], v[64:67], a[64:67]
 ds_read_b128 a[172:175], v4 offset:7168
 v_cvt_pk_bf16_f32 v40, v144, v145
 v_mfma_f32_16x16x32_bf16 a[64:67], a[180:183], v[68:71], a[64:67]
 v_exp_f32 v146, v146
 v_mfma_f32_16x16x32_bf16 v[152:155], a[144:147], v[84:87], v[176:179]
 ds_read_b128 a[192:195], v7 offset:20480
 v_and_b32 v196, 496, v1
 v_mfma_f32_16x16x32_bf16 v[152:155], a[148:151], v[116:119], v[152:155]
 v_exp_f32 v147, v147
 v_mfma_f32_16x16x32_bf16 v[152:155], a[152:155], v[100:103], v[152:155]
 ds_read_b128 a[196:199], v7 offset:21504
 v_cvt_pk_bf16_f32 v41, v146, v147
 v_mfma_f32_16x16x32_bf16 v[152:155], a[156:159], v[132:135], v[152:155]
 v_exp_f32 v148, v148
 v_mfma_f32_16x16x32_bf16 a[32:35], a[176:179], v[56:59], a[32:35]
 ds_read_b128 a[200:203], v7 offset:22528
 v_lshl_add_u32 v196, v196, 3, s85
 v_mfma_f32_16x16x32_bf16 a[32:35], a[180:183], v[60:63], a[32:35]
 v_exp_f32 v149, v149
 v_mfma_f32_16x16x32_bf16 a[0:3], a[176:179], v[48:51], a[0:3]
 ds_read_b128 a[204:207], v7 offset:23552
 v_cvt_pk_bf16_f32 v32, v148, v149
 v_mfma_f32_16x16x32_bf16 a[0:3], a[180:183], v[52:55], a[0:3]
 v_exp_f32 v150, v150
 v_mfma_f32_16x16x32_bf16 v[156:159], a[144:147], v[80:83], v[160:163]
 ds_read_b128 a[144:147], v4 offset:8192
 v_subrev_u32 v197, 4194304, v196
 v_mfma_f32_16x16x32_bf16 v[156:159], a[148:151], v[112:115], v[156:159]
 v_exp_f32 v151, v151
 v_mfma_f32_16x16x32_bf16 v[156:159], a[152:155], v[96:99], v[156:159]
 ds_read_b128 a[148:151], v4 offset:9216
 v_cvt_pk_bf16_f32 v33, v150, v151
 v_mfma_f32_16x16x32_bf16 v[156:159], a[156:159], v[128:131], v[156:159]
 s_waitcnt lgkmcnt(2)
 v_exp_f32 v152, v152
 v_mfma_f32_16x16x32_bf16 a[100:103], a[184:187], v[72:75], a[100:103]
 ds_read_b128 a[152:155], v4 offset:10240
 v_xor_b32 v6, 0x8000, v6
 v_mfma_f32_16x16x32_bf16 a[100:103], a[188:191], v[76:79], a[100:103]
 v_exp_f32 v153, v153
 v_mfma_f32_16x16x32_bf16 a[68:71], a[184:187], v[64:67], a[68:71]
 ds_read_b128 a[156:159], v4 offset:11264
 v_cvt_pk_bf16_f32 v24, v152, v153
 v_mfma_f32_16x16x32_bf16 a[68:71], a[188:191], v[68:71], a[68:71]
 v_exp_f32 v154, v154
 v_mfma_f32_16x16x32_bf16 v[144:147], a[160:163], v[92:95], v[184:187]
 ds_read_b128 a[176:179], v7 offset:24576
 v_xor_b32 v5, 0x8000, v5
 v_mfma_f32_16x16x32_bf16 v[144:147], a[164:167], v[124:127], v[144:147]
 v_exp_f32 v155, v155
 v_mfma_f32_16x16x32_bf16 v[144:147], a[168:171], v[108:111], v[144:147]
 ds_read_b128 a[180:183], v7 offset:25600
 v_cvt_pk_bf16_f32 v25, v154, v155
 v_mfma_f32_16x16x32_bf16 v[144:147], a[172:175], v[140:143], v[144:147]
 buffer_load_dwordx4 v1, s[36:39], s90 offen offset:1024 sc1 lds
 v_mfma_f32_16x16x32_bf16 a[36:39], a[184:187], v[56:59], a[36:39]
 v_exp_f32 v156, v156
 v_mfma_f32_16x16x32_bf16 a[36:39], a[188:191], v[60:63], a[36:39]
 v_exp_f32 v157, v157
 v_mfma_f32_16x16x32_bf16 a[4:7], a[184:187], v[48:51], a[4:7]
 v_exp_f32 v158, v158
 v_mfma_f32_16x16x32_bf16 a[4:7], a[188:191], v[52:55], a[4:7]
 ds_read_b128 a[184:187], v7 offset:26624
 v_cvt_pk_bf16_f32 v16, v156, v157
 v_mfma_f32_16x16x32_bf16 a[104:107], a[192:195], v[72:75], a[104:107]
 v_exp_f32 v159, v159
 v_mfma_f32_16x16x32_bf16 a[104:107], a[196:199], v[76:79], a[104:107]
 ds_read_b128 a[188:191], v7 offset:27648
 v_cvt_pk_bf16_f32 v17, v158, v159
 v_mfma_f32_16x16x32_bf16 v[148:151], a[160:163], v[88:91], v[180:183]
 v_exp_f32 v144, v144
 v_mfma_f32_16x16x32_bf16 v[148:151], a[164:167], v[120:123], v[148:151]
 v_exp_f32 v145, v145
 v_mfma_f32_16x16x32_bf16 v[148:151], a[168:171], v[104:107], v[148:151]
 v_exp_f32 v146, v146
 v_mfma_f32_16x16x32_bf16 v[148:151], a[172:175], v[136:139], v[148:151]
 v_exp_f32 v147, v147
 v_mfma_f32_16x16x32_bf16 a[72:75], a[192:195], v[64:67], a[72:75]
 v_cvt_pk_bf16_f32 v43, v146, v147
 v_cvt_pk_bf16_f32 v42, v144, v145
 v_mfma_f32_16x16x32_bf16 a[72:75], a[196:199], v[68:71], a[72:75]
 v_mfma_f32_16x16x32_bf16 a[40:43], a[192:195], v[56:59], a[40:43]
 v_exp_f32 v148, v148
 v_mfma_f32_16x16x32_bf16 a[40:43], a[196:199], v[60:63], a[40:43]
 v_exp_f32 v149, v149
 v_mfma_f32_16x16x32_bf16 v[152:155], a[160:163], v[84:87], v[176:179]
 v_exp_f32 v150, v150
 v_mfma_f32_16x16x32_bf16 v[152:155], a[164:167], v[116:119], v[152:155]
 v_exp_f32 v151, v151
 v_mfma_f32_16x16x32_bf16 v[152:155], a[168:171], v[100:103], v[152:155]
 v_cvt_pk_bf16_f32 v35, v150, v151
 v_cvt_pk_bf16_f32 v34, v148, v149
 v_mfma_f32_16x16x32_bf16 v[152:155], a[172:175], v[132:135], v[152:155]
 v_mfma_f32_16x16x32_bf16 a[8:11], a[192:195], v[48:51], a[8:11]
 v_mfma_f32_16x16x32_bf16 a[8:11], a[196:199], v[52:55], a[8:11]
 buffer_load_dwordx4 v1, s[36:39], s90 offen offset:2048 sc1 lds
 v_mfma_f32_16x16x32_bf16 a[108:111], a[200:203], v[72:75], a[108:111]
 v_exp_f32 v152, v152
 v_mfma_f32_16x16x32_bf16 a[108:111], a[204:207], v[76:79], a[108:111]
 v_exp_f32 v153, v153
 v_mfma_f32_16x16x32_bf16 v[156:159], a[160:163], v[80:83], v[164:167]
 ds_read_b128 a[160:163], v4 offset:12288
 v_cvt_pk_bf16_f32 v26, v152, v153
 v_mfma_f32_16x16x32_bf16 v[156:159], a[164:167], v[112:115], v[156:159]
 v_exp_f32 v154, v154
 v_mfma_f32_16x16x32_bf16 v[156:159], a[168:171], v[96:99], v[156:159]
 ds_read_b128 a[164:167], v4 offset:13312
 v_mfma_f32_16x16x32_bf16 v[156:159], a[172:175], v[128:131], v[156:159]
 v_exp_f32 v155, v155
 v_mfma_f32_16x16x32_bf16 a[76:79], a[200:203], v[64:67], a[76:79]
 ds_read_b128 a[168:171], v4 offset:14336
 v_cvt_pk_bf16_f32 v27, v154, v155
 v_mfma_f32_16x16x32_bf16 a[76:79], a[204:207], v[68:71], a[76:79]
 ds_read_b128 a[172:175], v4 offset:15360
 v_mfma_f32_16x16x32_bf16 a[44:47], a[200:203], v[56:59], a[44:47]
 v_exp_f32 v156, v156
 v_mfma_f32_16x16x32_bf16 a[44:47], a[204:207], v[60:63], a[44:47]
 s_waitcnt lgkmcnt(2)
 ds_read_b128 a[192:195], v7 offset:28672
 v_mfma_f32_16x16x32_bf16 v[144:147], a[144:147], v[92:95], v[184:187]
 v_exp_f32 v157, v157
 v_mfma_f32_16x16x32_bf16 v[144:147], a[148:151], v[124:127], v[144:147]
 ds_read_b128 a[196:199], v7 offset:29696
 v_cvt_pk_bf16_f32 v18, v156, v157
 v_mfma_f32_16x16x32_bf16 v[144:147], a[152:155], v[108:111], v[144:147]
 v_exp_f32 v158, v158
 v_mfma_f32_16x16x32_bf16 v[144:147], a[156:159], v[140:143], v[144:147]
 v_exp_f32 v159, v159
 v_mfma_f32_16x16x32_bf16 a[12:15], a[200:203], v[48:51], a[12:15]
 v_cvt_pk_bf16_f32 v19, v158, v159
 v_mfma_f32_16x16x32_bf16 a[12:15], a[204:207], v[52:55], a[12:15]
 ds_read_b128 a[200:203], v7 offset:30720
 v_mfma_f32_16x16x32_bf16 a[112:115], a[176:179], v[72:75], a[112:115]
 v_exp_f32 v144, v144
 v_mfma_f32_16x16x32_bf16 a[112:115], a[180:183], v[76:79], a[112:115]
 ds_read_b128 a[204:207], v7 offset:31744
 v_mfma_f32_16x16x32_bf16 a[80:83], a[176:179], v[64:67], a[80:83]
 v_exp_f32 v145, v145
 v_mfma_f32_16x16x32_bf16 a[80:83], a[180:183], v[68:71], a[80:83]
 v_exp_f32 v146, v146
 v_mfma_f32_16x16x32_bf16 v[148:151], a[144:147], v[88:91], v[180:183]
 v_exp_f32 v147, v147
 v_mfma_f32_16x16x32_bf16 v[148:151], a[148:151], v[120:123], v[148:151]
 v_cvt_pk_bf16_f32 v45, v146, v147
 v_cvt_pk_bf16_f32 v44, v144, v145
 v_mfma_f32_16x16x32_bf16 v[148:151], a[152:155], v[104:107], v[148:151]
 buffer_load_dwordx4 v1, s[36:39], s90 offen offset:3072 sc1 lds
 v_mfma_f32_16x16x32_bf16 v[148:151], a[156:159], v[136:139], v[148:151]
 s_add_u32 m0, s92, 0
 s_xor_b32 s92, s92, 0x8000
 s_add_u32 s90, s90, 17408
 v_mfma_f32_16x16x32_bf16 a[48:51], a[176:179], v[56:59], a[48:51]
 v_mfma_f32_16x16x32_bf16 a[48:51], a[180:183], v[60:63], a[48:51]
 v_mfma_f32_16x16x32_bf16 a[16:19], a[176:179], v[48:51], a[16:19]
 v_exp_f32 v148, v148
 v_mfma_f32_16x16x32_bf16 a[16:19], a[180:183], v[52:55], a[16:19]
 v_exp_f32 v149, v149
 v_mfma_f32_16x16x32_bf16 v[152:155], a[144:147], v[84:87], v[176:179]
 buffer_load_dword v198, v196, s[52:55], 0 offen
 v_mfma_f32_16x16x32_bf16 v[152:155], a[148:151], v[116:119], v[152:155]
 v_exp_f32 v150, v150
 v_mfma_f32_16x16x32_bf16 v[152:155], a[152:155], v[100:103], v[152:155]
 v_exp_f32 v151, v151
 v_mfma_f32_16x16x32_bf16 v[152:155], a[156:159], v[132:135], v[152:155]
 v_cvt_pk_bf16_f32 v36, v148, v149
 v_cvt_pk_bf16_f32 v37, v150, v151
 v_mfma_f32_16x16x32_bf16 a[116:119], a[184:187], v[72:75], a[116:119]
 buffer_load_dword v198, v197, s[32:35], 0 offen
 v_mfma_f32_16x16x32_bf16 a[116:119], a[188:191], v[76:79], a[116:119]
 v_mfma_f32_16x16x32_bf16 a[84:87], a[184:187], v[64:67], a[84:87]
 v_exp_f32 v152, v152
 v_mfma_f32_16x16x32_bf16 a[84:87], a[188:191], v[68:71], a[84:87]
 v_exp_f32 v153, v153
 v_mfma_f32_16x16x32_bf16 v[156:159], a[144:147], v[80:83], v[168:171]
 v_exp_f32 v154, v154
 v_mfma_f32_16x16x32_bf16 v[156:159], a[148:151], v[112:115], v[156:159]
 v_exp_f32 v155, v155
 v_mfma_f32_16x16x32_bf16 v[156:159], a[152:155], v[96:99], v[156:159]
 v_cvt_pk_bf16_f32 v29, v154, v155
 v_cvt_pk_bf16_f32 v28, v152, v153
 v_mfma_f32_16x16x32_bf16 v[156:159], a[156:159], v[128:131], v[156:159]
 v_mfma_f32_16x16x32_bf16 a[52:55], a[184:187], v[56:59], a[52:55]
 v_mfma_f32_16x16x32_bf16 a[52:55], a[188:191], v[60:63], a[52:55]
 v_mfma_f32_16x16x32_bf16 a[20:23], a[184:187], v[48:51], a[20:23]
 v_exp_f32 v156, v156
 v_mfma_f32_16x16x32_bf16 a[20:23], a[188:191], v[52:55], a[20:23]
 v_exp_f32 v157, v157
 v_mfma_f32_16x16x32_bf16 v[144:147], a[160:163], v[92:95], v[184:187]
 v_exp_f32 v158, v158
 v_mfma_f32_16x16x32_bf16 v[144:147], a[164:167], v[124:127], v[144:147]
 s_waitcnt lgkmcnt(5)
 v_exp_f32 v159, v159
 v_mfma_f32_16x16x32_bf16 v[144:147], a[168:171], v[108:111], v[144:147]
 s_waitcnt vmcnt(14) lgkmcnt(0)
 v_cvt_pk_bf16_f32 v20, v156, v157
 v_cvt_pk_bf16_f32 v21, v158, v159
 v_mfma_f32_16x16x32_bf16 v[144:147], a[172:175], v[140:143], v[144:147]
 s_barrier
 v_mfma_f32_16x16x32_bf16 a[120:123], a[192:195], v[72:75], a[120:123]
 ds_read_b128 a[144:147], v4 offset:16384
 v_mfma_f32_16x16x32_bf16 a[120:123], a[196:199], v[76:79], a[120:123]
 buffer_load_dwordx4 v1, s[56:59], s91 offen offset:0 sc1 lds
 v_mfma_f32_16x16x32_bf16 a[88:91], a[192:195], v[64:67], a[88:91]
 ds_read_b128 a[148:151], v4 offset:17408
 v_mfma_f32_16x16x32_bf16 a[88:91], a[196:199], v[68:71], a[88:91]
 v_exp_f32 v144, v144
 v_mfma_f32_16x16x32_bf16 a[56:59], a[192:195], v[56:59], a[56:59]
 ds_read_b128 a[152:155], v4 offset:18432
 v_mfma_f32_16x16x32_bf16 a[56:59], a[196:199], v[60:63], a[56:59]
 v_exp_f32 v145, v145
 v_mfma_f32_16x16x32_bf16 v[148:151], a[160:163], v[88:91], v[180:183]
 ds_read_b128 a[156:159], v4 offset:19456
 v_cvt_pk_bf16_f32 v46, v144, v145
 v_mfma_f32_16x16x32_bf16 v[148:151], a[164:167], v[120:123], v[148:151]
 v_exp_f32 v146, v146
 v_mfma_f32_16x16x32_bf16 v[148:151], a[168:171], v[104:107], v[148:151]
 v_exp_f32 v147, v147
 v_mfma_f32_16x16x32_bf16 v[148:151], a[172:175], v[136:139], v[148:151]
 buffer_load_dwordx4 v1, s[56:59], s91 offen offset:1024 sc1 lds
 v_mfma_f32_16x16x32_bf16 a[24:27], a[192:195], v[48:51], a[24:27]
 v_cvt_pk_bf16_f32 v47, v146, v147
 v_mfma_f32_16x16x32_bf16 a[24:27], a[196:199], v[52:55], a[24:27]
 v_mfma_f32_16x16x32_bf16 a[124:127], a[200:203], v[72:75], a[124:127]
 v_exp_f32 v148, v148
 v_mfma_f32_16x16x32_bf16 a[124:127], a[204:207], v[76:79], a[124:127]
 v_exp_f32 v149, v149
 v_mfma_f32_16x16x32_bf16 v[152:155], a[160:163], v[84:87], v[176:179]
 v_exp_f32 v150, v150
 v_mfma_f32_16x16x32_bf16 v[152:155], a[164:167], v[116:119], v[152:155]
 v_exp_f32 v151, v151
 v_mfma_f32_16x16x32_bf16 v[152:155], a[168:171], v[100:103], v[152:155]
 v_cvt_pk_bf16_f32 v38, v148, v149
 v_cvt_pk_bf16_f32 v39, v150, v151
 v_mfma_f32_16x16x32_bf16 v[152:155], a[172:175], v[132:135], v[152:155]
 v_mfma_f32_16x16x32_bf16 a[92:95], a[200:203], v[64:67], a[92:95]
 v_mfma_f32_16x16x32_bf16 a[92:95], a[204:207], v[68:71], a[92:95]
 buffer_load_dwordx4 v1, s[56:59], s91 offen offset:2048 sc1 lds
 v_mfma_f32_16x16x32_bf16 a[60:63], a[200:203], v[56:59], a[60:63]
 v_exp_f32 v152, v152
 v_mfma_f32_16x16x32_bf16 a[60:63], a[204:207], v[60:63], a[60:63]
 v_exp_f32 v153, v153
 v_mfma_f32_16x16x32_bf16 v[156:159], a[160:163], v[80:83], v[172:175]
 v_exp_f32 v154, v154
 v_mfma_f32_16x16x32_bf16 v[156:159], a[164:167], v[112:115], v[156:159]
 v_exp_f32 v155, v155
 v_mfma_f32_16x16x32_bf16 v[156:159], a[168:171], v[96:99], v[156:159]
 v_cvt_pk_bf16_f32 v31, v154, v155
 v_cvt_pk_bf16_f32 v30, v152, v153
 v_mfma_f32_16x16x32_bf16 v[156:159], a[172:175], v[128:131], v[156:159]
 v_mfma_f32_16x16x32_bf16 a[28:31], a[200:203], v[48:51], a[28:31]
 v_mfma_f32_16x16x32_bf16 a[28:31], a[204:207], v[52:55], a[28:31]
 v_mfma_f32_16x16x32_bf16 a[140:143], v[212:215], v[72:75], a[140:143]
 v_exp_f32 v156, v156
 v_mfma_f32_16x16x32_bf16 a[140:143], v[212:215], v[76:79], a[140:143]
 s_waitcnt lgkmcnt(0)
 buffer_load_dwordx4 v1, s[56:59], s91 offen offset:3072 sc1 lds
 v_mfma_f32_16x16x32_bf16 v[144:147], a[144:147], v[92:95], v[188:191]
 s_add_u32 s91, s91, 17408
 ds_read_b128 a[176:179], v6 offset:0
 v_mfma_f32_16x16x32_bf16 v[144:147], a[148:151], v[124:127], v[144:147]
 v_exp_f32 v157, v157
 v_mfma_f32_16x16x32_bf16 v[144:147], a[152:155], v[108:111], v[144:147]
 v_exp_f32 v158, v158
 v_mfma_f32_16x16x32_bf16 v[144:147], a[156:159], v[140:143], v[144:147]
 ds_read_b128 a[180:183], v6 offset:1024
 v_cvt_pk_bf16_f32 v22, v156, v157
 v_mfma_f32_16x16x32_bf16 a[136:139], v[212:215], v[64:67], a[136:139]
 v_exp_f32 v159, v159
 v_mfma_f32_16x16x32_bf16 a[136:139], v[212:215], v[68:71], a[136:139]
 v_cvt_pk_bf16_f32 v23, v158, v159
 v_mfma_f32_16x16x32_bf16 a[132:135], v[212:215], v[56:59], a[132:135]
 ds_read_b128 a[160:163], v4 offset:20480
 v_mfma_f32_16x16x32_bf16 a[132:135], v[212:215], v[60:63], a[132:135]
 v_mfma_f32_16x16x32_bf16 a[128:131], v[212:215], v[48:51], a[128:131]
 v_mfma_f32_16x16x32_bf16 a[128:131], v[212:215], v[52:55], a[128:131]
 s_cmp_lg_u32 s94, 0
 ds_read_b128 a[164:167], v4 offset:21504
 s_cbranch_scc1 L_dloop
 s_branch L_three
L_spin_h:
 s_mov_b32 s87, 0
L_spin2_h:
 s_sleep 4
 buffer_load_dwordx4 v[200:203], v1, s[40:43], s72 offen sc1
 s_add_u32 s87, s87, 1
 s_cmp_gt_u32 s87, 200000
 s_waitcnt vmcnt(0)
 s_cbranch_scc1 L_back_h
 v_min_u32 v251, v200, v201
 v_min3_u32 v251, v251, v202, v203
 v_cmp_eq_u32 vcc, 0, v251
 s_nop 1
 s_cbranch_vccnz L_spin2_h
 s_branch L_back_h
L_setbad:
 s_xor_b32 s85, s95, 1
 v_mov_b32 v221, s85
 ds_write_b32 v220, v221
 s_branch L_setbad_back
L_fallback:
 s_mov_b32 s95, 1
 s_waitcnt vmcnt(0) lgkmcnt(0)
 s_barrier
 s_lshl_b32 s85, s62, 7
 s_sub_u32 s86, 1920, s85
 v_add_u32 v160, s85, v248
 v_add_u32 v161, s85, v249
 v_add_u32 v162, s86, v248
 v_add_u32 v163, s86, v249
 v_add_u32 v161, 64, v161
 v_add_u32 v163, 64, v163
 v_mov_b32 v254, v160
 v_mov_b32 v196, v250
 v_mov_b32 v197, v250
 v_mov_b32 v198, v250
 v_mov_b32 v199, v250
 s_mov_b32 s94, 0
 s_lshl_b32 s87, s62, 3
 s_sub_u32 s87, 128, s87
L_fb_loop:
 s_lshr_b32 s85, s94, 2
 s_mul_i32 s85, s85, 17408
 s_and_b32 s86, s94, 3
 s_lshl_b32 s86, s86, 12
 s_add_u32 s85, s85, s86
 buffer_load_dwordx4 a[144:147], v1, s[36:39], s85 offen offset:0 sc1
 buffer_load_dwordx4 a[148:151], v1, s[36:39], s85 offen offset:1024 sc1
 buffer_load_dwordx4 a[152:155], v1, s[36:39], s85 offen offset:2048 sc1
 buffer_load_dwordx4 a[156:159], v1, s[36:39], s85 offen offset:3072 sc1
 s_waitcnt vmcnt(0)
 v_mfma_f32_16x16x32_bf16 v[144:147], a[144:147], v[80:83], 0
 v_mfma_f32_16x16x32_bf16 v[144:147], a[148:151], v[112:115], v[144:147]
 v_mfma_f32_16x16x32_bf16 v[144:147], a[152:155], v[96:99], v[144:147]
 v_mfma_f32_16x16x32_bf16 v[144:147], a[156:159], v[128:131], v[144:147]
 v_mfma_f32_16x16x32_bf16 v[148:151], a[144:147], v[84:87], 0
 v_mfma_f32_16x16x32_bf16 v[148:151], a[148:151], v[116:119], v[148:151]
 v_mfma_f32_16x16x32_bf16 v[148:151], a[152:155], v[100:103], v[148:151]
 v_mfma_f32_16x16x32_bf16 v[148:151], a[156:159], v[132:135], v[148:151]
 v_mfma_f32_16x16x32_bf16 v[152:155], a[144:147], v[88:91], 0
 v_mfma_f32_16x16x32_bf16 v[152:155], a[148:151], v[120:123], v[152:155]
 v_mfma_f32_16x16x32_bf16 v[152:155], a[152:155], v[104:107], v[152:155]
 v_mfma_f32_16x16x32_bf16 v[152:155], a[156:159], v[136:139], v[152:155]
 v_mfma_f32_16x16x32_bf16 v[156:159], a[144:147], v[92:95], 0
 v_mfma_f32_16x16x32_bf16 v[156:159], a[148:151], v[124:127], v[156:159]
 v_mfma_f32_16x16x32_bf16 v[156:159], a[152:155], v[108:111], v[156:159]
 v_mfma_f32_16x16x32_bf16 v[156:159], a[156:159], v[140:143], v[156:159]
 s_nop 7
 v_cmp_le_i32 vcc, 0, v160
 v_cmp_le_i32 s[98:99], 1, v160
 v_cmp_le_i32 s[100:101], 2, v160
 v_cndmask_b32 v144, v250, v144, vcc
 v_cmp_le_i32 vcc, 3, v160
 v_cndmask_b32 v145, v250, v145, s[98:99]
 v_cndmask_b32 v146, v250, v146, s[100:101]
 v_cndmask_b32 v147, v250, v147, vcc
 v_max3_f32 v196, v196, v144, v145
 v_max3_f32 v196, v196, v146, v147
 v_subrev_u32 v160, 16, v160
 v_cmp_le_i32 vcc, 0, v161
 v_cmp_le_i32 s[98:99], 1, v161
 v_cmp_le_i32 s[100:101], 2, v161
 v_cndmask_b32 v148, v250, v148, vcc
 v_cmp_le_i32 vcc, 3, v161
 v_cndmask_b32 v149, v250, v149, s[98:99]
 v_cndmask_b32 v150, v250, v150, s[100:101]
 v_cndmask_b32 v151, v250, v151, vcc
 v_max3_f32 v197, v197, v148, v149
 v_max3_f32 v197, v197, v150, v151
 v_subrev_u32 v161, 16, v161
 v_cmp_le_i32 vcc, 0, v162
 v_cmp_le_i32 s[98:99], 1, v162
 v_cmp_le_i32 s[100:101], 2, v162
 v_cndmask_b32 v152, v250, v152, vcc
 v_cmp_le_i32 vcc, 3, v162
 v_cndmask_b32 v153, v250, v153, s[98:99]
 v_cndmask_b32 v154, v250, v154, s[100:101]
 v_cndmask_b32 v155, v250, v155, vcc
 v_max3_f32 v198, v198, v152, v153
 v_max3_f32 v198, v198, v154, v155
 v_subrev_u32 v162, 16, v162
 v_cmp_le_i32 vcc, 0, v163
 v_cmp_le_i32 s[98:99], 1, v163
 v_cmp_le_i32 s[100:101], 2, v163
 v_cndmask_b32 v156, v250, v156, vcc
 v_cmp_le_i32 vcc, 3, v163
 v_cndmask_b32 v157, v250, v157, s[98:99]
 v_cndmask_b32 v158, v250, v158, s[100:101]
 v_cndmask_b32 v159, v250, v159, vcc
 v_max3_f32 v199, v199, v156, v157
 v_max3_f32 v199, v199, v158, v159
 v_subrev_u32 v163, 16, v163
 s_add_u32 s94, s94, 1
 s_cmp_lt_u32 s94, s87
 s_cbranch_scc1 L_fb_loop
 v_mov_b32 v200, v196
 v_mov_b32 v201, v197
 v_mov_b32 v202, v198
 v_mov_b32 v203, v199
 v_permlane16_swap_b32 v196, v200
 v_permlane16_swap_b32 v197, v201
 v_permlane16_swap_b32 v198, v202
 v_permlane16_swap_b32 v199, v203
 v_max_f32 v196, v196, v200
 v_max_f32 v197, v197, v201
 v_max_f32 v198, v198, v202
 v_max_f32 v199, v199, v203
 v_mov_b32 v200, v196
 v_mov_b32 v201, v197
 v_mov_b32 v202, v198
 v_mov_b32 v203, v199
 v_permlane32_swap_b32 v196, v200
 v_permlane32_swap_b32 v197, v201
 v_permlane32_swap_b32 v198, v202
 v_permlane32_swap_b32 v199, v203
 v_max_f32 v196, v196, v200
 v_max_f32 v197, v197, v201
 v_max_f32 v198, v198, v202
 v_max_f32 v199, v199, v203
 v_add_u32 v4, 65536, v1
 v_add_u32 v5, 98304, v1
 v_mov_b32 v6, v1
 v_add_u32 v7, 32768, v1
 s_lshl_b32 s92, s60, 12
 s_add_u32 s93, s92, 32768
 s_mov_b32 s90, s92
 s_mov_b32 s91, s92
 s_mov_b64 s[88:89], 0
 s_add_u32 m0, s92, 65536
 s_nop 0
 buffer_load_dwordx4 v1, s[36:39], s90 offen offset:0 sc1 lds
 buffer_load_dwordx4 v1, s[36:39], s90 offen offset:1024 sc1 lds
 buffer_load_dwordx4 v1, s[36:39], s90 offen offset:2048 sc1 lds
 buffer_load_dwordx4 v1, s[36:39], s90 offen offset:3072 sc1 lds
 s_add_u32 s90, s90, 17408
 s_add_u32 m0, s92, 81920
 s_nop 0
 buffer_load_dwordx4 v1, s[36:39], s90 offen offset:0 sc1 lds
 buffer_load_dwordx4 v1, s[36:39], s90 offen offset:1024 sc1 lds
 buffer_load_dwordx4 v1, s[36:39], s90 offen offset:2048 sc1 lds
 buffer_load_dwordx4 v1, s[36:39], s90 offen offset:3072 sc1 lds
 s_add_u32 s90, s90, 17408
 s_add_u32 m0, s93, 65536
 s_nop 0
 buffer_load_dwordx4 v1, s[36:39], s90 offen offset:0 sc1 lds
 buffer_load_dwordx4 v1, s[36:39], s90 offen offset:1024 sc1 lds
 buffer_load_dwordx4 v1, s[36:39], s90 offen offset:2048 sc1 lds
 buffer_load_dwordx4 v1, s[36:39], s90 offen offset:3072 sc1 lds
 s_add_u32 s90, s90, 17408
 s_add_u32 m0, s92, 0
 s_nop 0
 buffer_load_dwordx4 v1, s[56:59], s91 offen offset:0 sc1 lds
 buffer_load_dwordx4 v1, s[56:59], s91 offen offset:1024 sc1 lds
 buffer_load_dwordx4 v1, s[56:59], s91 offen offset:2048 sc1 lds
 buffer_load_dwordx4 v1, s[56:59], s91 offen offset:3072 sc1 lds
 s_add_u32 s91, s91, 17408
 s_add_u32 m0, s92, 16384
 s_nop 0
 buffer_load_dwordx4 v1, s[56:59], s91 offen offset:0 sc1 lds
 buffer_load_dwordx4 v1, s[56:59], s91 offen offset:1024 sc1 lds
 buffer_load_dwordx4 v1, s[56:59], s91 offen offset:2048 sc1 lds
 buffer_load_dwordx4 v1, s[56:59], s91 offen offset:3072 sc1 lds
 s_add_u32 s91, s91, 17408
 v_mfma_f32_32x32x16_bf16 a[0:15], v[208:211], v[208:211], 0
 v_mfma_f32_32x32x16_bf16 a[16:31], v[208:211], v[208:211], 0
 v_mfma_f32_32x32x16_bf16 a[32:47], v[208:211], v[208:211], 0
 v_mfma_f32_32x32x16_bf16 a[48:63], v[208:211], v[208:211], 0
 v_mfma_f32_32x32x16_bf16 a[64:79], v[208:211], v[208:211], 0
 v_mfma_f32_32x32x16_bf16 a[80:95], v[208:211], v[208:211], 0
 v_mfma_f32_32x32x16_bf16 a[96:111], v[208:211], v[208:211], 0
 v_mfma_f32_32x32x16_bf16 a[112:127], v[208:211], v[208:211], 0
 v_mfma_f32_32x32x16_bf16 a[128:143], v[208:211], v[208:211], 0
 s_waitcnt vmcnt(0)
 s_barrier
 ds_read_b128 a[144:147], v4 offset:0
 ds_read_b128 a[148:151], v4 offset:1024
 ds_read_b128 a[152:155], v4 offset:2048
 ds_read_b128 a[156:159], v4 offset:3072
 ds_read_b128 a[160:163], v4 offset:4096
 ds_read_b128 a[164:167], v4 offset:5120
 s_waitcnt lgkmcnt(0)
 s_branch L_att_go
L_spin_c:
 s_mov_b32 s87, 0
L_spin2_c:
 s_load_dwordx8 s[88:95], s[70:71], 0x0 glc
 s_add_u32 s87, s87, 1
 s_cmp_gt_u32 s87, 400000
 s_waitcnt lgkmcnt(0)
 s_cbranch_scc1 L_back_c
 s_and_b64 s[88:89], s[88:89], s[90:91]
 s_and_b64 s[92:93], s[92:93], s[94:95]
 s_and_b64 s[88:89], s[88:89], s[92:93]
 s_and_b32 s88, s88, s89
 s_cmp_eq_u32 s88, 0
 s_cbranch_scc0 L_back_c
 s_sleep 2
 s_branch L_spin2_c
L_xspin:
 s_add_u32 s94, s94, 1
 s_cmp_gt_u32 s94, 200000
 s_cbranch_scc1 L_xok
 s_sleep 3
 buffer_load_dwordx4 v[80:83], v1, s[40:43], s77 offen offset:0 sc1
 buffer_load_dwordx4 v[84:87], v1, s[40:43], s77 offen offset:1024 sc1
 buffer_load_dwordx4 v[88:91], v1, s[40:43], s77 offen offset:2048 sc1
 buffer_load_dwordx4 v[92:95], v1, s[40:43], s77 offen offset:3072 sc1
 buffer_load_dwordx4 v[96:99], v1, s[40:43], s85 offen offset:0 sc1
 buffer_load_dwordx4 v[100:103], v1, s[40:43], s85 offen offset:1024 sc1
 s_branch L_xchk
L_code_end:
 s_endpgm
.section .rodata,"a"
.p2align 6
.amdhsa_kernel parallel_sum__compressed_kv_cla__dense_activation_mish__prompt_kernel
  .amdhsa_next_free_vgpr 512
  .amdhsa_next_free_sgpr 102
  .amdhsa_accum_offset 256
  .amdhsa_group_segment_fixed_size 0
  .amdhsa_kernarg_size 104
  .amdhsa_user_sgpr_count 2
  .amdhsa_user_sgpr_kernarg_segment_ptr 1
  .amdhsa_system_sgpr_workgroup_id_x 1
.end_amdhsa_kernel
```
